```python
import torch

def _softmax(x, axis=-1):
    return torch.softmax(x, dim=axis)
def _gelu(x):
    return torch.nn.functional.gelu(x, approximate="tanh")
def _silu(x):
    return torch.nn.functional.silu(x)
def _sigmoid(x):
    return torch.sigmoid(x)
def _layernorm(x, axis=-1, eps=1e-5):
    m = x.mean(dim=axis, keepdim=True)
    v = x.var(dim=axis, keepdim=True, unbiased=False)
    return (x - m) / torch.sqrt(v + eps)
def _scatter_add(tgt, idx, src, axis=0):
    return tgt.clone().index_add_(axis, idx, src)
def _segment_sum(src, seg, n):
    out = torch.zeros((n,) + src.shape[1:], dtype=src.dtype)
    return out.index_add_(0, seg, src)
def _pad(x, pw):
    flat = tuple(v for pair in reversed(pw) for v in pair)
    return torch.nn.functional.pad(x, flat)

kernel_name = 'sequential_preLN__mha_block__geglu_ffn__prompt'

def setup_inputs():

    _w = (lambda a: (lambda t: t.to(torch.bfloat16) if t.is_floating_point() else t)(torch.as_tensor(a)))
    def _A_setup():
        B, S, D, H = 1, 2048, 576, 32
        return {
            "x": _w((lambda *s: torch.randn(*s, dtype=torch.bfloat16) * 0.05)(B, S, D)),
            "wqkv": _w((lambda *s: torch.randn(*s, dtype=torch.bfloat16) * 0.05)(D, 3 * D)),
            "wo": _w((lambda *s: torch.randn(*s, dtype=torch.bfloat16) * 0.05)(D, D)),
        }
    _A_in = _A_setup()

    def _B_setup():
        B, S, D, F = 1, 2048, 576, 4608
        return {
            "x": _w((lambda *s: torch.randn(*s, dtype=torch.bfloat16) * 0.05)(B, S, D)),
            "w_gate": _w((lambda *s: torch.randn(*s, dtype=torch.bfloat16) * 0.05)(D, F)),
            "w_up": _w((lambda *s: torch.randn(*s, dtype=torch.bfloat16) * 0.05)(D, F)),
            "w_down": _w((lambda *s: torch.randn(*s, dtype=torch.bfloat16) * 0.05)(F, D)),
        }
    _B_in = _B_setup()

    return {
        "A_x": _A_in["x"],
        "A_wqkv": _A_in["wqkv"],
        "A_wo": _A_in["wo"],
        "B_x": _B_in["x"],
        "B_w_gate": _B_in["w_gate"],
        "B_w_up": _B_in["w_up"],
        "B_w_down": _B_in["w_down"],
    }

def reference(A_x, A_wqkv, A_wo, B_x, B_w_gate, B_w_up, B_w_down):
    def _A_ref(x, wqkv, wo):
        B, S, D = x.shape
        H = 32
        Dh = D // H
        qkv = (lambda x, *d: x.permute(*d))((x @ wqkv).reshape(B, S, 3, H, Dh), 2, 0, 3, 1, 4)
        q, k, v = qkv[0], qkv[1], qkv[2]
        scores = torch.einsum("bhqd,bhkd->bhqk", q, k) * (Dh ** -0.5)
        p = _softmax(scores, axis=-1)
        o = torch.einsum("bhqk,bhkd->bhqd", p, v)
        return (lambda x, *d: x.permute(*d))(o, 0, 2, 1, 3).reshape(B, S, D) @ wo

    def _B_ref(x, w_gate, w_up, w_down):
        return (_gelu(x @ w_gate) * (x @ w_up)) @ w_down

    x = A_x
    h = x + _A_ref(_layernorm(x, axis=-1), A_wqkv, A_wo)
    h2 = h + _B_ref(_layernorm(h, axis=-1), B_w_gate, B_w_up, B_w_down)
    return h2
```

```asm
; @launch kernel=k234_mid_kernel grid=(256,1,1) block=(512,1,1) lds=163840
.amdgcn_target "amdgcn-amd-amdhsa--gfx950"
.text
.globl k234_mid_kernel
.type k234_mid_kernel,@function
.p2align 8
k234_mid_kernel:
    s_cmp_ge_u32 s2, 256
    s_cbranch_scc1 k234_mid_kernel_end
    s_load_dwordx2 s[48:49], s[0:1], 64
    s_lshl_b32 s50, s2, 7
    s_add_u32 s50, s50, 8298496
    s_load_dwordx4 s[4:7], s[0:1], 0
    s_load_dwordx2 s[28:29], s[0:1], 16
    s_load_dwordx2 s[30:31], s[0:1], 72
    v_lshrrev_b32 v16, 6, v0
    v_and_b32 v1, 63, v0
    v_readfirstlane_b32 s20, v16
    v_and_b32 v2, 15, v0
    v_bfe_u32 v3, v0, 4, 2
    s_mov_b32 s24, 0x3f803f80
    s_cmp_ge_u32 s2, 192
    s_cbranch_scc1 k234_mid_kernel_a_aux
    s_cmp_lg_u32 s20, 7
    s_cbranch_scc1 k234_mid_kernel_a_cpf
    s_getpc_b64 s[44:45]
k234_mid_kernel_a_pc:
    s_lshr_b32 s46, s2, 3
    s_and_b32 s46, s46, 7
    s_lshl_b32 s46, s46, 13
    v_and_b32 v16, 63, v0
    v_lshlrev_b32 v16, 7, v16
    v_add_u32 v16, s46, v16
    v_min_u32 v16, k234_mid_kernel_a_end-k234_mid_kernel_a_pc, v16
    global_load_dword v170, v16, s[44:45]
k234_mid_kernel_a_cpf:
    s_and_b32 s25, s2, 7
    s_lshr_b32 s26, s2, 3
    s_lshr_b32 s21, s25, 1
    s_lshl_b32 s21, s21, 2
    s_and_b32 s42, s26, 3
    s_add_u32 s21, s21, s42
    s_and_b32 s22, s25, 1
    s_mul_i32 s22, s22, 6
    s_lshr_b32 s43, s26, 2
    s_add_u32 s22, s22, s43
    s_lshl_b32 s50, s22, 4
    s_add_u32 s50, s50, s21
    s_lshl_b32 s50, s50, 7
    s_add_u32 s50, s50, 8298496
    s_and_b32 s36, s20, 3
    s_lshr_b32 s37, s20, 2
    s_lshl_b32 s23, s21, 2
    s_add_u32 s23, s23, s36
    s_mul_i32 s38, s22, 288
    s_lshl_b32 s25, s21, 4
    s_add_u32 s25, s25, s20
    s_mul_i32 s39, s25, 9216
    s_add_u32 s40, s39, 73728
    s_lshl_b32 s41, s20, 10
    v_lshrrev_b32 v16, 3, v1
    v_and_b32 v17, 7, v1
    v_xor_b32 v17, v17, v16
    v_mul_u32_u24 v16, 1152, v16
    v_lshl_add_u32 v7, v17, 4, v16
    v_add_u32 v16, 0, v0
    v_mul_u32_u24 v17, 3641, v16
    v_lshrrev_b32 v17, 16, v17
    v_mul_u32_u24 v18, 18, v17
    v_sub_u32 v18, v16, v18
    v_and_b32 v16, 0x63, v17
    v_bfe_u32 v19, v17, 2, 2
    v_lshl_or_b32 v16, v19, 3, v16
    v_bfe_u32 v19, v17, 4, 1
    v_lshl_or_b32 v16, v19, 2, v16
    v_mul_u32_u24 v16, 3456, v16
    v_lshl_add_u32 v4, v18, 4, v16
    v_add_u32 v16, 512, v0
    v_mul_u32_u24 v17, 3641, v16
    v_lshrrev_b32 v17, 16, v17
    v_mul_u32_u24 v18, 18, v17
    v_sub_u32 v18, v16, v18
    v_and_b32 v16, 0x63, v17
    v_bfe_u32 v19, v17, 2, 2
    v_lshl_or_b32 v16, v19, 3, v16
    v_bfe_u32 v19, v17, 4, 1
    v_lshl_or_b32 v16, v19, 2, v16
    v_mul_u32_u24 v16, 3456, v16
    v_lshl_add_u32 v5, v18, 4, v16
    v_add_u32 v16, 1024, v0
    v_mul_u32_u24 v17, 3641, v16
    v_lshrrev_b32 v17, 16, v17
    v_mul_u32_u24 v18, 18, v17
    v_sub_u32 v18, v16, v18
    v_and_b32 v16, 0x63, v17
    v_bfe_u32 v19, v17, 2, 2
    v_lshl_or_b32 v16, v19, 3, v16
    v_bfe_u32 v19, v17, 4, 1
    v_lshl_or_b32 v16, v19, 2, v16
    v_mul_u32_u24 v16, 3456, v16
    v_lshl_add_u32 v6, v18, 4, v16
    v_mul_u32_u24 v17, 21846, v1
    v_lshrrev_b32 v17, 16, v17
    v_mul_u32_u24 v18, 3, v17
    v_sub_u32 v18, v1, v18
    v_min_u32 v17, 15, v17
    v_mul_u32_u24 v16, 3456, v17
    v_lshl_add_u32 v168, v18, 7, v16
    s_and_b32 s25, s43, 3
    s_lshl_b32 s25, s25, 5
    s_lshl_b32 s26, s21, 7
    s_add_u32 s25, s25, s26
    v_and_b32 v16, 31, v1
    v_add_u32 v16, s25, v16
    v_mul_u32_u24 v16, 1152, v16
    v_lshrrev_b32 v17, 5, v1
    v_lshl_add_u32 v172, v17, 7, v16
    s_mul_i32 s44, s42, 55296
    s_add_u32 s44, s44, s38
    s_cmp_ge_u32 s20, 3
    s_cselect_b32 s45, 1, 0
    s_mul_i32 s46, s45, 3
    s_sub_u32 s46, s20, s46
    s_lshl_b32 s25, s45, 1
    s_add_u32 s25, s25, s46
    s_mul_i32 s25, s25, 221184
    s_add_u32 s25, s25, s44
    s_lshl_b32 s45, s45, 8
    s_waitcnt lgkmcnt(0)
    s_mov_b32 s8, s4
    s_mov_b32 s9, s5
    s_mov_b32 s10, 2359296
    s_mov_b32 s11, 0x00020000
    s_mov_b32 s12, s6
    s_mov_b32 s13, s7
    s_mov_b32 s14, 1990656
    s_mov_b32 s15, 0x00020000
    s_mov_b32 s16, s30
    s_mov_b32 s17, s31
    s_mov_b32 s18, 67108864
    s_mov_b32 s19, 0x00020000
    s_cmp_ge_u32 s20, 3
    s_cbranch_scc1 k234_mid_kernel_a_te0
    s_cmp_eq_u32 s46, 2
    s_cbranch_scc1 k234_mid_kernel_a_tx0
    buffer_load_dword v169, v168, s[12:15], s25 offen
    s_branch k234_mid_kernel_a_te0
k234_mid_kernel_a_tx0:
    s_cmp_ge_u32 s43, 4
    s_cbranch_scc1 k234_mid_kernel_a_te0
    buffer_load_dword v169, v172, s[8:11], s45 offen
k234_mid_kernel_a_te0:
    s_add_u32 m0, s41, 0
    s_nop 0
    buffer_load_dwordx4 v4, s[12:15], s38 offen lds
    s_add_u32 m0, s41, 18432
    s_nop 0
    buffer_load_dwordx4 v7, s[8:11], s39 offen lds
    s_add_u32 s39, s39, 128
    s_add_u32 m0, s41, 8192
    s_nop 0
    buffer_load_dwordx4 v5, s[12:15], s38 offen lds
    s_add_u32 m0, s41, 26624
    s_nop 0
    buffer_load_dwordx4 v7, s[8:11], s40 offen lds
    s_add_u32 s40, s40, 128
    s_cmp_ge_u32 s20, 2
    s_cbranch_scc1 k234_mid_kernel_a_sk1
    s_add_u32 m0, s41, 16384
    s_nop 0
    buffer_load_dwordx4 v6, s[12:15], s38 offen lds
k234_mid_kernel_a_sk1:
    s_add_u32 s38, s38, 221184
    buffer_load_dword v171, v1, s[16:19], 0 offen
    s_add_u32 m0, s41, 34816
    s_nop 0
    buffer_load_dwordx4 v4, s[12:15], s38 offen lds
    s_add_u32 m0, s41, 53248
    s_nop 0
    buffer_load_dwordx4 v7, s[8:11], s39 offen lds
    s_add_u32 s39, s39, 128
    s_add_u32 m0, s41, 43008
    s_nop 0
    buffer_load_dwordx4 v5, s[12:15], s38 offen lds
    s_add_u32 m0, s41, 61440
    s_nop 0
    buffer_load_dwordx4 v7, s[8:11], s40 offen lds
    s_add_u32 s40, s40, 128
    s_cmp_ge_u32 s20, 2
    s_cbranch_scc1 k234_mid_kernel_a_sk2
    s_add_u32 m0, s41, 51200
    s_nop 0
    buffer_load_dwordx4 v6, s[12:15], s38 offen lds
k234_mid_kernel_a_sk2:
    s_add_u32 s38, s38, 221184
    v_mov_b32 v124, 0
    v_mov_b32 v125, 0
    v_mov_b32 v126, 0
    v_mov_b32 v127, 0
    v_mov_b32 v128, 0
    v_mov_b32 v129, 0
    v_mov_b32 v130, 0
    v_mov_b32 v131, 0
    v_mov_b32 v132, 0
    v_mov_b32 v133, 0
    v_mov_b32 v134, 0
    v_mov_b32 v135, 0
    v_mov_b32 v136, 0
    v_mov_b32 v137, 0
    v_mov_b32 v138, 0
    v_mov_b32 v139, 0
    v_mov_b32 v140, 0
    v_mov_b32 v141, 0
    v_mov_b32 v142, 0
    v_mov_b32 v143, 0
    v_mov_b32 v144, s24
    v_mov_b32 v20, 0
    v_mov_b32 v24, 0
    v_mov_b32 v145, s24
    v_mov_b32 v21, 0
    v_mov_b32 v25, 0
    v_mov_b32 v146, s24
    v_mov_b32 v22, 0
    v_mov_b32 v26, 0
    v_mov_b32 v147, s24
    v_mov_b32 v23, 0
    v_mov_b32 v27, 0
    s_lshl_b32 s25, s36, 12
    v_lshlrev_b32 v16, 7, v2
    v_add_u32 v16, s25, v16
    v_and_b32 v17, 7, v2
    v_xor_b32 v17, v17, v3
    v_lshl_add_u32 v12, v17, 4, v16
    v_add_u32 v13, 69632, v12
    v_xor_b32 v14, 64, v12
    v_add_u32 v15, 69632, v14
    v_lshrrev_b32 v16, 2, v1
    v_mul_u32_u24 v16, 288, v16
    v_and_b32 v17, 3, v1
    v_mul_u32_u24 v18, 72, v17
    v_add3_u32 v10, v18, v16, 32
    v_add_u32 v11, 69632, v10
    v_lshrrev_b32 v18, 1, v17
    v_lshl_add_u32 v18, v17, 1, v18
    s_cmp_ge_u32 s22, 8
    s_cselect_b64 vcc, -1, 0
    v_cndmask_b32 v18, v18, v17, vcc
    v_lshl_add_u32 v8, v18, 3, v16
    v_add_u32 v9, 69632, v8
    s_waitcnt vmcnt(5)
    s_barrier
    s_cmp_ge_u32 s22, 8
    s_cbranch_scc1 k234_mid_kernel_a_v
    s_cmp_lg_u32 s37, 0
    s_cbranch_scc1 k234_mid_kernel_a_qk1
    ds_read_b128 v[108:111], v12 offset:18432
    ds_read_b128 v[112:115], v12 offset:20480
    ds_read_b64_tr_b16 v[68:69], v8 offset:0
    ds_read_b64_tr_b16 v[70:71], v8 offset:4608
    ds_read_b64_tr_b16 v[72:73], v8 offset:8
    ds_read_b64_tr_b16 v[74:75], v8 offset:4616
    ds_read_b64_tr_b16 v[76:77], v8 offset:72
    ds_read_b64_tr_b16 v[78:79], v8 offset:4680
    ds_read_b64_tr_b16 v[80:81], v8 offset:80
    ds_read_b64_tr_b16 v[82:83], v8 offset:4688
    ds_read_b64_tr_b16 v[84:85], v10 offset:0
    ds_read_b64_tr_b16 v[86:87], v10 offset:4608
    s_waitcnt lgkmcnt(8)
    v_mfma_f32_16x16x32_bf16 v[28:31], v[68:71], v[108:111], 0
    ds_read_b128 v[116:119], v14 offset:18432
    ds_read_b128 v[120:123], v14 offset:20480
    s_add_u32 m0, s41, 69632
    s_nop 0
    buffer_load_dwordx4 v4, s[12:15], s38 offen lds
    v_mfma_f32_16x16x32_bf16 v[32:35], v[68:71], v[112:115], 0
    ds_read_b64_tr_b16 v[88:89], v8 offset:9216
    ds_read_b64_tr_b16 v[90:91], v8 offset:13824
    s_add_u32 m0, s41, 88064
    s_nop 0
    buffer_load_dwordx4 v7, s[8:11], s39 offen lds
    s_add_u32 s39, s39, 128
    s_waitcnt lgkmcnt(10)
    v_mfma_f32_16x16x32_bf16 v[36:39], v[72:75], v[108:111], 0
    ds_read_b64_tr_b16 v[92:93], v8 offset:9224
    ds_read_b64_tr_b16 v[94:95], v8 offset:13832
    s_add_u32 m0, s41, 77824
    s_nop 0
    buffer_load_dwordx4 v5, s[12:15], s38 offen lds
    v_mfma_f32_16x16x32_bf16 v[40:43], v[72:75], v[112:115], 0
    ds_read_b64_tr_b16 v[96:97], v8 offset:9288
    ds_read_b64_tr_b16 v[98:99], v8 offset:13896
    v_mfma_f32_16x16x32_bf16 v[20:23], v[144:147], v[108:111], v[20:23]
    s_waitcnt lgkmcnt(12)
    v_mfma_f32_16x16x32_bf16 v[44:47], v[76:79], v[108:111], 0
    ds_read_b64_tr_b16 v[100:101], v8 offset:9296
    ds_read_b64_tr_b16 v[102:103], v8 offset:13904
    s_add_u32 m0, s41, 96256
    s_nop 0
    buffer_load_dwordx4 v7, s[8:11], s40 offen lds
    s_add_u32 s40, s40, 128
    v_mfma_f32_16x16x32_bf16 v[48:51], v[76:79], v[112:115], 0
    ds_read_b64_tr_b16 v[104:105], v10 offset:9216
    ds_read_b64_tr_b16 v[106:107], v10 offset:13824
    v_mfma_f32_16x16x32_bf16 v[24:27], v[108:111], v[108:111], v[24:27]
    s_waitcnt lgkmcnt(14)
    v_mfma_f32_16x16x32_bf16 v[52:55], v[80:83], v[108:111], 0
    s_cmp_ge_u32 s20, 2
    s_cbranch_scc1 k234_mid_kernel_a_qk0sk3
    s_add_u32 m0, s41, 86016
    s_nop 0
    buffer_load_dwordx4 v6, s[12:15], s38 offen lds
k234_mid_kernel_a_qk0sk3:
    s_add_u32 s38, s38, 221184
    v_mfma_f32_16x16x32_bf16 v[56:59], v[80:83], v[112:115], 0
    s_add_u32 m0, s41, 104448
    s_nop 0
    buffer_load_dwordx4 v4, s[12:15], s38 offen lds
    s_waitcnt lgkmcnt(12)
    v_mfma_f32_16x16x32_bf16 v[60:63], v[84:87], v[108:111], 0
    v_mfma_f32_16x16x32_bf16 v[64:67], v[84:87], v[112:115], 0
    s_cmp_lg_u32 s36, 0
    s_cbranch_scc1 k234_mid_kernel_a_qk0cs0
    v_mfma_f32_16x16x32_bf16 v[124:127], v[68:71], v[144:147], v[124:127]
    v_mfma_f32_16x16x32_bf16 v[128:131], v[72:75], v[144:147], v[128:131]
    v_mfma_f32_16x16x32_bf16 v[132:135], v[76:79], v[144:147], v[132:135]
    v_mfma_f32_16x16x32_bf16 v[136:139], v[80:83], v[144:147], v[136:139]
    v_mfma_f32_16x16x32_bf16 v[140:143], v[84:87], v[144:147], v[140:143]
k234_mid_kernel_a_qk0cs0:
    s_waitcnt vmcnt(5)
    s_barrier
    s_waitcnt lgkmcnt(8)
    v_mfma_f32_16x16x32_bf16 v[28:31], v[88:91], v[116:119], v[28:31]
    ds_read_b128 v[108:111], v12 offset:53248
    ds_read_b128 v[112:115], v12 offset:55296
    v_mfma_f32_16x16x32_bf16 v[32:35], v[88:91], v[120:123], v[32:35]
    ds_read_b64_tr_b16 v[68:69], v8 offset:34816
    ds_read_b64_tr_b16 v[70:71], v8 offset:39424
    s_add_u32 m0, s41, 122880
    s_nop 0
    buffer_load_dwordx4 v7, s[8:11], s39 offen lds
    s_add_u32 s39, s39, 128
    s_waitcnt lgkmcnt(10)
    v_mfma_f32_16x16x32_bf16 v[36:39], v[92:95], v[116:119], v[36:39]
    ds_read_b64_tr_b16 v[72:73], v8 offset:34824
    ds_read_b64_tr_b16 v[74:75], v8 offset:39432
    v_mfma_f32_16x16x32_bf16 v[40:43], v[92:95], v[120:123], v[40:43]
    ds_read_b64_tr_b16 v[76:77], v8 offset:34888
    ds_read_b64_tr_b16 v[78:79], v8 offset:39496
    v_mfma_f32_16x16x32_bf16 v[20:23], v[144:147], v[116:119], v[20:23]
    s_waitcnt lgkmcnt(12)
    v_mfma_f32_16x16x32_bf16 v[44:47], v[96:99], v[116:119], v[44:47]
    ds_read_b64_tr_b16 v[80:81], v8 offset:34896
    ds_read_b64_tr_b16 v[82:83], v8 offset:39504
    s_add_u32 m0, s41, 112640
    s_nop 0
    buffer_load_dwordx4 v5, s[12:15], s38 offen lds
    v_mfma_f32_16x16x32_bf16 v[48:51], v[96:99], v[120:123], v[48:51]
    ds_read_b64_tr_b16 v[84:85], v10 offset:34816
    ds_read_b64_tr_b16 v[86:87], v10 offset:39424
    v_mfma_f32_16x16x32_bf16 v[24:27], v[116:119], v[116:119], v[24:27]
    s_waitcnt lgkmcnt(14)
    v_mfma_f32_16x16x32_bf16 v[52:55], v[100:103], v[116:119], v[52:55]
    v_mfma_f32_16x16x32_bf16 v[56:59], v[100:103], v[120:123], v[56:59]
    s_add_u32 m0, s41, 131072
    s_nop 0
    buffer_load_dwordx4 v7, s[8:11], s40 offen lds
    s_add_u32 s40, s40, 128
    s_waitcnt lgkmcnt(12)
    v_mfma_f32_16x16x32_bf16 v[60:63], v[104:107], v[116:119], v[60:63]
    v_mfma_f32_16x16x32_bf16 v[64:67], v[104:107], v[120:123], v[64:67]
    s_cmp_lg_u32 s36, 1
    s_cbranch_scc1 k234_mid_kernel_a_qk0cs1
    v_mfma_f32_16x16x32_bf16 v[124:127], v[88:91], v[144:147], v[124:127]
    v_mfma_f32_16x16x32_bf16 v[128:131], v[92:95], v[144:147], v[128:131]
    v_mfma_f32_16x16x32_bf16 v[132:135], v[96:99], v[144:147], v[132:135]
    v_mfma_f32_16x16x32_bf16 v[136:139], v[100:103], v[144:147], v[136:139]
    v_mfma_f32_16x16x32_bf16 v[140:143], v[104:107], v[144:147], v[140:143]
k234_mid_kernel_a_qk0cs1:
    s_waitcnt lgkmcnt(8)
    v_mfma_f32_16x16x32_bf16 v[28:31], v[68:71], v[108:111], v[28:31]
    ds_read_b128 v[116:119], v14 offset:53248
    ds_read_b128 v[120:123], v14 offset:55296
    v_mfma_f32_16x16x32_bf16 v[32:35], v[68:71], v[112:115], v[32:35]
    ds_read_b64_tr_b16 v[88:89], v8 offset:44032
    ds_read_b64_tr_b16 v[90:91], v8 offset:48640
    s_cmp_ge_u32 s20, 2
    s_cbranch_scc1 k234_mid_kernel_a_qk0sk4
    s_add_u32 m0, s41, 120832
    s_nop 0
    buffer_load_dwordx4 v6, s[12:15], s38 offen lds
k234_mid_kernel_a_qk0sk4:
    s_add_u32 s38, s38, 221184
    s_waitcnt lgkmcnt(10)
    v_mfma_f32_16x16x32_bf16 v[36:39], v[72:75], v[108:111], v[36:39]
    ds_read_b64_tr_b16 v[92:93], v8 offset:44040
    ds_read_b64_tr_b16 v[94:95], v8 offset:48648
    v_mfma_f32_16x16x32_bf16 v[40:43], v[72:75], v[112:115], v[40:43]
    ds_read_b64_tr_b16 v[96:97], v8 offset:44104
    ds_read_b64_tr_b16 v[98:99], v8 offset:48712
    v_mfma_f32_16x16x32_bf16 v[20:23], v[144:147], v[108:111], v[20:23]
    s_waitcnt lgkmcnt(12)
    v_mfma_f32_16x16x32_bf16 v[44:47], v[76:79], v[108:111], v[44:47]
    ds_read_b64_tr_b16 v[100:101], v8 offset:44112
    ds_read_b64_tr_b16 v[102:103], v8 offset:48720
    v_mfma_f32_16x16x32_bf16 v[48:51], v[76:79], v[112:115], v[48:51]
    ds_read_b64_tr_b16 v[104:105], v10 offset:44032
    ds_read_b64_tr_b16 v[106:107], v10 offset:48640
    v_mfma_f32_16x16x32_bf16 v[24:27], v[108:111], v[108:111], v[24:27]
    s_waitcnt lgkmcnt(14)
    v_mfma_f32_16x16x32_bf16 v[52:55], v[80:83], v[108:111], v[52:55]
    v_mfma_f32_16x16x32_bf16 v[56:59], v[80:83], v[112:115], v[56:59]
    s_waitcnt lgkmcnt(12)
    v_mfma_f32_16x16x32_bf16 v[60:63], v[84:87], v[108:111], v[60:63]
    v_mfma_f32_16x16x32_bf16 v[64:67], v[84:87], v[112:115], v[64:67]
    s_cmp_lg_u32 s36, 2
    s_cbranch_scc1 k234_mid_kernel_a_qk0cs2
    v_mfma_f32_16x16x32_bf16 v[124:127], v[68:71], v[144:147], v[124:127]
    v_mfma_f32_16x16x32_bf16 v[128:131], v[72:75], v[144:147], v[128:131]
    v_mfma_f32_16x16x32_bf16 v[132:135], v[76:79], v[144:147], v[132:135]
    v_mfma_f32_16x16x32_bf16 v[136:139], v[80:83], v[144:147], v[136:139]
    v_mfma_f32_16x16x32_bf16 v[140:143], v[84:87], v[144:147], v[140:143]
k234_mid_kernel_a_qk0cs2:
    s_waitcnt vmcnt(4)
    s_barrier
    s_waitcnt lgkmcnt(8)
    v_mfma_f32_16x16x32_bf16 v[28:31], v[88:91], v[116:119], v[28:31]
    ds_read_b128 v[108:111], v13 offset:18432
    ds_read_b128 v[112:115], v13 offset:20480
    v_mfma_f32_16x16x32_bf16 v[32:35], v[88:91], v[120:123], v[32:35]
    ds_read_b64_tr_b16 v[68:69], v9 offset:0
    ds_read_b64_tr_b16 v[70:71], v9 offset:4608
    s_add_u32 m0, s41, 0
    s_nop 0
    buffer_load_dwordx4 v4, s[12:15], s38 offen lds
    s_waitcnt lgkmcnt(10)
    v_mfma_f32_16x16x32_bf16 v[36:39], v[92:95], v[116:119], v[36:39]
    ds_read_b64_tr_b16 v[72:73], v9 offset:8
    ds_read_b64_tr_b16 v[74:75], v9 offset:4616
    v_mfma_f32_16x16x32_bf16 v[40:43], v[92:95], v[120:123], v[40:43]
    ds_read_b64_tr_b16 v[76:77], v9 offset:72
    ds_read_b64_tr_b16 v[78:79], v9 offset:4680
    v_mfma_f32_16x16x32_bf16 v[20:23], v[144:147], v[116:119], v[20:23]
    s_waitcnt lgkmcnt(12)
    v_mfma_f32_16x16x32_bf16 v[44:47], v[96:99], v[116:119], v[44:47]
    ds_read_b64_tr_b16 v[80:81], v9 offset:80
    ds_read_b64_tr_b16 v[82:83], v9 offset:4688
    s_add_u32 m0, s41, 18432
    s_nop 0
    buffer_load_dwordx4 v7, s[8:11], s39 offen lds
    s_add_u32 s39, s39, 128
    v_mfma_f32_16x16x32_bf16 v[48:51], v[96:99], v[120:123], v[48:51]
    ds_read_b64_tr_b16 v[84:85], v11 offset:0
    ds_read_b64_tr_b16 v[86:87], v11 offset:4608
    v_mfma_f32_16x16x32_bf16 v[24:27], v[116:119], v[116:119], v[24:27]
    s_waitcnt lgkmcnt(14)
    v_mfma_f32_16x16x32_bf16 v[52:55], v[100:103], v[116:119], v[52:55]
    v_mfma_f32_16x16x32_bf16 v[56:59], v[100:103], v[120:123], v[56:59]
    s_add_u32 m0, s41, 8192
    s_nop 0
    buffer_load_dwordx4 v5, s[12:15], s38 offen lds
    s_waitcnt lgkmcnt(12)
    v_mfma_f32_16x16x32_bf16 v[60:63], v[104:107], v[116:119], v[60:63]
    v_mfma_f32_16x16x32_bf16 v[64:67], v[104:107], v[120:123], v[64:67]
    s_cmp_lg_u32 s36, 3
    s_cbranch_scc1 k234_mid_kernel_a_qk0cs3
    v_mfma_f32_16x16x32_bf16 v[124:127], v[88:91], v[144:147], v[124:127]
    v_mfma_f32_16x16x32_bf16 v[128:131], v[92:95], v[144:147], v[128:131]
    v_mfma_f32_16x16x32_bf16 v[132:135], v[96:99], v[144:147], v[132:135]
    v_mfma_f32_16x16x32_bf16 v[136:139], v[100:103], v[144:147], v[136:139]
    v_mfma_f32_16x16x32_bf16 v[140:143], v[104:107], v[144:147], v[140:143]
k234_mid_kernel_a_qk0cs3:
    s_waitcnt lgkmcnt(8)
    v_mfma_f32_16x16x32_bf16 v[28:31], v[68:71], v[108:111], v[28:31]
    ds_read_b128 v[116:119], v15 offset:18432
    ds_read_b128 v[120:123], v15 offset:20480
    v_mfma_f32_16x16x32_bf16 v[32:35], v[68:71], v[112:115], v[32:35]
    ds_read_b64_tr_b16 v[88:89], v9 offset:9216
    ds_read_b64_tr_b16 v[90:91], v9 offset:13824
    s_add_u32 m0, s41, 26624
    s_nop 0
    buffer_load_dwordx4 v7, s[8:11], s40 offen lds
    s_add_u32 s40, s40, 128
    s_waitcnt lgkmcnt(10)
    v_mfma_f32_16x16x32_bf16 v[36:39], v[72:75], v[108:111], v[36:39]
    ds_read_b64_tr_b16 v[92:93], v9 offset:9224
    ds_read_b64_tr_b16 v[94:95], v9 offset:13832
    v_mfma_f32_16x16x32_bf16 v[40:43], v[72:75], v[112:115], v[40:43]
    ds_read_b64_tr_b16 v[96:97], v9 offset:9288
    ds_read_b64_tr_b16 v[98:99], v9 offset:13896
    v_mfma_f32_16x16x32_bf16 v[20:23], v[144:147], v[108:111], v[20:23]
    s_waitcnt lgkmcnt(12)
    v_mfma_f32_16x16x32_bf16 v[44:47], v[76:79], v[108:111], v[44:47]
    ds_read_b64_tr_b16 v[100:101], v9 offset:9296
    ds_read_b64_tr_b16 v[102:103], v9 offset:13904
    s_cmp_ge_u32 s20, 2
    s_cbranch_scc1 k234_mid_kernel_a_qk0sk5
    s_add_u32 m0, s41, 16384
    s_nop 0
    buffer_load_dwordx4 v6, s[12:15], s38 offen lds
k234_mid_kernel_a_qk0sk5:
    s_add_u32 s38, s38, 221184
    v_mfma_f32_16x16x32_bf16 v[48:51], v[76:79], v[112:115], v[48:51]
    ds_read_b64_tr_b16 v[104:105], v11 offset:9216
    ds_read_b64_tr_b16 v[106:107], v11 offset:13824
    v_mfma_f32_16x16x32_bf16 v[24:27], v[108:111], v[108:111], v[24:27]
    s_waitcnt lgkmcnt(14)
    v_mfma_f32_16x16x32_bf16 v[52:55], v[80:83], v[108:111], v[52:55]
    v_mfma_f32_16x16x32_bf16 v[56:59], v[80:83], v[112:115], v[56:59]
    s_waitcnt lgkmcnt(12)
    v_mfma_f32_16x16x32_bf16 v[60:63], v[84:87], v[108:111], v[60:63]
    v_mfma_f32_16x16x32_bf16 v[64:67], v[84:87], v[112:115], v[64:67]
    s_cmp_lg_u32 s36, 0
    s_cbranch_scc1 k234_mid_kernel_a_qk0cs4
    v_mfma_f32_16x16x32_bf16 v[124:127], v[68:71], v[144:147], v[124:127]
    v_mfma_f32_16x16x32_bf16 v[128:131], v[72:75], v[144:147], v[128:131]
    v_mfma_f32_16x16x32_bf16 v[132:135], v[76:79], v[144:147], v[132:135]
    v_mfma_f32_16x16x32_bf16 v[136:139], v[80:83], v[144:147], v[136:139]
    v_mfma_f32_16x16x32_bf16 v[140:143], v[84:87], v[144:147], v[140:143]
k234_mid_kernel_a_qk0cs4:
    s_waitcnt vmcnt(4)
    s_barrier
    s_waitcnt lgkmcnt(8)
    v_mfma_f32_16x16x32_bf16 v[28:31], v[88:91], v[116:119], v[28:31]
    ds_read_b128 v[108:111], v13 offset:53248
    ds_read_b128 v[112:115], v13 offset:55296
    v_mfma_f32_16x16x32_bf16 v[32:35], v[88:91], v[120:123], v[32:35]
    ds_read_b64_tr_b16 v[68:69], v9 offset:34816
    ds_read_b64_tr_b16 v[70:71], v9 offset:39424
    s_add_u32 m0, s41, 34816
    s_nop 0
    buffer_load_dwordx4 v4, s[12:15], s38 offen lds
    s_waitcnt lgkmcnt(10)
    v_mfma_f32_16x16x32_bf16 v[36:39], v[92:95], v[116:119], v[36:39]
    ds_read_b64_tr_b16 v[72:73], v9 offset:34824
    ds_read_b64_tr_b16 v[74:75], v9 offset:39432
    v_mfma_f32_16x16x32_bf16 v[40:43], v[92:95], v[120:123], v[40:43]
    ds_read_b64_tr_b16 v[76:77], v9 offset:34888
    ds_read_b64_tr_b16 v[78:79], v9 offset:39496
    v_mfma_f32_16x16x32_bf16 v[20:23], v[144:147], v[116:119], v[20:23]
    s_waitcnt lgkmcnt(12)
    v_mfma_f32_16x16x32_bf16 v[44:47], v[96:99], v[116:119], v[44:47]
    ds_read_b64_tr_b16 v[80:81], v9 offset:34896
    ds_read_b64_tr_b16 v[82:83], v9 offset:39504
    s_add_u32 m0, s41, 53248
    s_nop 0
    buffer_load_dwordx4 v7, s[8:11], s39 offen lds
    s_add_u32 s39, s39, 128
    v_mfma_f32_16x16x32_bf16 v[48:51], v[96:99], v[120:123], v[48:51]
    ds_read_b64_tr_b16 v[84:85], v11 offset:34816
    ds_read_b64_tr_b16 v[86:87], v11 offset:39424
    v_mfma_f32_16x16x32_bf16 v[24:27], v[116:119], v[116:119], v[24:27]
    s_waitcnt lgkmcnt(14)
    v_mfma_f32_16x16x32_bf16 v[52:55], v[100:103], v[116:119], v[52:55]
    v_mfma_f32_16x16x32_bf16 v[56:59], v[100:103], v[120:123], v[56:59]
    s_add_u32 m0, s41, 43008
    s_nop 0
    buffer_load_dwordx4 v5, s[12:15], s38 offen lds
    s_waitcnt lgkmcnt(12)
    v_mfma_f32_16x16x32_bf16 v[60:63], v[104:107], v[116:119], v[60:63]
    v_mfma_f32_16x16x32_bf16 v[64:67], v[104:107], v[120:123], v[64:67]
    s_cmp_lg_u32 s36, 1
    s_cbranch_scc1 k234_mid_kernel_a_qk0cs5
    v_mfma_f32_16x16x32_bf16 v[124:127], v[88:91], v[144:147], v[124:127]
    v_mfma_f32_16x16x32_bf16 v[128:131], v[92:95], v[144:147], v[128:131]
    v_mfma_f32_16x16x32_bf16 v[132:135], v[96:99], v[144:147], v[132:135]
    v_mfma_f32_16x16x32_bf16 v[136:139], v[100:103], v[144:147], v[136:139]
    v_mfma_f32_16x16x32_bf16 v[140:143], v[104:107], v[144:147], v[140:143]
k234_mid_kernel_a_qk0cs5:
    s_waitcnt lgkmcnt(8)
    v_mfma_f32_16x16x32_bf16 v[28:31], v[68:71], v[108:111], v[28:31]
    ds_read_b128 v[116:119], v15 offset:53248
    ds_read_b128 v[120:123], v15 offset:55296
    v_mfma_f32_16x16x32_bf16 v[32:35], v[68:71], v[112:115], v[32:35]
    ds_read_b64_tr_b16 v[88:89], v9 offset:44032
    ds_read_b64_tr_b16 v[90:91], v9 offset:48640
    s_add_u32 m0, s41, 61440
    s_nop 0
    buffer_load_dwordx4 v7, s[8:11], s40 offen lds
    s_add_u32 s40, s40, 128
    s_waitcnt lgkmcnt(10)
    v_mfma_f32_16x16x32_bf16 v[36:39], v[72:75], v[108:111], v[36:39]
    ds_read_b64_tr_b16 v[92:93], v9 offset:44040
    ds_read_b64_tr_b16 v[94:95], v9 offset:48648
    v_mfma_f32_16x16x32_bf16 v[40:43], v[72:75], v[112:115], v[40:43]
    ds_read_b64_tr_b16 v[96:97], v9 offset:44104
    ds_read_b64_tr_b16 v[98:99], v9 offset:48712
    v_mfma_f32_16x16x32_bf16 v[20:23], v[144:147], v[108:111], v[20:23]
    s_waitcnt lgkmcnt(12)
    v_mfma_f32_16x16x32_bf16 v[44:47], v[76:79], v[108:111], v[44:47]
    ds_read_b64_tr_b16 v[100:101], v9 offset:44112
    ds_read_b64_tr_b16 v[102:103], v9 offset:48720
    s_cmp_ge_u32 s20, 2
    s_cbranch_scc1 k234_mid_kernel_a_qk0sk6
    s_add_u32 m0, s41, 51200
    s_nop 0
    buffer_load_dwordx4 v6, s[12:15], s38 offen lds
k234_mid_kernel_a_qk0sk6:
    s_add_u32 s38, s38, 221184
    v_mfma_f32_16x16x32_bf16 v[48:51], v[76:79], v[112:115], v[48:51]
    ds_read_b64_tr_b16 v[104:105], v11 offset:44032
    ds_read_b64_tr_b16 v[106:107], v11 offset:48640
    v_mfma_f32_16x16x32_bf16 v[24:27], v[108:111], v[108:111], v[24:27]
    s_waitcnt lgkmcnt(14)
    v_mfma_f32_16x16x32_bf16 v[52:55], v[80:83], v[108:111], v[52:55]
    v_mfma_f32_16x16x32_bf16 v[56:59], v[80:83], v[112:115], v[56:59]
    s_waitcnt lgkmcnt(12)
    v_mfma_f32_16x16x32_bf16 v[60:63], v[84:87], v[108:111], v[60:63]
    v_mfma_f32_16x16x32_bf16 v[64:67], v[84:87], v[112:115], v[64:67]
    s_cmp_lg_u32 s36, 2
    s_cbranch_scc1 k234_mid_kernel_a_qk0cs6
    v_mfma_f32_16x16x32_bf16 v[124:127], v[68:71], v[144:147], v[124:127]
    v_mfma_f32_16x16x32_bf16 v[128:131], v[72:75], v[144:147], v[128:131]
    v_mfma_f32_16x16x32_bf16 v[132:135], v[76:79], v[144:147], v[132:135]
    v_mfma_f32_16x16x32_bf16 v[136:139], v[80:83], v[144:147], v[136:139]
    v_mfma_f32_16x16x32_bf16 v[140:143], v[84:87], v[144:147], v[140:143]
k234_mid_kernel_a_qk0cs6:
    s_waitcnt vmcnt(4)
    s_barrier
    s_waitcnt lgkmcnt(8)
    v_mfma_f32_16x16x32_bf16 v[28:31], v[88:91], v[116:119], v[28:31]
    ds_read_b128 v[108:111], v12 offset:18432
    ds_read_b128 v[112:115], v12 offset:20480
    v_mfma_f32_16x16x32_bf16 v[32:35], v[88:91], v[120:123], v[32:35]
    ds_read_b64_tr_b16 v[68:69], v8 offset:0
    ds_read_b64_tr_b16 v[70:71], v8 offset:4608
    s_add_u32 m0, s41, 69632
    s_nop 0
    buffer_load_dwordx4 v4, s[12:15], s38 offen lds
    s_waitcnt lgkmcnt(10)
    v_mfma_f32_16x16x32_bf16 v[36:39], v[92:95], v[116:119], v[36:39]
    ds_read_b64_tr_b16 v[72:73], v8 offset:8
    ds_read_b64_tr_b16 v[74:75], v8 offset:4616
    v_mfma_f32_16x16x32_bf16 v[40:43], v[92:95], v[120:123], v[40:43]
    ds_read_b64_tr_b16 v[76:77], v8 offset:72
    ds_read_b64_tr_b16 v[78:79], v8 offset:4680
    v_mfma_f32_16x16x32_bf16 v[20:23], v[144:147], v[116:119], v[20:23]
    s_waitcnt lgkmcnt(12)
    v_mfma_f32_16x16x32_bf16 v[44:47], v[96:99], v[116:119], v[44:47]
    ds_read_b64_tr_b16 v[80:81], v8 offset:80
    ds_read_b64_tr_b16 v[82:83], v8 offset:4688
    s_add_u32 m0, s41, 88064
    s_nop 0
    buffer_load_dwordx4 v7, s[8:11], s39 offen lds
    s_add_u32 s39, s39, 128
    v_mfma_f32_16x16x32_bf16 v[48:51], v[96:99], v[120:123], v[48:51]
    ds_read_b64_tr_b16 v[84:85], v10 offset:0
    ds_read_b64_tr_b16 v[86:87], v10 offset:4608
    v_mfma_f32_16x16x32_bf16 v[24:27], v[116:119], v[116:119], v[24:27]
    s_waitcnt lgkmcnt(14)
    v_mfma_f32_16x16x32_bf16 v[52:55], v[100:103], v[116:119], v[52:55]
    v_mfma_f32_16x16x32_bf16 v[56:59], v[100:103], v[120:123], v[56:59]
    s_add_u32 m0, s41, 77824
    s_nop 0
    buffer_load_dwordx4 v5, s[12:15], s38 offen lds
    s_waitcnt lgkmcnt(12)
    v_mfma_f32_16x16x32_bf16 v[60:63], v[104:107], v[116:119], v[60:63]
    v_mfma_f32_16x16x32_bf16 v[64:67], v[104:107], v[120:123], v[64:67]
    s_cmp_lg_u32 s36, 3
    s_cbranch_scc1 k234_mid_kernel_a_qk0cs7
    v_mfma_f32_16x16x32_bf16 v[124:127], v[88:91], v[144:147], v[124:127]
    v_mfma_f32_16x16x32_bf16 v[128:131], v[92:95], v[144:147], v[128:131]
    v_mfma_f32_16x16x32_bf16 v[132:135], v[96:99], v[144:147], v[132:135]
    v_mfma_f32_16x16x32_bf16 v[136:139], v[100:103], v[144:147], v[136:139]
    v_mfma_f32_16x16x32_bf16 v[140:143], v[104:107], v[144:147], v[140:143]
k234_mid_kernel_a_qk0cs7:
    s_waitcnt lgkmcnt(8)
    v_mfma_f32_16x16x32_bf16 v[28:31], v[68:71], v[108:111], v[28:31]
    ds_read_b128 v[116:119], v14 offset:18432
    ds_read_b128 v[120:123], v14 offset:20480
    v_mfma_f32_16x16x32_bf16 v[32:35], v[68:71], v[112:115], v[32:35]
    ds_read_b64_tr_b16 v[88:89], v8 offset:9216
    ds_read_b64_tr_b16 v[90:91], v8 offset:13824
    s_add_u32 m0, s41, 96256
    s_nop 0
    buffer_load_dwordx4 v7, s[8:11], s40 offen lds
    s_add_u32 s40, s40, 128
    s_waitcnt lgkmcnt(10)
    v_mfma_f32_16x16x32_bf16 v[36:39], v[72:75], v[108:111], v[36:39]
    ds_read_b64_tr_b16 v[92:93], v8 offset:9224
    ds_read_b64_tr_b16 v[94:95], v8 offset:13832
    v_mfma_f32_16x16x32_bf16 v[40:43], v[72:75], v[112:115], v[40:43]
    ds_read_b64_tr_b16 v[96:97], v8 offset:9288
    ds_read_b64_tr_b16 v[98:99], v8 offset:13896
    v_mfma_f32_16x16x32_bf16 v[20:23], v[144:147], v[108:111], v[20:23]
    s_waitcnt lgkmcnt(12)
    v_mfma_f32_16x16x32_bf16 v[44:47], v[76:79], v[108:111], v[44:47]
    ds_read_b64_tr_b16 v[100:101], v8 offset:9296
    ds_read_b64_tr_b16 v[102:103], v8 offset:13904
    s_cmp_ge_u32 s20, 2
    s_cbranch_scc1 k234_mid_kernel_a_qk0sk7
    s_add_u32 m0, s41, 86016
    s_nop 0
    buffer_load_dwordx4 v6, s[12:15], s38 offen lds
k234_mid_kernel_a_qk0sk7:
    s_add_u32 s38, s38, 221184
    v_mfma_f32_16x16x32_bf16 v[48:51], v[76:79], v[112:115], v[48:51]
    ds_read_b64_tr_b16 v[104:105], v10 offset:9216
    ds_read_b64_tr_b16 v[106:107], v10 offset:13824
    v_mfma_f32_16x16x32_bf16 v[24:27], v[108:111], v[108:111], v[24:27]
    s_waitcnt lgkmcnt(14)
    v_mfma_f32_16x16x32_bf16 v[52:55], v[80:83], v[108:111], v[52:55]
    v_mfma_f32_16x16x32_bf16 v[56:59], v[80:83], v[112:115], v[56:59]
    s_waitcnt lgkmcnt(12)
    v_mfma_f32_16x16x32_bf16 v[60:63], v[84:87], v[108:111], v[60:63]
    v_mfma_f32_16x16x32_bf16 v[64:67], v[84:87], v[112:115], v[64:67]
    s_cmp_lg_u32 s36, 0
    s_cbranch_scc1 k234_mid_kernel_a_qk0cs8
    v_mfma_f32_16x16x32_bf16 v[124:127], v[68:71], v[144:147], v[124:127]
    v_mfma_f32_16x16x32_bf16 v[128:131], v[72:75], v[144:147], v[128:131]
    v_mfma_f32_16x16x32_bf16 v[132:135], v[76:79], v[144:147], v[132:135]
    v_mfma_f32_16x16x32_bf16 v[136:139], v[80:83], v[144:147], v[136:139]
    v_mfma_f32_16x16x32_bf16 v[140:143], v[84:87], v[144:147], v[140:143]
k234_mid_kernel_a_qk0cs8:
    s_waitcnt vmcnt(4)
    s_barrier
    s_waitcnt lgkmcnt(8)
    v_mfma_f32_16x16x32_bf16 v[28:31], v[88:91], v[116:119], v[28:31]
    ds_read_b128 v[108:111], v12 offset:53248
    ds_read_b128 v[112:115], v12 offset:55296
    v_mfma_f32_16x16x32_bf16 v[32:35], v[88:91], v[120:123], v[32:35]
    ds_read_b64_tr_b16 v[68:69], v8 offset:34816
    ds_read_b64_tr_b16 v[70:71], v8 offset:39424
    s_add_u32 m0, s41, 104448
    s_nop 0
    buffer_load_dwordx4 v4, s[12:15], s38 offen lds
    s_waitcnt lgkmcnt(10)
    v_mfma_f32_16x16x32_bf16 v[36:39], v[92:95], v[116:119], v[36:39]
    ds_read_b64_tr_b16 v[72:73], v8 offset:34824
    ds_read_b64_tr_b16 v[74:75], v8 offset:39432
    v_mfma_f32_16x16x32_bf16 v[40:43], v[92:95], v[120:123], v[40:43]
    ds_read_b64_tr_b16 v[76:77], v8 offset:34888
    ds_read_b64_tr_b16 v[78:79], v8 offset:39496
    v_mfma_f32_16x16x32_bf16 v[20:23], v[144:147], v[116:119], v[20:23]
    s_waitcnt lgkmcnt(12)
    v_mfma_f32_16x16x32_bf16 v[44:47], v[96:99], v[116:119], v[44:47]
    ds_read_b64_tr_b16 v[80:81], v8 offset:34896
    ds_read_b64_tr_b16 v[82:83], v8 offset:39504
    s_add_u32 m0, s41, 122880
    s_nop 0
    buffer_load_dwordx4 v7, s[8:11], s39 offen lds
    s_add_u32 s39, s39, 128
    v_mfma_f32_16x16x32_bf16 v[48:51], v[96:99], v[120:123], v[48:51]
    ds_read_b64_tr_b16 v[84:85], v10 offset:34816
    ds_read_b64_tr_b16 v[86:87], v10 offset:39424
    v_mfma_f32_16x16x32_bf16 v[24:27], v[116:119], v[116:119], v[24:27]
    s_waitcnt lgkmcnt(14)
    v_mfma_f32_16x16x32_bf16 v[52:55], v[100:103], v[116:119], v[52:55]
    v_mfma_f32_16x16x32_bf16 v[56:59], v[100:103], v[120:123], v[56:59]
    s_add_u32 m0, s41, 112640
    s_nop 0
    buffer_load_dwordx4 v5, s[12:15], s38 offen lds
    s_waitcnt lgkmcnt(12)
    v_mfma_f32_16x16x32_bf16 v[60:63], v[104:107], v[116:119], v[60:63]
    v_mfma_f32_16x16x32_bf16 v[64:67], v[104:107], v[120:123], v[64:67]
    s_cmp_lg_u32 s36, 1
    s_cbranch_scc1 k234_mid_kernel_a_qk0cs9
    v_mfma_f32_16x16x32_bf16 v[124:127], v[88:91], v[144:147], v[124:127]
    v_mfma_f32_16x16x32_bf16 v[128:131], v[92:95], v[144:147], v[128:131]
    v_mfma_f32_16x16x32_bf16 v[132:135], v[96:99], v[144:147], v[132:135]
    v_mfma_f32_16x16x32_bf16 v[136:139], v[100:103], v[144:147], v[136:139]
    v_mfma_f32_16x16x32_bf16 v[140:143], v[104:107], v[144:147], v[140:143]
k234_mid_kernel_a_qk0cs9:
    s_waitcnt lgkmcnt(8)
    v_mfma_f32_16x16x32_bf16 v[28:31], v[68:71], v[108:111], v[28:31]
    ds_read_b128 v[116:119], v14 offset:53248
    ds_read_b128 v[120:123], v14 offset:55296
    v_mfma_f32_16x16x32_bf16 v[32:35], v[68:71], v[112:115], v[32:35]
    ds_read_b64_tr_b16 v[88:89], v8 offset:44032
    ds_read_b64_tr_b16 v[90:91], v8 offset:48640
    s_add_u32 m0, s41, 131072
    s_nop 0
    buffer_load_dwordx4 v7, s[8:11], s40 offen lds
    s_add_u32 s40, s40, 128
    s_waitcnt lgkmcnt(10)
    v_mfma_f32_16x16x32_bf16 v[36:39], v[72:75], v[108:111], v[36:39]
    ds_read_b64_tr_b16 v[92:93], v8 offset:44040
    ds_read_b64_tr_b16 v[94:95], v8 offset:48648
    v_mfma_f32_16x16x32_bf16 v[40:43], v[72:75], v[112:115], v[40:43]
    ds_read_b64_tr_b16 v[96:97], v8 offset:44104
    ds_read_b64_tr_b16 v[98:99], v8 offset:48712
    v_mfma_f32_16x16x32_bf16 v[20:23], v[144:147], v[108:111], v[20:23]
    s_waitcnt lgkmcnt(12)
    v_mfma_f32_16x16x32_bf16 v[44:47], v[76:79], v[108:111], v[44:47]
    ds_read_b64_tr_b16 v[100:101], v8 offset:44112
    ds_read_b64_tr_b16 v[102:103], v8 offset:48720
    s_cmp_ge_u32 s20, 2
    s_cbranch_scc1 k234_mid_kernel_a_qk0sk8
    s_add_u32 m0, s41, 120832
    s_nop 0
    buffer_load_dwordx4 v6, s[12:15], s38 offen lds
k234_mid_kernel_a_qk0sk8:
    s_add_u32 s38, s38, 221184
    v_mfma_f32_16x16x32_bf16 v[48:51], v[76:79], v[112:115], v[48:51]
    ds_read_b64_tr_b16 v[104:105], v10 offset:44032
    ds_read_b64_tr_b16 v[106:107], v10 offset:48640
    v_mfma_f32_16x16x32_bf16 v[24:27], v[108:111], v[108:111], v[24:27]
    s_waitcnt lgkmcnt(14)
    v_mfma_f32_16x16x32_bf16 v[52:55], v[80:83], v[108:111], v[52:55]
    v_mfma_f32_16x16x32_bf16 v[56:59], v[80:83], v[112:115], v[56:59]
    s_waitcnt lgkmcnt(12)
    v_mfma_f32_16x16x32_bf16 v[60:63], v[84:87], v[108:111], v[60:63]
    v_mfma_f32_16x16x32_bf16 v[64:67], v[84:87], v[112:115], v[64:67]
    s_cmp_lg_u32 s36, 2
    s_cbranch_scc1 k234_mid_kernel_a_qk0cs10
    v_mfma_f32_16x16x32_bf16 v[124:127], v[68:71], v[144:147], v[124:127]
    v_mfma_f32_16x16x32_bf16 v[128:131], v[72:75], v[144:147], v[128:131]
    v_mfma_f32_16x16x32_bf16 v[132:135], v[76:79], v[144:147], v[132:135]
    v_mfma_f32_16x16x32_bf16 v[136:139], v[80:83], v[144:147], v[136:139]
    v_mfma_f32_16x16x32_bf16 v[140:143], v[84:87], v[144:147], v[140:143]
k234_mid_kernel_a_qk0cs10:
    s_waitcnt vmcnt(4)
    s_barrier
    s_waitcnt lgkmcnt(8)
    v_mfma_f32_16x16x32_bf16 v[28:31], v[88:91], v[116:119], v[28:31]
    ds_read_b128 v[108:111], v13 offset:18432
    ds_read_b128 v[112:115], v13 offset:20480
    v_mfma_f32_16x16x32_bf16 v[32:35], v[88:91], v[120:123], v[32:35]
    ds_read_b64_tr_b16 v[68:69], v9 offset:0
    ds_read_b64_tr_b16 v[70:71], v9 offset:4608
    s_add_u32 m0, s41, 0
    s_nop 0
    buffer_load_dwordx4 v4, s[12:15], s38 offen lds
    s_waitcnt lgkmcnt(10)
    v_mfma_f32_16x16x32_bf16 v[36:39], v[92:95], v[116:119], v[36:39]
    ds_read_b64_tr_b16 v[72:73], v9 offset:8
    ds_read_b64_tr_b16 v[74:75], v9 offset:4616
    v_mfma_f32_16x16x32_bf16 v[40:43], v[92:95], v[120:123], v[40:43]
    ds_read_b64_tr_b16 v[76:77], v9 offset:72
    ds_read_b64_tr_b16 v[78:79], v9 offset:4680
    v_mfma_f32_16x16x32_bf16 v[20:23], v[144:147], v[116:119], v[20:23]
    s_waitcnt lgkmcnt(12)
    v_mfma_f32_16x16x32_bf16 v[44:47], v[96:99], v[116:119], v[44:47]
    ds_read_b64_tr_b16 v[80:81], v9 offset:80
    ds_read_b64_tr_b16 v[82:83], v9 offset:4688
    s_add_u32 m0, s41, 18432
    s_nop 0
    buffer_load_dwordx4 v7, s[8:11], s39 offen lds
    s_add_u32 s39, s39, 128
    v_mfma_f32_16x16x32_bf16 v[48:51], v[96:99], v[120:123], v[48:51]
    ds_read_b64_tr_b16 v[84:85], v11 offset:0
    ds_read_b64_tr_b16 v[86:87], v11 offset:4608
    v_mfma_f32_16x16x32_bf16 v[24:27], v[116:119], v[116:119], v[24:27]
    s_waitcnt lgkmcnt(14)
    v_mfma_f32_16x16x32_bf16 v[52:55], v[100:103], v[116:119], v[52:55]
    v_mfma_f32_16x16x32_bf16 v[56:59], v[100:103], v[120:123], v[56:59]
    s_add_u32 m0, s41, 8192
    s_nop 0
    buffer_load_dwordx4 v5, s[12:15], s38 offen lds
    s_waitcnt lgkmcnt(12)
    v_mfma_f32_16x16x32_bf16 v[60:63], v[104:107], v[116:119], v[60:63]
    v_mfma_f32_16x16x32_bf16 v[64:67], v[104:107], v[120:123], v[64:67]
    s_cmp_lg_u32 s36, 3
    s_cbranch_scc1 k234_mid_kernel_a_qk0cs11
    v_mfma_f32_16x16x32_bf16 v[124:127], v[88:91], v[144:147], v[124:127]
    v_mfma_f32_16x16x32_bf16 v[128:131], v[92:95], v[144:147], v[128:131]
    v_mfma_f32_16x16x32_bf16 v[132:135], v[96:99], v[144:147], v[132:135]
    v_mfma_f32_16x16x32_bf16 v[136:139], v[100:103], v[144:147], v[136:139]
    v_mfma_f32_16x16x32_bf16 v[140:143], v[104:107], v[144:147], v[140:143]
k234_mid_kernel_a_qk0cs11:
    s_waitcnt lgkmcnt(8)
    v_mfma_f32_16x16x32_bf16 v[28:31], v[68:71], v[108:111], v[28:31]
    ds_read_b128 v[116:119], v15 offset:18432
    ds_read_b128 v[120:123], v15 offset:20480
    v_mfma_f32_16x16x32_bf16 v[32:35], v[68:71], v[112:115], v[32:35]
    ds_read_b64_tr_b16 v[88:89], v9 offset:9216
    ds_read_b64_tr_b16 v[90:91], v9 offset:13824
    s_add_u32 m0, s41, 26624
    s_nop 0
    buffer_load_dwordx4 v7, s[8:11], s40 offen lds
    s_add_u32 s40, s40, 128
    s_waitcnt lgkmcnt(10)
    v_mfma_f32_16x16x32_bf16 v[36:39], v[72:75], v[108:111], v[36:39]
    ds_read_b64_tr_b16 v[92:93], v9 offset:9224
    ds_read_b64_tr_b16 v[94:95], v9 offset:13832
    v_mfma_f32_16x16x32_bf16 v[40:43], v[72:75], v[112:115], v[40:43]
    ds_read_b64_tr_b16 v[96:97], v9 offset:9288
    ds_read_b64_tr_b16 v[98:99], v9 offset:13896
    v_mfma_f32_16x16x32_bf16 v[20:23], v[144:147], v[108:111], v[20:23]
    s_waitcnt lgkmcnt(12)
    v_mfma_f32_16x16x32_bf16 v[44:47], v[76:79], v[108:111], v[44:47]
    ds_read_b64_tr_b16 v[100:101], v9 offset:9296
    ds_read_b64_tr_b16 v[102:103], v9 offset:13904
    s_cmp_ge_u32 s20, 2
    s_cbranch_scc1 k234_mid_kernel_a_qk0sk9
    s_add_u32 m0, s41, 16384
    s_nop 0
    buffer_load_dwordx4 v6, s[12:15], s38 offen lds
k234_mid_kernel_a_qk0sk9:
    s_add_u32 s38, s38, 221184
    v_mfma_f32_16x16x32_bf16 v[48:51], v[76:79], v[112:115], v[48:51]
    ds_read_b64_tr_b16 v[104:105], v11 offset:9216
    ds_read_b64_tr_b16 v[106:107], v11 offset:13824
    v_mfma_f32_16x16x32_bf16 v[24:27], v[108:111], v[108:111], v[24:27]
    s_waitcnt lgkmcnt(14)
    v_mfma_f32_16x16x32_bf16 v[52:55], v[80:83], v[108:111], v[52:55]
    v_mfma_f32_16x16x32_bf16 v[56:59], v[80:83], v[112:115], v[56:59]
    s_waitcnt lgkmcnt(12)
    v_mfma_f32_16x16x32_bf16 v[60:63], v[84:87], v[108:111], v[60:63]
    v_mfma_f32_16x16x32_bf16 v[64:67], v[84:87], v[112:115], v[64:67]
    s_cmp_lg_u32 s36, 0
    s_cbranch_scc1 k234_mid_kernel_a_qk0cs12
    v_mfma_f32_16x16x32_bf16 v[124:127], v[68:71], v[144:147], v[124:127]
    v_mfma_f32_16x16x32_bf16 v[128:131], v[72:75], v[144:147], v[128:131]
    v_mfma_f32_16x16x32_bf16 v[132:135], v[76:79], v[144:147], v[132:135]
    v_mfma_f32_16x16x32_bf16 v[136:139], v[80:83], v[144:147], v[136:139]
    v_mfma_f32_16x16x32_bf16 v[140:143], v[84:87], v[144:147], v[140:143]
k234_mid_kernel_a_qk0cs12:
    s_waitcnt vmcnt(4)
    s_barrier
    s_waitcnt lgkmcnt(8)
    v_mfma_f32_16x16x32_bf16 v[28:31], v[88:91], v[116:119], v[28:31]
    ds_read_b128 v[108:111], v13 offset:53248
    ds_read_b128 v[112:115], v13 offset:55296
    v_mfma_f32_16x16x32_bf16 v[32:35], v[88:91], v[120:123], v[32:35]
    ds_read_b64_tr_b16 v[68:69], v9 offset:34816
    ds_read_b64_tr_b16 v[70:71], v9 offset:39424
    s_waitcnt lgkmcnt(10)
    v_mfma_f32_16x16x32_bf16 v[36:39], v[92:95], v[116:119], v[36:39]
    ds_read_b64_tr_b16 v[72:73], v9 offset:34824
    ds_read_b64_tr_b16 v[74:75], v9 offset:39432
    v_mfma_f32_16x16x32_bf16 v[40:43], v[92:95], v[120:123], v[40:43]
    ds_read_b64_tr_b16 v[76:77], v9 offset:34888
    ds_read_b64_tr_b16 v[78:79], v9 offset:39496
    v_mfma_f32_16x16x32_bf16 v[20:23], v[144:147], v[116:119], v[20:23]
    s_waitcnt lgkmcnt(12)
    v_mfma_f32_16x16x32_bf16 v[44:47], v[96:99], v[116:119], v[44:47]
    ds_read_b64_tr_b16 v[80:81], v9 offset:34896
    ds_read_b64_tr_b16 v[82:83], v9 offset:39504
    v_mfma_f32_16x16x32_bf16 v[48:51], v[96:99], v[120:123], v[48:51]
    ds_read_b64_tr_b16 v[84:85], v11 offset:34816
    ds_read_b64_tr_b16 v[86:87], v11 offset:39424
    v_mfma_f32_16x16x32_bf16 v[24:27], v[116:119], v[116:119], v[24:27]
    s_waitcnt lgkmcnt(14)
    v_mfma_f32_16x16x32_bf16 v[52:55], v[100:103], v[116:119], v[52:55]
    v_mfma_f32_16x16x32_bf16 v[56:59], v[100:103], v[120:123], v[56:59]
    s_waitcnt lgkmcnt(12)
    v_mfma_f32_16x16x32_bf16 v[60:63], v[104:107], v[116:119], v[60:63]
    v_mfma_f32_16x16x32_bf16 v[64:67], v[104:107], v[120:123], v[64:67]
    s_cmp_lg_u32 s36, 1
    s_cbranch_scc1 k234_mid_kernel_a_qk0cs13
    v_mfma_f32_16x16x32_bf16 v[124:127], v[88:91], v[144:147], v[124:127]
    v_mfma_f32_16x16x32_bf16 v[128:131], v[92:95], v[144:147], v[128:131]
    v_mfma_f32_16x16x32_bf16 v[132:135], v[96:99], v[144:147], v[132:135]
    v_mfma_f32_16x16x32_bf16 v[136:139], v[100:103], v[144:147], v[136:139]
    v_mfma_f32_16x16x32_bf16 v[140:143], v[104:107], v[144:147], v[140:143]
k234_mid_kernel_a_qk0cs13:
    s_waitcnt lgkmcnt(8)
    v_mfma_f32_16x16x32_bf16 v[28:31], v[68:71], v[108:111], v[28:31]
    ds_read_b128 v[116:119], v15 offset:53248
    ds_read_b128 v[120:123], v15 offset:55296
    v_mfma_f32_16x16x32_bf16 v[32:35], v[68:71], v[112:115], v[32:35]
    ds_read_b64_tr_b16 v[88:89], v9 offset:44032
    ds_read_b64_tr_b16 v[90:91], v9 offset:48640
    s_waitcnt lgkmcnt(10)
    v_mfma_f32_16x16x32_bf16 v[36:39], v[72:75], v[108:111], v[36:39]
    ds_read_b64_tr_b16 v[92:93], v9 offset:44040
    ds_read_b64_tr_b16 v[94:95], v9 offset:48648
    v_mfma_f32_16x16x32_bf16 v[40:43], v[72:75], v[112:115], v[40:43]
    ds_read_b64_tr_b16 v[96:97], v9 offset:44104
    ds_read_b64_tr_b16 v[98:99], v9 offset:48712
    v_mfma_f32_16x16x32_bf16 v[20:23], v[144:147], v[108:111], v[20:23]
    s_waitcnt lgkmcnt(12)
    v_mfma_f32_16x16x32_bf16 v[44:47], v[76:79], v[108:111], v[44:47]
    ds_read_b64_tr_b16 v[100:101], v9 offset:44112
    ds_read_b64_tr_b16 v[102:103], v9 offset:48720
    v_mfma_f32_16x16x32_bf16 v[48:51], v[76:79], v[112:115], v[48:51]
    ds_read_b64_tr_b16 v[104:105], v11 offset:44032
    ds_read_b64_tr_b16 v[106:107], v11 offset:48640
    v_mfma_f32_16x16x32_bf16 v[24:27], v[108:111], v[108:111], v[24:27]
    s_waitcnt lgkmcnt(14)
    v_mfma_f32_16x16x32_bf16 v[52:55], v[80:83], v[108:111], v[52:55]
    v_mfma_f32_16x16x32_bf16 v[56:59], v[80:83], v[112:115], v[56:59]
    s_waitcnt lgkmcnt(12)
    v_mfma_f32_16x16x32_bf16 v[60:63], v[84:87], v[108:111], v[60:63]
    v_mfma_f32_16x16x32_bf16 v[64:67], v[84:87], v[112:115], v[64:67]
    s_cmp_lg_u32 s36, 2
    s_cbranch_scc1 k234_mid_kernel_a_qk0cs14
    v_mfma_f32_16x16x32_bf16 v[124:127], v[68:71], v[144:147], v[124:127]
    v_mfma_f32_16x16x32_bf16 v[128:131], v[72:75], v[144:147], v[128:131]
    v_mfma_f32_16x16x32_bf16 v[132:135], v[76:79], v[144:147], v[132:135]
    v_mfma_f32_16x16x32_bf16 v[136:139], v[80:83], v[144:147], v[136:139]
    v_mfma_f32_16x16x32_bf16 v[140:143], v[84:87], v[144:147], v[140:143]
k234_mid_kernel_a_qk0cs14:
    s_waitcnt vmcnt(0)
    s_barrier
    s_waitcnt lgkmcnt(8)
    v_mfma_f32_16x16x32_bf16 v[28:31], v[88:91], v[116:119], v[28:31]
    ds_read_b128 v[108:111], v12 offset:18432
    ds_read_b128 v[112:115], v12 offset:20480
    v_mfma_f32_16x16x32_bf16 v[32:35], v[88:91], v[120:123], v[32:35]
    ds_read_b64_tr_b16 v[68:69], v8 offset:0
    ds_read_b64_tr_b16 v[70:71], v8 offset:4608
    s_waitcnt lgkmcnt(10)
    v_mfma_f32_16x16x32_bf16 v[36:39], v[92:95], v[116:119], v[36:39]
    ds_read_b64_tr_b16 v[72:73], v8 offset:8
    ds_read_b64_tr_b16 v[74:75], v8 offset:4616
    v_mfma_f32_16x16x32_bf16 v[40:43], v[92:95], v[120:123], v[40:43]
    ds_read_b64_tr_b16 v[76:77], v8 offset:72
    ds_read_b64_tr_b16 v[78:79], v8 offset:4680
    v_mfma_f32_16x16x32_bf16 v[20:23], v[144:147], v[116:119], v[20:23]
    s_waitcnt lgkmcnt(12)
    v_mfma_f32_16x16x32_bf16 v[44:47], v[96:99], v[116:119], v[44:47]
    ds_read_b64_tr_b16 v[80:81], v8 offset:80
    ds_read_b64_tr_b16 v[82:83], v8 offset:4688
    v_mfma_f32_16x16x32_bf16 v[48:51], v[96:99], v[120:123], v[48:51]
    ds_read_b64_tr_b16 v[84:85], v10 offset:0
    ds_read_b64_tr_b16 v[86:87], v10 offset:4608
    v_mfma_f32_16x16x32_bf16 v[24:27], v[116:119], v[116:119], v[24:27]
    s_waitcnt lgkmcnt(14)
    v_mfma_f32_16x16x32_bf16 v[52:55], v[100:103], v[116:119], v[52:55]
    v_mfma_f32_16x16x32_bf16 v[56:59], v[100:103], v[120:123], v[56:59]
    s_waitcnt lgkmcnt(12)
    v_mfma_f32_16x16x32_bf16 v[60:63], v[104:107], v[116:119], v[60:63]
    v_mfma_f32_16x16x32_bf16 v[64:67], v[104:107], v[120:123], v[64:67]
    s_cmp_lg_u32 s36, 3
    s_cbranch_scc1 k234_mid_kernel_a_qk0cs15
    v_mfma_f32_16x16x32_bf16 v[124:127], v[88:91], v[144:147], v[124:127]
    v_mfma_f32_16x16x32_bf16 v[128:131], v[92:95], v[144:147], v[128:131]
    v_mfma_f32_16x16x32_bf16 v[132:135], v[96:99], v[144:147], v[132:135]
    v_mfma_f32_16x16x32_bf16 v[136:139], v[100:103], v[144:147], v[136:139]
    v_mfma_f32_16x16x32_bf16 v[140:143], v[104:107], v[144:147], v[140:143]
k234_mid_kernel_a_qk0cs15:
    s_waitcnt lgkmcnt(8)
    v_mfma_f32_16x16x32_bf16 v[28:31], v[68:71], v[108:111], v[28:31]
    ds_read_b128 v[116:119], v14 offset:18432
    ds_read_b128 v[120:123], v14 offset:20480
    v_mfma_f32_16x16x32_bf16 v[32:35], v[68:71], v[112:115], v[32:35]
    ds_read_b64_tr_b16 v[88:89], v8 offset:9216
    ds_read_b64_tr_b16 v[90:91], v8 offset:13824
    s_waitcnt lgkmcnt(10)
    v_mfma_f32_16x16x32_bf16 v[36:39], v[72:75], v[108:111], v[36:39]
    ds_read_b64_tr_b16 v[92:93], v8 offset:9224
    ds_read_b64_tr_b16 v[94:95], v8 offset:13832
    v_mfma_f32_16x16x32_bf16 v[40:43], v[72:75], v[112:115], v[40:43]
    ds_read_b64_tr_b16 v[96:97], v8 offset:9288
    ds_read_b64_tr_b16 v[98:99], v8 offset:13896
    v_mfma_f32_16x16x32_bf16 v[20:23], v[144:147], v[108:111], v[20:23]
    s_waitcnt lgkmcnt(12)
    v_mfma_f32_16x16x32_bf16 v[44:47], v[76:79], v[108:111], v[44:47]
    ds_read_b64_tr_b16 v[100:101], v8 offset:9296
    ds_read_b64_tr_b16 v[102:103], v8 offset:13904
    v_mfma_f32_16x16x32_bf16 v[48:51], v[76:79], v[112:115], v[48:51]
    ds_read_b64_tr_b16 v[104:105], v10 offset:9216
    ds_read_b64_tr_b16 v[106:107], v10 offset:13824
    v_mfma_f32_16x16x32_bf16 v[24:27], v[108:111], v[108:111], v[24:27]
    s_waitcnt lgkmcnt(14)
    v_mfma_f32_16x16x32_bf16 v[52:55], v[80:83], v[108:111], v[52:55]
    v_mfma_f32_16x16x32_bf16 v[56:59], v[80:83], v[112:115], v[56:59]
    s_waitcnt lgkmcnt(12)
    v_mfma_f32_16x16x32_bf16 v[60:63], v[84:87], v[108:111], v[60:63]
    v_mfma_f32_16x16x32_bf16 v[64:67], v[84:87], v[112:115], v[64:67]
    s_cmp_lg_u32 s36, 0
    s_cbranch_scc1 k234_mid_kernel_a_qk0cs16
    v_mfma_f32_16x16x32_bf16 v[124:127], v[68:71], v[144:147], v[124:127]
    v_mfma_f32_16x16x32_bf16 v[128:131], v[72:75], v[144:147], v[128:131]
    v_mfma_f32_16x16x32_bf16 v[132:135], v[76:79], v[144:147], v[132:135]
    v_mfma_f32_16x16x32_bf16 v[136:139], v[80:83], v[144:147], v[136:139]
    v_mfma_f32_16x16x32_bf16 v[140:143], v[84:87], v[144:147], v[140:143]
k234_mid_kernel_a_qk0cs16:
    s_waitcnt lgkmcnt(8)
    v_mfma_f32_16x16x32_bf16 v[28:31], v[88:91], v[116:119], v[28:31]
    v_mfma_f32_16x16x32_bf16 v[32:35], v[88:91], v[120:123], v[32:35]
    s_waitcnt lgkmcnt(6)
    v_mfma_f32_16x16x32_bf16 v[36:39], v[92:95], v[116:119], v[36:39]
    v_mfma_f32_16x16x32_bf16 v[40:43], v[92:95], v[120:123], v[40:43]
    v_mfma_f32_16x16x32_bf16 v[20:23], v[144:147], v[116:119], v[20:23]
    s_waitcnt lgkmcnt(4)
    v_mfma_f32_16x16x32_bf16 v[44:47], v[96:99], v[116:119], v[44:47]
    v_mfma_f32_16x16x32_bf16 v[48:51], v[96:99], v[120:123], v[48:51]
    v_mfma_f32_16x16x32_bf16 v[24:27], v[116:119], v[116:119], v[24:27]
    s_waitcnt lgkmcnt(2)
    v_mfma_f32_16x16x32_bf16 v[52:55], v[100:103], v[116:119], v[52:55]
    v_mfma_f32_16x16x32_bf16 v[56:59], v[100:103], v[120:123], v[56:59]
    s_waitcnt lgkmcnt(0)
    v_mfma_f32_16x16x32_bf16 v[60:63], v[104:107], v[116:119], v[60:63]
    v_mfma_f32_16x16x32_bf16 v[64:67], v[104:107], v[120:123], v[64:67]
    s_cmp_lg_u32 s36, 1
    s_cbranch_scc1 k234_mid_kernel_a_qk0cs17
    v_mfma_f32_16x16x32_bf16 v[124:127], v[88:91], v[144:147], v[124:127]
    v_mfma_f32_16x16x32_bf16 v[128:131], v[92:95], v[144:147], v[128:131]
    v_mfma_f32_16x16x32_bf16 v[132:135], v[96:99], v[144:147], v[132:135]
    v_mfma_f32_16x16x32_bf16 v[136:139], v[100:103], v[144:147], v[136:139]
    v_mfma_f32_16x16x32_bf16 v[140:143], v[104:107], v[144:147], v[140:143]
k234_mid_kernel_a_qk0cs17:
    s_nop 5
    v_and_b32 v17, 1, v2
    v_cmp_eq_u32 vcc, 1, v17
    s_nop 1
    v_cndmask_b32 v24, v24, v25, vcc
    v_cndmask_b32 v26, v26, v27, vcc
    v_and_b32 v17, 2, v2
    v_cmp_eq_u32 vcc, 2, v17
    s_nop 1
    v_cndmask_b32 v24, v24, v26, vcc
    v_lshrrev_b32 v17, 2, v2
    v_cmp_eq_u32 vcc, v17, v3
    s_nop 1
    v_cndmask_b32 v22, 0, v24, vcc
    v_mov_b32 v17, v22
    s_nop 1
    v_permlane32_swap_b32 v22, v17
    v_add_f32 v22, v22, v17
    v_mov_b32 v17, v22
    s_nop 1
    v_permlane16_swap_b32 v22, v17
    v_add_f32 v22, v22, v17
    v_mul_f32 v20, 0x3ae38e39, v20
    v_mul_f32 v17, v20, v20
    v_mov_b32 v18, 0x3ae38e39
    v_fma_f32 v22, v22, v18, -v17
    v_max_f32 v22, 0, v22
    v_add_f32 v22, 0x3727c5ac, v22
    v_rsq_f32 v22, v22
    s_mul_i32 s25, s36, 576
    v_lshlrev_b32 v16, 4, v3
    v_add_u32 v16, s25, v16
    v_add_u32 v16, 139264, v16
    s_lshl_b32 s25, s36, 8
    s_add_u32 s25, s25, 141568
    v_lshlrev_b32 v19, 3, v2
    v_add_u32 v19, s25, v19
    s_cmp_ge_u32 s22, 4
    s_cbranch_scc1 k234_mid_kernel_a_qk0noq
    v_mul_f32 v22, 0x3eae1a93, v22
    s_cmp_lg_u32 s22, 0
    s_cbranch_scc1 k234_mid_kernel_a_qk0noq
    s_lshl_b32 s25, s23, 7
    s_add_u32 s25, s25, 7241728
    v_lshlrev_b32 v17, 2, v2
    buffer_store_dword v20, v17, s[16:19], s25 offen sc1
k234_mid_kernel_a_qk0noq:
    s_nop 1
    v_mul_f32 v23, v20, v22
    ds_write_b64 v19, v[22:23]
    v_cmp_eq_u32 vcc, 0, v2
    s_nop 0
    s_and_saveexec_b64 s[32:33], vcc
    ds_write_b128 v16, v[124:127] offset:0
    ds_write_b128 v16, v[128:131] offset:64
    ds_write_b128 v16, v[132:135] offset:128
    ds_write_b128 v16, v[136:139] offset:192
    ds_write_b128 v16, v[140:143] offset:512
    s_mov_b64 exec, s[32:33]
    s_lshl_b32 s25, s36, 8
    s_add_u32 s25, s25, 141568
    v_lshlrev_b32 v19, 3, v2
    v_add_u32 v19, s25, v19
    v_lshlrev_b32 v16, 4, v3
    v_add_u32 v16, 139264, v16
    s_lshr_b32 s34, s23, 5
    s_mul_i32 s34, s34, 18944
    s_bfe_u32 s35, s23, 0x20003
    s_mul_i32 s35, s35, 37888
    s_add_u32 s34, s34, s35
    s_and_b32 s35, s23, 7
    s_waitcnt lgkmcnt(0)
    s_barrier
    ds_read_b64 v[108:109], v19
    ds_read_b64 v[110:111], v19 offset:128
    ds_read_b128 v[148:151], v16 offset:0
    ds_read_b128 v[68:71], v16 offset:576
    ds_read_b128 v[88:91], v16 offset:1152
    ds_read_b128 v[168:171], v16 offset:1728
    ds_read_b128 v[152:155], v16 offset:64
    ds_read_b128 v[72:75], v16 offset:640
    ds_read_b128 v[92:95], v16 offset:1216
    ds_read_b128 v[172:175], v16 offset:1792
    ds_read_b128 v[156:159], v16 offset:128
    ds_read_b128 v[76:79], v16 offset:704
    ds_read_b128 v[96:99], v16 offset:1280
    ds_read_b128 v[176:179], v16 offset:1856
    ds_read_b128 v[160:163], v16 offset:192
    ds_read_b128 v[80:83], v16 offset:768
    ds_read_b128 v[100:103], v16 offset:1344
    ds_read_b128 v[180:183], v16 offset:1920
    ds_read_b128 v[164:167], v16 offset:512
    ds_read_b128 v[84:87], v16 offset:1088
    ds_read_b128 v[104:107], v16 offset:1664
    ds_read_b128 v[184:187], v16 offset:2240
    s_waitcnt lgkmcnt(15)
    v_add_f32 v148, v148, v68
    v_add_f32 v88, v88, v168
    v_add_f32 v149, v149, v69
    v_add_f32 v89, v89, v169
    v_add_f32 v150, v150, v70
    v_add_f32 v90, v90, v170
    v_add_f32 v151, v151, v71
    v_add_f32 v91, v91, v171
    v_add_f32 v148, v148, v88
    v_add_f32 v149, v149, v89
    v_add_f32 v150, v150, v90
    v_add_f32 v151, v151, v91
    v_mul_f32 v24, v109, v148
    v_mul_f32 v25, v109, v149
    v_mul_f32 v26, v109, v150
    v_mul_f32 v27, v109, v151
    v_fma_f32 v28, v28, v108, -v24
    v_fma_f32 v29, v29, v108, -v25
    v_fma_f32 v30, v30, v108, -v26
    v_fma_f32 v31, v31, v108, -v27
    v_mul_f32 v24, v111, v148
    v_mul_f32 v25, v111, v149
    v_mul_f32 v26, v111, v150
    v_mul_f32 v27, v111, v151
    v_fma_f32 v32, v32, v110, -v24
    v_fma_f32 v33, v33, v110, -v25
    v_fma_f32 v34, v34, v110, -v26
    v_fma_f32 v35, v35, v110, -v27
    s_waitcnt lgkmcnt(12)
    v_add_f32 v152, v152, v72
    v_add_f32 v92, v92, v172
    v_add_f32 v153, v153, v73
    v_add_f32 v93, v93, v173
    v_add_f32 v154, v154, v74
    v_add_f32 v94, v94, v174
    v_add_f32 v155, v155, v75
    v_add_f32 v95, v95, v175
    v_add_f32 v152, v152, v92
    v_add_f32 v153, v153, v93
    v_add_f32 v154, v154, v94
    v_add_f32 v155, v155, v95
    v_mul_f32 v24, v109, v152
    v_mul_f32 v25, v109, v153
    v_mul_f32 v26, v109, v154
    v_mul_f32 v27, v109, v155
    v_fma_f32 v36, v36, v108, -v24
    v_fma_f32 v37, v37, v108, -v25
    v_fma_f32 v38, v38, v108, -v26
    v_fma_f32 v39, v39, v108, -v27
    v_mul_f32 v24, v111, v152
    v_mul_f32 v25, v111, v153
    v_mul_f32 v26, v111, v154
    v_mul_f32 v27, v111, v155
    v_fma_f32 v40, v40, v110, -v24
    v_fma_f32 v41, v41, v110, -v25
    v_fma_f32 v42, v42, v110, -v26
    v_fma_f32 v43, v43, v110, -v27
    s_waitcnt lgkmcnt(8)
    v_add_f32 v156, v156, v76
    v_add_f32 v96, v96, v176
    v_add_f32 v157, v157, v77
    v_add_f32 v97, v97, v177
    v_add_f32 v158, v158, v78
    v_add_f32 v98, v98, v178
    v_add_f32 v159, v159, v79
    v_add_f32 v99, v99, v179
    v_add_f32 v156, v156, v96
    v_add_f32 v157, v157, v97
    v_add_f32 v158, v158, v98
    v_add_f32 v159, v159, v99
    v_mul_f32 v24, v109, v156
    v_mul_f32 v25, v109, v157
    v_mul_f32 v26, v109, v158
    v_mul_f32 v27, v109, v159
    v_fma_f32 v44, v44, v108, -v24
    v_fma_f32 v45, v45, v108, -v25
    v_fma_f32 v46, v46, v108, -v26
    v_fma_f32 v47, v47, v108, -v27
    v_mul_f32 v24, v111, v156
    v_mul_f32 v25, v111, v157
    v_mul_f32 v26, v111, v158
    v_mul_f32 v27, v111, v159
    v_fma_f32 v48, v48, v110, -v24
    v_fma_f32 v49, v49, v110, -v25
    v_fma_f32 v50, v50, v110, -v26
    v_fma_f32 v51, v51, v110, -v27
    s_waitcnt lgkmcnt(4)
    v_add_f32 v160, v160, v80
    v_add_f32 v100, v100, v180
    v_add_f32 v161, v161, v81
    v_add_f32 v101, v101, v181
    v_add_f32 v162, v162, v82
    v_add_f32 v102, v102, v182
    v_add_f32 v163, v163, v83
    v_add_f32 v103, v103, v183
    v_add_f32 v160, v160, v100
    v_add_f32 v161, v161, v101
    v_add_f32 v162, v162, v102
    v_add_f32 v163, v163, v103
    v_mul_f32 v24, v109, v160
    v_mul_f32 v25, v109, v161
    v_mul_f32 v26, v109, v162
    v_mul_f32 v27, v109, v163
    v_fma_f32 v52, v52, v108, -v24
    v_fma_f32 v53, v53, v108, -v25
    v_fma_f32 v54, v54, v108, -v26
    v_fma_f32 v55, v55, v108, -v27
    v_mul_f32 v24, v111, v160
    v_mul_f32 v25, v111, v161
    v_mul_f32 v26, v111, v162
    v_mul_f32 v27, v111, v163
    v_fma_f32 v56, v56, v110, -v24
    v_fma_f32 v57, v57, v110, -v25
    v_fma_f32 v58, v58, v110, -v26
    v_fma_f32 v59, v59, v110, -v27
    s_waitcnt lgkmcnt(0)
    v_add_f32 v164, v164, v84
    v_add_f32 v104, v104, v184
    v_add_f32 v165, v165, v85
    v_add_f32 v105, v105, v185
    v_add_f32 v166, v166, v86
    v_add_f32 v106, v106, v186
    v_add_f32 v167, v167, v87
    v_add_f32 v107, v107, v187
    v_add_f32 v164, v164, v104
    v_add_f32 v165, v165, v105
    v_add_f32 v166, v166, v106
    v_add_f32 v167, v167, v107
    v_mul_f32 v24, v109, v164
    v_mul_f32 v25, v109, v165
    v_mul_f32 v26, v109, v166
    v_mul_f32 v27, v109, v167
    v_fma_f32 v60, v60, v108, -v24
    v_fma_f32 v61, v61, v108, -v25
    v_fma_f32 v62, v62, v108, -v26
    v_fma_f32 v63, v63, v108, -v27
    v_mul_f32 v24, v111, v164
    v_mul_f32 v25, v111, v165
    v_mul_f32 v26, v111, v166
    v_mul_f32 v27, v111, v167
    v_fma_f32 v64, v64, v110, -v24
    v_fma_f32 v65, v65, v110, -v25
    v_fma_f32 v66, v66, v110, -v26
    v_fma_f32 v67, v67, v110, -v27
    s_cmp_ge_u32 s22, 4
    s_cbranch_scc1 k234_mid_kernel_a_qk0kst
    s_lshl_b32 s25, s22, 19
    s_lshl_b32 s26, s23, 10
    s_add_u32 s25, s25, s26
    s_add_u32 s25, s25, 0
    v_lshrrev_b32 v16, 1, v3
    v_lshlrev_b32 v16, 16, v16
    v_and_b32 v17, 1, v3
    v_lshl_add_u32 v16, v17, 9, v16
    v_lshl_add_u32 v16, v2, 4, v16
    v_cvt_pk_bf16_f32 v68, v28, v29
    v_cvt_pk_bf16_f32 v70, v36, v37
    v_cvt_pk_bf16_f32 v69, v30, v31
    v_cvt_pk_bf16_f32 v71, v38, v39
    buffer_store_dwordx4 v[68:71], v16, s[16:19], s25 offen offset:0 sc1
    v_cvt_pk_bf16_f32 v72, v32, v33
    v_cvt_pk_bf16_f32 v74, v40, v41
    v_cvt_pk_bf16_f32 v73, v34, v35
    v_cvt_pk_bf16_f32 v75, v42, v43
    buffer_store_dwordx4 v[72:75], v16, s[16:19], s25 offen offset:256 sc1
    s_add_u32 s25, s25, 131072
    v_cvt_pk_bf16_f32 v76, v44, v45
    v_cvt_pk_bf16_f32 v78, v52, v53
    v_cvt_pk_bf16_f32 v77, v46, v47
    v_cvt_pk_bf16_f32 v79, v54, v55
    buffer_store_dwordx4 v[76:79], v16, s[16:19], s25 offen offset:0 sc1
    v_cvt_pk_bf16_f32 v80, v48, v49
    v_cvt_pk_bf16_f32 v82, v56, v57
    v_cvt_pk_bf16_f32 v81, v50, v51
    v_cvt_pk_bf16_f32 v83, v58, v59
    buffer_store_dwordx4 v[80:83], v16, s[16:19], s25 offen offset:256 sc1
    s_lshl_b32 s25, s22, 16
    s_lshl_b32 s26, s23, 7
    s_add_u32 s25, s25, s26
    s_add_u32 s25, s25, 2097152
    s_add_u32 s26, s25, 8192
    v_lshlrev_b32 v16, 14, v3
    v_lshl_add_u32 v16, v2, 2, v16
    v_cvt_pk_bf16_f32 v84, v60, v61
    v_cvt_pk_bf16_f32 v85, v62, v63
    buffer_store_dword v84, v16, s[16:19], s25 offen offset:0 sc1
    buffer_store_dword v85, v16, s[16:19], s26 offen offset:0 sc1
    v_cvt_pk_bf16_f32 v86, v64, v65
    v_cvt_pk_bf16_f32 v87, v66, v67
    buffer_store_dword v86, v16, s[16:19], s25 offen offset:64 sc1
    buffer_store_dword v87, v16, s[16:19], s26 offen offset:64 sc1
    s_branch k234_mid_kernel_a_fin
k234_mid_kernel_a_qk0kst:
    s_sub_u32 s25, s22, 4
    s_mul_i32 s25, s25, 1212416
    s_add_u32 s25, s25, s34
    s_add_u32 s27, s25, 2359296
    s_lshl_b32 s26, s35, 10
    s_add_u32 s25, s27, s26
    s_add_u32 s25, s25, 0
    v_and_b32 v18, 7, v2
    v_lshrrev_b32 v19, 3, v2
    v_lshl_or_b32 v18, v19, 4, v18
    v_lshlrev_b32 v18, 4, v18
    v_lshrrev_b32 v16, 1, v3
    v_mul_u32_u24 v16, 151552, v16
    v_and_b32 v17, 1, v3
    v_lshl_add_u32 v16, v17, 9, v16
    v_add_u32 v16, v16, v18
    v_cvt_pk_bf16_f32 v68, v28, v29
    v_cvt_pk_bf16_f32 v70, v36, v37
    v_cvt_pk_bf16_f32 v69, v30, v31
    v_cvt_pk_bf16_f32 v71, v38, v39
    buffer_store_dwordx4 v[68:71], v16, s[16:19], s25 offen offset:0 sc1
    v_dot2_f32_bf16 v124, v68, v68, 0
    v_dot2_f32_bf16 v124, v69, v69, v124
    v_dot2_f32_bf16 v124, v70, v70, v124
    v_dot2_f32_bf16 v124, v71, v71, v124
    v_cvt_pk_bf16_f32 v72, v32, v33
    v_cvt_pk_bf16_f32 v74, v40, v41
    v_cvt_pk_bf16_f32 v73, v34, v35
    v_cvt_pk_bf16_f32 v75, v42, v43
    buffer_store_dwordx4 v[72:75], v16, s[16:19], s25 offen offset:128 sc1
    v_dot2_f32_bf16 v17, v72, v72, 0
    v_dot2_f32_bf16 v17, v73, v73, v17
    v_dot2_f32_bf16 v17, v74, v74, v17
    v_dot2_f32_bf16 v17, v75, v75, v17
    s_nop 2
    v_max_f32 v124, v124, v17
    s_add_u32 s25, s25, 303104
    v_cvt_pk_bf16_f32 v76, v44, v45
    v_cvt_pk_bf16_f32 v78, v52, v53
    v_cvt_pk_bf16_f32 v77, v46, v47
    v_cvt_pk_bf16_f32 v79, v54, v55
    buffer_store_dwordx4 v[76:79], v16, s[16:19], s25 offen offset:0 sc1
    v_dot2_f32_bf16 v125, v76, v76, 0
    v_dot2_f32_bf16 v125, v77, v77, v125
    v_dot2_f32_bf16 v125, v78, v78, v125
    v_dot2_f32_bf16 v125, v79, v79, v125
    v_cvt_pk_bf16_f32 v80, v48, v49
    v_cvt_pk_bf16_f32 v82, v56, v57
    v_cvt_pk_bf16_f32 v81, v50, v51
    v_cvt_pk_bf16_f32 v83, v58, v59
    buffer_store_dwordx4 v[80:83], v16, s[16:19], s25 offen offset:128 sc1
    v_dot2_f32_bf16 v17, v80, v80, 0
    v_dot2_f32_bf16 v17, v81, v81, v17
    v_dot2_f32_bf16 v17, v82, v82, v17
    v_dot2_f32_bf16 v17, v83, v83, v17
    s_nop 2
    v_max_f32 v125, v125, v17
    s_lshr_b32 s26, s35, 2
    s_lshl_b32 s26, s26, 9
    s_add_u32 s25, s27, s26
    s_and_b32 s27, s35, 3
    s_lshl_b32 s27, s27, 2
    s_add_u32 s25, s25, s27
    s_add_u32 s25, s25, 8192
    s_add_u32 s26, s25, 151552
    v_mul_u32_u24 v16, 303104, v3
    v_add_u32 v16, v16, v18
    s_sub_u32 s44, s25, s27
    s_mul_i32 s45, s20, 303104
    s_add_u32 s44, s44, s45
    v_lshlrev_b32 v16, 10, v3
    v_add3_u32 v16, v16, v18, s27
    v_cvt_pk_bf16_f32 v84, v60, v61
    v_cvt_pk_bf16_f32 v85, v62, v63
    ds_write_b32 v16, v84 offset:0
    ds_write_b32 v16, v85 offset:512
    v_dot2_f32_bf16 v126, v84, v84, 0
    v_dot2_f32_bf16 v127, v85, v85, 0
    v_cvt_pk_bf16_f32 v86, v64, v65
    v_cvt_pk_bf16_f32 v87, v66, v67
    ds_write_b32 v16, v86 offset:128
    ds_write_b32 v16, v87 offset:640
    v_dot2_f32_bf16 v17, v86, v86, 0
    s_nop 2
    v_max_f32 v126, v126, v17
    v_dot2_f32_bf16 v17, v87, v87, 0
    s_nop 2
    v_max_f32 v127, v127, v17
    v_max_f32_dpp v124, v124, v124 row_ror:8 row_mask:0xf bank_mask:0xf
    v_max_f32_dpp v125, v125, v125 row_ror:8 row_mask:0xf bank_mask:0xf
    v_max_f32_dpp v126, v126, v126 row_ror:8 row_mask:0xf bank_mask:0xf
    v_max_f32_dpp v127, v127, v127 row_ror:8 row_mask:0xf bank_mask:0xf
    v_max_f32_dpp v124, v124, v124 row_ror:4 row_mask:0xf bank_mask:0xf
    v_max_f32_dpp v125, v125, v125 row_ror:4 row_mask:0xf bank_mask:0xf
    v_max_f32_dpp v126, v126, v126 row_ror:4 row_mask:0xf bank_mask:0xf
    v_max_f32_dpp v127, v127, v127 row_ror:4 row_mask:0xf bank_mask:0xf
    v_max_f32_dpp v124, v124, v124 row_ror:2 row_mask:0xf bank_mask:0xf
    v_max_f32_dpp v125, v125, v125 row_ror:2 row_mask:0xf bank_mask:0xf
    v_max_f32_dpp v126, v126, v126 row_ror:2 row_mask:0xf bank_mask:0xf
    v_max_f32_dpp v127, v127, v127 row_ror:2 row_mask:0xf bank_mask:0xf
    v_max_f32_dpp v124, v124, v124 row_ror:1 row_mask:0xf bank_mask:0xf
    v_max_f32_dpp v125, v125, v125 row_ror:1 row_mask:0xf bank_mask:0xf
    v_max_f32_dpp v126, v126, v126 row_ror:1 row_mask:0xf bank_mask:0xf
    v_max_f32_dpp v127, v127, v127 row_ror:1 row_mask:0xf bank_mask:0xf
    s_lshl_b32 s26, s36, 4
    v_lshrrev_b32 v18, 1, v3
    v_lshlrev_b32 v18, 6, v18
    v_and_b32 v17, 1, v3
    v_lshl_add_u32 v18, v17, 2, v18
    v_add_u32 v18, s26, v18
    v_lshlrev_b32 v19, 7, v3
    v_add_u32 v19, s26, v19
    v_cmp_eq_u32 vcc, 0, v2
    s_nop 0
    s_and_saveexec_b64 s[32:33], vcc
    ds_write_b32 v18, v124 offset:4096
    ds_write_b32 v18, v125 offset:4224
    ds_write_b32 v19, v126 offset:4104
    ds_write_b32 v19, v127 offset:4168
    ds_write_b32 v19, v126 offset:4108
    ds_write_b32 v19, v127 offset:4172
    s_mov_b64 exec, -1
    s_waitcnt lgkmcnt(0)
    s_barrier
    s_lshl_b32 s45, s20, 10
    v_lshlrev_b32 v16, 4, v1
    v_add_u32 v16, s45, v16
    ds_read_b128 v[68:71], v16
    v_lshrrev_b32 v18, 5, v1
    v_mul_u32_u24 v18, 151552, v18
    v_and_b32 v19, 31, v1
    v_lshl_add_u32 v18, v19, 4, v18
    s_waitcnt lgkmcnt(0)
    buffer_store_dwordx4 v[68:71], v18, s[16:19], s44 offen sc1
    s_branch k234_mid_kernel_a_fin
k234_mid_kernel_a_qk1:
    ds_read_b128 v[108:111], v12 offset:18432
    ds_read_b128 v[112:115], v12 offset:20480
    ds_read_b64_tr_b16 v[68:69], v8 offset:144
    ds_read_b64_tr_b16 v[70:71], v8 offset:4752
    ds_read_b64_tr_b16 v[72:73], v8 offset:152
    ds_read_b64_tr_b16 v[74:75], v8 offset:4760
    ds_read_b64_tr_b16 v[76:77], v8 offset:216
    ds_read_b64_tr_b16 v[78:79], v8 offset:4824
    ds_read_b64_tr_b16 v[80:81], v8 offset:224
    ds_read_b64_tr_b16 v[82:83], v8 offset:4832
    s_waitcnt lgkmcnt(6)
    v_mfma_f32_16x16x32_bf16 v[28:31], v[68:71], v[108:111], 0
    ds_read_b128 v[116:119], v14 offset:18432
    ds_read_b128 v[120:123], v14 offset:20480
    s_add_u32 m0, s41, 69632
    s_nop 0
    buffer_load_dwordx4 v4, s[12:15], s38 offen lds
    v_mfma_f32_16x16x32_bf16 v[32:35], v[68:71], v[112:115], 0
    ds_read_b64_tr_b16 v[88:89], v8 offset:9360
    ds_read_b64_tr_b16 v[90:91], v8 offset:13968
    s_add_u32 m0, s41, 88064
    s_nop 0
    buffer_load_dwordx4 v7, s[8:11], s39 offen lds
    s_add_u32 s39, s39, 128
    s_waitcnt lgkmcnt(8)
    v_mfma_f32_16x16x32_bf16 v[36:39], v[72:75], v[108:111], 0
    ds_read_b64_tr_b16 v[92:93], v8 offset:9368
    ds_read_b64_tr_b16 v[94:95], v8 offset:13976
    s_add_u32 m0, s41, 77824
    s_nop 0
    buffer_load_dwordx4 v5, s[12:15], s38 offen lds
    v_mfma_f32_16x16x32_bf16 v[40:43], v[72:75], v[112:115], 0
    ds_read_b64_tr_b16 v[96:97], v8 offset:9432
    ds_read_b64_tr_b16 v[98:99], v8 offset:14040
    v_mfma_f32_16x16x32_bf16 v[20:23], v[144:147], v[112:115], v[20:23]
    s_waitcnt lgkmcnt(10)
    v_mfma_f32_16x16x32_bf16 v[44:47], v[76:79], v[108:111], 0
    ds_read_b64_tr_b16 v[100:101], v8 offset:9440
    ds_read_b64_tr_b16 v[102:103], v8 offset:14048
    s_add_u32 m0, s41, 96256
    s_nop 0
    buffer_load_dwordx4 v7, s[8:11], s40 offen lds
    s_add_u32 s40, s40, 128
    v_mfma_f32_16x16x32_bf16 v[48:51], v[76:79], v[112:115], 0
    v_mfma_f32_16x16x32_bf16 v[24:27], v[112:115], v[112:115], v[24:27]
    s_waitcnt lgkmcnt(10)
    v_mfma_f32_16x16x32_bf16 v[52:55], v[80:83], v[108:111], 0
    s_add_u32 s38, s38, 221184
    v_mfma_f32_16x16x32_bf16 v[56:59], v[80:83], v[112:115], 0
    s_add_u32 m0, s41, 104448
    s_nop 0
    buffer_load_dwordx4 v4, s[12:15], s38 offen lds
    s_cmp_lg_u32 s36, 0
    s_cbranch_scc1 k234_mid_kernel_a_qk1cs0
    v_mfma_f32_16x16x32_bf16 v[124:127], v[68:71], v[144:147], v[124:127]
    v_mfma_f32_16x16x32_bf16 v[128:131], v[72:75], v[144:147], v[128:131]
    v_mfma_f32_16x16x32_bf16 v[132:135], v[76:79], v[144:147], v[132:135]
    v_mfma_f32_16x16x32_bf16 v[136:139], v[80:83], v[144:147], v[136:139]
k234_mid_kernel_a_qk1cs0:
    s_waitcnt vmcnt(5)
    s_barrier
    s_waitcnt lgkmcnt(6)
    v_mfma_f32_16x16x32_bf16 v[28:31], v[88:91], v[116:119], v[28:31]
    ds_read_b128 v[108:111], v12 offset:53248
    ds_read_b128 v[112:115], v12 offset:55296
    v_mfma_f32_16x16x32_bf16 v[32:35], v[88:91], v[120:123], v[32:35]
    ds_read_b64_tr_b16 v[68:69], v8 offset:34960
    ds_read_b64_tr_b16 v[70:71], v8 offset:39568
    s_add_u32 m0, s41, 122880
    s_nop 0
    buffer_load_dwordx4 v7, s[8:11], s39 offen lds
    s_add_u32 s39, s39, 128
    s_waitcnt lgkmcnt(8)
    v_mfma_f32_16x16x32_bf16 v[36:39], v[92:95], v[116:119], v[36:39]
    ds_read_b64_tr_b16 v[72:73], v8 offset:34968
    ds_read_b64_tr_b16 v[74:75], v8 offset:39576
    v_mfma_f32_16x16x32_bf16 v[40:43], v[92:95], v[120:123], v[40:43]
    ds_read_b64_tr_b16 v[76:77], v8 offset:35032
    ds_read_b64_tr_b16 v[78:79], v8 offset:39640
    v_mfma_f32_16x16x32_bf16 v[20:23], v[144:147], v[120:123], v[20:23]
    s_waitcnt lgkmcnt(10)
    v_mfma_f32_16x16x32_bf16 v[44:47], v[96:99], v[116:119], v[44:47]
    ds_read_b64_tr_b16 v[80:81], v8 offset:35040
    ds_read_b64_tr_b16 v[82:83], v8 offset:39648
    s_add_u32 m0, s41, 112640
    s_nop 0
    buffer_load_dwordx4 v5, s[12:15], s38 offen lds
    v_mfma_f32_16x16x32_bf16 v[48:51], v[96:99], v[120:123], v[48:51]
    v_mfma_f32_16x16x32_bf16 v[24:27], v[120:123], v[120:123], v[24:27]
    s_waitcnt lgkmcnt(10)
    v_mfma_f32_16x16x32_bf16 v[52:55], v[100:103], v[116:119], v[52:55]
    v_mfma_f32_16x16x32_bf16 v[56:59], v[100:103], v[120:123], v[56:59]
    s_add_u32 m0, s41, 131072
    s_nop 0
    buffer_load_dwordx4 v7, s[8:11], s40 offen lds
    s_add_u32 s40, s40, 128
    s_cmp_lg_u32 s36, 1
    s_cbranch_scc1 k234_mid_kernel_a_qk1cs1
    v_mfma_f32_16x16x32_bf16 v[124:127], v[88:91], v[144:147], v[124:127]
    v_mfma_f32_16x16x32_bf16 v[128:131], v[92:95], v[144:147], v[128:131]
    v_mfma_f32_16x16x32_bf16 v[132:135], v[96:99], v[144:147], v[132:135]
    v_mfma_f32_16x16x32_bf16 v[136:139], v[100:103], v[144:147], v[136:139]
k234_mid_kernel_a_qk1cs1:
    s_waitcnt lgkmcnt(6)
    v_mfma_f32_16x16x32_bf16 v[28:31], v[68:71], v[108:111], v[28:31]
    ds_read_b128 v[116:119], v14 offset:53248
    ds_read_b128 v[120:123], v14 offset:55296
    v_mfma_f32_16x16x32_bf16 v[32:35], v[68:71], v[112:115], v[32:35]
    ds_read_b64_tr_b16 v[88:89], v8 offset:44176
    ds_read_b64_tr_b16 v[90:91], v8 offset:48784
    s_add_u32 s38, s38, 221184
    s_waitcnt lgkmcnt(8)
    v_mfma_f32_16x16x32_bf16 v[36:39], v[72:75], v[108:111], v[36:39]
    ds_read_b64_tr_b16 v[92:93], v8 offset:44184
    ds_read_b64_tr_b16 v[94:95], v8 offset:48792
    v_mfma_f32_16x16x32_bf16 v[40:43], v[72:75], v[112:115], v[40:43]
    ds_read_b64_tr_b16 v[96:97], v8 offset:44248
    ds_read_b64_tr_b16 v[98:99], v8 offset:48856
    v_mfma_f32_16x16x32_bf16 v[20:23], v[144:147], v[112:115], v[20:23]
    s_waitcnt lgkmcnt(10)
    v_mfma_f32_16x16x32_bf16 v[44:47], v[76:79], v[108:111], v[44:47]
    ds_read_b64_tr_b16 v[100:101], v8 offset:44256
    ds_read_b64_tr_b16 v[102:103], v8 offset:48864
    v_mfma_f32_16x16x32_bf16 v[48:51], v[76:79], v[112:115], v[48:51]
    v_mfma_f32_16x16x32_bf16 v[24:27], v[112:115], v[112:115], v[24:27]
    s_waitcnt lgkmcnt(10)
    v_mfma_f32_16x16x32_bf16 v[52:55], v[80:83], v[108:111], v[52:55]
    v_mfma_f32_16x16x32_bf16 v[56:59], v[80:83], v[112:115], v[56:59]
    s_cmp_lg_u32 s36, 2
    s_cbranch_scc1 k234_mid_kernel_a_qk1cs2
    v_mfma_f32_16x16x32_bf16 v[124:127], v[68:71], v[144:147], v[124:127]
    v_mfma_f32_16x16x32_bf16 v[128:131], v[72:75], v[144:147], v[128:131]
    v_mfma_f32_16x16x32_bf16 v[132:135], v[76:79], v[144:147], v[132:135]
    v_mfma_f32_16x16x32_bf16 v[136:139], v[80:83], v[144:147], v[136:139]
k234_mid_kernel_a_qk1cs2:
    s_waitcnt vmcnt(4)
    s_barrier
    s_waitcnt lgkmcnt(6)
    v_mfma_f32_16x16x32_bf16 v[28:31], v[88:91], v[116:119], v[28:31]
    ds_read_b128 v[108:111], v13 offset:18432
    ds_read_b128 v[112:115], v13 offset:20480
    v_mfma_f32_16x16x32_bf16 v[32:35], v[88:91], v[120:123], v[32:35]
    ds_read_b64_tr_b16 v[68:69], v9 offset:144
    ds_read_b64_tr_b16 v[70:71], v9 offset:4752
    s_add_u32 m0, s41, 0
    s_nop 0
    buffer_load_dwordx4 v4, s[12:15], s38 offen lds
    s_waitcnt lgkmcnt(8)
    v_mfma_f32_16x16x32_bf16 v[36:39], v[92:95], v[116:119], v[36:39]
    ds_read_b64_tr_b16 v[72:73], v9 offset:152
    ds_read_b64_tr_b16 v[74:75], v9 offset:4760
    v_mfma_f32_16x16x32_bf16 v[40:43], v[92:95], v[120:123], v[40:43]
    ds_read_b64_tr_b16 v[76:77], v9 offset:216
    ds_read_b64_tr_b16 v[78:79], v9 offset:4824
    v_mfma_f32_16x16x32_bf16 v[20:23], v[144:147], v[120:123], v[20:23]
    s_waitcnt lgkmcnt(10)
    v_mfma_f32_16x16x32_bf16 v[44:47], v[96:99], v[116:119], v[44:47]
    ds_read_b64_tr_b16 v[80:81], v9 offset:224
    ds_read_b64_tr_b16 v[82:83], v9 offset:4832
    s_add_u32 m0, s41, 18432
    s_nop 0
    buffer_load_dwordx4 v7, s[8:11], s39 offen lds
    s_add_u32 s39, s39, 128
    v_mfma_f32_16x16x32_bf16 v[48:51], v[96:99], v[120:123], v[48:51]
    v_mfma_f32_16x16x32_bf16 v[24:27], v[120:123], v[120:123], v[24:27]
    s_waitcnt lgkmcnt(10)
    v_mfma_f32_16x16x32_bf16 v[52:55], v[100:103], v[116:119], v[52:55]
    v_mfma_f32_16x16x32_bf16 v[56:59], v[100:103], v[120:123], v[56:59]
    s_add_u32 m0, s41, 8192
    s_nop 0
    buffer_load_dwordx4 v5, s[12:15], s38 offen lds
    s_cmp_lg_u32 s36, 3
    s_cbranch_scc1 k234_mid_kernel_a_qk1cs3
    v_mfma_f32_16x16x32_bf16 v[124:127], v[88:91], v[144:147], v[124:127]
    v_mfma_f32_16x16x32_bf16 v[128:131], v[92:95], v[144:147], v[128:131]
    v_mfma_f32_16x16x32_bf16 v[132:135], v[96:99], v[144:147], v[132:135]
    v_mfma_f32_16x16x32_bf16 v[136:139], v[100:103], v[144:147], v[136:139]
k234_mid_kernel_a_qk1cs3:
    s_waitcnt lgkmcnt(6)
    v_mfma_f32_16x16x32_bf16 v[28:31], v[68:71], v[108:111], v[28:31]
    ds_read_b128 v[116:119], v15 offset:18432
    ds_read_b128 v[120:123], v15 offset:20480
    v_mfma_f32_16x16x32_bf16 v[32:35], v[68:71], v[112:115], v[32:35]
    ds_read_b64_tr_b16 v[88:89], v9 offset:9360
    ds_read_b64_tr_b16 v[90:91], v9 offset:13968
    s_add_u32 m0, s41, 26624
    s_nop 0
    buffer_load_dwordx4 v7, s[8:11], s40 offen lds
    s_add_u32 s40, s40, 128
    s_waitcnt lgkmcnt(8)
    v_mfma_f32_16x16x32_bf16 v[36:39], v[72:75], v[108:111], v[36:39]
    ds_read_b64_tr_b16 v[92:93], v9 offset:9368
    ds_read_b64_tr_b16 v[94:95], v9 offset:13976
    v_mfma_f32_16x16x32_bf16 v[40:43], v[72:75], v[112:115], v[40:43]
    ds_read_b64_tr_b16 v[96:97], v9 offset:9432
    ds_read_b64_tr_b16 v[98:99], v9 offset:14040
    v_mfma_f32_16x16x32_bf16 v[20:23], v[144:147], v[112:115], v[20:23]
    s_waitcnt lgkmcnt(10)
    v_mfma_f32_16x16x32_bf16 v[44:47], v[76:79], v[108:111], v[44:47]
    ds_read_b64_tr_b16 v[100:101], v9 offset:9440
    ds_read_b64_tr_b16 v[102:103], v9 offset:14048
    s_add_u32 s38, s38, 221184
    v_mfma_f32_16x16x32_bf16 v[48:51], v[76:79], v[112:115], v[48:51]
    v_mfma_f32_16x16x32_bf16 v[24:27], v[112:115], v[112:115], v[24:27]
    s_waitcnt lgkmcnt(10)
    v_mfma_f32_16x16x32_bf16 v[52:55], v[80:83], v[108:111], v[52:55]
    v_mfma_f32_16x16x32_bf16 v[56:59], v[80:83], v[112:115], v[56:59]
    s_cmp_lg_u32 s36, 0
    s_cbranch_scc1 k234_mid_kernel_a_qk1cs4
    v_mfma_f32_16x16x32_bf16 v[124:127], v[68:71], v[144:147], v[124:127]
    v_mfma_f32_16x16x32_bf16 v[128:131], v[72:75], v[144:147], v[128:131]
    v_mfma_f32_16x16x32_bf16 v[132:135], v[76:79], v[144:147], v[132:135]
    v_mfma_f32_16x16x32_bf16 v[136:139], v[80:83], v[144:147], v[136:139]
k234_mid_kernel_a_qk1cs4:
    s_waitcnt vmcnt(4)
    s_barrier
    s_waitcnt lgkmcnt(6)
    v_mfma_f32_16x16x32_bf16 v[28:31], v[88:91], v[116:119], v[28:31]
    ds_read_b128 v[108:111], v13 offset:53248
    ds_read_b128 v[112:115], v13 offset:55296
    v_mfma_f32_16x16x32_bf16 v[32:35], v[88:91], v[120:123], v[32:35]
    ds_read_b64_tr_b16 v[68:69], v9 offset:34960
    ds_read_b64_tr_b16 v[70:71], v9 offset:39568
    s_add_u32 m0, s41, 34816
    s_nop 0
    buffer_load_dwordx4 v4, s[12:15], s38 offen lds
    s_waitcnt lgkmcnt(8)
    v_mfma_f32_16x16x32_bf16 v[36:39], v[92:95], v[116:119], v[36:39]
    ds_read_b64_tr_b16 v[72:73], v9 offset:34968
    ds_read_b64_tr_b16 v[74:75], v9 offset:39576
    v_mfma_f32_16x16x32_bf16 v[40:43], v[92:95], v[120:123], v[40:43]
    ds_read_b64_tr_b16 v[76:77], v9 offset:35032
    ds_read_b64_tr_b16 v[78:79], v9 offset:39640
    v_mfma_f32_16x16x32_bf16 v[20:23], v[144:147], v[120:123], v[20:23]
    s_waitcnt lgkmcnt(10)
    v_mfma_f32_16x16x32_bf16 v[44:47], v[96:99], v[116:119], v[44:47]
    ds_read_b64_tr_b16 v[80:81], v9 offset:35040
    ds_read_b64_tr_b16 v[82:83], v9 offset:39648
    s_add_u32 m0, s41, 53248
    s_nop 0
    buffer_load_dwordx4 v7, s[8:11], s39 offen lds
    s_add_u32 s39, s39, 128
    v_mfma_f32_16x16x32_bf16 v[48:51], v[96:99], v[120:123], v[48:51]
    v_mfma_f32_16x16x32_bf16 v[24:27], v[120:123], v[120:123], v[24:27]
    s_waitcnt lgkmcnt(10)
    v_mfma_f32_16x16x32_bf16 v[52:55], v[100:103], v[116:119], v[52:55]
    v_mfma_f32_16x16x32_bf16 v[56:59], v[100:103], v[120:123], v[56:59]
    s_add_u32 m0, s41, 43008
    s_nop 0
    buffer_load_dwordx4 v5, s[12:15], s38 offen lds
    s_cmp_lg_u32 s36, 1
    s_cbranch_scc1 k234_mid_kernel_a_qk1cs5
    v_mfma_f32_16x16x32_bf16 v[124:127], v[88:91], v[144:147], v[124:127]
    v_mfma_f32_16x16x32_bf16 v[128:131], v[92:95], v[144:147], v[128:131]
    v_mfma_f32_16x16x32_bf16 v[132:135], v[96:99], v[144:147], v[132:135]
    v_mfma_f32_16x16x32_bf16 v[136:139], v[100:103], v[144:147], v[136:139]
k234_mid_kernel_a_qk1cs5:
    s_waitcnt lgkmcnt(6)
    v_mfma_f32_16x16x32_bf16 v[28:31], v[68:71], v[108:111], v[28:31]
    ds_read_b128 v[116:119], v15 offset:53248
    ds_read_b128 v[120:123], v15 offset:55296
    v_mfma_f32_16x16x32_bf16 v[32:35], v[68:71], v[112:115], v[32:35]
    ds_read_b64_tr_b16 v[88:89], v9 offset:44176
    ds_read_b64_tr_b16 v[90:91], v9 offset:48784
    s_add_u32 m0, s41, 61440
    s_nop 0
    buffer_load_dwordx4 v7, s[8:11], s40 offen lds
    s_add_u32 s40, s40, 128
    s_waitcnt lgkmcnt(8)
    v_mfma_f32_16x16x32_bf16 v[36:39], v[72:75], v[108:111], v[36:39]
    ds_read_b64_tr_b16 v[92:93], v9 offset:44184
    ds_read_b64_tr_b16 v[94:95], v9 offset:48792
    v_mfma_f32_16x16x32_bf16 v[40:43], v[72:75], v[112:115], v[40:43]
    ds_read_b64_tr_b16 v[96:97], v9 offset:44248
    ds_read_b64_tr_b16 v[98:99], v9 offset:48856
    v_mfma_f32_16x16x32_bf16 v[20:23], v[144:147], v[112:115], v[20:23]
    s_waitcnt lgkmcnt(10)
    v_mfma_f32_16x16x32_bf16 v[44:47], v[76:79], v[108:111], v[44:47]
    ds_read_b64_tr_b16 v[100:101], v9 offset:44256
    ds_read_b64_tr_b16 v[102:103], v9 offset:48864
    s_add_u32 s38, s38, 221184
    v_mfma_f32_16x16x32_bf16 v[48:51], v[76:79], v[112:115], v[48:51]
    v_mfma_f32_16x16x32_bf16 v[24:27], v[112:115], v[112:115], v[24:27]
    s_waitcnt lgkmcnt(10)
    v_mfma_f32_16x16x32_bf16 v[52:55], v[80:83], v[108:111], v[52:55]
    v_mfma_f32_16x16x32_bf16 v[56:59], v[80:83], v[112:115], v[56:59]
    s_cmp_lg_u32 s36, 2
    s_cbranch_scc1 k234_mid_kernel_a_qk1cs6
    v_mfma_f32_16x16x32_bf16 v[124:127], v[68:71], v[144:147], v[124:127]
    v_mfma_f32_16x16x32_bf16 v[128:131], v[72:75], v[144:147], v[128:131]
    v_mfma_f32_16x16x32_bf16 v[132:135], v[76:79], v[144:147], v[132:135]
    v_mfma_f32_16x16x32_bf16 v[136:139], v[80:83], v[144:147], v[136:139]
k234_mid_kernel_a_qk1cs6:
    s_waitcnt vmcnt(4)
    s_barrier
    s_waitcnt lgkmcnt(6)
    v_mfma_f32_16x16x32_bf16 v[28:31], v[88:91], v[116:119], v[28:31]
    ds_read_b128 v[108:111], v12 offset:18432
    ds_read_b128 v[112:115], v12 offset:20480
    v_mfma_f32_16x16x32_bf16 v[32:35], v[88:91], v[120:123], v[32:35]
    ds_read_b64_tr_b16 v[68:69], v8 offset:144
    ds_read_b64_tr_b16 v[70:71], v8 offset:4752
    s_add_u32 m0, s41, 69632
    s_nop 0
    buffer_load_dwordx4 v4, s[12:15], s38 offen lds
    s_waitcnt lgkmcnt(8)
    v_mfma_f32_16x16x32_bf16 v[36:39], v[92:95], v[116:119], v[36:39]
    ds_read_b64_tr_b16 v[72:73], v8 offset:152
    ds_read_b64_tr_b16 v[74:75], v8 offset:4760
    v_mfma_f32_16x16x32_bf16 v[40:43], v[92:95], v[120:123], v[40:43]
    ds_read_b64_tr_b16 v[76:77], v8 offset:216
    ds_read_b64_tr_b16 v[78:79], v8 offset:4824
    v_mfma_f32_16x16x32_bf16 v[20:23], v[144:147], v[120:123], v[20:23]
    s_waitcnt lgkmcnt(10)
    v_mfma_f32_16x16x32_bf16 v[44:47], v[96:99], v[116:119], v[44:47]
    ds_read_b64_tr_b16 v[80:81], v8 offset:224
    ds_read_b64_tr_b16 v[82:83], v8 offset:4832
    s_add_u32 m0, s41, 88064
    s_nop 0
    buffer_load_dwordx4 v7, s[8:11], s39 offen lds
    s_add_u32 s39, s39, 128
    v_mfma_f32_16x16x32_bf16 v[48:51], v[96:99], v[120:123], v[48:51]
    v_mfma_f32_16x16x32_bf16 v[24:27], v[120:123], v[120:123], v[24:27]
    s_waitcnt lgkmcnt(10)
    v_mfma_f32_16x16x32_bf16 v[52:55], v[100:103], v[116:119], v[52:55]
    v_mfma_f32_16x16x32_bf16 v[56:59], v[100:103], v[120:123], v[56:59]
    s_add_u32 m0, s41, 77824
    s_nop 0
    buffer_load_dwordx4 v5, s[12:15], s38 offen lds
    s_cmp_lg_u32 s36, 3
    s_cbranch_scc1 k234_mid_kernel_a_qk1cs7
    v_mfma_f32_16x16x32_bf16 v[124:127], v[88:91], v[144:147], v[124:127]
    v_mfma_f32_16x16x32_bf16 v[128:131], v[92:95], v[144:147], v[128:131]
    v_mfma_f32_16x16x32_bf16 v[132:135], v[96:99], v[144:147], v[132:135]
    v_mfma_f32_16x16x32_bf16 v[136:139], v[100:103], v[144:147], v[136:139]
k234_mid_kernel_a_qk1cs7:
    s_waitcnt lgkmcnt(6)
    v_mfma_f32_16x16x32_bf16 v[28:31], v[68:71], v[108:111], v[28:31]
    ds_read_b128 v[116:119], v14 offset:18432
    ds_read_b128 v[120:123], v14 offset:20480
    v_mfma_f32_16x16x32_bf16 v[32:35], v[68:71], v[112:115], v[32:35]
    ds_read_b64_tr_b16 v[88:89], v8 offset:9360
    ds_read_b64_tr_b16 v[90:91], v8 offset:13968
    s_add_u32 m0, s41, 96256
    s_nop 0
    buffer_load_dwordx4 v7, s[8:11], s40 offen lds
    s_add_u32 s40, s40, 128
    s_waitcnt lgkmcnt(8)
    v_mfma_f32_16x16x32_bf16 v[36:39], v[72:75], v[108:111], v[36:39]
    ds_read_b64_tr_b16 v[92:93], v8 offset:9368
    ds_read_b64_tr_b16 v[94:95], v8 offset:13976
    v_mfma_f32_16x16x32_bf16 v[40:43], v[72:75], v[112:115], v[40:43]
    ds_read_b64_tr_b16 v[96:97], v8 offset:9432
    ds_read_b64_tr_b16 v[98:99], v8 offset:14040
    v_mfma_f32_16x16x32_bf16 v[20:23], v[144:147], v[112:115], v[20:23]
    s_waitcnt lgkmcnt(10)
    v_mfma_f32_16x16x32_bf16 v[44:47], v[76:79], v[108:111], v[44:47]
    ds_read_b64_tr_b16 v[100:101], v8 offset:9440
    ds_read_b64_tr_b16 v[102:103], v8 offset:14048
    s_add_u32 s38, s38, 221184
    v_mfma_f32_16x16x32_bf16 v[48:51], v[76:79], v[112:115], v[48:51]
    v_mfma_f32_16x16x32_bf16 v[24:27], v[112:115], v[112:115], v[24:27]
    s_waitcnt lgkmcnt(10)
    v_mfma_f32_16x16x32_bf16 v[52:55], v[80:83], v[108:111], v[52:55]
    v_mfma_f32_16x16x32_bf16 v[56:59], v[80:83], v[112:115], v[56:59]
    s_cmp_lg_u32 s36, 0
    s_cbranch_scc1 k234_mid_kernel_a_qk1cs8
    v_mfma_f32_16x16x32_bf16 v[124:127], v[68:71], v[144:147], v[124:127]
    v_mfma_f32_16x16x32_bf16 v[128:131], v[72:75], v[144:147], v[128:131]
    v_mfma_f32_16x16x32_bf16 v[132:135], v[76:79], v[144:147], v[132:135]
    v_mfma_f32_16x16x32_bf16 v[136:139], v[80:83], v[144:147], v[136:139]
k234_mid_kernel_a_qk1cs8:
    s_waitcnt vmcnt(4)
    s_barrier
    s_waitcnt lgkmcnt(6)
    v_mfma_f32_16x16x32_bf16 v[28:31], v[88:91], v[116:119], v[28:31]
    ds_read_b128 v[108:111], v12 offset:53248
    ds_read_b128 v[112:115], v12 offset:55296
    v_mfma_f32_16x16x32_bf16 v[32:35], v[88:91], v[120:123], v[32:35]
    ds_read_b64_tr_b16 v[68:69], v8 offset:34960
    ds_read_b64_tr_b16 v[70:71], v8 offset:39568
    s_add_u32 m0, s41, 104448
    s_nop 0
    buffer_load_dwordx4 v4, s[12:15], s38 offen lds
    s_waitcnt lgkmcnt(8)
    v_mfma_f32_16x16x32_bf16 v[36:39], v[92:95], v[116:119], v[36:39]
    ds_read_b64_tr_b16 v[72:73], v8 offset:34968
    ds_read_b64_tr_b16 v[74:75], v8 offset:39576
    v_mfma_f32_16x16x32_bf16 v[40:43], v[92:95], v[120:123], v[40:43]
    ds_read_b64_tr_b16 v[76:77], v8 offset:35032
    ds_read_b64_tr_b16 v[78:79], v8 offset:39640
    v_mfma_f32_16x16x32_bf16 v[20:23], v[144:147], v[120:123], v[20:23]
    s_waitcnt lgkmcnt(10)
    v_mfma_f32_16x16x32_bf16 v[44:47], v[96:99], v[116:119], v[44:47]
    ds_read_b64_tr_b16 v[80:81], v8 offset:35040
    ds_read_b64_tr_b16 v[82:83], v8 offset:39648
    s_add_u32 m0, s41, 122880
    s_nop 0
    buffer_load_dwordx4 v7, s[8:11], s39 offen lds
    s_add_u32 s39, s39, 128
    v_mfma_f32_16x16x32_bf16 v[48:51], v[96:99], v[120:123], v[48:51]
    v_mfma_f32_16x16x32_bf16 v[24:27], v[120:123], v[120:123], v[24:27]
    s_waitcnt lgkmcnt(10)
    v_mfma_f32_16x16x32_bf16 v[52:55], v[100:103], v[116:119], v[52:55]
    v_mfma_f32_16x16x32_bf16 v[56:59], v[100:103], v[120:123], v[56:59]
    s_add_u32 m0, s41, 112640
    s_nop 0
    buffer_load_dwordx4 v5, s[12:15], s38 offen lds
    s_cmp_lg_u32 s36, 1
    s_cbranch_scc1 k234_mid_kernel_a_qk1cs9
    v_mfma_f32_16x16x32_bf16 v[124:127], v[88:91], v[144:147], v[124:127]
    v_mfma_f32_16x16x32_bf16 v[128:131], v[92:95], v[144:147], v[128:131]
    v_mfma_f32_16x16x32_bf16 v[132:135], v[96:99], v[144:147], v[132:135]
    v_mfma_f32_16x16x32_bf16 v[136:139], v[100:103], v[144:147], v[136:139]
k234_mid_kernel_a_qk1cs9:
    s_waitcnt lgkmcnt(6)
    v_mfma_f32_16x16x32_bf16 v[28:31], v[68:71], v[108:111], v[28:31]
    ds_read_b128 v[116:119], v14 offset:53248
    ds_read_b128 v[120:123], v14 offset:55296
    v_mfma_f32_16x16x32_bf16 v[32:35], v[68:71], v[112:115], v[32:35]
    ds_read_b64_tr_b16 v[88:89], v8 offset:44176
    ds_read_b64_tr_b16 v[90:91], v8 offset:48784
    s_add_u32 m0, s41, 131072
    s_nop 0
    buffer_load_dwordx4 v7, s[8:11], s40 offen lds
    s_add_u32 s40, s40, 128
    s_waitcnt lgkmcnt(8)
    v_mfma_f32_16x16x32_bf16 v[36:39], v[72:75], v[108:111], v[36:39]
    ds_read_b64_tr_b16 v[92:93], v8 offset:44184
    ds_read_b64_tr_b16 v[94:95], v8 offset:48792
    v_mfma_f32_16x16x32_bf16 v[40:43], v[72:75], v[112:115], v[40:43]
    ds_read_b64_tr_b16 v[96:97], v8 offset:44248
    ds_read_b64_tr_b16 v[98:99], v8 offset:48856
    v_mfma_f32_16x16x32_bf16 v[20:23], v[144:147], v[112:115], v[20:23]
    s_waitcnt lgkmcnt(10)
    v_mfma_f32_16x16x32_bf16 v[44:47], v[76:79], v[108:111], v[44:47]
    ds_read_b64_tr_b16 v[100:101], v8 offset:44256
    ds_read_b64_tr_b16 v[102:103], v8 offset:48864
    s_add_u32 s38, s38, 221184
    v_mfma_f32_16x16x32_bf16 v[48:51], v[76:79], v[112:115], v[48:51]
    v_mfma_f32_16x16x32_bf16 v[24:27], v[112:115], v[112:115], v[24:27]
    s_waitcnt lgkmcnt(10)
    v_mfma_f32_16x16x32_bf16 v[52:55], v[80:83], v[108:111], v[52:55]
    v_mfma_f32_16x16x32_bf16 v[56:59], v[80:83], v[112:115], v[56:59]
    s_cmp_lg_u32 s36, 2
    s_cbranch_scc1 k234_mid_kernel_a_qk1cs10
    v_mfma_f32_16x16x32_bf16 v[124:127], v[68:71], v[144:147], v[124:127]
    v_mfma_f32_16x16x32_bf16 v[128:131], v[72:75], v[144:147], v[128:131]
    v_mfma_f32_16x16x32_bf16 v[132:135], v[76:79], v[144:147], v[132:135]
    v_mfma_f32_16x16x32_bf16 v[136:139], v[80:83], v[144:147], v[136:139]
k234_mid_kernel_a_qk1cs10:
    s_waitcnt vmcnt(4)
    s_barrier
    s_waitcnt lgkmcnt(6)
    v_mfma_f32_16x16x32_bf16 v[28:31], v[88:91], v[116:119], v[28:31]
    ds_read_b128 v[108:111], v13 offset:18432
    ds_read_b128 v[112:115], v13 offset:20480
    v_mfma_f32_16x16x32_bf16 v[32:35], v[88:91], v[120:123], v[32:35]
    ds_read_b64_tr_b16 v[68:69], v9 offset:144
    ds_read_b64_tr_b16 v[70:71], v9 offset:4752
    s_add_u32 m0, s41, 0
    s_nop 0
    buffer_load_dwordx4 v4, s[12:15], s38 offen lds
    s_waitcnt lgkmcnt(8)
    v_mfma_f32_16x16x32_bf16 v[36:39], v[92:95], v[116:119], v[36:39]
    ds_read_b64_tr_b16 v[72:73], v9 offset:152
    ds_read_b64_tr_b16 v[74:75], v9 offset:4760
    v_mfma_f32_16x16x32_bf16 v[40:43], v[92:95], v[120:123], v[40:43]
    ds_read_b64_tr_b16 v[76:77], v9 offset:216
    ds_read_b64_tr_b16 v[78:79], v9 offset:4824
    v_mfma_f32_16x16x32_bf16 v[20:23], v[144:147], v[120:123], v[20:23]
    s_waitcnt lgkmcnt(10)
    v_mfma_f32_16x16x32_bf16 v[44:47], v[96:99], v[116:119], v[44:47]
    ds_read_b64_tr_b16 v[80:81], v9 offset:224
    ds_read_b64_tr_b16 v[82:83], v9 offset:4832
    s_add_u32 m0, s41, 18432
    s_nop 0
    buffer_load_dwordx4 v7, s[8:11], s39 offen lds
    s_add_u32 s39, s39, 128
    v_mfma_f32_16x16x32_bf16 v[48:51], v[96:99], v[120:123], v[48:51]
    v_mfma_f32_16x16x32_bf16 v[24:27], v[120:123], v[120:123], v[24:27]
    s_waitcnt lgkmcnt(10)
    v_mfma_f32_16x16x32_bf16 v[52:55], v[100:103], v[116:119], v[52:55]
    v_mfma_f32_16x16x32_bf16 v[56:59], v[100:103], v[120:123], v[56:59]
    s_add_u32 m0, s41, 8192
    s_nop 0
    buffer_load_dwordx4 v5, s[12:15], s38 offen lds
    s_cmp_lg_u32 s36, 3
    s_cbranch_scc1 k234_mid_kernel_a_qk1cs11
    v_mfma_f32_16x16x32_bf16 v[124:127], v[88:91], v[144:147], v[124:127]
    v_mfma_f32_16x16x32_bf16 v[128:131], v[92:95], v[144:147], v[128:131]
    v_mfma_f32_16x16x32_bf16 v[132:135], v[96:99], v[144:147], v[132:135]
    v_mfma_f32_16x16x32_bf16 v[136:139], v[100:103], v[144:147], v[136:139]
k234_mid_kernel_a_qk1cs11:
    s_waitcnt lgkmcnt(6)
    v_mfma_f32_16x16x32_bf16 v[28:31], v[68:71], v[108:111], v[28:31]
    ds_read_b128 v[116:119], v15 offset:18432
    ds_read_b128 v[120:123], v15 offset:20480
    v_mfma_f32_16x16x32_bf16 v[32:35], v[68:71], v[112:115], v[32:35]
    ds_read_b64_tr_b16 v[88:89], v9 offset:9360
    ds_read_b64_tr_b16 v[90:91], v9 offset:13968
    s_add_u32 m0, s41, 26624
    s_nop 0
    buffer_load_dwordx4 v7, s[8:11], s40 offen lds
    s_add_u32 s40, s40, 128
    s_waitcnt lgkmcnt(8)
    v_mfma_f32_16x16x32_bf16 v[36:39], v[72:75], v[108:111], v[36:39]
    ds_read_b64_tr_b16 v[92:93], v9 offset:9368
    ds_read_b64_tr_b16 v[94:95], v9 offset:13976
    v_mfma_f32_16x16x32_bf16 v[40:43], v[72:75], v[112:115], v[40:43]
    ds_read_b64_tr_b16 v[96:97], v9 offset:9432
    ds_read_b64_tr_b16 v[98:99], v9 offset:14040
    v_mfma_f32_16x16x32_bf16 v[20:23], v[144:147], v[112:115], v[20:23]
    s_waitcnt lgkmcnt(10)
    v_mfma_f32_16x16x32_bf16 v[44:47], v[76:79], v[108:111], v[44:47]
    ds_read_b64_tr_b16 v[100:101], v9 offset:9440
    ds_read_b64_tr_b16 v[102:103], v9 offset:14048
    s_add_u32 s38, s38, 221184
    v_mfma_f32_16x16x32_bf16 v[48:51], v[76:79], v[112:115], v[48:51]
    v_mfma_f32_16x16x32_bf16 v[24:27], v[112:115], v[112:115], v[24:27]
    s_waitcnt lgkmcnt(10)
    v_mfma_f32_16x16x32_bf16 v[52:55], v[80:83], v[108:111], v[52:55]
    v_mfma_f32_16x16x32_bf16 v[56:59], v[80:83], v[112:115], v[56:59]
    s_cmp_lg_u32 s36, 0
    s_cbranch_scc1 k234_mid_kernel_a_qk1cs12
    v_mfma_f32_16x16x32_bf16 v[124:127], v[68:71], v[144:147], v[124:127]
    v_mfma_f32_16x16x32_bf16 v[128:131], v[72:75], v[144:147], v[128:131]
    v_mfma_f32_16x16x32_bf16 v[132:135], v[76:79], v[144:147], v[132:135]
    v_mfma_f32_16x16x32_bf16 v[136:139], v[80:83], v[144:147], v[136:139]
k234_mid_kernel_a_qk1cs12:
    s_waitcnt vmcnt(4)
    s_barrier
    s_waitcnt lgkmcnt(6)
    v_mfma_f32_16x16x32_bf16 v[28:31], v[88:91], v[116:119], v[28:31]
    ds_read_b128 v[108:111], v13 offset:53248
    ds_read_b128 v[112:115], v13 offset:55296
    v_mfma_f32_16x16x32_bf16 v[32:35], v[88:91], v[120:123], v[32:35]
    ds_read_b64_tr_b16 v[68:69], v9 offset:34960
    ds_read_b64_tr_b16 v[70:71], v9 offset:39568
    s_waitcnt lgkmcnt(8)
    v_mfma_f32_16x16x32_bf16 v[36:39], v[92:95], v[116:119], v[36:39]
    ds_read_b64_tr_b16 v[72:73], v9 offset:34968
    ds_read_b64_tr_b16 v[74:75], v9 offset:39576
    v_mfma_f32_16x16x32_bf16 v[40:43], v[92:95], v[120:123], v[40:43]
    ds_read_b64_tr_b16 v[76:77], v9 offset:35032
    ds_read_b64_tr_b16 v[78:79], v9 offset:39640
    v_mfma_f32_16x16x32_bf16 v[20:23], v[144:147], v[120:123], v[20:23]
    s_waitcnt lgkmcnt(10)
    v_mfma_f32_16x16x32_bf16 v[44:47], v[96:99], v[116:119], v[44:47]
    ds_read_b64_tr_b16 v[80:81], v9 offset:35040
    ds_read_b64_tr_b16 v[82:83], v9 offset:39648
    v_mfma_f32_16x16x32_bf16 v[48:51], v[96:99], v[120:123], v[48:51]
    v_mfma_f32_16x16x32_bf16 v[24:27], v[120:123], v[120:123], v[24:27]
    s_waitcnt lgkmcnt(10)
    v_mfma_f32_16x16x32_bf16 v[52:55], v[100:103], v[116:119], v[52:55]
    v_mfma_f32_16x16x32_bf16 v[56:59], v[100:103], v[120:123], v[56:59]
    s_cmp_lg_u32 s36, 1
    s_cbranch_scc1 k234_mid_kernel_a_qk1cs13
    v_mfma_f32_16x16x32_bf16 v[124:127], v[88:91], v[144:147], v[124:127]
    v_mfma_f32_16x16x32_bf16 v[128:131], v[92:95], v[144:147], v[128:131]
    v_mfma_f32_16x16x32_bf16 v[132:135], v[96:99], v[144:147], v[132:135]
    v_mfma_f32_16x16x32_bf16 v[136:139], v[100:103], v[144:147], v[136:139]
k234_mid_kernel_a_qk1cs13:
    s_waitcnt lgkmcnt(6)
    v_mfma_f32_16x16x32_bf16 v[28:31], v[68:71], v[108:111], v[28:31]
    ds_read_b128 v[116:119], v15 offset:53248
    ds_read_b128 v[120:123], v15 offset:55296
    v_mfma_f32_16x16x32_bf16 v[32:35], v[68:71], v[112:115], v[32:35]
    ds_read_b64_tr_b16 v[88:89], v9 offset:44176
    ds_read_b64_tr_b16 v[90:91], v9 offset:48784
    s_waitcnt lgkmcnt(8)
    v_mfma_f32_16x16x32_bf16 v[36:39], v[72:75], v[108:111], v[36:39]
    ds_read_b64_tr_b16 v[92:93], v9 offset:44184
    ds_read_b64_tr_b16 v[94:95], v9 offset:48792
    v_mfma_f32_16x16x32_bf16 v[40:43], v[72:75], v[112:115], v[40:43]
    ds_read_b64_tr_b16 v[96:97], v9 offset:44248
    ds_read_b64_tr_b16 v[98:99], v9 offset:48856
    v_mfma_f32_16x16x32_bf16 v[20:23], v[144:147], v[112:115], v[20:23]
    s_waitcnt lgkmcnt(10)
    v_mfma_f32_16x16x32_bf16 v[44:47], v[76:79], v[108:111], v[44:47]
    ds_read_b64_tr_b16 v[100:101], v9 offset:44256
    ds_read_b64_tr_b16 v[102:103], v9 offset:48864
    v_mfma_f32_16x16x32_bf16 v[48:51], v[76:79], v[112:115], v[48:51]
    v_mfma_f32_16x16x32_bf16 v[24:27], v[112:115], v[112:115], v[24:27]
    s_waitcnt lgkmcnt(10)
    v_mfma_f32_16x16x32_bf16 v[52:55], v[80:83], v[108:111], v[52:55]
    v_mfma_f32_16x16x32_bf16 v[56:59], v[80:83], v[112:115], v[56:59]
    s_cmp_lg_u32 s36, 2
    s_cbranch_scc1 k234_mid_kernel_a_qk1cs14
    v_mfma_f32_16x16x32_bf16 v[124:127], v[68:71], v[144:147], v[124:127]
    v_mfma_f32_16x16x32_bf16 v[128:131], v[72:75], v[144:147], v[128:131]
    v_mfma_f32_16x16x32_bf16 v[132:135], v[76:79], v[144:147], v[132:135]
    v_mfma_f32_16x16x32_bf16 v[136:139], v[80:83], v[144:147], v[136:139]
k234_mid_kernel_a_qk1cs14:
    s_waitcnt vmcnt(0)
    s_barrier
    s_waitcnt lgkmcnt(6)
    v_mfma_f32_16x16x32_bf16 v[28:31], v[88:91], v[116:119], v[28:31]
    ds_read_b128 v[108:111], v12 offset:18432
    ds_read_b128 v[112:115], v12 offset:20480
    v_mfma_f32_16x16x32_bf16 v[32:35], v[88:91], v[120:123], v[32:35]
    ds_read_b64_tr_b16 v[68:69], v8 offset:144
    ds_read_b64_tr_b16 v[70:71], v8 offset:4752
    s_waitcnt lgkmcnt(8)
    v_mfma_f32_16x16x32_bf16 v[36:39], v[92:95], v[116:119], v[36:39]
    ds_read_b64_tr_b16 v[72:73], v8 offset:152
    ds_read_b64_tr_b16 v[74:75], v8 offset:4760
    v_mfma_f32_16x16x32_bf16 v[40:43], v[92:95], v[120:123], v[40:43]
    ds_read_b64_tr_b16 v[76:77], v8 offset:216
    ds_read_b64_tr_b16 v[78:79], v8 offset:4824
    v_mfma_f32_16x16x32_bf16 v[20:23], v[144:147], v[120:123], v[20:23]
    s_waitcnt lgkmcnt(10)
    v_mfma_f32_16x16x32_bf16 v[44:47], v[96:99], v[116:119], v[44:47]
    ds_read_b64_tr_b16 v[80:81], v8 offset:224
    ds_read_b64_tr_b16 v[82:83], v8 offset:4832
    v_mfma_f32_16x16x32_bf16 v[48:51], v[96:99], v[120:123], v[48:51]
    v_mfma_f32_16x16x32_bf16 v[24:27], v[120:123], v[120:123], v[24:27]
    s_waitcnt lgkmcnt(10)
    v_mfma_f32_16x16x32_bf16 v[52:55], v[100:103], v[116:119], v[52:55]
    v_mfma_f32_16x16x32_bf16 v[56:59], v[100:103], v[120:123], v[56:59]
    s_cmp_lg_u32 s36, 3
    s_cbranch_scc1 k234_mid_kernel_a_qk1cs15
    v_mfma_f32_16x16x32_bf16 v[124:127], v[88:91], v[144:147], v[124:127]
    v_mfma_f32_16x16x32_bf16 v[128:131], v[92:95], v[144:147], v[128:131]
    v_mfma_f32_16x16x32_bf16 v[132:135], v[96:99], v[144:147], v[132:135]
    v_mfma_f32_16x16x32_bf16 v[136:139], v[100:103], v[144:147], v[136:139]
k234_mid_kernel_a_qk1cs15:
    s_waitcnt lgkmcnt(6)
    v_mfma_f32_16x16x32_bf16 v[28:31], v[68:71], v[108:111], v[28:31]
    ds_read_b128 v[116:119], v14 offset:18432
    ds_read_b128 v[120:123], v14 offset:20480
    v_mfma_f32_16x16x32_bf16 v[32:35], v[68:71], v[112:115], v[32:35]
    ds_read_b64_tr_b16 v[88:89], v8 offset:9360
    ds_read_b64_tr_b16 v[90:91], v8 offset:13968
    s_waitcnt lgkmcnt(8)
    v_mfma_f32_16x16x32_bf16 v[36:39], v[72:75], v[108:111], v[36:39]
    ds_read_b64_tr_b16 v[92:93], v8 offset:9368
    ds_read_b64_tr_b16 v[94:95], v8 offset:13976
    v_mfma_f32_16x16x32_bf16 v[40:43], v[72:75], v[112:115], v[40:43]
    ds_read_b64_tr_b16 v[96:97], v8 offset:9432
    ds_read_b64_tr_b16 v[98:99], v8 offset:14040
    v_mfma_f32_16x16x32_bf16 v[20:23], v[144:147], v[112:115], v[20:23]
    s_waitcnt lgkmcnt(10)
    v_mfma_f32_16x16x32_bf16 v[44:47], v[76:79], v[108:111], v[44:47]
    ds_read_b64_tr_b16 v[100:101], v8 offset:9440
    ds_read_b64_tr_b16 v[102:103], v8 offset:14048
    v_mfma_f32_16x16x32_bf16 v[48:51], v[76:79], v[112:115], v[48:51]
    v_mfma_f32_16x16x32_bf16 v[24:27], v[112:115], v[112:115], v[24:27]
    s_waitcnt lgkmcnt(10)
    v_mfma_f32_16x16x32_bf16 v[52:55], v[80:83], v[108:111], v[52:55]
    v_mfma_f32_16x16x32_bf16 v[56:59], v[80:83], v[112:115], v[56:59]
    s_cmp_lg_u32 s36, 0
    s_cbranch_scc1 k234_mid_kernel_a_qk1cs16
    v_mfma_f32_16x16x32_bf16 v[124:127], v[68:71], v[144:147], v[124:127]
    v_mfma_f32_16x16x32_bf16 v[128:131], v[72:75], v[144:147], v[128:131]
    v_mfma_f32_16x16x32_bf16 v[132:135], v[76:79], v[144:147], v[132:135]
    v_mfma_f32_16x16x32_bf16 v[136:139], v[80:83], v[144:147], v[136:139]
k234_mid_kernel_a_qk1cs16:
    s_waitcnt lgkmcnt(6)
    v_mfma_f32_16x16x32_bf16 v[28:31], v[88:91], v[116:119], v[28:31]
    v_mfma_f32_16x16x32_bf16 v[32:35], v[88:91], v[120:123], v[32:35]
    s_waitcnt lgkmcnt(4)
    v_mfma_f32_16x16x32_bf16 v[36:39], v[92:95], v[116:119], v[36:39]
    v_mfma_f32_16x16x32_bf16 v[40:43], v[92:95], v[120:123], v[40:43]
    v_mfma_f32_16x16x32_bf16 v[20:23], v[144:147], v[120:123], v[20:23]
    s_waitcnt lgkmcnt(2)
    v_mfma_f32_16x16x32_bf16 v[44:47], v[96:99], v[116:119], v[44:47]
    v_mfma_f32_16x16x32_bf16 v[48:51], v[96:99], v[120:123], v[48:51]
    v_mfma_f32_16x16x32_bf16 v[24:27], v[120:123], v[120:123], v[24:27]
    s_waitcnt lgkmcnt(0)
    v_mfma_f32_16x16x32_bf16 v[52:55], v[100:103], v[116:119], v[52:55]
    v_mfma_f32_16x16x32_bf16 v[56:59], v[100:103], v[120:123], v[56:59]
    s_cmp_lg_u32 s36, 1
    s_cbranch_scc1 k234_mid_kernel_a_qk1cs17
    v_mfma_f32_16x16x32_bf16 v[124:127], v[88:91], v[144:147], v[124:127]
    v_mfma_f32_16x16x32_bf16 v[128:131], v[92:95], v[144:147], v[128:131]
    v_mfma_f32_16x16x32_bf16 v[132:135], v[96:99], v[144:147], v[132:135]
    v_mfma_f32_16x16x32_bf16 v[136:139], v[100:103], v[144:147], v[136:139]
k234_mid_kernel_a_qk1cs17:
    s_nop 5
    v_and_b32 v17, 1, v2
    v_cmp_eq_u32 vcc, 1, v17
    s_nop 1
    v_cndmask_b32 v24, v24, v25, vcc
    v_cndmask_b32 v26, v26, v27, vcc
    v_and_b32 v17, 2, v2
    v_cmp_eq_u32 vcc, 2, v17
    s_nop 1
    v_cndmask_b32 v24, v24, v26, vcc
    v_lshrrev_b32 v17, 2, v2
    v_cmp_eq_u32 vcc, v17, v3
    s_nop 1
    v_cndmask_b32 v22, 0, v24, vcc
    v_mov_b32 v17, v22
    s_nop 1
    v_permlane32_swap_b32 v22, v17
    v_add_f32 v22, v22, v17
    v_mov_b32 v17, v22
    s_nop 1
    v_permlane16_swap_b32 v22, v17
    v_add_f32 v22, v22, v17
    v_mul_f32 v20, 0x3ae38e39, v20
    v_mul_f32 v17, v20, v20
    v_mov_b32 v18, 0x3ae38e39
    v_fma_f32 v22, v22, v18, -v17
    v_max_f32 v22, 0, v22
    v_add_f32 v22, 0x3727c5ac, v22
    v_rsq_f32 v22, v22
    s_mul_i32 s25, s36, 576
    v_lshlrev_b32 v16, 4, v3
    v_add_u32 v16, s25, v16
    v_add_u32 v16, 139264, v16
    s_lshl_b32 s25, s36, 8
    s_add_u32 s25, s25, 141696
    v_lshlrev_b32 v19, 3, v2
    v_add_u32 v19, s25, v19
    s_cmp_ge_u32 s22, 4
    s_cbranch_scc1 k234_mid_kernel_a_qk1noq
    v_mul_f32 v22, 0x3eae1a93, v22
    s_cmp_lg_u32 s22, 0
    s_cbranch_scc1 k234_mid_kernel_a_qk1noq
    s_lshl_b32 s25, s23, 7
    s_add_u32 s25, s25, 7241792
    v_lshlrev_b32 v17, 2, v2
    buffer_store_dword v20, v17, s[16:19], s25 offen sc1
k234_mid_kernel_a_qk1noq:
    s_nop 1
    v_mul_f32 v23, v20, v22
    ds_write_b64 v19, v[22:23]
    v_cmp_eq_u32 vcc, 0, v2
    s_nop 0
    s_and_saveexec_b64 s[32:33], vcc
    ds_write_b128 v16, v[124:127] offset:256
    ds_write_b128 v16, v[128:131] offset:320
    ds_write_b128 v16, v[132:135] offset:384
    ds_write_b128 v16, v[136:139] offset:448
    s_mov_b64 exec, s[32:33]
    s_lshl_b32 s25, s36, 8
    s_add_u32 s25, s25, 141568
    v_lshlrev_b32 v19, 3, v2
    v_add_u32 v19, s25, v19
    v_lshlrev_b32 v16, 4, v3
    v_add_u32 v16, 139264, v16
    s_lshr_b32 s34, s23, 5
    s_mul_i32 s34, s34, 18944
    s_bfe_u32 s35, s23, 0x20003
    s_mul_i32 s35, s35, 37888
    s_add_u32 s34, s34, s35
    s_and_b32 s35, s23, 7
    s_waitcnt lgkmcnt(0)
    s_barrier
    ds_read_b64 v[108:109], v19
    ds_read_b64 v[110:111], v19 offset:128
    ds_read_b128 v[148:151], v16 offset:256
    ds_read_b128 v[68:71], v16 offset:832
    ds_read_b128 v[88:91], v16 offset:1408
    ds_read_b128 v[168:171], v16 offset:1984
    ds_read_b128 v[152:155], v16 offset:320
    ds_read_b128 v[72:75], v16 offset:896
    ds_read_b128 v[92:95], v16 offset:1472
    ds_read_b128 v[172:175], v16 offset:2048
    ds_read_b128 v[156:159], v16 offset:384
    ds_read_b128 v[76:79], v16 offset:960
    ds_read_b128 v[96:99], v16 offset:1536
    ds_read_b128 v[176:179], v16 offset:2112
    ds_read_b128 v[160:163], v16 offset:448
    ds_read_b128 v[80:83], v16 offset:1024
    ds_read_b128 v[100:103], v16 offset:1600
    ds_read_b128 v[180:183], v16 offset:2176
    s_waitcnt lgkmcnt(12)
    v_add_f32 v148, v148, v68
    v_add_f32 v88, v88, v168
    v_add_f32 v149, v149, v69
    v_add_f32 v89, v89, v169
    v_add_f32 v150, v150, v70
    v_add_f32 v90, v90, v170
    v_add_f32 v151, v151, v71
    v_add_f32 v91, v91, v171
    v_add_f32 v148, v148, v88
    v_add_f32 v149, v149, v89
    v_add_f32 v150, v150, v90
    v_add_f32 v151, v151, v91
    v_mul_f32 v24, v109, v148
    v_mul_f32 v25, v109, v149
    v_mul_f32 v26, v109, v150
    v_mul_f32 v27, v109, v151
    v_fma_f32 v28, v28, v108, -v24
    v_fma_f32 v29, v29, v108, -v25
    v_fma_f32 v30, v30, v108, -v26
    v_fma_f32 v31, v31, v108, -v27
    v_mul_f32 v24, v111, v148
    v_mul_f32 v25, v111, v149
    v_mul_f32 v26, v111, v150
    v_mul_f32 v27, v111, v151
    v_fma_f32 v32, v32, v110, -v24
    v_fma_f32 v33, v33, v110, -v25
    v_fma_f32 v34, v34, v110, -v26
    v_fma_f32 v35, v35, v110, -v27
    s_waitcnt lgkmcnt(8)
    v_add_f32 v152, v152, v72
    v_add_f32 v92, v92, v172
    v_add_f32 v153, v153, v73
    v_add_f32 v93, v93, v173
    v_add_f32 v154, v154, v74
    v_add_f32 v94, v94, v174
    v_add_f32 v155, v155, v75
    v_add_f32 v95, v95, v175
    v_add_f32 v152, v152, v92
    v_add_f32 v153, v153, v93
    v_add_f32 v154, v154, v94
    v_add_f32 v155, v155, v95
    v_mul_f32 v24, v109, v152
    v_mul_f32 v25, v109, v153
    v_mul_f32 v26, v109, v154
    v_mul_f32 v27, v109, v155
    v_fma_f32 v36, v36, v108, -v24
    v_fma_f32 v37, v37, v108, -v25
    v_fma_f32 v38, v38, v108, -v26
    v_fma_f32 v39, v39, v108, -v27
    v_mul_f32 v24, v111, v152
    v_mul_f32 v25, v111, v153
    v_mul_f32 v26, v111, v154
    v_mul_f32 v27, v111, v155
    v_fma_f32 v40, v40, v110, -v24
    v_fma_f32 v41, v41, v110, -v25
    v_fma_f32 v42, v42, v110, -v26
    v_fma_f32 v43, v43, v110, -v27
    s_waitcnt lgkmcnt(4)
    v_add_f32 v156, v156, v76
    v_add_f32 v96, v96, v176
    v_add_f32 v157, v157, v77
    v_add_f32 v97, v97, v177
    v_add_f32 v158, v158, v78
    v_add_f32 v98, v98, v178
    v_add_f32 v159, v159, v79
    v_add_f32 v99, v99, v179
    v_add_f32 v156, v156, v96
    v_add_f32 v157, v157, v97
    v_add_f32 v158, v158, v98
    v_add_f32 v159, v159, v99
    v_mul_f32 v24, v109, v156
    v_mul_f32 v25, v109, v157
    v_mul_f32 v26, v109, v158
    v_mul_f32 v27, v109, v159
    v_fma_f32 v44, v44, v108, -v24
    v_fma_f32 v45, v45, v108, -v25
    v_fma_f32 v46, v46, v108, -v26
    v_fma_f32 v47, v47, v108, -v27
    v_mul_f32 v24, v111, v156
    v_mul_f32 v25, v111, v157
    v_mul_f32 v26, v111, v158
    v_mul_f32 v27, v111, v159
    v_fma_f32 v48, v48, v110, -v24
    v_fma_f32 v49, v49, v110, -v25
    v_fma_f32 v50, v50, v110, -v26
    v_fma_f32 v51, v51, v110, -v27
    s_waitcnt lgkmcnt(0)
    v_add_f32 v160, v160, v80
    v_add_f32 v100, v100, v180
    v_add_f32 v161, v161, v81
    v_add_f32 v101, v101, v181
    v_add_f32 v162, v162, v82
    v_add_f32 v102, v102, v182
    v_add_f32 v163, v163, v83
    v_add_f32 v103, v103, v183
    v_add_f32 v160, v160, v100
    v_add_f32 v161, v161, v101
    v_add_f32 v162, v162, v102
    v_add_f32 v163, v163, v103
    v_mul_f32 v24, v109, v160
    v_mul_f32 v25, v109, v161
    v_mul_f32 v26, v109, v162
    v_mul_f32 v27, v109, v163
    v_fma_f32 v52, v52, v108, -v24
    v_fma_f32 v53, v53, v108, -v25
    v_fma_f32 v54, v54, v108, -v26
    v_fma_f32 v55, v55, v108, -v27
    v_mul_f32 v24, v111, v160
    v_mul_f32 v25, v111, v161
    v_mul_f32 v26, v111, v162
    v_mul_f32 v27, v111, v163
    v_fma_f32 v56, v56, v110, -v24
    v_fma_f32 v57, v57, v110, -v25
    v_fma_f32 v58, v58, v110, -v26
    v_fma_f32 v59, v59, v110, -v27
    s_cmp_ge_u32 s22, 4
    s_cbranch_scc1 k234_mid_kernel_a_qk1kst
    s_lshl_b32 s25, s22, 19
    s_lshl_b32 s26, s23, 10
    s_add_u32 s25, s25, s26
    s_add_u32 s25, s25, 262144
    v_lshrrev_b32 v16, 1, v3
    v_lshlrev_b32 v16, 16, v16
    v_and_b32 v17, 1, v3
    v_lshl_add_u32 v16, v17, 9, v16
    v_lshl_add_u32 v16, v2, 4, v16
    v_cvt_pk_bf16_f32 v68, v28, v29
    v_cvt_pk_bf16_f32 v70, v36, v37
    v_cvt_pk_bf16_f32 v69, v30, v31
    v_cvt_pk_bf16_f32 v71, v38, v39
    buffer_store_dwordx4 v[68:71], v16, s[16:19], s25 offen offset:0 sc1
    v_cvt_pk_bf16_f32 v72, v32, v33
    v_cvt_pk_bf16_f32 v74, v40, v41
    v_cvt_pk_bf16_f32 v73, v34, v35
    v_cvt_pk_bf16_f32 v75, v42, v43
    buffer_store_dwordx4 v[72:75], v16, s[16:19], s25 offen offset:256 sc1
    s_add_u32 s25, s25, 131072
    v_cvt_pk_bf16_f32 v76, v44, v45
    v_cvt_pk_bf16_f32 v78, v52, v53
    v_cvt_pk_bf16_f32 v77, v46, v47
    v_cvt_pk_bf16_f32 v79, v54, v55
    buffer_store_dwordx4 v[76:79], v16, s[16:19], s25 offen offset:0 sc1
    v_cvt_pk_bf16_f32 v80, v48, v49
    v_cvt_pk_bf16_f32 v82, v56, v57
    v_cvt_pk_bf16_f32 v81, v50, v51
    v_cvt_pk_bf16_f32 v83, v58, v59
    buffer_store_dwordx4 v[80:83], v16, s[16:19], s25 offen offset:256 sc1
    s_branch k234_mid_kernel_a_fin
k234_mid_kernel_a_qk1kst:
    s_sub_u32 s25, s22, 4
    s_mul_i32 s25, s25, 1212416
    s_add_u32 s25, s25, s34
    s_add_u32 s27, s25, 2359296
    s_lshl_b32 s26, s35, 10
    s_add_u32 s25, s27, s26
    s_add_u32 s25, s25, 606208
    v_and_b32 v18, 7, v2
    v_lshrrev_b32 v19, 3, v2
    v_lshl_or_b32 v18, v19, 4, v18
    v_lshlrev_b32 v18, 4, v18
    v_lshrrev_b32 v16, 1, v3
    v_mul_u32_u24 v16, 151552, v16
    v_and_b32 v17, 1, v3
    v_lshl_add_u32 v16, v17, 9, v16
    v_add_u32 v16, v16, v18
    v_cvt_pk_bf16_f32 v68, v28, v29
    v_cvt_pk_bf16_f32 v70, v36, v37
    v_cvt_pk_bf16_f32 v69, v30, v31
    v_cvt_pk_bf16_f32 v71, v38, v39
    buffer_store_dwordx4 v[68:71], v16, s[16:19], s25 offen offset:0 sc1
    v_dot2_f32_bf16 v124, v68, v68, 0
    v_dot2_f32_bf16 v124, v69, v69, v124
    v_dot2_f32_bf16 v124, v70, v70, v124
    v_dot2_f32_bf16 v124, v71, v71, v124
    v_cvt_pk_bf16_f32 v72, v32, v33
    v_cvt_pk_bf16_f32 v74, v40, v41
    v_cvt_pk_bf16_f32 v73, v34, v35
    v_cvt_pk_bf16_f32 v75, v42, v43
    buffer_store_dwordx4 v[72:75], v16, s[16:19], s25 offen offset:128 sc1
    v_dot2_f32_bf16 v17, v72, v72, 0
    v_dot2_f32_bf16 v17, v73, v73, v17
    v_dot2_f32_bf16 v17, v74, v74, v17
    v_dot2_f32_bf16 v17, v75, v75, v17
    s_nop 2
    v_max_f32 v124, v124, v17
    s_add_u32 s25, s25, 303104
    v_cvt_pk_bf16_f32 v76, v44, v45
    v_cvt_pk_bf16_f32 v78, v52, v53
    v_cvt_pk_bf16_f32 v77, v46, v47
    v_cvt_pk_bf16_f32 v79, v54, v55
    buffer_store_dwordx4 v[76:79], v16, s[16:19], s25 offen offset:0 sc1
    v_dot2_f32_bf16 v125, v76, v76, 0
    v_dot2_f32_bf16 v125, v77, v77, v125
    v_dot2_f32_bf16 v125, v78, v78, v125
    v_dot2_f32_bf16 v125, v79, v79, v125
    v_cvt_pk_bf16_f32 v80, v48, v49
    v_cvt_pk_bf16_f32 v82, v56, v57
    v_cvt_pk_bf16_f32 v81, v50, v51
    v_cvt_pk_bf16_f32 v83, v58, v59
    buffer_store_dwordx4 v[80:83], v16, s[16:19], s25 offen offset:128 sc1
    v_dot2_f32_bf16 v17, v80, v80, 0
    v_dot2_f32_bf16 v17, v81, v81, v17
    v_dot2_f32_bf16 v17, v82, v82, v17
    v_dot2_f32_bf16 v17, v83, v83, v17
    s_nop 2
    v_max_f32 v125, v125, v17
    v_max_f32_dpp v124, v124, v124 row_ror:8 row_mask:0xf bank_mask:0xf
    s_nop 0
    v_max_f32_dpp v125, v125, v125 row_ror:8 row_mask:0xf bank_mask:0xf
    v_max_f32_dpp v124, v124, v124 row_ror:4 row_mask:0xf bank_mask:0xf
    s_nop 0
    v_max_f32_dpp v125, v125, v125 row_ror:4 row_mask:0xf bank_mask:0xf
    v_max_f32_dpp v124, v124, v124 row_ror:2 row_mask:0xf bank_mask:0xf
    s_nop 0
    v_max_f32_dpp v125, v125, v125 row_ror:2 row_mask:0xf bank_mask:0xf
    v_max_f32_dpp v124, v124, v124 row_ror:1 row_mask:0xf bank_mask:0xf
    s_nop 0
    v_max_f32_dpp v125, v125, v125 row_ror:1 row_mask:0xf bank_mask:0xf
    s_lshl_b32 s26, s36, 4
    v_lshrrev_b32 v18, 1, v3
    v_lshlrev_b32 v18, 6, v18
    v_and_b32 v17, 1, v3
    v_lshl_add_u32 v18, v17, 2, v18
    v_add_u32 v18, s26, v18
    v_lshlrev_b32 v19, 7, v3
    v_add_u32 v19, s26, v19
    v_cmp_eq_u32 vcc, 0, v2
    s_nop 0
    s_and_saveexec_b64 s[32:33], vcc
    ds_write_b32 v18, v124 offset:4352
    ds_write_b32 v18, v125 offset:4480
    s_mov_b64 exec, -1
    s_waitcnt lgkmcnt(0)
    s_barrier
    s_cmp_lg_u32 s36, 0
    s_cbranch_scc1 k234_mid_kernel_a_fin
    v_lshlrev_b32 v16, 4, v1
    ds_read_b128 v[68:71], v16 offset:4096
    s_sub_u32 s25, s22, 4
    s_lshl_b32 s25, s25, 4
    s_add_u32 s25, s25, s21
    s_lshl_b32 s25, s25, 9
    s_add_u32 s25, s25, 7208960
    s_mov_b32 exec_hi, 0
    s_waitcnt lgkmcnt(0)
    buffer_store_dwordx4 v[68:71], v16, s[16:19], s25 offen sc1
    s_branch k234_mid_kernel_a_fin
k234_mid_kernel_a_v:
    s_cmp_lg_u32 s37, 0
    s_cbranch_scc1 k234_mid_kernel_a_v1
    ds_read_b128 v[108:111], v12 offset:18432
    ds_read_b128 v[112:115], v12 offset:20480
    ds_read_b64_tr_b16 v[68:69], v8 offset:0
    ds_read_b64_tr_b16 v[70:71], v8 offset:4608
    ds_read_b64_tr_b16 v[72:73], v8 offset:32
    ds_read_b64_tr_b16 v[74:75], v8 offset:4640
    ds_read_b64_tr_b16 v[76:77], v8 offset:64
    ds_read_b64_tr_b16 v[78:79], v8 offset:4672
    ds_read_b64_tr_b16 v[80:81], v8 offset:96
    ds_read_b64_tr_b16 v[82:83], v8 offset:4704
    ds_read_b64_tr_b16 v[84:85], v8 offset:128
    ds_read_b64_tr_b16 v[86:87], v8 offset:4736
    s_waitcnt lgkmcnt(8)
    v_mfma_f32_16x16x32_bf16 v[28:31], v[108:111], v[68:71], 0
    ds_read_b128 v[116:119], v14 offset:18432
    ds_read_b128 v[120:123], v14 offset:20480
    s_add_u32 m0, s41, 69632
    s_nop 0
    buffer_load_dwordx4 v4, s[12:15], s38 offen lds
    v_mfma_f32_16x16x32_bf16 v[32:35], v[112:115], v[68:71], 0
    ds_read_b64_tr_b16 v[88:89], v8 offset:9216
    ds_read_b64_tr_b16 v[90:91], v8 offset:13824
    s_add_u32 m0, s41, 88064
    s_nop 0
    buffer_load_dwordx4 v7, s[8:11], s39 offen lds
    s_add_u32 s39, s39, 128
    s_waitcnt lgkmcnt(10)
    v_mfma_f32_16x16x32_bf16 v[36:39], v[108:111], v[72:75], 0
    ds_read_b64_tr_b16 v[92:93], v8 offset:9248
    ds_read_b64_tr_b16 v[94:95], v8 offset:13856
    s_add_u32 m0, s41, 77824
    s_nop 0
    buffer_load_dwordx4 v5, s[12:15], s38 offen lds
    v_mfma_f32_16x16x32_bf16 v[40:43], v[112:115], v[72:75], 0
    ds_read_b64_tr_b16 v[96:97], v8 offset:9280
    ds_read_b64_tr_b16 v[98:99], v8 offset:13888
    v_mfma_f32_16x16x32_bf16 v[20:23], v[144:147], v[108:111], v[20:23]
    s_waitcnt lgkmcnt(12)
    v_mfma_f32_16x16x32_bf16 v[44:47], v[108:111], v[76:79], 0
    ds_read_b64_tr_b16 v[100:101], v8 offset:9312
    ds_read_b64_tr_b16 v[102:103], v8 offset:13920
    s_add_u32 m0, s41, 96256
    s_nop 0
    buffer_load_dwordx4 v7, s[8:11], s40 offen lds
    s_add_u32 s40, s40, 128
    v_mfma_f32_16x16x32_bf16 v[48:51], v[112:115], v[76:79], 0
    ds_read_b64_tr_b16 v[104:105], v8 offset:9344
    ds_read_b64_tr_b16 v[106:107], v8 offset:13952
    v_mfma_f32_16x16x32_bf16 v[24:27], v[108:111], v[108:111], v[24:27]
    s_waitcnt lgkmcnt(14)
    v_mfma_f32_16x16x32_bf16 v[52:55], v[108:111], v[80:83], 0
    s_cmp_ge_u32 s20, 2
    s_cbranch_scc1 k234_mid_kernel_a_v0sk10
    s_add_u32 m0, s41, 86016
    s_nop 0
    buffer_load_dwordx4 v6, s[12:15], s38 offen lds
k234_mid_kernel_a_v0sk10:
    s_add_u32 s38, s38, 221184
    v_mfma_f32_16x16x32_bf16 v[56:59], v[112:115], v[80:83], 0
    s_add_u32 m0, s41, 104448
    s_nop 0
    buffer_load_dwordx4 v4, s[12:15], s38 offen lds
    s_waitcnt lgkmcnt(12)
    v_mfma_f32_16x16x32_bf16 v[60:63], v[108:111], v[84:87], 0
    v_mfma_f32_16x16x32_bf16 v[64:67], v[112:115], v[84:87], 0
    s_cmp_lg_u32 s36, 0
    s_cbranch_scc1 k234_mid_kernel_a_v0cs0
    v_mfma_f32_16x16x32_bf16 v[124:127], v[68:71], v[144:147], v[124:127]
    v_mfma_f32_16x16x32_bf16 v[128:131], v[72:75], v[144:147], v[128:131]
    v_mfma_f32_16x16x32_bf16 v[132:135], v[76:79], v[144:147], v[132:135]
    v_mfma_f32_16x16x32_bf16 v[136:139], v[80:83], v[144:147], v[136:139]
    v_mfma_f32_16x16x32_bf16 v[140:143], v[84:87], v[144:147], v[140:143]
k234_mid_kernel_a_v0cs0:
    s_waitcnt vmcnt(5)
    s_barrier
    s_waitcnt lgkmcnt(8)
    v_mfma_f32_16x16x32_bf16 v[28:31], v[116:119], v[88:91], v[28:31]
    ds_read_b128 v[108:111], v12 offset:53248
    ds_read_b128 v[112:115], v12 offset:55296
    v_mfma_f32_16x16x32_bf16 v[32:35], v[120:123], v[88:91], v[32:35]
    ds_read_b64_tr_b16 v[68:69], v8 offset:34816
    ds_read_b64_tr_b16 v[70:71], v8 offset:39424
    s_add_u32 m0, s41, 122880
    s_nop 0
    buffer_load_dwordx4 v7, s[8:11], s39 offen lds
    s_add_u32 s39, s39, 128
    s_waitcnt lgkmcnt(10)
    v_mfma_f32_16x16x32_bf16 v[36:39], v[116:119], v[92:95], v[36:39]
    ds_read_b64_tr_b16 v[72:73], v8 offset:34848
    ds_read_b64_tr_b16 v[74:75], v8 offset:39456
    v_mfma_f32_16x16x32_bf16 v[40:43], v[120:123], v[92:95], v[40:43]
    ds_read_b64_tr_b16 v[76:77], v8 offset:34880
    ds_read_b64_tr_b16 v[78:79], v8 offset:39488
    v_mfma_f32_16x16x32_bf16 v[20:23], v[144:147], v[116:119], v[20:23]
    s_waitcnt lgkmcnt(12)
    v_mfma_f32_16x16x32_bf16 v[44:47], v[116:119], v[96:99], v[44:47]
    ds_read_b64_tr_b16 v[80:81], v8 offset:34912
    ds_read_b64_tr_b16 v[82:83], v8 offset:39520
    s_add_u32 m0, s41, 112640
    s_nop 0
    buffer_load_dwordx4 v5, s[12:15], s38 offen lds
    v_mfma_f32_16x16x32_bf16 v[48:51], v[120:123], v[96:99], v[48:51]
    ds_read_b64_tr_b16 v[84:85], v8 offset:34944
    ds_read_b64_tr_b16 v[86:87], v8 offset:39552
    v_mfma_f32_16x16x32_bf16 v[24:27], v[116:119], v[116:119], v[24:27]
    s_waitcnt lgkmcnt(14)
    v_mfma_f32_16x16x32_bf16 v[52:55], v[116:119], v[100:103], v[52:55]
    v_mfma_f32_16x16x32_bf16 v[56:59], v[120:123], v[100:103], v[56:59]
    s_add_u32 m0, s41, 131072
    s_nop 0
    buffer_load_dwordx4 v7, s[8:11], s40 offen lds
    s_add_u32 s40, s40, 128
    s_waitcnt lgkmcnt(12)
    v_mfma_f32_16x16x32_bf16 v[60:63], v[116:119], v[104:107], v[60:63]
    v_mfma_f32_16x16x32_bf16 v[64:67], v[120:123], v[104:107], v[64:67]
    s_cmp_lg_u32 s36, 1
    s_cbranch_scc1 k234_mid_kernel_a_v0cs1
    v_mfma_f32_16x16x32_bf16 v[124:127], v[88:91], v[144:147], v[124:127]
    v_mfma_f32_16x16x32_bf16 v[128:131], v[92:95], v[144:147], v[128:131]
    v_mfma_f32_16x16x32_bf16 v[132:135], v[96:99], v[144:147], v[132:135]
    v_mfma_f32_16x16x32_bf16 v[136:139], v[100:103], v[144:147], v[136:139]
    v_mfma_f32_16x16x32_bf16 v[140:143], v[104:107], v[144:147], v[140:143]
k234_mid_kernel_a_v0cs1:
    s_waitcnt lgkmcnt(8)
    v_mfma_f32_16x16x32_bf16 v[28:31], v[108:111], v[68:71], v[28:31]
    ds_read_b128 v[116:119], v14 offset:53248
    ds_read_b128 v[120:123], v14 offset:55296
    v_mfma_f32_16x16x32_bf16 v[32:35], v[112:115], v[68:71], v[32:35]
    ds_read_b64_tr_b16 v[88:89], v8 offset:44032
    ds_read_b64_tr_b16 v[90:91], v8 offset:48640
    s_cmp_ge_u32 s20, 2
    s_cbranch_scc1 k234_mid_kernel_a_v0sk11
    s_add_u32 m0, s41, 120832
    s_nop 0
    buffer_load_dwordx4 v6, s[12:15], s38 offen lds
k234_mid_kernel_a_v0sk11:
    s_add_u32 s38, s38, 221184
    s_waitcnt lgkmcnt(10)
    v_mfma_f32_16x16x32_bf16 v[36:39], v[108:111], v[72:75], v[36:39]
    ds_read_b64_tr_b16 v[92:93], v8 offset:44064
    ds_read_b64_tr_b16 v[94:95], v8 offset:48672
    v_mfma_f32_16x16x32_bf16 v[40:43], v[112:115], v[72:75], v[40:43]
    ds_read_b64_tr_b16 v[96:97], v8 offset:44096
    ds_read_b64_tr_b16 v[98:99], v8 offset:48704
    v_mfma_f32_16x16x32_bf16 v[20:23], v[144:147], v[108:111], v[20:23]
    s_waitcnt lgkmcnt(12)
    v_mfma_f32_16x16x32_bf16 v[44:47], v[108:111], v[76:79], v[44:47]
    ds_read_b64_tr_b16 v[100:101], v8 offset:44128
    ds_read_b64_tr_b16 v[102:103], v8 offset:48736
    v_mfma_f32_16x16x32_bf16 v[48:51], v[112:115], v[76:79], v[48:51]
    ds_read_b64_tr_b16 v[104:105], v8 offset:44160
    ds_read_b64_tr_b16 v[106:107], v8 offset:48768
    v_mfma_f32_16x16x32_bf16 v[24:27], v[108:111], v[108:111], v[24:27]
    s_waitcnt lgkmcnt(14)
    v_mfma_f32_16x16x32_bf16 v[52:55], v[108:111], v[80:83], v[52:55]
    v_mfma_f32_16x16x32_bf16 v[56:59], v[112:115], v[80:83], v[56:59]
    s_waitcnt lgkmcnt(12)
    v_mfma_f32_16x16x32_bf16 v[60:63], v[108:111], v[84:87], v[60:63]
    v_mfma_f32_16x16x32_bf16 v[64:67], v[112:115], v[84:87], v[64:67]
    s_cmp_lg_u32 s36, 2
    s_cbranch_scc1 k234_mid_kernel_a_v0cs2
    v_mfma_f32_16x16x32_bf16 v[124:127], v[68:71], v[144:147], v[124:127]
    v_mfma_f32_16x16x32_bf16 v[128:131], v[72:75], v[144:147], v[128:131]
    v_mfma_f32_16x16x32_bf16 v[132:135], v[76:79], v[144:147], v[132:135]
    v_mfma_f32_16x16x32_bf16 v[136:139], v[80:83], v[144:147], v[136:139]
    v_mfma_f32_16x16x32_bf16 v[140:143], v[84:87], v[144:147], v[140:143]
k234_mid_kernel_a_v0cs2:
    s_waitcnt vmcnt(4)
    s_barrier
    s_waitcnt lgkmcnt(8)
    v_mfma_f32_16x16x32_bf16 v[28:31], v[116:119], v[88:91], v[28:31]
    ds_read_b128 v[108:111], v13 offset:18432
    ds_read_b128 v[112:115], v13 offset:20480
    v_mfma_f32_16x16x32_bf16 v[32:35], v[120:123], v[88:91], v[32:35]
    ds_read_b64_tr_b16 v[68:69], v9 offset:0
    ds_read_b64_tr_b16 v[70:71], v9 offset:4608
    s_add_u32 m0, s41, 0
    s_nop 0
    buffer_load_dwordx4 v4, s[12:15], s38 offen lds
    s_waitcnt lgkmcnt(10)
    v_mfma_f32_16x16x32_bf16 v[36:39], v[116:119], v[92:95], v[36:39]
    ds_read_b64_tr_b16 v[72:73], v9 offset:32
    ds_read_b64_tr_b16 v[74:75], v9 offset:4640
    v_mfma_f32_16x16x32_bf16 v[40:43], v[120:123], v[92:95], v[40:43]
    ds_read_b64_tr_b16 v[76:77], v9 offset:64
    ds_read_b64_tr_b16 v[78:79], v9 offset:4672
    v_mfma_f32_16x16x32_bf16 v[20:23], v[144:147], v[116:119], v[20:23]
    s_waitcnt lgkmcnt(12)
    v_mfma_f32_16x16x32_bf16 v[44:47], v[116:119], v[96:99], v[44:47]
    ds_read_b64_tr_b16 v[80:81], v9 offset:96
    ds_read_b64_tr_b16 v[82:83], v9 offset:4704
    s_add_u32 m0, s41, 18432
    s_nop 0
    buffer_load_dwordx4 v7, s[8:11], s39 offen lds
    s_add_u32 s39, s39, 128
    v_mfma_f32_16x16x32_bf16 v[48:51], v[120:123], v[96:99], v[48:51]
    ds_read_b64_tr_b16 v[84:85], v9 offset:128
    ds_read_b64_tr_b16 v[86:87], v9 offset:4736
    v_mfma_f32_16x16x32_bf16 v[24:27], v[116:119], v[116:119], v[24:27]
    s_waitcnt lgkmcnt(14)
    v_mfma_f32_16x16x32_bf16 v[52:55], v[116:119], v[100:103], v[52:55]
    v_mfma_f32_16x16x32_bf16 v[56:59], v[120:123], v[100:103], v[56:59]
    s_add_u32 m0, s41, 8192
    s_nop 0
    buffer_load_dwordx4 v5, s[12:15], s38 offen lds
    s_waitcnt lgkmcnt(12)
    v_mfma_f32_16x16x32_bf16 v[60:63], v[116:119], v[104:107], v[60:63]
    v_mfma_f32_16x16x32_bf16 v[64:67], v[120:123], v[104:107], v[64:67]
    s_cmp_lg_u32 s36, 3
    s_cbranch_scc1 k234_mid_kernel_a_v0cs3
    v_mfma_f32_16x16x32_bf16 v[124:127], v[88:91], v[144:147], v[124:127]
    v_mfma_f32_16x16x32_bf16 v[128:131], v[92:95], v[144:147], v[128:131]
    v_mfma_f32_16x16x32_bf16 v[132:135], v[96:99], v[144:147], v[132:135]
    v_mfma_f32_16x16x32_bf16 v[136:139], v[100:103], v[144:147], v[136:139]
    v_mfma_f32_16x16x32_bf16 v[140:143], v[104:107], v[144:147], v[140:143]
k234_mid_kernel_a_v0cs3:
    s_waitcnt lgkmcnt(8)
    v_mfma_f32_16x16x32_bf16 v[28:31], v[108:111], v[68:71], v[28:31]
    ds_read_b128 v[116:119], v15 offset:18432
    ds_read_b128 v[120:123], v15 offset:20480
    v_mfma_f32_16x16x32_bf16 v[32:35], v[112:115], v[68:71], v[32:35]
    ds_read_b64_tr_b16 v[88:89], v9 offset:9216
    ds_read_b64_tr_b16 v[90:91], v9 offset:13824
    s_add_u32 m0, s41, 26624
    s_nop 0
    buffer_load_dwordx4 v7, s[8:11], s40 offen lds
    s_add_u32 s40, s40, 128
    s_waitcnt lgkmcnt(10)
    v_mfma_f32_16x16x32_bf16 v[36:39], v[108:111], v[72:75], v[36:39]
    ds_read_b64_tr_b16 v[92:93], v9 offset:9248
    ds_read_b64_tr_b16 v[94:95], v9 offset:13856
    v_mfma_f32_16x16x32_bf16 v[40:43], v[112:115], v[72:75], v[40:43]
    ds_read_b64_tr_b16 v[96:97], v9 offset:9280
    ds_read_b64_tr_b16 v[98:99], v9 offset:13888
    v_mfma_f32_16x16x32_bf16 v[20:23], v[144:147], v[108:111], v[20:23]
    s_waitcnt lgkmcnt(12)
    v_mfma_f32_16x16x32_bf16 v[44:47], v[108:111], v[76:79], v[44:47]
    ds_read_b64_tr_b16 v[100:101], v9 offset:9312
    ds_read_b64_tr_b16 v[102:103], v9 offset:13920
    s_cmp_ge_u32 s20, 2
    s_cbranch_scc1 k234_mid_kernel_a_v0sk12
    s_add_u32 m0, s41, 16384
    s_nop 0
    buffer_load_dwordx4 v6, s[12:15], s38 offen lds
k234_mid_kernel_a_v0sk12:
    s_add_u32 s38, s38, 221184
    v_mfma_f32_16x16x32_bf16 v[48:51], v[112:115], v[76:79], v[48:51]
    ds_read_b64_tr_b16 v[104:105], v9 offset:9344
    ds_read_b64_tr_b16 v[106:107], v9 offset:13952
    v_mfma_f32_16x16x32_bf16 v[24:27], v[108:111], v[108:111], v[24:27]
    s_waitcnt lgkmcnt(14)
    v_mfma_f32_16x16x32_bf16 v[52:55], v[108:111], v[80:83], v[52:55]
    v_mfma_f32_16x16x32_bf16 v[56:59], v[112:115], v[80:83], v[56:59]
    s_waitcnt lgkmcnt(12)
    v_mfma_f32_16x16x32_bf16 v[60:63], v[108:111], v[84:87], v[60:63]
    v_mfma_f32_16x16x32_bf16 v[64:67], v[112:115], v[84:87], v[64:67]
    s_cmp_lg_u32 s36, 0
    s_cbranch_scc1 k234_mid_kernel_a_v0cs4
    v_mfma_f32_16x16x32_bf16 v[124:127], v[68:71], v[144:147], v[124:127]
    v_mfma_f32_16x16x32_bf16 v[128:131], v[72:75], v[144:147], v[128:131]
    v_mfma_f32_16x16x32_bf16 v[132:135], v[76:79], v[144:147], v[132:135]
    v_mfma_f32_16x16x32_bf16 v[136:139], v[80:83], v[144:147], v[136:139]
    v_mfma_f32_16x16x32_bf16 v[140:143], v[84:87], v[144:147], v[140:143]
k234_mid_kernel_a_v0cs4:
    s_waitcnt vmcnt(4)
    s_barrier
    s_waitcnt lgkmcnt(8)
    v_mfma_f32_16x16x32_bf16 v[28:31], v[116:119], v[88:91], v[28:31]
    ds_read_b128 v[108:111], v13 offset:53248
    ds_read_b128 v[112:115], v13 offset:55296
    v_mfma_f32_16x16x32_bf16 v[32:35], v[120:123], v[88:91], v[32:35]
    ds_read_b64_tr_b16 v[68:69], v9 offset:34816
    ds_read_b64_tr_b16 v[70:71], v9 offset:39424
    s_add_u32 m0, s41, 34816
    s_nop 0
    buffer_load_dwordx4 v4, s[12:15], s38 offen lds
    s_waitcnt lgkmcnt(10)
    v_mfma_f32_16x16x32_bf16 v[36:39], v[116:119], v[92:95], v[36:39]
    ds_read_b64_tr_b16 v[72:73], v9 offset:34848
    ds_read_b64_tr_b16 v[74:75], v9 offset:39456
    v_mfma_f32_16x16x32_bf16 v[40:43], v[120:123], v[92:95], v[40:43]
    ds_read_b64_tr_b16 v[76:77], v9 offset:34880
    ds_read_b64_tr_b16 v[78:79], v9 offset:39488
    v_mfma_f32_16x16x32_bf16 v[20:23], v[144:147], v[116:119], v[20:23]
    s_waitcnt lgkmcnt(12)
    v_mfma_f32_16x16x32_bf16 v[44:47], v[116:119], v[96:99], v[44:47]
    ds_read_b64_tr_b16 v[80:81], v9 offset:34912
    ds_read_b64_tr_b16 v[82:83], v9 offset:39520
    s_add_u32 m0, s41, 53248
    s_nop 0
    buffer_load_dwordx4 v7, s[8:11], s39 offen lds
    s_add_u32 s39, s39, 128
    v_mfma_f32_16x16x32_bf16 v[48:51], v[120:123], v[96:99], v[48:51]
    ds_read_b64_tr_b16 v[84:85], v9 offset:34944
    ds_read_b64_tr_b16 v[86:87], v9 offset:39552
    v_mfma_f32_16x16x32_bf16 v[24:27], v[116:119], v[116:119], v[24:27]
    s_waitcnt lgkmcnt(14)
    v_mfma_f32_16x16x32_bf16 v[52:55], v[116:119], v[100:103], v[52:55]
    v_mfma_f32_16x16x32_bf16 v[56:59], v[120:123], v[100:103], v[56:59]
    s_add_u32 m0, s41, 43008
    s_nop 0
    buffer_load_dwordx4 v5, s[12:15], s38 offen lds
    s_waitcnt lgkmcnt(12)
    v_mfma_f32_16x16x32_bf16 v[60:63], v[116:119], v[104:107], v[60:63]
    v_mfma_f32_16x16x32_bf16 v[64:67], v[120:123], v[104:107], v[64:67]
    s_cmp_lg_u32 s36, 1
    s_cbranch_scc1 k234_mid_kernel_a_v0cs5
    v_mfma_f32_16x16x32_bf16 v[124:127], v[88:91], v[144:147], v[124:127]
    v_mfma_f32_16x16x32_bf16 v[128:131], v[92:95], v[144:147], v[128:131]
    v_mfma_f32_16x16x32_bf16 v[132:135], v[96:99], v[144:147], v[132:135]
    v_mfma_f32_16x16x32_bf16 v[136:139], v[100:103], v[144:147], v[136:139]
    v_mfma_f32_16x16x32_bf16 v[140:143], v[104:107], v[144:147], v[140:143]
k234_mid_kernel_a_v0cs5:
    s_waitcnt lgkmcnt(8)
    v_mfma_f32_16x16x32_bf16 v[28:31], v[108:111], v[68:71], v[28:31]
    ds_read_b128 v[116:119], v15 offset:53248
    ds_read_b128 v[120:123], v15 offset:55296
    v_mfma_f32_16x16x32_bf16 v[32:35], v[112:115], v[68:71], v[32:35]
    ds_read_b64_tr_b16 v[88:89], v9 offset:44032
    ds_read_b64_tr_b16 v[90:91], v9 offset:48640
    s_add_u32 m0, s41, 61440
    s_nop 0
    buffer_load_dwordx4 v7, s[8:11], s40 offen lds
    s_add_u32 s40, s40, 128
    s_waitcnt lgkmcnt(10)
    v_mfma_f32_16x16x32_bf16 v[36:39], v[108:111], v[72:75], v[36:39]
    ds_read_b64_tr_b16 v[92:93], v9 offset:44064
    ds_read_b64_tr_b16 v[94:95], v9 offset:48672
    v_mfma_f32_16x16x32_bf16 v[40:43], v[112:115], v[72:75], v[40:43]
    ds_read_b64_tr_b16 v[96:97], v9 offset:44096
    ds_read_b64_tr_b16 v[98:99], v9 offset:48704
    v_mfma_f32_16x16x32_bf16 v[20:23], v[144:147], v[108:111], v[20:23]
    s_waitcnt lgkmcnt(12)
    v_mfma_f32_16x16x32_bf16 v[44:47], v[108:111], v[76:79], v[44:47]
    ds_read_b64_tr_b16 v[100:101], v9 offset:44128
    ds_read_b64_tr_b16 v[102:103], v9 offset:48736
    s_cmp_ge_u32 s20, 2
    s_cbranch_scc1 k234_mid_kernel_a_v0sk13
    s_add_u32 m0, s41, 51200
    s_nop 0
    buffer_load_dwordx4 v6, s[12:15], s38 offen lds
k234_mid_kernel_a_v0sk13:
    s_add_u32 s38, s38, 221184
    v_mfma_f32_16x16x32_bf16 v[48:51], v[112:115], v[76:79], v[48:51]
    ds_read_b64_tr_b16 v[104:105], v9 offset:44160
    ds_read_b64_tr_b16 v[106:107], v9 offset:48768
    v_mfma_f32_16x16x32_bf16 v[24:27], v[108:111], v[108:111], v[24:27]
    s_waitcnt lgkmcnt(14)
    v_mfma_f32_16x16x32_bf16 v[52:55], v[108:111], v[80:83], v[52:55]
    v_mfma_f32_16x16x32_bf16 v[56:59], v[112:115], v[80:83], v[56:59]
    s_waitcnt lgkmcnt(12)
    v_mfma_f32_16x16x32_bf16 v[60:63], v[108:111], v[84:87], v[60:63]
    v_mfma_f32_16x16x32_bf16 v[64:67], v[112:115], v[84:87], v[64:67]
    s_cmp_lg_u32 s36, 2
    s_cbranch_scc1 k234_mid_kernel_a_v0cs6
    v_mfma_f32_16x16x32_bf16 v[124:127], v[68:71], v[144:147], v[124:127]
    v_mfma_f32_16x16x32_bf16 v[128:131], v[72:75], v[144:147], v[128:131]
    v_mfma_f32_16x16x32_bf16 v[132:135], v[76:79], v[144:147], v[132:135]
    v_mfma_f32_16x16x32_bf16 v[136:139], v[80:83], v[144:147], v[136:139]
    v_mfma_f32_16x16x32_bf16 v[140:143], v[84:87], v[144:147], v[140:143]
k234_mid_kernel_a_v0cs6:
    s_waitcnt vmcnt(4)
    s_barrier
    s_waitcnt lgkmcnt(8)
    v_mfma_f32_16x16x32_bf16 v[28:31], v[116:119], v[88:91], v[28:31]
    ds_read_b128 v[108:111], v12 offset:18432
    ds_read_b128 v[112:115], v12 offset:20480
    v_mfma_f32_16x16x32_bf16 v[32:35], v[120:123], v[88:91], v[32:35]
    ds_read_b64_tr_b16 v[68:69], v8 offset:0
    ds_read_b64_tr_b16 v[70:71], v8 offset:4608
    s_add_u32 m0, s41, 69632
    s_nop 0
    buffer_load_dwordx4 v4, s[12:15], s38 offen lds
    s_waitcnt lgkmcnt(10)
    v_mfma_f32_16x16x32_bf16 v[36:39], v[116:119], v[92:95], v[36:39]
    ds_read_b64_tr_b16 v[72:73], v8 offset:32
    ds_read_b64_tr_b16 v[74:75], v8 offset:4640
    v_mfma_f32_16x16x32_bf16 v[40:43], v[120:123], v[92:95], v[40:43]
    ds_read_b64_tr_b16 v[76:77], v8 offset:64
    ds_read_b64_tr_b16 v[78:79], v8 offset:4672
    v_mfma_f32_16x16x32_bf16 v[20:23], v[144:147], v[116:119], v[20:23]
    s_waitcnt lgkmcnt(12)
    v_mfma_f32_16x16x32_bf16 v[44:47], v[116:119], v[96:99], v[44:47]
    ds_read_b64_tr_b16 v[80:81], v8 offset:96
    ds_read_b64_tr_b16 v[82:83], v8 offset:4704
    s_add_u32 m0, s41, 88064
    s_nop 0
    buffer_load_dwordx4 v7, s[8:11], s39 offen lds
    s_add_u32 s39, s39, 128
    v_mfma_f32_16x16x32_bf16 v[48:51], v[120:123], v[96:99], v[48:51]
    ds_read_b64_tr_b16 v[84:85], v8 offset:128
    ds_read_b64_tr_b16 v[86:87], v8 offset:4736
    v_mfma_f32_16x16x32_bf16 v[24:27], v[116:119], v[116:119], v[24:27]
    s_waitcnt lgkmcnt(14)
    v_mfma_f32_16x16x32_bf16 v[52:55], v[116:119], v[100:103], v[52:55]
    v_mfma_f32_16x16x32_bf16 v[56:59], v[120:123], v[100:103], v[56:59]
    s_add_u32 m0, s41, 77824
    s_nop 0
    buffer_load_dwordx4 v5, s[12:15], s38 offen lds
    s_waitcnt lgkmcnt(12)
    v_mfma_f32_16x16x32_bf16 v[60:63], v[116:119], v[104:107], v[60:63]
    v_mfma_f32_16x16x32_bf16 v[64:67], v[120:123], v[104:107], v[64:67]
    s_cmp_lg_u32 s36, 3
    s_cbranch_scc1 k234_mid_kernel_a_v0cs7
    v_mfma_f32_16x16x32_bf16 v[124:127], v[88:91], v[144:147], v[124:127]
    v_mfma_f32_16x16x32_bf16 v[128:131], v[92:95], v[144:147], v[128:131]
    v_mfma_f32_16x16x32_bf16 v[132:135], v[96:99], v[144:147], v[132:135]
    v_mfma_f32_16x16x32_bf16 v[136:139], v[100:103], v[144:147], v[136:139]
    v_mfma_f32_16x16x32_bf16 v[140:143], v[104:107], v[144:147], v[140:143]
k234_mid_kernel_a_v0cs7:
    s_waitcnt lgkmcnt(8)
    v_mfma_f32_16x16x32_bf16 v[28:31], v[108:111], v[68:71], v[28:31]
    ds_read_b128 v[116:119], v14 offset:18432
    ds_read_b128 v[120:123], v14 offset:20480
    v_mfma_f32_16x16x32_bf16 v[32:35], v[112:115], v[68:71], v[32:35]
    ds_read_b64_tr_b16 v[88:89], v8 offset:9216
    ds_read_b64_tr_b16 v[90:91], v8 offset:13824
    s_add_u32 m0, s41, 96256
    s_nop 0
    buffer_load_dwordx4 v7, s[8:11], s40 offen lds
    s_add_u32 s40, s40, 128
    s_waitcnt lgkmcnt(10)
    v_mfma_f32_16x16x32_bf16 v[36:39], v[108:111], v[72:75], v[36:39]
    ds_read_b64_tr_b16 v[92:93], v8 offset:9248
    ds_read_b64_tr_b16 v[94:95], v8 offset:13856
    v_mfma_f32_16x16x32_bf16 v[40:43], v[112:115], v[72:75], v[40:43]
    ds_read_b64_tr_b16 v[96:97], v8 offset:9280
    ds_read_b64_tr_b16 v[98:99], v8 offset:13888
    v_mfma_f32_16x16x32_bf16 v[20:23], v[144:147], v[108:111], v[20:23]
    s_waitcnt lgkmcnt(12)
    v_mfma_f32_16x16x32_bf16 v[44:47], v[108:111], v[76:79], v[44:47]
    ds_read_b64_tr_b16 v[100:101], v8 offset:9312
    ds_read_b64_tr_b16 v[102:103], v8 offset:13920
    s_cmp_ge_u32 s20, 2
    s_cbranch_scc1 k234_mid_kernel_a_v0sk14
    s_add_u32 m0, s41, 86016
    s_nop 0
    buffer_load_dwordx4 v6, s[12:15], s38 offen lds
k234_mid_kernel_a_v0sk14:
    s_add_u32 s38, s38, 221184
    v_mfma_f32_16x16x32_bf16 v[48:51], v[112:115], v[76:79], v[48:51]
    ds_read_b64_tr_b16 v[104:105], v8 offset:9344
    ds_read_b64_tr_b16 v[106:107], v8 offset:13952
    v_mfma_f32_16x16x32_bf16 v[24:27], v[108:111], v[108:111], v[24:27]
    s_waitcnt lgkmcnt(14)
    v_mfma_f32_16x16x32_bf16 v[52:55], v[108:111], v[80:83], v[52:55]
    v_mfma_f32_16x16x32_bf16 v[56:59], v[112:115], v[80:83], v[56:59]
    s_waitcnt lgkmcnt(12)
    v_mfma_f32_16x16x32_bf16 v[60:63], v[108:111], v[84:87], v[60:63]
    v_mfma_f32_16x16x32_bf16 v[64:67], v[112:115], v[84:87], v[64:67]
    s_cmp_lg_u32 s36, 0
    s_cbranch_scc1 k234_mid_kernel_a_v0cs8
    v_mfma_f32_16x16x32_bf16 v[124:127], v[68:71], v[144:147], v[124:127]
    v_mfma_f32_16x16x32_bf16 v[128:131], v[72:75], v[144:147], v[128:131]
    v_mfma_f32_16x16x32_bf16 v[132:135], v[76:79], v[144:147], v[132:135]
    v_mfma_f32_16x16x32_bf16 v[136:139], v[80:83], v[144:147], v[136:139]
    v_mfma_f32_16x16x32_bf16 v[140:143], v[84:87], v[144:147], v[140:143]
k234_mid_kernel_a_v0cs8:
    s_waitcnt vmcnt(4)
    s_barrier
    s_waitcnt lgkmcnt(8)
    v_mfma_f32_16x16x32_bf16 v[28:31], v[116:119], v[88:91], v[28:31]
    ds_read_b128 v[108:111], v12 offset:53248
    ds_read_b128 v[112:115], v12 offset:55296
    v_mfma_f32_16x16x32_bf16 v[32:35], v[120:123], v[88:91], v[32:35]
    ds_read_b64_tr_b16 v[68:69], v8 offset:34816
    ds_read_b64_tr_b16 v[70:71], v8 offset:39424
    s_add_u32 m0, s41, 104448
    s_nop 0
    buffer_load_dwordx4 v4, s[12:15], s38 offen lds
    s_waitcnt lgkmcnt(10)
    v_mfma_f32_16x16x32_bf16 v[36:39], v[116:119], v[92:95], v[36:39]
    ds_read_b64_tr_b16 v[72:73], v8 offset:34848
    ds_read_b64_tr_b16 v[74:75], v8 offset:39456
    v_mfma_f32_16x16x32_bf16 v[40:43], v[120:123], v[92:95], v[40:43]
    ds_read_b64_tr_b16 v[76:77], v8 offset:34880
    ds_read_b64_tr_b16 v[78:79], v8 offset:39488
    v_mfma_f32_16x16x32_bf16 v[20:23], v[144:147], v[116:119], v[20:23]
    s_waitcnt lgkmcnt(12)
    v_mfma_f32_16x16x32_bf16 v[44:47], v[116:119], v[96:99], v[44:47]
    ds_read_b64_tr_b16 v[80:81], v8 offset:34912
    ds_read_b64_tr_b16 v[82:83], v8 offset:39520
    s_add_u32 m0, s41, 122880
    s_nop 0
    buffer_load_dwordx4 v7, s[8:11], s39 offen lds
    s_add_u32 s39, s39, 128
    v_mfma_f32_16x16x32_bf16 v[48:51], v[120:123], v[96:99], v[48:51]
    ds_read_b64_tr_b16 v[84:85], v8 offset:34944
    ds_read_b64_tr_b16 v[86:87], v8 offset:39552
    v_mfma_f32_16x16x32_bf16 v[24:27], v[116:119], v[116:119], v[24:27]
    s_waitcnt lgkmcnt(14)
    v_mfma_f32_16x16x32_bf16 v[52:55], v[116:119], v[100:103], v[52:55]
    v_mfma_f32_16x16x32_bf16 v[56:59], v[120:123], v[100:103], v[56:59]
    s_add_u32 m0, s41, 112640
    s_nop 0
    buffer_load_dwordx4 v5, s[12:15], s38 offen lds
    s_waitcnt lgkmcnt(12)
    v_mfma_f32_16x16x32_bf16 v[60:63], v[116:119], v[104:107], v[60:63]
    v_mfma_f32_16x16x32_bf16 v[64:67], v[120:123], v[104:107], v[64:67]
    s_cmp_lg_u32 s36, 1
    s_cbranch_scc1 k234_mid_kernel_a_v0cs9
    v_mfma_f32_16x16x32_bf16 v[124:127], v[88:91], v[144:147], v[124:127]
    v_mfma_f32_16x16x32_bf16 v[128:131], v[92:95], v[144:147], v[128:131]
    v_mfma_f32_16x16x32_bf16 v[132:135], v[96:99], v[144:147], v[132:135]
    v_mfma_f32_16x16x32_bf16 v[136:139], v[100:103], v[144:147], v[136:139]
    v_mfma_f32_16x16x32_bf16 v[140:143], v[104:107], v[144:147], v[140:143]
k234_mid_kernel_a_v0cs9:
    s_waitcnt lgkmcnt(8)
    v_mfma_f32_16x16x32_bf16 v[28:31], v[108:111], v[68:71], v[28:31]
    ds_read_b128 v[116:119], v14 offset:53248
    ds_read_b128 v[120:123], v14 offset:55296
    v_mfma_f32_16x16x32_bf16 v[32:35], v[112:115], v[68:71], v[32:35]
    ds_read_b64_tr_b16 v[88:89], v8 offset:44032
    ds_read_b64_tr_b16 v[90:91], v8 offset:48640
    s_add_u32 m0, s41, 131072
    s_nop 0
    buffer_load_dwordx4 v7, s[8:11], s40 offen lds
    s_add_u32 s40, s40, 128
    s_waitcnt lgkmcnt(10)
    v_mfma_f32_16x16x32_bf16 v[36:39], v[108:111], v[72:75], v[36:39]
    ds_read_b64_tr_b16 v[92:93], v8 offset:44064
    ds_read_b64_tr_b16 v[94:95], v8 offset:48672
    v_mfma_f32_16x16x32_bf16 v[40:43], v[112:115], v[72:75], v[40:43]
    ds_read_b64_tr_b16 v[96:97], v8 offset:44096
    ds_read_b64_tr_b16 v[98:99], v8 offset:48704
    v_mfma_f32_16x16x32_bf16 v[20:23], v[144:147], v[108:111], v[20:23]
    s_waitcnt lgkmcnt(12)
    v_mfma_f32_16x16x32_bf16 v[44:47], v[108:111], v[76:79], v[44:47]
    ds_read_b64_tr_b16 v[100:101], v8 offset:44128
    ds_read_b64_tr_b16 v[102:103], v8 offset:48736
    s_cmp_ge_u32 s20, 2
    s_cbranch_scc1 k234_mid_kernel_a_v0sk15
    s_add_u32 m0, s41, 120832
    s_nop 0
    buffer_load_dwordx4 v6, s[12:15], s38 offen lds
k234_mid_kernel_a_v0sk15:
    s_add_u32 s38, s38, 221184
    v_mfma_f32_16x16x32_bf16 v[48:51], v[112:115], v[76:79], v[48:51]
    ds_read_b64_tr_b16 v[104:105], v8 offset:44160
    ds_read_b64_tr_b16 v[106:107], v8 offset:48768
    v_mfma_f32_16x16x32_bf16 v[24:27], v[108:111], v[108:111], v[24:27]
    s_waitcnt lgkmcnt(14)
    v_mfma_f32_16x16x32_bf16 v[52:55], v[108:111], v[80:83], v[52:55]
    v_mfma_f32_16x16x32_bf16 v[56:59], v[112:115], v[80:83], v[56:59]
    s_waitcnt lgkmcnt(12)
    v_mfma_f32_16x16x32_bf16 v[60:63], v[108:111], v[84:87], v[60:63]
    v_mfma_f32_16x16x32_bf16 v[64:67], v[112:115], v[84:87], v[64:67]
    s_cmp_lg_u32 s36, 2
    s_cbranch_scc1 k234_mid_kernel_a_v0cs10
    v_mfma_f32_16x16x32_bf16 v[124:127], v[68:71], v[144:147], v[124:127]
    v_mfma_f32_16x16x32_bf16 v[128:131], v[72:75], v[144:147], v[128:131]
    v_mfma_f32_16x16x32_bf16 v[132:135], v[76:79], v[144:147], v[132:135]
    v_mfma_f32_16x16x32_bf16 v[136:139], v[80:83], v[144:147], v[136:139]
    v_mfma_f32_16x16x32_bf16 v[140:143], v[84:87], v[144:147], v[140:143]
k234_mid_kernel_a_v0cs10:
    s_waitcnt vmcnt(4)
    s_barrier
    s_waitcnt lgkmcnt(8)
    v_mfma_f32_16x16x32_bf16 v[28:31], v[116:119], v[88:91], v[28:31]
    ds_read_b128 v[108:111], v13 offset:18432
    ds_read_b128 v[112:115], v13 offset:20480
    v_mfma_f32_16x16x32_bf16 v[32:35], v[120:123], v[88:91], v[32:35]
    ds_read_b64_tr_b16 v[68:69], v9 offset:0
    ds_read_b64_tr_b16 v[70:71], v9 offset:4608
    s_add_u32 m0, s41, 0
    s_nop 0
    buffer_load_dwordx4 v4, s[12:15], s38 offen lds
    s_waitcnt lgkmcnt(10)
    v_mfma_f32_16x16x32_bf16 v[36:39], v[116:119], v[92:95], v[36:39]
    ds_read_b64_tr_b16 v[72:73], v9 offset:32
    ds_read_b64_tr_b16 v[74:75], v9 offset:4640
    v_mfma_f32_16x16x32_bf16 v[40:43], v[120:123], v[92:95], v[40:43]
    ds_read_b64_tr_b16 v[76:77], v9 offset:64
    ds_read_b64_tr_b16 v[78:79], v9 offset:4672
    v_mfma_f32_16x16x32_bf16 v[20:23], v[144:147], v[116:119], v[20:23]
    s_waitcnt lgkmcnt(12)
    v_mfma_f32_16x16x32_bf16 v[44:47], v[116:119], v[96:99], v[44:47]
    ds_read_b64_tr_b16 v[80:81], v9 offset:96
    ds_read_b64_tr_b16 v[82:83], v9 offset:4704
    s_add_u32 m0, s41, 18432
    s_nop 0
    buffer_load_dwordx4 v7, s[8:11], s39 offen lds
    s_add_u32 s39, s39, 128
    v_mfma_f32_16x16x32_bf16 v[48:51], v[120:123], v[96:99], v[48:51]
    ds_read_b64_tr_b16 v[84:85], v9 offset:128
    ds_read_b64_tr_b16 v[86:87], v9 offset:4736
    v_mfma_f32_16x16x32_bf16 v[24:27], v[116:119], v[116:119], v[24:27]
    s_waitcnt lgkmcnt(14)
    v_mfma_f32_16x16x32_bf16 v[52:55], v[116:119], v[100:103], v[52:55]
    v_mfma_f32_16x16x32_bf16 v[56:59], v[120:123], v[100:103], v[56:59]
    s_add_u32 m0, s41, 8192
    s_nop 0
    buffer_load_dwordx4 v5, s[12:15], s38 offen lds
    s_waitcnt lgkmcnt(12)
    v_mfma_f32_16x16x32_bf16 v[60:63], v[116:119], v[104:107], v[60:63]
    v_mfma_f32_16x16x32_bf16 v[64:67], v[120:123], v[104:107], v[64:67]
    s_cmp_lg_u32 s36, 3
    s_cbranch_scc1 k234_mid_kernel_a_v0cs11
    v_mfma_f32_16x16x32_bf16 v[124:127], v[88:91], v[144:147], v[124:127]
    v_mfma_f32_16x16x32_bf16 v[128:131], v[92:95], v[144:147], v[128:131]
    v_mfma_f32_16x16x32_bf16 v[132:135], v[96:99], v[144:147], v[132:135]
    v_mfma_f32_16x16x32_bf16 v[136:139], v[100:103], v[144:147], v[136:139]
    v_mfma_f32_16x16x32_bf16 v[140:143], v[104:107], v[144:147], v[140:143]
k234_mid_kernel_a_v0cs11:
    s_waitcnt lgkmcnt(8)
    v_mfma_f32_16x16x32_bf16 v[28:31], v[108:111], v[68:71], v[28:31]
    ds_read_b128 v[116:119], v15 offset:18432
    ds_read_b128 v[120:123], v15 offset:20480
    v_mfma_f32_16x16x32_bf16 v[32:35], v[112:115], v[68:71], v[32:35]
    ds_read_b64_tr_b16 v[88:89], v9 offset:9216
    ds_read_b64_tr_b16 v[90:91], v9 offset:13824
    s_add_u32 m0, s41, 26624
    s_nop 0
    buffer_load_dwordx4 v7, s[8:11], s40 offen lds
    s_add_u32 s40, s40, 128
    s_waitcnt lgkmcnt(10)
    v_mfma_f32_16x16x32_bf16 v[36:39], v[108:111], v[72:75], v[36:39]
    ds_read_b64_tr_b16 v[92:93], v9 offset:9248
    ds_read_b64_tr_b16 v[94:95], v9 offset:13856
    v_mfma_f32_16x16x32_bf16 v[40:43], v[112:115], v[72:75], v[40:43]
    ds_read_b64_tr_b16 v[96:97], v9 offset:9280
    ds_read_b64_tr_b16 v[98:99], v9 offset:13888
    v_mfma_f32_16x16x32_bf16 v[20:23], v[144:147], v[108:111], v[20:23]
    s_waitcnt lgkmcnt(12)
    v_mfma_f32_16x16x32_bf16 v[44:47], v[108:111], v[76:79], v[44:47]
    ds_read_b64_tr_b16 v[100:101], v9 offset:9312
    ds_read_b64_tr_b16 v[102:103], v9 offset:13920
    s_cmp_ge_u32 s20, 2
    s_cbranch_scc1 k234_mid_kernel_a_v0sk16
    s_add_u32 m0, s41, 16384
    s_nop 0
    buffer_load_dwordx4 v6, s[12:15], s38 offen lds
k234_mid_kernel_a_v0sk16:
    s_add_u32 s38, s38, 221184
    v_mfma_f32_16x16x32_bf16 v[48:51], v[112:115], v[76:79], v[48:51]
    ds_read_b64_tr_b16 v[104:105], v9 offset:9344
    ds_read_b64_tr_b16 v[106:107], v9 offset:13952
    v_mfma_f32_16x16x32_bf16 v[24:27], v[108:111], v[108:111], v[24:27]
    s_waitcnt lgkmcnt(14)
    v_mfma_f32_16x16x32_bf16 v[52:55], v[108:111], v[80:83], v[52:55]
    v_mfma_f32_16x16x32_bf16 v[56:59], v[112:115], v[80:83], v[56:59]
    s_waitcnt lgkmcnt(12)
    v_mfma_f32_16x16x32_bf16 v[60:63], v[108:111], v[84:87], v[60:63]
    v_mfma_f32_16x16x32_bf16 v[64:67], v[112:115], v[84:87], v[64:67]
    s_cmp_lg_u32 s36, 0
    s_cbranch_scc1 k234_mid_kernel_a_v0cs12
    v_mfma_f32_16x16x32_bf16 v[124:127], v[68:71], v[144:147], v[124:127]
    v_mfma_f32_16x16x32_bf16 v[128:131], v[72:75], v[144:147], v[128:131]
    v_mfma_f32_16x16x32_bf16 v[132:135], v[76:79], v[144:147], v[132:135]
    v_mfma_f32_16x16x32_bf16 v[136:139], v[80:83], v[144:147], v[136:139]
    v_mfma_f32_16x16x32_bf16 v[140:143], v[84:87], v[144:147], v[140:143]
k234_mid_kernel_a_v0cs12:
    s_waitcnt vmcnt(4)
    s_barrier
    s_waitcnt lgkmcnt(8)
    v_mfma_f32_16x16x32_bf16 v[28:31], v[116:119], v[88:91], v[28:31]
    ds_read_b128 v[108:111], v13 offset:53248
    ds_read_b128 v[112:115], v13 offset:55296
    v_mfma_f32_16x16x32_bf16 v[32:35], v[120:123], v[88:91], v[32:35]
    ds_read_b64_tr_b16 v[68:69], v9 offset:34816
    ds_read_b64_tr_b16 v[70:71], v9 offset:39424
    s_waitcnt lgkmcnt(10)
    v_mfma_f32_16x16x32_bf16 v[36:39], v[116:119], v[92:95], v[36:39]
    ds_read_b64_tr_b16 v[72:73], v9 offset:34848
    ds_read_b64_tr_b16 v[74:75], v9 offset:39456
    v_mfma_f32_16x16x32_bf16 v[40:43], v[120:123], v[92:95], v[40:43]
    ds_read_b64_tr_b16 v[76:77], v9 offset:34880
    ds_read_b64_tr_b16 v[78:79], v9 offset:39488
    v_mfma_f32_16x16x32_bf16 v[20:23], v[144:147], v[116:119], v[20:23]
    s_waitcnt lgkmcnt(12)
    v_mfma_f32_16x16x32_bf16 v[44:47], v[116:119], v[96:99], v[44:47]
    ds_read_b64_tr_b16 v[80:81], v9 offset:34912
    ds_read_b64_tr_b16 v[82:83], v9 offset:39520
    v_mfma_f32_16x16x32_bf16 v[48:51], v[120:123], v[96:99], v[48:51]
    ds_read_b64_tr_b16 v[84:85], v9 offset:34944
    ds_read_b64_tr_b16 v[86:87], v9 offset:39552
    v_mfma_f32_16x16x32_bf16 v[24:27], v[116:119], v[116:119], v[24:27]
    s_waitcnt lgkmcnt(14)
    v_mfma_f32_16x16x32_bf16 v[52:55], v[116:119], v[100:103], v[52:55]
    v_mfma_f32_16x16x32_bf16 v[56:59], v[120:123], v[100:103], v[56:59]
    s_waitcnt lgkmcnt(12)
    v_mfma_f32_16x16x32_bf16 v[60:63], v[116:119], v[104:107], v[60:63]
    v_mfma_f32_16x16x32_bf16 v[64:67], v[120:123], v[104:107], v[64:67]
    s_cmp_lg_u32 s36, 1
    s_cbranch_scc1 k234_mid_kernel_a_v0cs13
    v_mfma_f32_16x16x32_bf16 v[124:127], v[88:91], v[144:147], v[124:127]
    v_mfma_f32_16x16x32_bf16 v[128:131], v[92:95], v[144:147], v[128:131]
    v_mfma_f32_16x16x32_bf16 v[132:135], v[96:99], v[144:147], v[132:135]
    v_mfma_f32_16x16x32_bf16 v[136:139], v[100:103], v[144:147], v[136:139]
    v_mfma_f32_16x16x32_bf16 v[140:143], v[104:107], v[144:147], v[140:143]
k234_mid_kernel_a_v0cs13:
    s_waitcnt lgkmcnt(8)
    v_mfma_f32_16x16x32_bf16 v[28:31], v[108:111], v[68:71], v[28:31]
    ds_read_b128 v[116:119], v15 offset:53248
    ds_read_b128 v[120:123], v15 offset:55296
    v_mfma_f32_16x16x32_bf16 v[32:35], v[112:115], v[68:71], v[32:35]
    ds_read_b64_tr_b16 v[88:89], v9 offset:44032
    ds_read_b64_tr_b16 v[90:91], v9 offset:48640
    s_waitcnt lgkmcnt(10)
    v_mfma_f32_16x16x32_bf16 v[36:39], v[108:111], v[72:75], v[36:39]
    ds_read_b64_tr_b16 v[92:93], v9 offset:44064
    ds_read_b64_tr_b16 v[94:95], v9 offset:48672
    v_mfma_f32_16x16x32_bf16 v[40:43], v[112:115], v[72:75], v[40:43]
    ds_read_b64_tr_b16 v[96:97], v9 offset:44096
    ds_read_b64_tr_b16 v[98:99], v9 offset:48704
    v_mfma_f32_16x16x32_bf16 v[20:23], v[144:147], v[108:111], v[20:23]
    s_waitcnt lgkmcnt(12)
    v_mfma_f32_16x16x32_bf16 v[44:47], v[108:111], v[76:79], v[44:47]
    ds_read_b64_tr_b16 v[100:101], v9 offset:44128
    ds_read_b64_tr_b16 v[102:103], v9 offset:48736
    v_mfma_f32_16x16x32_bf16 v[48:51], v[112:115], v[76:79], v[48:51]
    ds_read_b64_tr_b16 v[104:105], v9 offset:44160
    ds_read_b64_tr_b16 v[106:107], v9 offset:48768
    v_mfma_f32_16x16x32_bf16 v[24:27], v[108:111], v[108:111], v[24:27]
    s_waitcnt lgkmcnt(14)
    v_mfma_f32_16x16x32_bf16 v[52:55], v[108:111], v[80:83], v[52:55]
    v_mfma_f32_16x16x32_bf16 v[56:59], v[112:115], v[80:83], v[56:59]
    s_waitcnt lgkmcnt(12)
    v_mfma_f32_16x16x32_bf16 v[60:63], v[108:111], v[84:87], v[60:63]
    v_mfma_f32_16x16x32_bf16 v[64:67], v[112:115], v[84:87], v[64:67]
    s_cmp_lg_u32 s36, 2
    s_cbranch_scc1 k234_mid_kernel_a_v0cs14
    v_mfma_f32_16x16x32_bf16 v[124:127], v[68:71], v[144:147], v[124:127]
    v_mfma_f32_16x16x32_bf16 v[128:131], v[72:75], v[144:147], v[128:131]
    v_mfma_f32_16x16x32_bf16 v[132:135], v[76:79], v[144:147], v[132:135]
    v_mfma_f32_16x16x32_bf16 v[136:139], v[80:83], v[144:147], v[136:139]
    v_mfma_f32_16x16x32_bf16 v[140:143], v[84:87], v[144:147], v[140:143]
k234_mid_kernel_a_v0cs14:
    s_waitcnt vmcnt(0)
    s_barrier
    s_waitcnt lgkmcnt(8)
    v_mfma_f32_16x16x32_bf16 v[28:31], v[116:119], v[88:91], v[28:31]
    ds_read_b128 v[108:111], v12 offset:18432
    ds_read_b128 v[112:115], v12 offset:20480
    v_mfma_f32_16x16x32_bf16 v[32:35], v[120:123], v[88:91], v[32:35]
    ds_read_b64_tr_b16 v[68:69], v8 offset:0
    ds_read_b64_tr_b16 v[70:71], v8 offset:4608
    s_waitcnt lgkmcnt(10)
    v_mfma_f32_16x16x32_bf16 v[36:39], v[116:119], v[92:95], v[36:39]
    ds_read_b64_tr_b16 v[72:73], v8 offset:32
    ds_read_b64_tr_b16 v[74:75], v8 offset:4640
    v_mfma_f32_16x16x32_bf16 v[40:43], v[120:123], v[92:95], v[40:43]
    ds_read_b64_tr_b16 v[76:77], v8 offset:64
    ds_read_b64_tr_b16 v[78:79], v8 offset:4672
    v_mfma_f32_16x16x32_bf16 v[20:23], v[144:147], v[116:119], v[20:23]
    s_waitcnt lgkmcnt(12)
    v_mfma_f32_16x16x32_bf16 v[44:47], v[116:119], v[96:99], v[44:47]
    ds_read_b64_tr_b16 v[80:81], v8 offset:96
    ds_read_b64_tr_b16 v[82:83], v8 offset:4704
    v_mfma_f32_16x16x32_bf16 v[48:51], v[120:123], v[96:99], v[48:51]
    ds_read_b64_tr_b16 v[84:85], v8 offset:128
    ds_read_b64_tr_b16 v[86:87], v8 offset:4736
    v_mfma_f32_16x16x32_bf16 v[24:27], v[116:119], v[116:119], v[24:27]
    s_waitcnt lgkmcnt(14)
    v_mfma_f32_16x16x32_bf16 v[52:55], v[116:119], v[100:103], v[52:55]
    v_mfma_f32_16x16x32_bf16 v[56:59], v[120:123], v[100:103], v[56:59]
    s_waitcnt lgkmcnt(12)
    v_mfma_f32_16x16x32_bf16 v[60:63], v[116:119], v[104:107], v[60:63]
    v_mfma_f32_16x16x32_bf16 v[64:67], v[120:123], v[104:107], v[64:67]
    s_cmp_lg_u32 s36, 3
    s_cbranch_scc1 k234_mid_kernel_a_v0cs15
    v_mfma_f32_16x16x32_bf16 v[124:127], v[88:91], v[144:147], v[124:127]
    v_mfma_f32_16x16x32_bf16 v[128:131], v[92:95], v[144:147], v[128:131]
    v_mfma_f32_16x16x32_bf16 v[132:135], v[96:99], v[144:147], v[132:135]
    v_mfma_f32_16x16x32_bf16 v[136:139], v[100:103], v[144:147], v[136:139]
    v_mfma_f32_16x16x32_bf16 v[140:143], v[104:107], v[144:147], v[140:143]
k234_mid_kernel_a_v0cs15:
    s_waitcnt lgkmcnt(8)
    v_mfma_f32_16x16x32_bf16 v[28:31], v[108:111], v[68:71], v[28:31]
    ds_read_b128 v[116:119], v14 offset:18432
    ds_read_b128 v[120:123], v14 offset:20480
    v_mfma_f32_16x16x32_bf16 v[32:35], v[112:115], v[68:71], v[32:35]
    ds_read_b64_tr_b16 v[88:89], v8 offset:9216
    ds_read_b64_tr_b16 v[90:91], v8 offset:13824
    s_waitcnt lgkmcnt(10)
    v_mfma_f32_16x16x32_bf16 v[36:39], v[108:111], v[72:75], v[36:39]
    ds_read_b64_tr_b16 v[92:93], v8 offset:9248
    ds_read_b64_tr_b16 v[94:95], v8 offset:13856
    v_mfma_f32_16x16x32_bf16 v[40:43], v[112:115], v[72:75], v[40:43]
    ds_read_b64_tr_b16 v[96:97], v8 offset:9280
    ds_read_b64_tr_b16 v[98:99], v8 offset:13888
    v_mfma_f32_16x16x32_bf16 v[20:23], v[144:147], v[108:111], v[20:23]
    s_waitcnt lgkmcnt(12)
    v_mfma_f32_16x16x32_bf16 v[44:47], v[108:111], v[76:79], v[44:47]
    ds_read_b64_tr_b16 v[100:101], v8 offset:9312
    ds_read_b64_tr_b16 v[102:103], v8 offset:13920
    v_mfma_f32_16x16x32_bf16 v[48:51], v[112:115], v[76:79], v[48:51]
    ds_read_b64_tr_b16 v[104:105], v8 offset:9344
    ds_read_b64_tr_b16 v[106:107], v8 offset:13952
    v_mfma_f32_16x16x32_bf16 v[24:27], v[108:111], v[108:111], v[24:27]
    s_waitcnt lgkmcnt(14)
    v_mfma_f32_16x16x32_bf16 v[52:55], v[108:111], v[80:83], v[52:55]
    v_mfma_f32_16x16x32_bf16 v[56:59], v[112:115], v[80:83], v[56:59]
    s_waitcnt lgkmcnt(12)
    v_mfma_f32_16x16x32_bf16 v[60:63], v[108:111], v[84:87], v[60:63]
    v_mfma_f32_16x16x32_bf16 v[64:67], v[112:115], v[84:87], v[64:67]
    s_cmp_lg_u32 s36, 0
    s_cbranch_scc1 k234_mid_kernel_a_v0cs16
    v_mfma_f32_16x16x32_bf16 v[124:127], v[68:71], v[144:147], v[124:127]
    v_mfma_f32_16x16x32_bf16 v[128:131], v[72:75], v[144:147], v[128:131]
    v_mfma_f32_16x16x32_bf16 v[132:135], v[76:79], v[144:147], v[132:135]
    v_mfma_f32_16x16x32_bf16 v[136:139], v[80:83], v[144:147], v[136:139]
    v_mfma_f32_16x16x32_bf16 v[140:143], v[84:87], v[144:147], v[140:143]
k234_mid_kernel_a_v0cs16:
    s_waitcnt lgkmcnt(8)
    v_mfma_f32_16x16x32_bf16 v[28:31], v[116:119], v[88:91], v[28:31]
    v_mfma_f32_16x16x32_bf16 v[32:35], v[120:123], v[88:91], v[32:35]
    s_waitcnt lgkmcnt(6)
    v_mfma_f32_16x16x32_bf16 v[36:39], v[116:119], v[92:95], v[36:39]
    v_mfma_f32_16x16x32_bf16 v[40:43], v[120:123], v[92:95], v[40:43]
    v_mfma_f32_16x16x32_bf16 v[20:23], v[144:147], v[116:119], v[20:23]
    s_waitcnt lgkmcnt(4)
    v_mfma_f32_16x16x32_bf16 v[44:47], v[116:119], v[96:99], v[44:47]
    v_mfma_f32_16x16x32_bf16 v[48:51], v[120:123], v[96:99], v[48:51]
    v_mfma_f32_16x16x32_bf16 v[24:27], v[116:119], v[116:119], v[24:27]
    s_waitcnt lgkmcnt(2)
    v_mfma_f32_16x16x32_bf16 v[52:55], v[116:119], v[100:103], v[52:55]
    v_mfma_f32_16x16x32_bf16 v[56:59], v[120:123], v[100:103], v[56:59]
    s_waitcnt lgkmcnt(0)
    v_mfma_f32_16x16x32_bf16 v[60:63], v[116:119], v[104:107], v[60:63]
    v_mfma_f32_16x16x32_bf16 v[64:67], v[120:123], v[104:107], v[64:67]
    s_cmp_lg_u32 s36, 1
    s_cbranch_scc1 k234_mid_kernel_a_v0cs17
    v_mfma_f32_16x16x32_bf16 v[124:127], v[88:91], v[144:147], v[124:127]
    v_mfma_f32_16x16x32_bf16 v[128:131], v[92:95], v[144:147], v[128:131]
    v_mfma_f32_16x16x32_bf16 v[132:135], v[96:99], v[144:147], v[132:135]
    v_mfma_f32_16x16x32_bf16 v[136:139], v[100:103], v[144:147], v[136:139]
    v_mfma_f32_16x16x32_bf16 v[140:143], v[104:107], v[144:147], v[140:143]
k234_mid_kernel_a_v0cs17:
    s_nop 5
    v_and_b32 v17, 1, v2
    v_cmp_eq_u32 vcc, 1, v17
    s_nop 1
    v_cndmask_b32 v24, v24, v25, vcc
    v_cndmask_b32 v26, v26, v27, vcc
    v_and_b32 v17, 2, v2
    v_cmp_eq_u32 vcc, 2, v17
    s_nop 1
    v_cndmask_b32 v24, v24, v26, vcc
    v_lshrrev_b32 v17, 2, v2
    v_cmp_eq_u32 vcc, v17, v3
    s_nop 1
    v_cndmask_b32 v22, 0, v24, vcc
    v_mov_b32 v17, v22
    s_nop 1
    v_permlane32_swap_b32 v22, v17
    v_add_f32 v22, v22, v17
    v_mov_b32 v17, v22
    s_nop 1
    v_permlane16_swap_b32 v22, v17
    v_add_f32 v22, v22, v17
    v_mul_f32 v20, 0x3ae38e39, v20
    v_mul_f32 v17, v20, v20
    v_mov_b32 v18, 0x3ae38e39
    v_fma_f32 v22, v22, v18, -v17
    v_max_f32 v22, 0, v22
    v_add_f32 v22, 0x3727c5ac, v22
    v_rsq_f32 v22, v22
    s_mul_i32 s25, s36, 576
    v_lshlrev_b32 v16, 4, v3
    v_add_u32 v16, s25, v16
    v_add_u32 v16, 139264, v16
    s_lshl_b32 s25, s36, 8
    s_add_u32 s25, s25, 141568
    v_lshlrev_b32 v19, 3, v2
    v_add_u32 v19, s25, v19
    v_mul_f32 v23, v20, v22
    ds_write_b64 v19, v[22:23]
    v_cmp_eq_u32 vcc, 0, v2
    s_nop 0
    s_and_saveexec_b64 s[32:33], vcc
    ds_write_b128 v16, v[124:127] offset:0
    ds_write_b128 v16, v[128:131] offset:64
    ds_write_b128 v16, v[132:135] offset:128
    ds_write_b128 v16, v[136:139] offset:192
    ds_write_b128 v16, v[140:143] offset:256
    s_mov_b64 exec, s[32:33]
    s_lshl_b32 s25, s36, 8
    s_add_u32 s25, s25, 141568
    v_lshlrev_b32 v19, 5, v3
    v_add_u32 v19, s25, v19
    v_lshlrev_b32 v16, 2, v2
    v_add_u32 v16, 139264, v16
    s_lshr_b32 s34, s23, 5
    s_mul_i32 s34, s34, 18944
    s_bfe_u32 s35, s23, 0x20003
    s_mul_i32 s35, s35, 37888
    s_add_u32 s34, s34, s35
    s_and_b32 s35, s23, 7
    s_waitcnt lgkmcnt(0)
    s_barrier
    ds_read_b128 v[108:111], v19 offset:0
    ds_read_b128 v[112:115], v19 offset:16
    ds_read_b128 v[116:119], v19 offset:128
    ds_read_b128 v[120:123], v19 offset:144
    ds_read_b32 v148, v16 offset:0
    ds_read_b32 v149, v16 offset:576
    ds_read_b32 v150, v16 offset:1152
    ds_read_b32 v151, v16 offset:1728
    ds_read_b32 v152, v16 offset:64
    ds_read_b32 v153, v16 offset:640
    ds_read_b32 v154, v16 offset:1216
    ds_read_b32 v155, v16 offset:1792
    ds_read_b32 v156, v16 offset:128
    ds_read_b32 v157, v16 offset:704
    ds_read_b32 v158, v16 offset:1280
    ds_read_b32 v159, v16 offset:1856
    ds_read_b32 v160, v16 offset:192
    ds_read_b32 v161, v16 offset:768
    ds_read_b32 v162, v16 offset:1344
    ds_read_b32 v163, v16 offset:1920
    ds_read_b32 v164, v16 offset:256
    ds_read_b32 v165, v16 offset:832
    ds_read_b32 v166, v16 offset:1408
    ds_read_b32 v167, v16 offset:1984
    s_sub_u32 s25, s22, 8
    s_mul_i32 s25, s25, 1212416
    s_add_u32 s25, s25, s34
    s_and_b32 s26, s35, 4
    s_mul_i32 s26, s26, 1216
    s_add_u32 s25, s25, s26
    s_add_u32 s25, s25, 2368512
    v_mul_u32_u24 v19, 304, v3
    s_and_b32 s26, s35, 3
    s_mul_i32 s26, s26, 1216
    v_add_u32 v19, s26, v19
    v_add_u32 v16, 0, v2
    v_mul_u32_u24 v17, 3641, v16
    v_lshrrev_b32 v17, 16, v17
    v_mul_u32_u24 v18, 4576, v17
    v_lshl_add_u32 v18, v16, 4, v18
    v_add_u32 v168, v18, v19
    s_waitcnt lgkmcnt(15)
    v_add_f32 v148, v148, v149
    v_add_f32 v150, v150, v151
    v_add_f32 v148, v148, v150
    v_mul_f32 v24, v109, v148
    v_mul_f32 v25, v111, v148
    v_mul_f32 v26, v113, v148
    v_mul_f32 v27, v115, v148
    v_fma_f32 v28, v28, v108, -v24
    v_fma_f32 v29, v29, v110, -v25
    v_fma_f32 v30, v30, v112, -v26
    v_fma_f32 v31, v31, v114, -v27
    v_cvt_pk_bf16_f32 v68, v28, v29
    v_cvt_pk_bf16_f32 v69, v30, v31
    v_mul_f32 v24, v117, v148
    v_mul_f32 v25, v119, v148
    v_mul_f32 v26, v121, v148
    v_mul_f32 v27, v123, v148
    v_fma_f32 v32, v32, v116, -v24
    v_fma_f32 v33, v33, v118, -v25
    v_fma_f32 v34, v34, v120, -v26
    v_fma_f32 v35, v35, v122, -v27
    v_cvt_pk_bf16_f32 v70, v32, v33
    v_cvt_pk_bf16_f32 v71, v34, v35
    ds_write_b128 v168, v[68:71]
    v_add_u32 v16, 16, v2
    v_mul_u32_u24 v17, 3641, v16
    v_lshrrev_b32 v17, 16, v17
    v_mul_u32_u24 v18, 4576, v17
    v_lshl_add_u32 v18, v16, 4, v18
    v_add_u32 v169, v18, v19
    s_waitcnt lgkmcnt(12)
    v_add_f32 v152, v152, v153
    v_add_f32 v154, v154, v155
    v_add_f32 v152, v152, v154
    v_mul_f32 v24, v109, v152
    v_mul_f32 v25, v111, v152
    v_mul_f32 v26, v113, v152
    v_mul_f32 v27, v115, v152
    v_fma_f32 v36, v36, v108, -v24
    v_fma_f32 v37, v37, v110, -v25
    v_fma_f32 v38, v38, v112, -v26
    v_fma_f32 v39, v39, v114, -v27
    v_cvt_pk_bf16_f32 v72, v36, v37
    v_cvt_pk_bf16_f32 v73, v38, v39
    v_mul_f32 v24, v117, v152
    v_mul_f32 v25, v119, v152
    v_mul_f32 v26, v121, v152
    v_mul_f32 v27, v123, v152
    v_fma_f32 v40, v40, v116, -v24
    v_fma_f32 v41, v41, v118, -v25
    v_fma_f32 v42, v42, v120, -v26
    v_fma_f32 v43, v43, v122, -v27
    v_cvt_pk_bf16_f32 v74, v40, v41
    v_cvt_pk_bf16_f32 v75, v42, v43
    ds_write_b128 v169, v[72:75]
    v_add_u32 v16, 32, v2
    v_mul_u32_u24 v17, 3641, v16
    v_lshrrev_b32 v17, 16, v17
    v_mul_u32_u24 v18, 4576, v17
    v_lshl_add_u32 v18, v16, 4, v18
    v_add_u32 v170, v18, v19
    s_waitcnt lgkmcnt(8)
    v_add_f32 v156, v156, v157
    v_add_f32 v158, v158, v159
    v_add_f32 v156, v156, v158
    v_mul_f32 v24, v109, v156
    v_mul_f32 v25, v111, v156
    v_mul_f32 v26, v113, v156
    v_mul_f32 v27, v115, v156
    v_fma_f32 v44, v44, v108, -v24
    v_fma_f32 v45, v45, v110, -v25
    v_fma_f32 v46, v46, v112, -v26
    v_fma_f32 v47, v47, v114, -v27
    v_cvt_pk_bf16_f32 v76, v44, v45
    v_cvt_pk_bf16_f32 v77, v46, v47
    v_mul_f32 v24, v117, v156
    v_mul_f32 v25, v119, v156
    v_mul_f32 v26, v121, v156
    v_mul_f32 v27, v123, v156
    v_fma_f32 v48, v48, v116, -v24
    v_fma_f32 v49, v49, v118, -v25
    v_fma_f32 v50, v50, v120, -v26
    v_fma_f32 v51, v51, v122, -v27
    v_cvt_pk_bf16_f32 v78, v48, v49
    v_cvt_pk_bf16_f32 v79, v50, v51
    ds_write_b128 v170, v[76:79]
    v_add_u32 v16, 48, v2
    v_mul_u32_u24 v17, 3641, v16
    v_lshrrev_b32 v17, 16, v17
    v_mul_u32_u24 v18, 4576, v17
    v_lshl_add_u32 v18, v16, 4, v18
    v_add_u32 v171, v18, v19
    s_waitcnt lgkmcnt(4)
    v_add_f32 v160, v160, v161
    v_add_f32 v162, v162, v163
    v_add_f32 v160, v160, v162
    v_mul_f32 v24, v109, v160
    v_mul_f32 v25, v111, v160
    v_mul_f32 v26, v113, v160
    v_mul_f32 v27, v115, v160
    v_fma_f32 v52, v52, v108, -v24
    v_fma_f32 v53, v53, v110, -v25
    v_fma_f32 v54, v54, v112, -v26
    v_fma_f32 v55, v55, v114, -v27
    v_cvt_pk_bf16_f32 v80, v52, v53
    v_cvt_pk_bf16_f32 v81, v54, v55
    v_mul_f32 v24, v117, v160
    v_mul_f32 v25, v119, v160
    v_mul_f32 v26, v121, v160
    v_mul_f32 v27, v123, v160
    v_fma_f32 v56, v56, v116, -v24
    v_fma_f32 v57, v57, v118, -v25
    v_fma_f32 v58, v58, v120, -v26
    v_fma_f32 v59, v59, v122, -v27
    v_cvt_pk_bf16_f32 v82, v56, v57
    v_cvt_pk_bf16_f32 v83, v58, v59
    ds_write_b128 v171, v[80:83]
    v_add_u32 v16, 64, v2
    v_mul_u32_u24 v17, 3641, v16
    v_lshrrev_b32 v17, 16, v17
    v_mul_u32_u24 v18, 4576, v17
    v_lshl_add_u32 v18, v16, 4, v18
    v_add_u32 v172, v18, v19
    s_waitcnt lgkmcnt(0)
    v_add_f32 v164, v164, v165
    v_add_f32 v166, v166, v167
    v_add_f32 v164, v164, v166
    v_mul_f32 v24, v109, v164
    v_mul_f32 v25, v111, v164
    v_mul_f32 v26, v113, v164
    v_mul_f32 v27, v115, v164
    v_fma_f32 v60, v60, v108, -v24
    v_fma_f32 v61, v61, v110, -v25
    v_fma_f32 v62, v62, v112, -v26
    v_fma_f32 v63, v63, v114, -v27
    v_cvt_pk_bf16_f32 v84, v60, v61
    v_cvt_pk_bf16_f32 v85, v62, v63
    v_mul_f32 v24, v117, v164
    v_mul_f32 v25, v119, v164
    v_mul_f32 v26, v121, v164
    v_mul_f32 v27, v123, v164
    v_fma_f32 v64, v64, v116, -v24
    v_fma_f32 v65, v65, v118, -v25
    v_fma_f32 v66, v66, v120, -v26
    v_fma_f32 v67, v67, v122, -v27
    v_cvt_pk_bf16_f32 v86, v64, v65
    v_cvt_pk_bf16_f32 v87, v66, v67
    ds_write_b128 v172, v[84:87]
    v_add_u32 v16, 0, v0
    v_min_u32 v16, 2431, v16
    v_mul_u32_u24 v17, 3450, v16
    v_lshrrev_b32 v17, 20, v17
    v_mul_u32_u24 v17, 146688, v17
    v_lshlrev_b32 v148, 4, v16
    v_add_u32 v168, v148, v17
    v_add_u32 v16, 512, v0
    v_min_u32 v16, 2431, v16
    v_mul_u32_u24 v17, 3450, v16
    v_lshrrev_b32 v17, 20, v17
    v_mul_u32_u24 v17, 146688, v17
    v_lshlrev_b32 v149, 4, v16
    v_add_u32 v169, v149, v17
    v_add_u32 v16, 1024, v0
    v_min_u32 v16, 2431, v16
    v_mul_u32_u24 v17, 3450, v16
    v_lshrrev_b32 v17, 20, v17
    v_mul_u32_u24 v17, 146688, v17
    v_lshlrev_b32 v150, 4, v16
    v_add_u32 v170, v150, v17
    v_add_u32 v16, 1536, v0
    v_min_u32 v16, 2431, v16
    v_mul_u32_u24 v17, 3450, v16
    v_lshrrev_b32 v17, 20, v17
    v_mul_u32_u24 v17, 146688, v17
    v_lshlrev_b32 v151, 4, v16
    v_add_u32 v171, v151, v17
    v_add_u32 v16, 2048, v0
    v_min_u32 v16, 2431, v16
    v_mul_u32_u24 v17, 3450, v16
    v_lshrrev_b32 v17, 20, v17
    v_mul_u32_u24 v17, 146688, v17
    v_lshlrev_b32 v152, 4, v16
    v_add_u32 v172, v152, v17
    s_waitcnt lgkmcnt(0)
    s_barrier
    ds_read_b128 v[28:31], v148
    ds_read_b128 v[32:35], v149
    ds_read_b128 v[36:39], v150
    ds_read_b128 v[40:43], v151
    ds_read_b128 v[44:47], v152
    s_waitcnt lgkmcnt(4)
    buffer_store_dwordx4 v[28:31], v168, s[16:19], s25 offen sc1
    s_waitcnt lgkmcnt(3)
    buffer_store_dwordx4 v[32:35], v169, s[16:19], s25 offen sc1
    s_waitcnt lgkmcnt(2)
    buffer_store_dwordx4 v[36:39], v170, s[16:19], s25 offen sc1
    s_waitcnt lgkmcnt(1)
    buffer_store_dwordx4 v[40:43], v171, s[16:19], s25 offen sc1
    s_waitcnt lgkmcnt(0)
    s_cmp_ge_u32 s20, 6
    s_cbranch_scc1 k234_mid_kernel_a_fin
    buffer_store_dwordx4 v[44:47], v172, s[16:19], s25 offen sc1
    s_branch k234_mid_kernel_a_fin
k234_mid_kernel_a_v1:
    ds_read_b128 v[108:111], v12 offset:18432
    ds_read_b128 v[112:115], v12 offset:20480
    ds_read_b64_tr_b16 v[68:69], v8 offset:160
    ds_read_b64_tr_b16 v[70:71], v8 offset:4768
    ds_read_b64_tr_b16 v[72:73], v8 offset:192
    ds_read_b64_tr_b16 v[74:75], v8 offset:4800
    ds_read_b64_tr_b16 v[76:77], v8 offset:224
    ds_read_b64_tr_b16 v[78:79], v8 offset:4832
    ds_read_b64_tr_b16 v[80:81], v8 offset:256
    ds_read_b64_tr_b16 v[82:83], v8 offset:4864
    s_waitcnt lgkmcnt(6)
    v_mfma_f32_16x16x32_bf16 v[28:31], v[108:111], v[68:71], 0
    ds_read_b128 v[116:119], v14 offset:18432
    ds_read_b128 v[120:123], v14 offset:20480
    s_add_u32 m0, s41, 69632
    s_nop 0
    buffer_load_dwordx4 v4, s[12:15], s38 offen lds
    v_mfma_f32_16x16x32_bf16 v[32:35], v[112:115], v[68:71], 0
    ds_read_b64_tr_b16 v[88:89], v8 offset:9376
    ds_read_b64_tr_b16 v[90:91], v8 offset:13984
    s_add_u32 m0, s41, 88064
    s_nop 0
    buffer_load_dwordx4 v7, s[8:11], s39 offen lds
    s_add_u32 s39, s39, 128
    s_waitcnt lgkmcnt(8)
    v_mfma_f32_16x16x32_bf16 v[36:39], v[108:111], v[72:75], 0
    ds_read_b64_tr_b16 v[92:93], v8 offset:9408
    ds_read_b64_tr_b16 v[94:95], v8 offset:14016
    s_add_u32 m0, s41, 77824
    s_nop 0
    buffer_load_dwordx4 v5, s[12:15], s38 offen lds
    v_mfma_f32_16x16x32_bf16 v[40:43], v[112:115], v[72:75], 0
    ds_read_b64_tr_b16 v[96:97], v8 offset:9440
    ds_read_b64_tr_b16 v[98:99], v8 offset:14048
    v_mfma_f32_16x16x32_bf16 v[20:23], v[144:147], v[112:115], v[20:23]
    s_waitcnt lgkmcnt(10)
    v_mfma_f32_16x16x32_bf16 v[44:47], v[108:111], v[76:79], 0
    ds_read_b64_tr_b16 v[100:101], v8 offset:9472
    ds_read_b64_tr_b16 v[102:103], v8 offset:14080
    s_add_u32 m0, s41, 96256
    s_nop 0
    buffer_load_dwordx4 v7, s[8:11], s40 offen lds
    s_add_u32 s40, s40, 128
    v_mfma_f32_16x16x32_bf16 v[48:51], v[112:115], v[76:79], 0
    v_mfma_f32_16x16x32_bf16 v[24:27], v[112:115], v[112:115], v[24:27]
    s_waitcnt lgkmcnt(10)
    v_mfma_f32_16x16x32_bf16 v[52:55], v[108:111], v[80:83], 0
    s_add_u32 s38, s38, 221184
    v_mfma_f32_16x16x32_bf16 v[56:59], v[112:115], v[80:83], 0
    s_add_u32 m0, s41, 104448
    s_nop 0
    buffer_load_dwordx4 v4, s[12:15], s38 offen lds
    s_cmp_lg_u32 s36, 0
    s_cbranch_scc1 k234_mid_kernel_a_v1cs0
    v_mfma_f32_16x16x32_bf16 v[124:127], v[68:71], v[144:147], v[124:127]
    v_mfma_f32_16x16x32_bf16 v[128:131], v[72:75], v[144:147], v[128:131]
    v_mfma_f32_16x16x32_bf16 v[132:135], v[76:79], v[144:147], v[132:135]
    v_mfma_f32_16x16x32_bf16 v[136:139], v[80:83], v[144:147], v[136:139]
k234_mid_kernel_a_v1cs0:
    s_waitcnt vmcnt(5)
    s_barrier
    s_waitcnt lgkmcnt(6)
    v_mfma_f32_16x16x32_bf16 v[28:31], v[116:119], v[88:91], v[28:31]
    ds_read_b128 v[108:111], v12 offset:53248
    ds_read_b128 v[112:115], v12 offset:55296
    v_mfma_f32_16x16x32_bf16 v[32:35], v[120:123], v[88:91], v[32:35]
    ds_read_b64_tr_b16 v[68:69], v8 offset:34976
    ds_read_b64_tr_b16 v[70:71], v8 offset:39584
    s_add_u32 m0, s41, 122880
    s_nop 0
    buffer_load_dwordx4 v7, s[8:11], s39 offen lds
    s_add_u32 s39, s39, 128
    s_waitcnt lgkmcnt(8)
    v_mfma_f32_16x16x32_bf16 v[36:39], v[116:119], v[92:95], v[36:39]
    ds_read_b64_tr_b16 v[72:73], v8 offset:35008
    ds_read_b64_tr_b16 v[74:75], v8 offset:39616
    v_mfma_f32_16x16x32_bf16 v[40:43], v[120:123], v[92:95], v[40:43]
    ds_read_b64_tr_b16 v[76:77], v8 offset:35040
    ds_read_b64_tr_b16 v[78:79], v8 offset:39648
    v_mfma_f32_16x16x32_bf16 v[20:23], v[144:147], v[120:123], v[20:23]
    s_waitcnt lgkmcnt(10)
    v_mfma_f32_16x16x32_bf16 v[44:47], v[116:119], v[96:99], v[44:47]
    ds_read_b64_tr_b16 v[80:81], v8 offset:35072
    ds_read_b64_tr_b16 v[82:83], v8 offset:39680
    s_add_u32 m0, s41, 112640
    s_nop 0
    buffer_load_dwordx4 v5, s[12:15], s38 offen lds
    v_mfma_f32_16x16x32_bf16 v[48:51], v[120:123], v[96:99], v[48:51]
    v_mfma_f32_16x16x32_bf16 v[24:27], v[120:123], v[120:123], v[24:27]
    s_waitcnt lgkmcnt(10)
    v_mfma_f32_16x16x32_bf16 v[52:55], v[116:119], v[100:103], v[52:55]
    v_mfma_f32_16x16x32_bf16 v[56:59], v[120:123], v[100:103], v[56:59]
    s_add_u32 m0, s41, 131072
    s_nop 0
    buffer_load_dwordx4 v7, s[8:11], s40 offen lds
    s_add_u32 s40, s40, 128
    s_cmp_lg_u32 s36, 1
    s_cbranch_scc1 k234_mid_kernel_a_v1cs1
    v_mfma_f32_16x16x32_bf16 v[124:127], v[88:91], v[144:147], v[124:127]
    v_mfma_f32_16x16x32_bf16 v[128:131], v[92:95], v[144:147], v[128:131]
    v_mfma_f32_16x16x32_bf16 v[132:135], v[96:99], v[144:147], v[132:135]
    v_mfma_f32_16x16x32_bf16 v[136:139], v[100:103], v[144:147], v[136:139]
k234_mid_kernel_a_v1cs1:
    s_waitcnt lgkmcnt(6)
    v_mfma_f32_16x16x32_bf16 v[28:31], v[108:111], v[68:71], v[28:31]
    ds_read_b128 v[116:119], v14 offset:53248
    ds_read_b128 v[120:123], v14 offset:55296
    v_mfma_f32_16x16x32_bf16 v[32:35], v[112:115], v[68:71], v[32:35]
    ds_read_b64_tr_b16 v[88:89], v8 offset:44192
    ds_read_b64_tr_b16 v[90:91], v8 offset:48800
    s_add_u32 s38, s38, 221184
    s_waitcnt lgkmcnt(8)
    v_mfma_f32_16x16x32_bf16 v[36:39], v[108:111], v[72:75], v[36:39]
    ds_read_b64_tr_b16 v[92:93], v8 offset:44224
    ds_read_b64_tr_b16 v[94:95], v8 offset:48832
    v_mfma_f32_16x16x32_bf16 v[40:43], v[112:115], v[72:75], v[40:43]
    ds_read_b64_tr_b16 v[96:97], v8 offset:44256
    ds_read_b64_tr_b16 v[98:99], v8 offset:48864
    v_mfma_f32_16x16x32_bf16 v[20:23], v[144:147], v[112:115], v[20:23]
    s_waitcnt lgkmcnt(10)
    v_mfma_f32_16x16x32_bf16 v[44:47], v[108:111], v[76:79], v[44:47]
    ds_read_b64_tr_b16 v[100:101], v8 offset:44288
    ds_read_b64_tr_b16 v[102:103], v8 offset:48896
    v_mfma_f32_16x16x32_bf16 v[48:51], v[112:115], v[76:79], v[48:51]
    v_mfma_f32_16x16x32_bf16 v[24:27], v[112:115], v[112:115], v[24:27]
    s_waitcnt lgkmcnt(10)
    v_mfma_f32_16x16x32_bf16 v[52:55], v[108:111], v[80:83], v[52:55]
    v_mfma_f32_16x16x32_bf16 v[56:59], v[112:115], v[80:83], v[56:59]
    s_cmp_lg_u32 s36, 2
    s_cbranch_scc1 k234_mid_kernel_a_v1cs2
    v_mfma_f32_16x16x32_bf16 v[124:127], v[68:71], v[144:147], v[124:127]
    v_mfma_f32_16x16x32_bf16 v[128:131], v[72:75], v[144:147], v[128:131]
    v_mfma_f32_16x16x32_bf16 v[132:135], v[76:79], v[144:147], v[132:135]
    v_mfma_f32_16x16x32_bf16 v[136:139], v[80:83], v[144:147], v[136:139]
k234_mid_kernel_a_v1cs2:
    s_waitcnt vmcnt(4)
    s_barrier
    s_waitcnt lgkmcnt(6)
    v_mfma_f32_16x16x32_bf16 v[28:31], v[116:119], v[88:91], v[28:31]
    ds_read_b128 v[108:111], v13 offset:18432
    ds_read_b128 v[112:115], v13 offset:20480
    v_mfma_f32_16x16x32_bf16 v[32:35], v[120:123], v[88:91], v[32:35]
    ds_read_b64_tr_b16 v[68:69], v9 offset:160
    ds_read_b64_tr_b16 v[70:71], v9 offset:4768
    s_add_u32 m0, s41, 0
    s_nop 0
    buffer_load_dwordx4 v4, s[12:15], s38 offen lds
    s_waitcnt lgkmcnt(8)
    v_mfma_f32_16x16x32_bf16 v[36:39], v[116:119], v[92:95], v[36:39]
    ds_read_b64_tr_b16 v[72:73], v9 offset:192
    ds_read_b64_tr_b16 v[74:75], v9 offset:4800
    v_mfma_f32_16x16x32_bf16 v[40:43], v[120:123], v[92:95], v[40:43]
    ds_read_b64_tr_b16 v[76:77], v9 offset:224
    ds_read_b64_tr_b16 v[78:79], v9 offset:4832
    v_mfma_f32_16x16x32_bf16 v[20:23], v[144:147], v[120:123], v[20:23]
    s_waitcnt lgkmcnt(10)
    v_mfma_f32_16x16x32_bf16 v[44:47], v[116:119], v[96:99], v[44:47]
    ds_read_b64_tr_b16 v[80:81], v9 offset:256
    ds_read_b64_tr_b16 v[82:83], v9 offset:4864
    s_add_u32 m0, s41, 18432
    s_nop 0
    buffer_load_dwordx4 v7, s[8:11], s39 offen lds
    s_add_u32 s39, s39, 128
    v_mfma_f32_16x16x32_bf16 v[48:51], v[120:123], v[96:99], v[48:51]
    v_mfma_f32_16x16x32_bf16 v[24:27], v[120:123], v[120:123], v[24:27]
    s_waitcnt lgkmcnt(10)
    v_mfma_f32_16x16x32_bf16 v[52:55], v[116:119], v[100:103], v[52:55]
    v_mfma_f32_16x16x32_bf16 v[56:59], v[120:123], v[100:103], v[56:59]
    s_add_u32 m0, s41, 8192
    s_nop 0
    buffer_load_dwordx4 v5, s[12:15], s38 offen lds
    s_cmp_lg_u32 s36, 3
    s_cbranch_scc1 k234_mid_kernel_a_v1cs3
    v_mfma_f32_16x16x32_bf16 v[124:127], v[88:91], v[144:147], v[124:127]
    v_mfma_f32_16x16x32_bf16 v[128:131], v[92:95], v[144:147], v[128:131]
    v_mfma_f32_16x16x32_bf16 v[132:135], v[96:99], v[144:147], v[132:135]
    v_mfma_f32_16x16x32_bf16 v[136:139], v[100:103], v[144:147], v[136:139]
k234_mid_kernel_a_v1cs3:
    s_waitcnt lgkmcnt(6)
    v_mfma_f32_16x16x32_bf16 v[28:31], v[108:111], v[68:71], v[28:31]
    ds_read_b128 v[116:119], v15 offset:18432
    ds_read_b128 v[120:123], v15 offset:20480
    v_mfma_f32_16x16x32_bf16 v[32:35], v[112:115], v[68:71], v[32:35]
    ds_read_b64_tr_b16 v[88:89], v9 offset:9376
    ds_read_b64_tr_b16 v[90:91], v9 offset:13984
    s_add_u32 m0, s41, 26624
    s_nop 0
    buffer_load_dwordx4 v7, s[8:11], s40 offen lds
    s_add_u32 s40, s40, 128
    s_waitcnt lgkmcnt(8)
    v_mfma_f32_16x16x32_bf16 v[36:39], v[108:111], v[72:75], v[36:39]
    ds_read_b64_tr_b16 v[92:93], v9 offset:9408
    ds_read_b64_tr_b16 v[94:95], v9 offset:14016
    v_mfma_f32_16x16x32_bf16 v[40:43], v[112:115], v[72:75], v[40:43]
    ds_read_b64_tr_b16 v[96:97], v9 offset:9440
    ds_read_b64_tr_b16 v[98:99], v9 offset:14048
    v_mfma_f32_16x16x32_bf16 v[20:23], v[144:147], v[112:115], v[20:23]
    s_waitcnt lgkmcnt(10)
    v_mfma_f32_16x16x32_bf16 v[44:47], v[108:111], v[76:79], v[44:47]
    ds_read_b64_tr_b16 v[100:101], v9 offset:9472
    ds_read_b64_tr_b16 v[102:103], v9 offset:14080
    s_add_u32 s38, s38, 221184
    v_mfma_f32_16x16x32_bf16 v[48:51], v[112:115], v[76:79], v[48:51]
    v_mfma_f32_16x16x32_bf16 v[24:27], v[112:115], v[112:115], v[24:27]
    s_waitcnt lgkmcnt(10)
    v_mfma_f32_16x16x32_bf16 v[52:55], v[108:111], v[80:83], v[52:55]
    v_mfma_f32_16x16x32_bf16 v[56:59], v[112:115], v[80:83], v[56:59]
    s_cmp_lg_u32 s36, 0
    s_cbranch_scc1 k234_mid_kernel_a_v1cs4
    v_mfma_f32_16x16x32_bf16 v[124:127], v[68:71], v[144:147], v[124:127]
    v_mfma_f32_16x16x32_bf16 v[128:131], v[72:75], v[144:147], v[128:131]
    v_mfma_f32_16x16x32_bf16 v[132:135], v[76:79], v[144:147], v[132:135]
    v_mfma_f32_16x16x32_bf16 v[136:139], v[80:83], v[144:147], v[136:139]
k234_mid_kernel_a_v1cs4:
    s_waitcnt vmcnt(4)
    s_barrier
    s_waitcnt lgkmcnt(6)
    v_mfma_f32_16x16x32_bf16 v[28:31], v[116:119], v[88:91], v[28:31]
    ds_read_b128 v[108:111], v13 offset:53248
    ds_read_b128 v[112:115], v13 offset:55296
    v_mfma_f32_16x16x32_bf16 v[32:35], v[120:123], v[88:91], v[32:35]
    ds_read_b64_tr_b16 v[68:69], v9 offset:34976
    ds_read_b64_tr_b16 v[70:71], v9 offset:39584
    s_add_u32 m0, s41, 34816
    s_nop 0
    buffer_load_dwordx4 v4, s[12:15], s38 offen lds
    s_waitcnt lgkmcnt(8)
    v_mfma_f32_16x16x32_bf16 v[36:39], v[116:119], v[92:95], v[36:39]
    ds_read_b64_tr_b16 v[72:73], v9 offset:35008
    ds_read_b64_tr_b16 v[74:75], v9 offset:39616
    v_mfma_f32_16x16x32_bf16 v[40:43], v[120:123], v[92:95], v[40:43]
    ds_read_b64_tr_b16 v[76:77], v9 offset:35040
    ds_read_b64_tr_b16 v[78:79], v9 offset:39648
    v_mfma_f32_16x16x32_bf16 v[20:23], v[144:147], v[120:123], v[20:23]
    s_waitcnt lgkmcnt(10)
    v_mfma_f32_16x16x32_bf16 v[44:47], v[116:119], v[96:99], v[44:47]
    ds_read_b64_tr_b16 v[80:81], v9 offset:35072
    ds_read_b64_tr_b16 v[82:83], v9 offset:39680
    s_add_u32 m0, s41, 53248
    s_nop 0
    buffer_load_dwordx4 v7, s[8:11], s39 offen lds
    s_add_u32 s39, s39, 128
    v_mfma_f32_16x16x32_bf16 v[48:51], v[120:123], v[96:99], v[48:51]
    v_mfma_f32_16x16x32_bf16 v[24:27], v[120:123], v[120:123], v[24:27]
    s_waitcnt lgkmcnt(10)
    v_mfma_f32_16x16x32_bf16 v[52:55], v[116:119], v[100:103], v[52:55]
    v_mfma_f32_16x16x32_bf16 v[56:59], v[120:123], v[100:103], v[56:59]
    s_add_u32 m0, s41, 43008
    s_nop 0
    buffer_load_dwordx4 v5, s[12:15], s38 offen lds
    s_cmp_lg_u32 s36, 1
    s_cbranch_scc1 k234_mid_kernel_a_v1cs5
    v_mfma_f32_16x16x32_bf16 v[124:127], v[88:91], v[144:147], v[124:127]
    v_mfma_f32_16x16x32_bf16 v[128:131], v[92:95], v[144:147], v[128:131]
    v_mfma_f32_16x16x32_bf16 v[132:135], v[96:99], v[144:147], v[132:135]
    v_mfma_f32_16x16x32_bf16 v[136:139], v[100:103], v[144:147], v[136:139]
k234_mid_kernel_a_v1cs5:
    s_waitcnt lgkmcnt(6)
    v_mfma_f32_16x16x32_bf16 v[28:31], v[108:111], v[68:71], v[28:31]
    ds_read_b128 v[116:119], v15 offset:53248
    ds_read_b128 v[120:123], v15 offset:55296
    v_mfma_f32_16x16x32_bf16 v[32:35], v[112:115], v[68:71], v[32:35]
    ds_read_b64_tr_b16 v[88:89], v9 offset:44192
    ds_read_b64_tr_b16 v[90:91], v9 offset:48800
    s_add_u32 m0, s41, 61440
    s_nop 0
    buffer_load_dwordx4 v7, s[8:11], s40 offen lds
    s_add_u32 s40, s40, 128
    s_waitcnt lgkmcnt(8)
    v_mfma_f32_16x16x32_bf16 v[36:39], v[108:111], v[72:75], v[36:39]
    ds_read_b64_tr_b16 v[92:93], v9 offset:44224
    ds_read_b64_tr_b16 v[94:95], v9 offset:48832
    v_mfma_f32_16x16x32_bf16 v[40:43], v[112:115], v[72:75], v[40:43]
    ds_read_b64_tr_b16 v[96:97], v9 offset:44256
    ds_read_b64_tr_b16 v[98:99], v9 offset:48864
    v_mfma_f32_16x16x32_bf16 v[20:23], v[144:147], v[112:115], v[20:23]
    s_waitcnt lgkmcnt(10)
    v_mfma_f32_16x16x32_bf16 v[44:47], v[108:111], v[76:79], v[44:47]
    ds_read_b64_tr_b16 v[100:101], v9 offset:44288
    ds_read_b64_tr_b16 v[102:103], v9 offset:48896
    s_add_u32 s38, s38, 221184
    v_mfma_f32_16x16x32_bf16 v[48:51], v[112:115], v[76:79], v[48:51]
    v_mfma_f32_16x16x32_bf16 v[24:27], v[112:115], v[112:115], v[24:27]
    s_waitcnt lgkmcnt(10)
    v_mfma_f32_16x16x32_bf16 v[52:55], v[108:111], v[80:83], v[52:55]
    v_mfma_f32_16x16x32_bf16 v[56:59], v[112:115], v[80:83], v[56:59]
    s_cmp_lg_u32 s36, 2
    s_cbranch_scc1 k234_mid_kernel_a_v1cs6
    v_mfma_f32_16x16x32_bf16 v[124:127], v[68:71], v[144:147], v[124:127]
    v_mfma_f32_16x16x32_bf16 v[128:131], v[72:75], v[144:147], v[128:131]
    v_mfma_f32_16x16x32_bf16 v[132:135], v[76:79], v[144:147], v[132:135]
    v_mfma_f32_16x16x32_bf16 v[136:139], v[80:83], v[144:147], v[136:139]
k234_mid_kernel_a_v1cs6:
    s_waitcnt vmcnt(4)
    s_barrier
    s_waitcnt lgkmcnt(6)
    v_mfma_f32_16x16x32_bf16 v[28:31], v[116:119], v[88:91], v[28:31]
    ds_read_b128 v[108:111], v12 offset:18432
    ds_read_b128 v[112:115], v12 offset:20480
    v_mfma_f32_16x16x32_bf16 v[32:35], v[120:123], v[88:91], v[32:35]
    ds_read_b64_tr_b16 v[68:69], v8 offset:160
    ds_read_b64_tr_b16 v[70:71], v8 offset:4768
    s_add_u32 m0, s41, 69632
    s_nop 0
    buffer_load_dwordx4 v4, s[12:15], s38 offen lds
    s_waitcnt lgkmcnt(8)
    v_mfma_f32_16x16x32_bf16 v[36:39], v[116:119], v[92:95], v[36:39]
    ds_read_b64_tr_b16 v[72:73], v8 offset:192
    ds_read_b64_tr_b16 v[74:75], v8 offset:4800
    v_mfma_f32_16x16x32_bf16 v[40:43], v[120:123], v[92:95], v[40:43]
    ds_read_b64_tr_b16 v[76:77], v8 offset:224
    ds_read_b64_tr_b16 v[78:79], v8 offset:4832
    v_mfma_f32_16x16x32_bf16 v[20:23], v[144:147], v[120:123], v[20:23]
    s_waitcnt lgkmcnt(10)
    v_mfma_f32_16x16x32_bf16 v[44:47], v[116:119], v[96:99], v[44:47]
    ds_read_b64_tr_b16 v[80:81], v8 offset:256
    ds_read_b64_tr_b16 v[82:83], v8 offset:4864
    s_add_u32 m0, s41, 88064
    s_nop 0
    buffer_load_dwordx4 v7, s[8:11], s39 offen lds
    s_add_u32 s39, s39, 128
    v_mfma_f32_16x16x32_bf16 v[48:51], v[120:123], v[96:99], v[48:51]
    v_mfma_f32_16x16x32_bf16 v[24:27], v[120:123], v[120:123], v[24:27]
    s_waitcnt lgkmcnt(10)
    v_mfma_f32_16x16x32_bf16 v[52:55], v[116:119], v[100:103], v[52:55]
    v_mfma_f32_16x16x32_bf16 v[56:59], v[120:123], v[100:103], v[56:59]
    s_add_u32 m0, s41, 77824
    s_nop 0
    buffer_load_dwordx4 v5, s[12:15], s38 offen lds
    s_cmp_lg_u32 s36, 3
    s_cbranch_scc1 k234_mid_kernel_a_v1cs7
    v_mfma_f32_16x16x32_bf16 v[124:127], v[88:91], v[144:147], v[124:127]
    v_mfma_f32_16x16x32_bf16 v[128:131], v[92:95], v[144:147], v[128:131]
    v_mfma_f32_16x16x32_bf16 v[132:135], v[96:99], v[144:147], v[132:135]
    v_mfma_f32_16x16x32_bf16 v[136:139], v[100:103], v[144:147], v[136:139]
k234_mid_kernel_a_v1cs7:
    s_waitcnt lgkmcnt(6)
    v_mfma_f32_16x16x32_bf16 v[28:31], v[108:111], v[68:71], v[28:31]
    ds_read_b128 v[116:119], v14 offset:18432
    ds_read_b128 v[120:123], v14 offset:20480
    v_mfma_f32_16x16x32_bf16 v[32:35], v[112:115], v[68:71], v[32:35]
    ds_read_b64_tr_b16 v[88:89], v8 offset:9376
    ds_read_b64_tr_b16 v[90:91], v8 offset:13984
    s_add_u32 m0, s41, 96256
    s_nop 0
    buffer_load_dwordx4 v7, s[8:11], s40 offen lds
    s_add_u32 s40, s40, 128
    s_waitcnt lgkmcnt(8)
    v_mfma_f32_16x16x32_bf16 v[36:39], v[108:111], v[72:75], v[36:39]
    ds_read_b64_tr_b16 v[92:93], v8 offset:9408
    ds_read_b64_tr_b16 v[94:95], v8 offset:14016
    v_mfma_f32_16x16x32_bf16 v[40:43], v[112:115], v[72:75], v[40:43]
    ds_read_b64_tr_b16 v[96:97], v8 offset:9440
    ds_read_b64_tr_b16 v[98:99], v8 offset:14048
    v_mfma_f32_16x16x32_bf16 v[20:23], v[144:147], v[112:115], v[20:23]
    s_waitcnt lgkmcnt(10)
    v_mfma_f32_16x16x32_bf16 v[44:47], v[108:111], v[76:79], v[44:47]
    ds_read_b64_tr_b16 v[100:101], v8 offset:9472
    ds_read_b64_tr_b16 v[102:103], v8 offset:14080
    s_add_u32 s38, s38, 221184
    v_mfma_f32_16x16x32_bf16 v[48:51], v[112:115], v[76:79], v[48:51]
    v_mfma_f32_16x16x32_bf16 v[24:27], v[112:115], v[112:115], v[24:27]
    s_waitcnt lgkmcnt(10)
    v_mfma_f32_16x16x32_bf16 v[52:55], v[108:111], v[80:83], v[52:55]
    v_mfma_f32_16x16x32_bf16 v[56:59], v[112:115], v[80:83], v[56:59]
    s_cmp_lg_u32 s36, 0
    s_cbranch_scc1 k234_mid_kernel_a_v1cs8
    v_mfma_f32_16x16x32_bf16 v[124:127], v[68:71], v[144:147], v[124:127]
    v_mfma_f32_16x16x32_bf16 v[128:131], v[72:75], v[144:147], v[128:131]
    v_mfma_f32_16x16x32_bf16 v[132:135], v[76:79], v[144:147], v[132:135]
    v_mfma_f32_16x16x32_bf16 v[136:139], v[80:83], v[144:147], v[136:139]
k234_mid_kernel_a_v1cs8:
    s_waitcnt vmcnt(4)
    s_barrier
    s_waitcnt lgkmcnt(6)
    v_mfma_f32_16x16x32_bf16 v[28:31], v[116:119], v[88:91], v[28:31]
    ds_read_b128 v[108:111], v12 offset:53248
    ds_read_b128 v[112:115], v12 offset:55296
    v_mfma_f32_16x16x32_bf16 v[32:35], v[120:123], v[88:91], v[32:35]
    ds_read_b64_tr_b16 v[68:69], v8 offset:34976
    ds_read_b64_tr_b16 v[70:71], v8 offset:39584
    s_add_u32 m0, s41, 104448
    s_nop 0
    buffer_load_dwordx4 v4, s[12:15], s38 offen lds
    s_waitcnt lgkmcnt(8)
    v_mfma_f32_16x16x32_bf16 v[36:39], v[116:119], v[92:95], v[36:39]
    ds_read_b64_tr_b16 v[72:73], v8 offset:35008
    ds_read_b64_tr_b16 v[74:75], v8 offset:39616
    v_mfma_f32_16x16x32_bf16 v[40:43], v[120:123], v[92:95], v[40:43]
    ds_read_b64_tr_b16 v[76:77], v8 offset:35040
    ds_read_b64_tr_b16 v[78:79], v8 offset:39648
    v_mfma_f32_16x16x32_bf16 v[20:23], v[144:147], v[120:123], v[20:23]
    s_waitcnt lgkmcnt(10)
    v_mfma_f32_16x16x32_bf16 v[44:47], v[116:119], v[96:99], v[44:47]
    ds_read_b64_tr_b16 v[80:81], v8 offset:35072
    ds_read_b64_tr_b16 v[82:83], v8 offset:39680
    s_add_u32 m0, s41, 122880
    s_nop 0
    buffer_load_dwordx4 v7, s[8:11], s39 offen lds
    s_add_u32 s39, s39, 128
    v_mfma_f32_16x16x32_bf16 v[48:51], v[120:123], v[96:99], v[48:51]
    v_mfma_f32_16x16x32_bf16 v[24:27], v[120:123], v[120:123], v[24:27]
    s_waitcnt lgkmcnt(10)
    v_mfma_f32_16x16x32_bf16 v[52:55], v[116:119], v[100:103], v[52:55]
    v_mfma_f32_16x16x32_bf16 v[56:59], v[120:123], v[100:103], v[56:59]
    s_add_u32 m0, s41, 112640
    s_nop 0
    buffer_load_dwordx4 v5, s[12:15], s38 offen lds
    s_cmp_lg_u32 s36, 1
    s_cbranch_scc1 k234_mid_kernel_a_v1cs9
    v_mfma_f32_16x16x32_bf16 v[124:127], v[88:91], v[144:147], v[124:127]
    v_mfma_f32_16x16x32_bf16 v[128:131], v[92:95], v[144:147], v[128:131]
    v_mfma_f32_16x16x32_bf16 v[132:135], v[96:99], v[144:147], v[132:135]
    v_mfma_f32_16x16x32_bf16 v[136:139], v[100:103], v[144:147], v[136:139]
k234_mid_kernel_a_v1cs9:
    s_waitcnt lgkmcnt(6)
    v_mfma_f32_16x16x32_bf16 v[28:31], v[108:111], v[68:71], v[28:31]
    ds_read_b128 v[116:119], v14 offset:53248
    ds_read_b128 v[120:123], v14 offset:55296
    v_mfma_f32_16x16x32_bf16 v[32:35], v[112:115], v[68:71], v[32:35]
    ds_read_b64_tr_b16 v[88:89], v8 offset:44192
    ds_read_b64_tr_b16 v[90:91], v8 offset:48800
    s_add_u32 m0, s41, 131072
    s_nop 0
    buffer_load_dwordx4 v7, s[8:11], s40 offen lds
    s_add_u32 s40, s40, 128
    s_waitcnt lgkmcnt(8)
    v_mfma_f32_16x16x32_bf16 v[36:39], v[108:111], v[72:75], v[36:39]
    ds_read_b64_tr_b16 v[92:93], v8 offset:44224
    ds_read_b64_tr_b16 v[94:95], v8 offset:48832
    v_mfma_f32_16x16x32_bf16 v[40:43], v[112:115], v[72:75], v[40:43]
    ds_read_b64_tr_b16 v[96:97], v8 offset:44256
    ds_read_b64_tr_b16 v[98:99], v8 offset:48864
    v_mfma_f32_16x16x32_bf16 v[20:23], v[144:147], v[112:115], v[20:23]
    s_waitcnt lgkmcnt(10)
    v_mfma_f32_16x16x32_bf16 v[44:47], v[108:111], v[76:79], v[44:47]
    ds_read_b64_tr_b16 v[100:101], v8 offset:44288
    ds_read_b64_tr_b16 v[102:103], v8 offset:48896
    s_add_u32 s38, s38, 221184
    v_mfma_f32_16x16x32_bf16 v[48:51], v[112:115], v[76:79], v[48:51]
    v_mfma_f32_16x16x32_bf16 v[24:27], v[112:115], v[112:115], v[24:27]
    s_waitcnt lgkmcnt(10)
    v_mfma_f32_16x16x32_bf16 v[52:55], v[108:111], v[80:83], v[52:55]
    v_mfma_f32_16x16x32_bf16 v[56:59], v[112:115], v[80:83], v[56:59]
    s_cmp_lg_u32 s36, 2
    s_cbranch_scc1 k234_mid_kernel_a_v1cs10
    v_mfma_f32_16x16x32_bf16 v[124:127], v[68:71], v[144:147], v[124:127]
    v_mfma_f32_16x16x32_bf16 v[128:131], v[72:75], v[144:147], v[128:131]
    v_mfma_f32_16x16x32_bf16 v[132:135], v[76:79], v[144:147], v[132:135]
    v_mfma_f32_16x16x32_bf16 v[136:139], v[80:83], v[144:147], v[136:139]
k234_mid_kernel_a_v1cs10:
    s_waitcnt vmcnt(4)
    s_barrier
    s_waitcnt lgkmcnt(6)
    v_mfma_f32_16x16x32_bf16 v[28:31], v[116:119], v[88:91], v[28:31]
    ds_read_b128 v[108:111], v13 offset:18432
    ds_read_b128 v[112:115], v13 offset:20480
    v_mfma_f32_16x16x32_bf16 v[32:35], v[120:123], v[88:91], v[32:35]
    ds_read_b64_tr_b16 v[68:69], v9 offset:160
    ds_read_b64_tr_b16 v[70:71], v9 offset:4768
    s_add_u32 m0, s41, 0
    s_nop 0
    buffer_load_dwordx4 v4, s[12:15], s38 offen lds
    s_waitcnt lgkmcnt(8)
    v_mfma_f32_16x16x32_bf16 v[36:39], v[116:119], v[92:95], v[36:39]
    ds_read_b64_tr_b16 v[72:73], v9 offset:192
    ds_read_b64_tr_b16 v[74:75], v9 offset:4800
    v_mfma_f32_16x16x32_bf16 v[40:43], v[120:123], v[92:95], v[40:43]
    ds_read_b64_tr_b16 v[76:77], v9 offset:224
    ds_read_b64_tr_b16 v[78:79], v9 offset:4832
    v_mfma_f32_16x16x32_bf16 v[20:23], v[144:147], v[120:123], v[20:23]
    s_waitcnt lgkmcnt(10)
    v_mfma_f32_16x16x32_bf16 v[44:47], v[116:119], v[96:99], v[44:47]
    ds_read_b64_tr_b16 v[80:81], v9 offset:256
    ds_read_b64_tr_b16 v[82:83], v9 offset:4864
    s_add_u32 m0, s41, 18432
    s_nop 0
    buffer_load_dwordx4 v7, s[8:11], s39 offen lds
    s_add_u32 s39, s39, 128
    v_mfma_f32_16x16x32_bf16 v[48:51], v[120:123], v[96:99], v[48:51]
    v_mfma_f32_16x16x32_bf16 v[24:27], v[120:123], v[120:123], v[24:27]
    s_waitcnt lgkmcnt(10)
    v_mfma_f32_16x16x32_bf16 v[52:55], v[116:119], v[100:103], v[52:55]
    v_mfma_f32_16x16x32_bf16 v[56:59], v[120:123], v[100:103], v[56:59]
    s_add_u32 m0, s41, 8192
    s_nop 0
    buffer_load_dwordx4 v5, s[12:15], s38 offen lds
    s_cmp_lg_u32 s36, 3
    s_cbranch_scc1 k234_mid_kernel_a_v1cs11
    v_mfma_f32_16x16x32_bf16 v[124:127], v[88:91], v[144:147], v[124:127]
    v_mfma_f32_16x16x32_bf16 v[128:131], v[92:95], v[144:147], v[128:131]
    v_mfma_f32_16x16x32_bf16 v[132:135], v[96:99], v[144:147], v[132:135]
    v_mfma_f32_16x16x32_bf16 v[136:139], v[100:103], v[144:147], v[136:139]
k234_mid_kernel_a_v1cs11:
    s_waitcnt lgkmcnt(6)
    v_mfma_f32_16x16x32_bf16 v[28:31], v[108:111], v[68:71], v[28:31]
    ds_read_b128 v[116:119], v15 offset:18432
    ds_read_b128 v[120:123], v15 offset:20480
    v_mfma_f32_16x16x32_bf16 v[32:35], v[112:115], v[68:71], v[32:35]
    ds_read_b64_tr_b16 v[88:89], v9 offset:9376
    ds_read_b64_tr_b16 v[90:91], v9 offset:13984
    s_add_u32 m0, s41, 26624
    s_nop 0
    buffer_load_dwordx4 v7, s[8:11], s40 offen lds
    s_add_u32 s40, s40, 128
    s_waitcnt lgkmcnt(8)
    v_mfma_f32_16x16x32_bf16 v[36:39], v[108:111], v[72:75], v[36:39]
    ds_read_b64_tr_b16 v[92:93], v9 offset:9408
    ds_read_b64_tr_b16 v[94:95], v9 offset:14016
    v_mfma_f32_16x16x32_bf16 v[40:43], v[112:115], v[72:75], v[40:43]
    ds_read_b64_tr_b16 v[96:97], v9 offset:9440
    ds_read_b64_tr_b16 v[98:99], v9 offset:14048
    v_mfma_f32_16x16x32_bf16 v[20:23], v[144:147], v[112:115], v[20:23]
    s_waitcnt lgkmcnt(10)
    v_mfma_f32_16x16x32_bf16 v[44:47], v[108:111], v[76:79], v[44:47]
    ds_read_b64_tr_b16 v[100:101], v9 offset:9472
    ds_read_b64_tr_b16 v[102:103], v9 offset:14080
    s_add_u32 s38, s38, 221184
    v_mfma_f32_16x16x32_bf16 v[48:51], v[112:115], v[76:79], v[48:51]
    v_mfma_f32_16x16x32_bf16 v[24:27], v[112:115], v[112:115], v[24:27]
    s_waitcnt lgkmcnt(10)
    v_mfma_f32_16x16x32_bf16 v[52:55], v[108:111], v[80:83], v[52:55]
    v_mfma_f32_16x16x32_bf16 v[56:59], v[112:115], v[80:83], v[56:59]
    s_cmp_lg_u32 s36, 0
    s_cbranch_scc1 k234_mid_kernel_a_v1cs12
    v_mfma_f32_16x16x32_bf16 v[124:127], v[68:71], v[144:147], v[124:127]
    v_mfma_f32_16x16x32_bf16 v[128:131], v[72:75], v[144:147], v[128:131]
    v_mfma_f32_16x16x32_bf16 v[132:135], v[76:79], v[144:147], v[132:135]
    v_mfma_f32_16x16x32_bf16 v[136:139], v[80:83], v[144:147], v[136:139]
k234_mid_kernel_a_v1cs12:
    s_waitcnt vmcnt(4)
    s_barrier
    s_waitcnt lgkmcnt(6)
    v_mfma_f32_16x16x32_bf16 v[28:31], v[116:119], v[88:91], v[28:31]
    ds_read_b128 v[108:111], v13 offset:53248
    ds_read_b128 v[112:115], v13 offset:55296
    v_mfma_f32_16x16x32_bf16 v[32:35], v[120:123], v[88:91], v[32:35]
    ds_read_b64_tr_b16 v[68:69], v9 offset:34976
    ds_read_b64_tr_b16 v[70:71], v9 offset:39584
    s_waitcnt lgkmcnt(8)
    v_mfma_f32_16x16x32_bf16 v[36:39], v[116:119], v[92:95], v[36:39]
    ds_read_b64_tr_b16 v[72:73], v9 offset:35008
    ds_read_b64_tr_b16 v[74:75], v9 offset:39616
    v_mfma_f32_16x16x32_bf16 v[40:43], v[120:123], v[92:95], v[40:43]
    ds_read_b64_tr_b16 v[76:77], v9 offset:35040
    ds_read_b64_tr_b16 v[78:79], v9 offset:39648
    v_mfma_f32_16x16x32_bf16 v[20:23], v[144:147], v[120:123], v[20:23]
    s_waitcnt lgkmcnt(10)
    v_mfma_f32_16x16x32_bf16 v[44:47], v[116:119], v[96:99], v[44:47]
    ds_read_b64_tr_b16 v[80:81], v9 offset:35072
    ds_read_b64_tr_b16 v[82:83], v9 offset:39680
    v_mfma_f32_16x16x32_bf16 v[48:51], v[120:123], v[96:99], v[48:51]
    v_mfma_f32_16x16x32_bf16 v[24:27], v[120:123], v[120:123], v[24:27]
    s_waitcnt lgkmcnt(10)
    v_mfma_f32_16x16x32_bf16 v[52:55], v[116:119], v[100:103], v[52:55]
    v_mfma_f32_16x16x32_bf16 v[56:59], v[120:123], v[100:103], v[56:59]
    s_cmp_lg_u32 s36, 1
    s_cbranch_scc1 k234_mid_kernel_a_v1cs13
    v_mfma_f32_16x16x32_bf16 v[124:127], v[88:91], v[144:147], v[124:127]
    v_mfma_f32_16x16x32_bf16 v[128:131], v[92:95], v[144:147], v[128:131]
    v_mfma_f32_16x16x32_bf16 v[132:135], v[96:99], v[144:147], v[132:135]
    v_mfma_f32_16x16x32_bf16 v[136:139], v[100:103], v[144:147], v[136:139]
k234_mid_kernel_a_v1cs13:
    s_waitcnt lgkmcnt(6)
    v_mfma_f32_16x16x32_bf16 v[28:31], v[108:111], v[68:71], v[28:31]
    ds_read_b128 v[116:119], v15 offset:53248
    ds_read_b128 v[120:123], v15 offset:55296
    v_mfma_f32_16x16x32_bf16 v[32:35], v[112:115], v[68:71], v[32:35]
    ds_read_b64_tr_b16 v[88:89], v9 offset:44192
    ds_read_b64_tr_b16 v[90:91], v9 offset:48800
    s_waitcnt lgkmcnt(8)
    v_mfma_f32_16x16x32_bf16 v[36:39], v[108:111], v[72:75], v[36:39]
    ds_read_b64_tr_b16 v[92:93], v9 offset:44224
    ds_read_b64_tr_b16 v[94:95], v9 offset:48832
    v_mfma_f32_16x16x32_bf16 v[40:43], v[112:115], v[72:75], v[40:43]
    ds_read_b64_tr_b16 v[96:97], v9 offset:44256
    ds_read_b64_tr_b16 v[98:99], v9 offset:48864
    v_mfma_f32_16x16x32_bf16 v[20:23], v[144:147], v[112:115], v[20:23]
    s_waitcnt lgkmcnt(10)
    v_mfma_f32_16x16x32_bf16 v[44:47], v[108:111], v[76:79], v[44:47]
    ds_read_b64_tr_b16 v[100:101], v9 offset:44288
    ds_read_b64_tr_b16 v[102:103], v9 offset:48896
    v_mfma_f32_16x16x32_bf16 v[48:51], v[112:115], v[76:79], v[48:51]
    v_mfma_f32_16x16x32_bf16 v[24:27], v[112:115], v[112:115], v[24:27]
    s_waitcnt lgkmcnt(10)
    v_mfma_f32_16x16x32_bf16 v[52:55], v[108:111], v[80:83], v[52:55]
    v_mfma_f32_16x16x32_bf16 v[56:59], v[112:115], v[80:83], v[56:59]
    s_cmp_lg_u32 s36, 2
    s_cbranch_scc1 k234_mid_kernel_a_v1cs14
    v_mfma_f32_16x16x32_bf16 v[124:127], v[68:71], v[144:147], v[124:127]
    v_mfma_f32_16x16x32_bf16 v[128:131], v[72:75], v[144:147], v[128:131]
    v_mfma_f32_16x16x32_bf16 v[132:135], v[76:79], v[144:147], v[132:135]
    v_mfma_f32_16x16x32_bf16 v[136:139], v[80:83], v[144:147], v[136:139]
k234_mid_kernel_a_v1cs14:
    s_waitcnt vmcnt(0)
    s_barrier
    s_waitcnt lgkmcnt(6)
    v_mfma_f32_16x16x32_bf16 v[28:31], v[116:119], v[88:91], v[28:31]
    ds_read_b128 v[108:111], v12 offset:18432
    ds_read_b128 v[112:115], v12 offset:20480
    v_mfma_f32_16x16x32_bf16 v[32:35], v[120:123], v[88:91], v[32:35]
    ds_read_b64_tr_b16 v[68:69], v8 offset:160
    ds_read_b64_tr_b16 v[70:71], v8 offset:4768
    s_waitcnt lgkmcnt(8)
    v_mfma_f32_16x16x32_bf16 v[36:39], v[116:119], v[92:95], v[36:39]
    ds_read_b64_tr_b16 v[72:73], v8 offset:192
    ds_read_b64_tr_b16 v[74:75], v8 offset:4800
    v_mfma_f32_16x16x32_bf16 v[40:43], v[120:123], v[92:95], v[40:43]
    ds_read_b64_tr_b16 v[76:77], v8 offset:224
    ds_read_b64_tr_b16 v[78:79], v8 offset:4832
    v_mfma_f32_16x16x32_bf16 v[20:23], v[144:147], v[120:123], v[20:23]
    s_waitcnt lgkmcnt(10)
    v_mfma_f32_16x16x32_bf16 v[44:47], v[116:119], v[96:99], v[44:47]
    ds_read_b64_tr_b16 v[80:81], v8 offset:256
    ds_read_b64_tr_b16 v[82:83], v8 offset:4864
    v_mfma_f32_16x16x32_bf16 v[48:51], v[120:123], v[96:99], v[48:51]
    v_mfma_f32_16x16x32_bf16 v[24:27], v[120:123], v[120:123], v[24:27]
    s_waitcnt lgkmcnt(10)
    v_mfma_f32_16x16x32_bf16 v[52:55], v[116:119], v[100:103], v[52:55]
    v_mfma_f32_16x16x32_bf16 v[56:59], v[120:123], v[100:103], v[56:59]
    s_cmp_lg_u32 s36, 3
    s_cbranch_scc1 k234_mid_kernel_a_v1cs15
    v_mfma_f32_16x16x32_bf16 v[124:127], v[88:91], v[144:147], v[124:127]
    v_mfma_f32_16x16x32_bf16 v[128:131], v[92:95], v[144:147], v[128:131]
    v_mfma_f32_16x16x32_bf16 v[132:135], v[96:99], v[144:147], v[132:135]
    v_mfma_f32_16x16x32_bf16 v[136:139], v[100:103], v[144:147], v[136:139]
k234_mid_kernel_a_v1cs15:
    s_waitcnt lgkmcnt(6)
    v_mfma_f32_16x16x32_bf16 v[28:31], v[108:111], v[68:71], v[28:31]
    ds_read_b128 v[116:119], v14 offset:18432
    ds_read_b128 v[120:123], v14 offset:20480
    v_mfma_f32_16x16x32_bf16 v[32:35], v[112:115], v[68:71], v[32:35]
    ds_read_b64_tr_b16 v[88:89], v8 offset:9376
    ds_read_b64_tr_b16 v[90:91], v8 offset:13984
    s_waitcnt lgkmcnt(8)
    v_mfma_f32_16x16x32_bf16 v[36:39], v[108:111], v[72:75], v[36:39]
    ds_read_b64_tr_b16 v[92:93], v8 offset:9408
    ds_read_b64_tr_b16 v[94:95], v8 offset:14016
    v_mfma_f32_16x16x32_bf16 v[40:43], v[112:115], v[72:75], v[40:43]
    ds_read_b64_tr_b16 v[96:97], v8 offset:9440
    ds_read_b64_tr_b16 v[98:99], v8 offset:14048
    v_mfma_f32_16x16x32_bf16 v[20:23], v[144:147], v[112:115], v[20:23]
    s_waitcnt lgkmcnt(10)
    v_mfma_f32_16x16x32_bf16 v[44:47], v[108:111], v[76:79], v[44:47]
    ds_read_b64_tr_b16 v[100:101], v8 offset:9472
    ds_read_b64_tr_b16 v[102:103], v8 offset:14080
    v_mfma_f32_16x16x32_bf16 v[48:51], v[112:115], v[76:79], v[48:51]
    v_mfma_f32_16x16x32_bf16 v[24:27], v[112:115], v[112:115], v[24:27]
    s_waitcnt lgkmcnt(10)
    v_mfma_f32_16x16x32_bf16 v[52:55], v[108:111], v[80:83], v[52:55]
    v_mfma_f32_16x16x32_bf16 v[56:59], v[112:115], v[80:83], v[56:59]
    s_cmp_lg_u32 s36, 0
    s_cbranch_scc1 k234_mid_kernel_a_v1cs16
    v_mfma_f32_16x16x32_bf16 v[124:127], v[68:71], v[144:147], v[124:127]
    v_mfma_f32_16x16x32_bf16 v[128:131], v[72:75], v[144:147], v[128:131]
    v_mfma_f32_16x16x32_bf16 v[132:135], v[76:79], v[144:147], v[132:135]
    v_mfma_f32_16x16x32_bf16 v[136:139], v[80:83], v[144:147], v[136:139]
k234_mid_kernel_a_v1cs16:
    s_waitcnt lgkmcnt(6)
    v_mfma_f32_16x16x32_bf16 v[28:31], v[116:119], v[88:91], v[28:31]
    v_mfma_f32_16x16x32_bf16 v[32:35], v[120:123], v[88:91], v[32:35]
    s_waitcnt lgkmcnt(4)
    v_mfma_f32_16x16x32_bf16 v[36:39], v[116:119], v[92:95], v[36:39]
    v_mfma_f32_16x16x32_bf16 v[40:43], v[120:123], v[92:95], v[40:43]
    v_mfma_f32_16x16x32_bf16 v[20:23], v[144:147], v[120:123], v[20:23]
    s_waitcnt lgkmcnt(2)
    v_mfma_f32_16x16x32_bf16 v[44:47], v[116:119], v[96:99], v[44:47]
    v_mfma_f32_16x16x32_bf16 v[48:51], v[120:123], v[96:99], v[48:51]
    v_mfma_f32_16x16x32_bf16 v[24:27], v[120:123], v[120:123], v[24:27]
    s_waitcnt lgkmcnt(0)
    v_mfma_f32_16x16x32_bf16 v[52:55], v[116:119], v[100:103], v[52:55]
    v_mfma_f32_16x16x32_bf16 v[56:59], v[120:123], v[100:103], v[56:59]
    s_cmp_lg_u32 s36, 1
    s_cbranch_scc1 k234_mid_kernel_a_v1cs17
    v_mfma_f32_16x16x32_bf16 v[124:127], v[88:91], v[144:147], v[124:127]
    v_mfma_f32_16x16x32_bf16 v[128:131], v[92:95], v[144:147], v[128:131]
    v_mfma_f32_16x16x32_bf16 v[132:135], v[96:99], v[144:147], v[132:135]
    v_mfma_f32_16x16x32_bf16 v[136:139], v[100:103], v[144:147], v[136:139]
k234_mid_kernel_a_v1cs17:
    s_nop 5
    v_and_b32 v17, 1, v2
    v_cmp_eq_u32 vcc, 1, v17
    s_nop 1
    v_cndmask_b32 v24, v24, v25, vcc
    v_cndmask_b32 v26, v26, v27, vcc
    v_and_b32 v17, 2, v2
    v_cmp_eq_u32 vcc, 2, v17
    s_nop 1
    v_cndmask_b32 v24, v24, v26, vcc
    v_lshrrev_b32 v17, 2, v2
    v_cmp_eq_u32 vcc, v17, v3
    s_nop 1
    v_cndmask_b32 v22, 0, v24, vcc
    v_mov_b32 v17, v22
    s_nop 1
    v_permlane32_swap_b32 v22, v17
    v_add_f32 v22, v22, v17
    v_mov_b32 v17, v22
    s_nop 1
    v_permlane16_swap_b32 v22, v17
    v_add_f32 v22, v22, v17
    v_mul_f32 v20, 0x3ae38e39, v20
    v_mul_f32 v17, v20, v20
    v_mov_b32 v18, 0x3ae38e39
    v_fma_f32 v22, v22, v18, -v17
    v_max_f32 v22, 0, v22
    v_add_f32 v22, 0x3727c5ac, v22
    v_rsq_f32 v22, v22
    s_mul_i32 s25, s36, 576
    v_lshlrev_b32 v16, 4, v3
    v_add_u32 v16, s25, v16
    v_add_u32 v16, 139264, v16
    s_lshl_b32 s25, s36, 8
    s_add_u32 s25, s25, 141696
    v_lshlrev_b32 v19, 3, v2
    v_add_u32 v19, s25, v19
    v_mul_f32 v23, v20, v22
    ds_write_b64 v19, v[22:23]
    v_cmp_eq_u32 vcc, 0, v2
    s_nop 0
    s_and_saveexec_b64 s[32:33], vcc
    ds_write_b128 v16, v[124:127] offset:320
    ds_write_b128 v16, v[128:131] offset:384
    ds_write_b128 v16, v[132:135] offset:448
    ds_write_b128 v16, v[136:139] offset:512
    s_mov_b64 exec, s[32:33]
    s_lshl_b32 s25, s36, 8
    s_add_u32 s25, s25, 141568
    v_lshlrev_b32 v19, 5, v3
    v_add_u32 v19, s25, v19
    v_lshlrev_b32 v16, 2, v2
    v_add_u32 v16, 139264, v16
    s_lshr_b32 s34, s23, 5
    s_mul_i32 s34, s34, 18944
    s_bfe_u32 s35, s23, 0x20003
    s_mul_i32 s35, s35, 37888
    s_add_u32 s34, s34, s35
    s_and_b32 s35, s23, 7
    s_waitcnt lgkmcnt(0)
    s_barrier
    ds_read_b128 v[108:111], v19 offset:0
    ds_read_b128 v[112:115], v19 offset:16
    ds_read_b128 v[116:119], v19 offset:128
    ds_read_b128 v[120:123], v19 offset:144
    ds_read_b32 v148, v16 offset:320
    ds_read_b32 v149, v16 offset:896
    ds_read_b32 v150, v16 offset:1472
    ds_read_b32 v151, v16 offset:2048
    ds_read_b32 v152, v16 offset:384
    ds_read_b32 v153, v16 offset:960
    ds_read_b32 v154, v16 offset:1536
    ds_read_b32 v155, v16 offset:2112
    ds_read_b32 v156, v16 offset:448
    ds_read_b32 v157, v16 offset:1024
    ds_read_b32 v158, v16 offset:1600
    ds_read_b32 v159, v16 offset:2176
    ds_read_b32 v160, v16 offset:512
    ds_read_b32 v161, v16 offset:1088
    ds_read_b32 v162, v16 offset:1664
    ds_read_b32 v163, v16 offset:2240
    s_sub_u32 s25, s22, 8
    s_mul_i32 s25, s25, 1212416
    s_add_u32 s25, s25, s34
    s_and_b32 s26, s35, 4
    s_mul_i32 s26, s26, 1216
    s_add_u32 s25, s25, s26
    s_add_u32 s25, s25, 2368512
    v_mul_u32_u24 v19, 304, v3
    s_and_b32 s26, s35, 3
    s_mul_i32 s26, s26, 1216
    v_add_u32 v19, s26, v19
    v_add_u32 v16, 80, v2
    v_mul_u32_u24 v17, 3641, v16
    v_lshrrev_b32 v17, 16, v17
    v_mul_u32_u24 v18, 4576, v17
    v_lshl_add_u32 v18, v16, 4, v18
    v_add_u32 v168, v18, v19
    s_waitcnt lgkmcnt(12)
    v_add_f32 v148, v148, v149
    v_add_f32 v150, v150, v151
    v_add_f32 v148, v148, v150
    v_mul_f32 v24, v109, v148
    v_mul_f32 v25, v111, v148
    v_mul_f32 v26, v113, v148
    v_mul_f32 v27, v115, v148
    v_fma_f32 v28, v28, v108, -v24
    v_fma_f32 v29, v29, v110, -v25
    v_fma_f32 v30, v30, v112, -v26
    v_fma_f32 v31, v31, v114, -v27
    v_cvt_pk_bf16_f32 v68, v28, v29
    v_cvt_pk_bf16_f32 v69, v30, v31
    v_mul_f32 v24, v117, v148
    v_mul_f32 v25, v119, v148
    v_mul_f32 v26, v121, v148
    v_mul_f32 v27, v123, v148
    v_fma_f32 v32, v32, v116, -v24
    v_fma_f32 v33, v33, v118, -v25
    v_fma_f32 v34, v34, v120, -v26
    v_fma_f32 v35, v35, v122, -v27
    v_cvt_pk_bf16_f32 v70, v32, v33
    v_cvt_pk_bf16_f32 v71, v34, v35
    ds_write_b128 v168, v[68:71]
    v_add_u32 v16, 96, v2
    v_mul_u32_u24 v17, 3641, v16
    v_lshrrev_b32 v17, 16, v17
    v_mul_u32_u24 v18, 4576, v17
    v_lshl_add_u32 v18, v16, 4, v18
    v_add_u32 v169, v18, v19
    s_waitcnt lgkmcnt(8)
    v_add_f32 v152, v152, v153
    v_add_f32 v154, v154, v155
    v_add_f32 v152, v152, v154
    v_mul_f32 v24, v109, v152
    v_mul_f32 v25, v111, v152
    v_mul_f32 v26, v113, v152
    v_mul_f32 v27, v115, v152
    v_fma_f32 v36, v36, v108, -v24
    v_fma_f32 v37, v37, v110, -v25
    v_fma_f32 v38, v38, v112, -v26
    v_fma_f32 v39, v39, v114, -v27
    v_cvt_pk_bf16_f32 v72, v36, v37
    v_cvt_pk_bf16_f32 v73, v38, v39
    v_mul_f32 v24, v117, v152
    v_mul_f32 v25, v119, v152
    v_mul_f32 v26, v121, v152
    v_mul_f32 v27, v123, v152
    v_fma_f32 v40, v40, v116, -v24
    v_fma_f32 v41, v41, v118, -v25
    v_fma_f32 v42, v42, v120, -v26
    v_fma_f32 v43, v43, v122, -v27
    v_cvt_pk_bf16_f32 v74, v40, v41
    v_cvt_pk_bf16_f32 v75, v42, v43
    ds_write_b128 v169, v[72:75]
    v_add_u32 v16, 112, v2
    v_mul_u32_u24 v17, 3641, v16
    v_lshrrev_b32 v17, 16, v17
    v_mul_u32_u24 v18, 4576, v17
    v_lshl_add_u32 v18, v16, 4, v18
    v_add_u32 v170, v18, v19
    s_waitcnt lgkmcnt(4)
    v_add_f32 v156, v156, v157
    v_add_f32 v158, v158, v159
    v_add_f32 v156, v156, v158
    v_mul_f32 v24, v109, v156
    v_mul_f32 v25, v111, v156
    v_mul_f32 v26, v113, v156
    v_mul_f32 v27, v115, v156
    v_fma_f32 v44, v44, v108, -v24
    v_fma_f32 v45, v45, v110, -v25
    v_fma_f32 v46, v46, v112, -v26
    v_fma_f32 v47, v47, v114, -v27
    v_cvt_pk_bf16_f32 v76, v44, v45
    v_cvt_pk_bf16_f32 v77, v46, v47
    v_mul_f32 v24, v117, v156
    v_mul_f32 v25, v119, v156
    v_mul_f32 v26, v121, v156
    v_mul_f32 v27, v123, v156
    v_fma_f32 v48, v48, v116, -v24
    v_fma_f32 v49, v49, v118, -v25
    v_fma_f32 v50, v50, v120, -v26
    v_fma_f32 v51, v51, v122, -v27
    v_cvt_pk_bf16_f32 v78, v48, v49
    v_cvt_pk_bf16_f32 v79, v50, v51
    ds_write_b128 v170, v[76:79]
    v_add_u32 v16, 128, v2
    v_mul_u32_u24 v17, 3641, v16
    v_lshrrev_b32 v17, 16, v17
    v_mul_u32_u24 v18, 4576, v17
    v_lshl_add_u32 v18, v16, 4, v18
    v_add_u32 v171, v18, v19
    s_waitcnt lgkmcnt(0)
    v_add_f32 v160, v160, v161
    v_add_f32 v162, v162, v163
    v_add_f32 v160, v160, v162
    v_mul_f32 v24, v109, v160
    v_mul_f32 v25, v111, v160
    v_mul_f32 v26, v113, v160
    v_mul_f32 v27, v115, v160
    v_fma_f32 v52, v52, v108, -v24
    v_fma_f32 v53, v53, v110, -v25
    v_fma_f32 v54, v54, v112, -v26
    v_fma_f32 v55, v55, v114, -v27
    v_cvt_pk_bf16_f32 v80, v52, v53
    v_cvt_pk_bf16_f32 v81, v54, v55
    v_mul_f32 v24, v117, v160
    v_mul_f32 v25, v119, v160
    v_mul_f32 v26, v121, v160
    v_mul_f32 v27, v123, v160
    v_fma_f32 v56, v56, v116, -v24
    v_fma_f32 v57, v57, v118, -v25
    v_fma_f32 v58, v58, v120, -v26
    v_fma_f32 v59, v59, v122, -v27
    v_cvt_pk_bf16_f32 v82, v56, v57
    v_cvt_pk_bf16_f32 v83, v58, v59
    ds_write_b128 v171, v[80:83]
    v_bfe_u32 v16, v1, 2, 3
    v_mul_u32_u24 v16, 4864, v16
    v_and_b32 v17, 3, v1
    v_mul_u32_u24 v17, 304, v17
    v_add3_u32 v16, v16, v17, s26
    ds_write_b128 v16, v[144:147] offset:288
    v_add_u32 v16, 0, v0
    v_min_u32 v16, 2431, v16
    v_mul_u32_u24 v17, 3450, v16
    v_lshrrev_b32 v17, 20, v17
    v_mul_u32_u24 v17, 146688, v17
    v_lshlrev_b32 v148, 4, v16
    v_add_u32 v168, v148, v17
    v_add_u32 v16, 512, v0
    v_min_u32 v16, 2431, v16
    v_mul_u32_u24 v17, 3450, v16
    v_lshrrev_b32 v17, 20, v17
    v_mul_u32_u24 v17, 146688, v17
    v_lshlrev_b32 v149, 4, v16
    v_add_u32 v169, v149, v17
    v_add_u32 v16, 1024, v0
    v_min_u32 v16, 2431, v16
    v_mul_u32_u24 v17, 3450, v16
    v_lshrrev_b32 v17, 20, v17
    v_mul_u32_u24 v17, 146688, v17
    v_lshlrev_b32 v150, 4, v16
    v_add_u32 v170, v150, v17
    v_add_u32 v16, 1536, v0
    v_min_u32 v16, 2431, v16
    v_mul_u32_u24 v17, 3450, v16
    v_lshrrev_b32 v17, 20, v17
    v_mul_u32_u24 v17, 146688, v17
    v_lshlrev_b32 v151, 4, v16
    v_add_u32 v171, v151, v17
    v_add_u32 v16, 2048, v0
    v_min_u32 v16, 2431, v16
    v_mul_u32_u24 v17, 3450, v16
    v_lshrrev_b32 v17, 20, v17
    v_mul_u32_u24 v17, 146688, v17
    v_lshlrev_b32 v152, 4, v16
    v_add_u32 v172, v152, v17
    s_waitcnt lgkmcnt(0)
    s_barrier
    ds_read_b128 v[28:31], v148
    ds_read_b128 v[32:35], v149
    ds_read_b128 v[36:39], v150
    ds_read_b128 v[40:43], v151
    ds_read_b128 v[44:47], v152
    s_waitcnt lgkmcnt(4)
    buffer_store_dwordx4 v[28:31], v168, s[16:19], s25 offen sc1
    s_waitcnt lgkmcnt(3)
    buffer_store_dwordx4 v[32:35], v169, s[16:19], s25 offen sc1
    s_waitcnt lgkmcnt(2)
    buffer_store_dwordx4 v[36:39], v170, s[16:19], s25 offen sc1
    s_waitcnt lgkmcnt(1)
    buffer_store_dwordx4 v[40:43], v171, s[16:19], s25 offen sc1
    s_waitcnt lgkmcnt(0)
    s_cmp_ge_u32 s20, 6
    s_cbranch_scc1 k234_mid_kernel_a_fin
    buffer_store_dwordx4 v[44:47], v172, s[16:19], s25 offen sc1
    s_branch k234_mid_kernel_a_fin
k234_mid_kernel_a_aux:
    s_sub_u32 s25, s2, 192
    s_lshr_b32 s26, s25, 3
    s_lshl_b32 s27, s20, 3
    s_add_u32 s27, s27, s26
    s_bfe_u32 s34, s2, 0x20001
    s_mul_i32 s34, s34, 589824
    s_and_b32 s35, s2, 1
    s_mul_i32 s35, s35, 1664
    v_mul_u32_u24 v19, 1152, v1
    s_waitcnt lgkmcnt(0)
    s_mov_b32 s8, s4
    s_mov_b32 s9, s5
    s_mov_b32 s10, 2359296
    s_mov_b32 s11, 0x00020000
    s_mov_b32 s12, s6
    s_mov_b32 s13, s7
    s_mov_b32 s14, 1990656
    s_mov_b32 s15, 0x00020000
    s_mov_b32 s16, s30
    s_mov_b32 s17, s31
    s_mov_b32 s18, 67108864
    s_mov_b32 s19, 0x00020000
    s_cmp_ge_u32 s27, 154
    s_cbranch_scc1 k234_mid_kernel_a_he
    s_mul_i32 s36, s27, 2979
    s_lshr_b32 s36, s36, 16
    s_mul_i32 s37, s36, 22
    s_sub_u32 s37, s27, s37
    s_add_u32 s36, s36, 2
    s_cmp_ge_u32 s37, 8
    s_cbranch_scc1 k234_mid_kernel_a_hw0
    s_mul_i32 s37, s37, 73728
    s_lshl_b32 s36, s36, 7
    s_add_u32 s36, s36, s37
    s_add_u32 s36, s36, s34
    buffer_load_dword v28, v19, s[8:11], s36 offen
    s_branch k234_mid_kernel_a_hn0
k234_mid_kernel_a_hw0:
    s_sub_u32 s37, s37, 8
    s_lshl_b32 s37, s37, 6
    v_add_u32 v16, s37, v1
    v_mul_u32_u24 v17, 4682, v16
    v_lshrrev_b32 v17, 16, v17
    v_mul_u32_u24 v18, 14, v17
    v_sub_u32 v18, v16, v18
    v_mul_u32_u24 v17, 3456, v17
    v_lshl_add_u32 v17, v18, 7, v17
    s_mul_i32 s36, s36, 221184
    s_add_u32 s36, s36, s35
    buffer_load_dword v28, v17, s[12:15], s36 offen
k234_mid_kernel_a_hn0:
    s_add_u32 s27, s27, 64
    s_cmp_ge_u32 s27, 154
    s_cbranch_scc1 k234_mid_kernel_a_he
    s_mul_i32 s36, s27, 2979
    s_lshr_b32 s36, s36, 16
    s_mul_i32 s37, s36, 22
    s_sub_u32 s37, s27, s37
    s_add_u32 s36, s36, 2
    s_cmp_ge_u32 s37, 8
    s_cbranch_scc1 k234_mid_kernel_a_hw1
    s_mul_i32 s37, s37, 73728
    s_lshl_b32 s36, s36, 7
    s_add_u32 s36, s36, s37
    s_add_u32 s36, s36, s34
    buffer_load_dword v29, v19, s[8:11], s36 offen
    s_branch k234_mid_kernel_a_hn1
k234_mid_kernel_a_hw1:
    s_sub_u32 s37, s37, 8
    s_lshl_b32 s37, s37, 6
    v_add_u32 v16, s37, v1
    v_mul_u32_u24 v17, 4682, v16
    v_lshrrev_b32 v17, 16, v17
    v_mul_u32_u24 v18, 14, v17
    v_sub_u32 v18, v16, v18
    v_mul_u32_u24 v17, 3456, v17
    v_lshl_add_u32 v17, v18, 7, v17
    s_mul_i32 s36, s36, 221184
    s_add_u32 s36, s36, s35
    buffer_load_dword v29, v17, s[12:15], s36 offen
k234_mid_kernel_a_hn1:
    s_add_u32 s27, s27, 64
    s_cmp_ge_u32 s27, 154
    s_cbranch_scc1 k234_mid_kernel_a_he
    s_mul_i32 s36, s27, 2979
    s_lshr_b32 s36, s36, 16
    s_mul_i32 s37, s36, 22
    s_sub_u32 s37, s27, s37
    s_add_u32 s36, s36, 2
    s_cmp_ge_u32 s37, 8
    s_cbranch_scc1 k234_mid_kernel_a_hw2
    s_mul_i32 s37, s37, 73728
    s_lshl_b32 s36, s36, 7
    s_add_u32 s36, s36, s37
    s_add_u32 s36, s36, s34
    buffer_load_dword v30, v19, s[8:11], s36 offen
    s_branch k234_mid_kernel_a_hn2
k234_mid_kernel_a_hw2:
    s_sub_u32 s37, s37, 8
    s_lshl_b32 s37, s37, 6
    v_add_u32 v16, s37, v1
    v_mul_u32_u24 v17, 4682, v16
    v_lshrrev_b32 v17, 16, v17
    v_mul_u32_u24 v18, 14, v17
    v_sub_u32 v18, v16, v18
    v_mul_u32_u24 v17, 3456, v17
    v_lshl_add_u32 v17, v18, 7, v17
    s_mul_i32 s36, s36, 221184
    s_add_u32 s36, s36, s35
    buffer_load_dword v30, v17, s[12:15], s36 offen
k234_mid_kernel_a_hn2:
    s_add_u32 s27, s27, 64
k234_mid_kernel_a_he:
    s_cmp_lg_u32 s20, 6
    s_cbranch_scc1 k234_mid_kernel_a_aux2
    s_cmp_lg_u32 s26, 7
    s_cbranch_scc1 k234_mid_kernel_a_aux2
    s_getpc_b64 s[44:45]
k234_mid_kernel_a_apc:
    s_and_b32 s27, s2, 7
    s_lshl_b32 s27, s27, 13
    v_lshlrev_b32 v16, 7, v1
    v_add_u32 v16, s27, v16
    v_min_u32 v16, text_end-k234_mid_kernel_a_apc, v16
    global_load_dword v17, v16, s[44:45]
k234_mid_kernel_a_aux2:
    s_lshl_b32 s27, s25, 3
    s_add_u32 s27, s27, s20
    v_lshlrev_b32 v16, 4, v1
    v_mov_b32 v104, -1
    v_mov_b32 v105, -1
    v_mov_b32 v106, -1
    v_mov_b32 v107, -1
    s_cmp_ge_u32 s27, 128
    s_cbranch_scc1 k234_mid_kernel_a_na
    s_lshr_b32 s36, s27, 1
    s_mul_i32 s36, s36, 18432
    s_and_b32 s37, s27, 1
    s_lshl_b32 s37, s37, 10
    s_add_u32 s36, s36, s37
    s_add_u32 s36, s36, 8404992
    buffer_store_dwordx4 v[104:107], v16, s[16:19], s36 offen sc1
    s_add_u32 s36, s36, 1179648
    buffer_store_dwordx4 v[104:107], v16, s[16:19], s36 offen sc1
    s_cmp_ge_u32 s27, 88
    s_cbranch_scc1 k234_mid_kernel_a_na
    s_lshl_b32 s37, s27, 10
    s_add_u32 s37, s37, 8298496
    buffer_store_dwordx4 v[104:107], v16, s[16:19], s37 offen sc1
k234_mid_kernel_a_na:
    s_waitcnt vmcnt(0)
    s_barrier
    s_cmp_lg_u32 s20, 0
    s_cbranch_scc1 k234_mid_kernel_a_nd
    s_cmp_ge_u32 s25, 16
    s_cbranch_scc1 k234_mid_kernel_a_nd
    s_mov_b32 s52, s48
    s_mov_b32 s53, s49
    s_mov_b32 s54, 256
    s_mov_b32 s55, 0x00020000
    v_mov_b32 v16, s25
    v_lshlrev_b32 v16, 4, v16
    s_mov_b64 exec, 1
    buffer_store_dword v104, v16, s[52:55], 0 offen sc1
    s_mov_b64 exec, -1
k234_mid_kernel_a_nd:
    s_mov_b32 s12, s28
    s_mov_b32 s13, s29
    s_mov_b32 s14, 663552
    s_mov_b32 s15, 0x00020000
    s_cmp_ge_u32 s25, 54
    s_cbranch_scc1 k234_mid_kernel_a_pk9
    s_mul_i32 s34, s25, 7282
    s_lshr_b32 s34, s34, 16
    s_mul_i32 s35, s34, 9
    s_sub_u32 s35, s25, s35
    s_cmp_ge_u32 s20, 4
    s_cbranch_scc1 k234_mid_kernel_a_pk2
    s_mul_i32 s36, s20, 192
    s_mul_i32 s37, s34, 192
    s_cmp_eq_u32 s35, 8
    s_cbranch_scc1 k234_mid_kernel_a_pk0
    s_mul_i32 s27, s35, 82944
    s_add_u32 s37, s37, s27
    v_add_u32 v16, 0, v1
    v_add_u32 v16, s36, v16
    v_mul_u32_u24 v17, 5462, v16
    v_lshrrev_b32 v17, 16, v17
    v_mul_u32_u24 v18, 12, v17
    v_sub_u32 v18, v16, v18
    v_lshrrev_b32 v16, 1, v17
    v_and_b32 v16, 2, v16
    v_xor_b32 v18, v18, v16
    v_lshlrev_b32 v18, 4, v18
    v_lshrrev_b32 v16, 5, v17
    v_bfe_u32 v104, v17, 4, 1
    v_bfe_u32 v19, v17, 3, 1
    v_lshl_add_u32 v19, v16, 1, v19
    v_mul_u32_u24 v19, 18, v19
    v_lshl_add_u32 v19, v104, 3, v19
    v_and_b32 v105, 7, v17
    v_add_u32 v19, v19, v105
    v_mul_u32_u24 v19, 1152, v19
    v_add_u32 v108, v19, v18
    v_add_u32 v16, 64, v1
    v_add_u32 v16, s36, v16
    v_mul_u32_u24 v17, 5462, v16
    v_lshrrev_b32 v17, 16, v17
    v_mul_u32_u24 v18, 12, v17
    v_sub_u32 v18, v16, v18
    v_lshrrev_b32 v16, 1, v17
    v_and_b32 v16, 2, v16
    v_xor_b32 v18, v18, v16
    v_lshlrev_b32 v18, 4, v18
    v_lshrrev_b32 v16, 5, v17
    v_bfe_u32 v104, v17, 4, 1
    v_bfe_u32 v19, v17, 3, 1
    v_lshl_add_u32 v19, v16, 1, v19
    v_mul_u32_u24 v19, 18, v19
    v_lshl_add_u32 v19, v104, 3, v19
    v_and_b32 v105, 7, v17
    v_add_u32 v19, v19, v105
    v_mul_u32_u24 v19, 1152, v19
    v_add_u32 v109, v19, v18
    v_add_u32 v16, 128, v1
    v_add_u32 v16, s36, v16
    v_mul_u32_u24 v17, 5462, v16
    v_lshrrev_b32 v17, 16, v17
    v_mul_u32_u24 v18, 12, v17
    v_sub_u32 v18, v16, v18
    v_lshrrev_b32 v16, 1, v17
    v_and_b32 v16, 2, v16
    v_xor_b32 v18, v18, v16
    v_lshlrev_b32 v18, 4, v18
    v_lshrrev_b32 v16, 5, v17
    v_bfe_u32 v104, v17, 4, 1
    v_bfe_u32 v19, v17, 3, 1
    v_lshl_add_u32 v19, v16, 1, v19
    v_mul_u32_u24 v19, 18, v19
    v_lshl_add_u32 v19, v104, 3, v19
    v_and_b32 v105, 7, v17
    v_add_u32 v19, v19, v105
    v_mul_u32_u24 v19, 1152, v19
    v_add_u32 v110, v19, v18
    s_branch k234_mid_kernel_a_pk1
k234_mid_kernel_a_pk0:
    v_add_u32 v16, 0, v1
    v_add_u32 v16, s36, v16
    v_mul_u32_u24 v17, 5462, v16
    v_lshrrev_b32 v17, 16, v17
    v_mul_u32_u24 v18, 12, v17
    v_sub_u32 v18, v16, v18
    v_lshrrev_b32 v16, 1, v17
    v_and_b32 v16, 2, v16
    v_xor_b32 v18, v18, v16
    v_lshlrev_b32 v18, 4, v18
    v_lshrrev_b32 v16, 5, v17
    v_bfe_u32 v104, v17, 4, 1
    v_bfe_u32 v19, v17, 2, 2
    v_lshl_add_u32 v19, v16, 2, v19
    v_lshlrev_b32 v19, 2, v19
    v_lshl_add_u32 v19, v104, 1, v19
    v_bfe_u32 v105, v17, 1, 1
    v_add_u32 v19, v19, v105
    v_mul_u32_u24 v19, 18, v19
    v_and_b32 v105, 1, v17
    v_add3_u32 v19, v19, v105, 16
    v_mul_u32_u24 v19, 1152, v19
    v_add_u32 v108, v19, v18
    v_add_u32 v16, 64, v1
    v_add_u32 v16, s36, v16
    v_mul_u32_u24 v17, 5462, v16
    v_lshrrev_b32 v17, 16, v17
    v_mul_u32_u24 v18, 12, v17
    v_sub_u32 v18, v16, v18
    v_lshrrev_b32 v16, 1, v17
    v_and_b32 v16, 2, v16
    v_xor_b32 v18, v18, v16
    v_lshlrev_b32 v18, 4, v18
    v_lshrrev_b32 v16, 5, v17
    v_bfe_u32 v104, v17, 4, 1
    v_bfe_u32 v19, v17, 2, 2
    v_lshl_add_u32 v19, v16, 2, v19
    v_lshlrev_b32 v19, 2, v19
    v_lshl_add_u32 v19, v104, 1, v19
    v_bfe_u32 v105, v17, 1, 1
    v_add_u32 v19, v19, v105
    v_mul_u32_u24 v19, 18, v19
    v_and_b32 v105, 1, v17
    v_add3_u32 v19, v19, v105, 16
    v_mul_u32_u24 v19, 1152, v19
    v_add_u32 v109, v19, v18
    v_add_u32 v16, 128, v1
    v_add_u32 v16, s36, v16
    v_mul_u32_u24 v17, 5462, v16
    v_lshrrev_b32 v17, 16, v17
    v_mul_u32_u24 v18, 12, v17
    v_sub_u32 v18, v16, v18
    v_lshrrev_b32 v16, 1, v17
    v_and_b32 v16, 2, v16
    v_xor_b32 v18, v18, v16
    v_lshlrev_b32 v18, 4, v18
    v_lshrrev_b32 v16, 5, v17
    v_bfe_u32 v104, v17, 4, 1
    v_bfe_u32 v19, v17, 2, 2
    v_lshl_add_u32 v19, v16, 2, v19
    v_lshlrev_b32 v19, 2, v19
    v_lshl_add_u32 v19, v104, 1, v19
    v_bfe_u32 v105, v17, 1, 1
    v_add_u32 v19, v19, v105
    v_mul_u32_u24 v19, 18, v19
    v_and_b32 v105, 1, v17
    v_add3_u32 v19, v19, v105, 16
    v_mul_u32_u24 v19, 1152, v19
    v_add_u32 v110, v19, v18
k234_mid_kernel_a_pk1:
    s_mul_i32 s36, s20, 3072
    s_add_u32 m0, s36, 0
    s_nop 0
    buffer_load_dwordx4 v108, s[12:15], s37 offen lds
    s_add_u32 m0, s36, 1024
    s_nop 0
    buffer_load_dwordx4 v109, s[12:15], s37 offen lds
    s_add_u32 m0, s36, 2048
    s_nop 0
    buffer_load_dwordx4 v110, s[12:15], s37 offen lds
    s_waitcnt vmcnt(0)
k234_mid_kernel_a_pk2:
    s_barrier
    s_cmp_ge_u32 s20, 6
    s_cbranch_scc1 k234_mid_kernel_a_pk9
    v_lshrrev_b32 v16, 2, v1
    v_mul_u32_u24 v16, 192, v16
    v_and_b32 v17, 3, v1
    v_lshl_add_u32 v16, v17, 3, v16
    v_bfe_u32 v17, v1, 4, 1
    s_and_b32 s36, s20, 1
    v_xor_b32 v17, s36, v17
    v_lshl_add_u32 v16, v17, 5, v16
    s_lshr_b32 s36, s20, 1
    s_lshl_b32 s36, s36, 6
    v_add_u32 v16, s36, v16
    v_lshlrev_b32 v17, 4, v1
    s_mul_i32 s36, s34, 18
    s_lshl_b32 s37, s35, 1
    s_add_u32 s36, s36, s37
    s_mul_i32 s36, s36, 6
    s_add_u32 s36, s36, s20
    s_lshl_b32 s36, s36, 10
    s_add_u32 s36, s36, 7405568
    s_add_u32 s37, s36, 6144
    ds_read_b64_tr_b16 v[112:113], v16 offset:0
    ds_read_b64_tr_b16 v[114:115], v16 offset:3072
    ds_read_b64_tr_b16 v[116:117], v16 offset:6144
    ds_read_b64_tr_b16 v[118:119], v16 offset:9216
    s_waitcnt lgkmcnt(0)
    buffer_store_dwordx4 v[112:115], v17, s[16:19], s36 offen sc1
    buffer_store_dwordx4 v[116:119], v17, s[16:19], s37 offen sc1
k234_mid_kernel_a_pk9:
    s_cmp_lg_u32 s20, 7
    s_cbranch_scc1 k234_mid_kernel_a_fin
    s_cmp_ge_u32 s25, 36
    s_cbranch_scc1 k234_mid_kernel_a_fin
    s_lshl_b32 s25, s25, 4
    v_add_u32 v19, s25, v2
    v_mul_u32_u24 v16, 1152, v19
    v_mul_u32_u24 v17, 288, v3
    v_add_u32 v16, v16, v17
    buffer_load_dwordx4 v[28:31], v16, s[12:15], 0 offen offset:0
    buffer_load_dwordx4 v[32:35], v16, s[12:15], 0 offen offset:16
    buffer_load_dwordx4 v[36:39], v16, s[12:15], 0 offen offset:32
    buffer_load_dwordx4 v[40:43], v16, s[12:15], 0 offen offset:48
    buffer_load_dwordx4 v[44:47], v16, s[12:15], 0 offen offset:64
    buffer_load_dwordx4 v[48:51], v16, s[12:15], 0 offen offset:80
    buffer_load_dwordx4 v[52:55], v16, s[12:15], 0 offen offset:96
    buffer_load_dwordx4 v[56:59], v16, s[12:15], 0 offen offset:112
    buffer_load_dwordx4 v[60:63], v16, s[12:15], 0 offen offset:128
    buffer_load_dwordx4 v[64:67], v16, s[12:15], 0 offen offset:144
    buffer_load_dwordx4 v[68:71], v16, s[12:15], 0 offen offset:160
    buffer_load_dwordx4 v[72:75], v16, s[12:15], 0 offen offset:176
    buffer_load_dwordx4 v[76:79], v16, s[12:15], 0 offen offset:192
    buffer_load_dwordx4 v[80:83], v16, s[12:15], 0 offen offset:208
    buffer_load_dwordx4 v[84:87], v16, s[12:15], 0 offen offset:224
    buffer_load_dwordx4 v[88:91], v16, s[12:15], 0 offen offset:240
    buffer_load_dwordx4 v[92:95], v16, s[12:15], 0 offen offset:256
    buffer_load_dwordx4 v[96:99], v16, s[12:15], 0 offen offset:272
    v_mov_b32 v20, 0
    v_mul_u32_u24 v104, 3641, v19
    v_lshrrev_b32 v104, 16, v104
    v_mul_u32_u24 v105, 18, v104
    v_sub_u32 v105, v19, v105
    v_lshrrev_b32 v106, 1, v104
    v_and_b32 v107, 1, v104
    v_lshlrev_b32 v107, 1, v107
    v_bfe_u32 v17, v105, 2, 1
    v_or_b32 v107, v107, v17
    v_bfe_u32 v108, v105, 3, 1
    v_lshlrev_b32 v108, 2, v108
    v_and_b32 v17, 3, v105
    v_or_b32 v108, v108, v17
    v_cmp_le_u32 vcc, 16, v105
    v_lshrrev_b32 v17, 4, v104
    v_add_u32 v17, 16, v17
    v_cndmask_b32 v106, v106, v17, vcc
    v_bfe_u32 v17, v104, 2, 2
    v_cndmask_b32 v107, v107, v17, vcc
    v_and_b32 v17, 3, v104
    v_lshlrev_b32 v17, 1, v17
    v_and_b32 v18, 1, v105
    v_or_b32 v17, v17, v18
    v_cndmask_b32 v108, v108, v17, vcc
    v_lshlrev_b32 v17, 1, v108
    v_lshl_add_u32 v17, v107, 5, v17
    v_lshl_add_u32 v17, v106, 7, v17
    v_and_b32 v18, 1, v3
    v_lshl_add_u32 v19, v18, 4, v17
    v_lshlrev_b32 v18, 4, v18
    s_waitcnt vmcnt(0)
    v_dot2_f32_bf16 v20, v28, s24, v20
    v_dot2_f32_bf16 v20, v29, s24, v20
    v_dot2_f32_bf16 v20, v30, s24, v20
    v_dot2_f32_bf16 v20, v31, s24, v20
    v_dot2_f32_bf16 v20, v32, s24, v20
    v_dot2_f32_bf16 v20, v33, s24, v20
    v_dot2_f32_bf16 v20, v34, s24, v20
    v_dot2_f32_bf16 v20, v35, s24, v20
    v_dot2_f32_bf16 v20, v36, s24, v20
    v_dot2_f32_bf16 v20, v37, s24, v20
    v_dot2_f32_bf16 v20, v38, s24, v20
    v_dot2_f32_bf16 v20, v39, s24, v20
    v_dot2_f32_bf16 v20, v40, s24, v20
    v_dot2_f32_bf16 v20, v41, s24, v20
    v_dot2_f32_bf16 v20, v42, s24, v20
    v_dot2_f32_bf16 v20, v43, s24, v20
    v_dot2_f32_bf16 v20, v44, s24, v20
    v_dot2_f32_bf16 v20, v45, s24, v20
    v_dot2_f32_bf16 v20, v46, s24, v20
    v_dot2_f32_bf16 v20, v47, s24, v20
    v_dot2_f32_bf16 v20, v48, s24, v20
    v_dot2_f32_bf16 v20, v49, s24, v20
    v_dot2_f32_bf16 v20, v50, s24, v20
    v_dot2_f32_bf16 v20, v51, s24, v20
    v_dot2_f32_bf16 v20, v52, s24, v20
    v_dot2_f32_bf16 v20, v53, s24, v20
    v_dot2_f32_bf16 v20, v54, s24, v20
    v_dot2_f32_bf16 v20, v55, s24, v20
    v_dot2_f32_bf16 v20, v56, s24, v20
    v_dot2_f32_bf16 v20, v57, s24, v20
    v_dot2_f32_bf16 v20, v58, s24, v20
    v_dot2_f32_bf16 v20, v59, s24, v20
    v_dot2_f32_bf16 v20, v60, s24, v20
    v_dot2_f32_bf16 v20, v61, s24, v20
    v_dot2_f32_bf16 v20, v62, s24, v20
    v_dot2_f32_bf16 v20, v63, s24, v20
    v_dot2_f32_bf16 v20, v64, s24, v20
    v_dot2_f32_bf16 v20, v65, s24, v20
    v_dot2_f32_bf16 v20, v66, s24, v20
    v_dot2_f32_bf16 v20, v67, s24, v20
    v_dot2_f32_bf16 v20, v68, s24, v20
    v_dot2_f32_bf16 v20, v69, s24, v20
    v_dot2_f32_bf16 v20, v70, s24, v20
    v_dot2_f32_bf16 v20, v71, s24, v20
    v_dot2_f32_bf16 v20, v72, s24, v20
    v_dot2_f32_bf16 v20, v73, s24, v20
    v_dot2_f32_bf16 v20, v74, s24, v20
    v_dot2_f32_bf16 v20, v75, s24, v20
    v_dot2_f32_bf16 v20, v76, s24, v20
    v_dot2_f32_bf16 v20, v77, s24, v20
    v_dot2_f32_bf16 v20, v78, s24, v20
    v_dot2_f32_bf16 v20, v79, s24, v20
    v_dot2_f32_bf16 v20, v80, s24, v20
    v_dot2_f32_bf16 v20, v81, s24, v20
    v_dot2_f32_bf16 v20, v82, s24, v20
    v_dot2_f32_bf16 v20, v83, s24, v20
    v_dot2_f32_bf16 v20, v84, s24, v20
    v_dot2_f32_bf16 v20, v85, s24, v20
    v_dot2_f32_bf16 v20, v86, s24, v20
    v_dot2_f32_bf16 v20, v87, s24, v20
    v_dot2_f32_bf16 v20, v88, s24, v20
    v_dot2_f32_bf16 v20, v89, s24, v20
    v_dot2_f32_bf16 v20, v90, s24, v20
    v_dot2_f32_bf16 v20, v91, s24, v20
    v_dot2_f32_bf16 v20, v92, s24, v20
    v_dot2_f32_bf16 v20, v93, s24, v20
    v_dot2_f32_bf16 v20, v94, s24, v20
    v_dot2_f32_bf16 v20, v95, s24, v20
    v_dot2_f32_bf16 v20, v96, s24, v20
    v_dot2_f32_bf16 v20, v97, s24, v20
    v_dot2_f32_bf16 v20, v98, s24, v20
    v_dot2_f32_bf16 v20, v99, s24, v20
    s_nop 2
    v_mov_b32 v17, v20
    s_nop 1
    v_permlane32_swap_b32 v20, v17
    v_add_f32 v20, v20, v17
    v_mov_b32 v17, v20
    s_nop 1
    v_permlane16_swap_b32 v20, v17
    v_add_f32 v20, v20, v17
    v_cvt_pk_bf16_f32 v16, v20, v20
    v_and_b32 v17, 0xffff0000, v16
    v_sub_f32 v17, v20, v17
    v_cvt_pk_bf16_f32 v112, v20, v17
    v_lshrrev_b32 v112, v18, v112
    s_mov_b32 s25, 7323648
    buffer_store_short v112, v19, s[16:19], s25 offen sc1
k234_mid_kernel_a_fin:
    s_mov_b64 exec, -1
    s_mov_b32 s52, s48
    s_mov_b32 s53, s49
    s_mov_b32 s54, 256
    s_mov_b32 s55, 0x00020000
    v_min_u32 v16, 15, v1
    v_lshlrev_b32 v16, 4, v16
    s_cmp_lg_u32 s20, 0
    s_cbranch_scc1 k234_mid_kernel_a_f1
    buffer_load_dword v17, v16, s[52:55], 0 offen sc1
k234_mid_kernel_a_f1:
    s_waitcnt vmcnt(0)
    s_barrier
    s_cmp_lg_u32 s20, 0
    s_cbranch_scc1 k234_mid_kernel_a_f3
    s_mov_b32 s51, 100000
k234_mid_kernel_a_f2:
    v_cmp_ne_u32 vcc, -1, v17
    s_sub_u32 s51, s51, 1
    s_cmp_le_i32 s51, 0
    s_cbranch_scc1 k234_mid_kernel_a_f4
    s_nop 1
    s_cbranch_vccz k234_mid_kernel_a_f4
    s_sleep 8
    buffer_load_dword v17, v16, s[52:55], 0 offen sc1
    s_waitcnt vmcnt(0)
    s_branch k234_mid_kernel_a_f2
k234_mid_kernel_a_f4:
    v_mov_b32 v16, 0
    s_mov_b64 exec, 1
    buffer_store_dword v16, v16, s[16:19], s50 offen sc1
    s_mov_b64 exec, -1
k234_mid_kernel_a_f3:
    s_mov_b64 exec, -1
k234_mid_kernel_a_end:
    s_nop 7
    s_load_dwordx2 s[4:5], s[0:1], 72
    s_load_dwordx4 s[24:27], s[0:1], 32
    s_load_dwordx2 s[28:29], s[0:1], 48
    s_load_dwordx2 s[30:31], s[0:1], 16
    s_load_dwordx2 s[40:41], s[0:1], 0
    v_lshrrev_b32 v2, 6, v0
    v_and_b32 v1, 63, v0
    v_readfirstlane_b32 s12, v2
    v_lshlrev_b32 v7, 4, v1
    s_cmp_lg_u32 s12, 7
    s_cbranch_scc1 k234_mid_kernel_cpf
    s_getpc_b64 s[36:37]
k234_mid_kernel_pc:
    s_lshr_b32 s38, s2, 3
    s_and_b32 s38, s38, 3
    s_lshl_b32 s38, s38, 13
    v_and_b32 v2, 63, v0
    v_lshlrev_b32 v2, 7, v2
    v_add_u32 v2, s38, v2
    v_min_u32 v2, k234_mid_kernel_aend-k234_mid_kernel_pc, v2
    global_load_dword v128, v2, s[36:37]
k234_mid_kernel_cpf:
    s_and_b32 s17, s2, 7
    s_lshr_b32 s18, s2, 3
    s_lshl_b32 s13, s17, 2
    s_lshr_b32 s19, s18, 3
    s_add_u32 s13, s13, s19
    s_and_b32 s18, s18, 7
    s_lshl_b32 s14, s18, 3
    s_add_u32 s14, s14, s12
    s_mul_i32 s16, s13, 151552
    s_add_u32 s16, s16, 2359296
    s_mov_b32 s15, 0x07060302
    s_waitcnt lgkmcnt(0)
    s_mov_b32 s8, s4
    s_mov_b32 s9, s5
    s_mov_b32 s10, 67108864
    s_mov_b32 s11, 0x00020000
    s_cmp_lg_u32 s12, 0
    s_cbranch_scc1 k234_mid_kernel_qn
    s_lshr_b32 s17, s13, 3
    s_lshl_b32 s17, s17, 4
    s_lshl_b32 s19, s18, 1
    s_add_u32 s19, s19, s17
    s_add_u32 s17, s17, 64
    s_lshr_b32 s20, s2, 3
    s_lshr_b32 s21, s20, 2
    s_sub_u32 s20, s20, s21
    s_bfe_u32 s20, s20, 0x10001
    s_and_b32 s21, s2, 7
    s_lshl_b32 s21, s21, 1
    s_add_u32 s20, s20, s21
    v_and_b32 v2, 15, v1
    v_bfe_u32 v3, v1, 4, 1
    v_lshl_add_u32 v2, v3, 6, v2
    v_add_u32 v2, s17, v2
    v_and_b32 v3, 1, v1
    v_add_u32 v3, s19, v3
    v_mov_b32 v4, s20
    v_cmp_gt_u32 vcc, 32, v1
    s_nop 1
    v_cndmask_b32 v2, v3, v2, vcc
    v_cmp_gt_u32 vcc, 48, v1
    s_nop 1
    v_cndmask_b32 v2, v4, v2, vcc
    v_lshlrev_b32 v2, 7, v2
    s_mov_b32 s17, 8298496
    s_mov_b32 s19, 100000
k234_mid_kernel_qp:
    buffer_load_dword v3, v2, s[8:11], s17 offen sc1
    s_waitcnt vmcnt(0)
    v_cmp_ne_u32 vcc, 0, v3
    s_sub_u32 s19, s19, 1
    s_cmp_le_i32 s19, 0
    s_cbranch_scc1 k234_mid_kernel_qn
    s_nop 1
    s_cbranch_vccz k234_mid_kernel_qn
    s_sleep 4
    s_branch k234_mid_kernel_qp
k234_mid_kernel_qn:
    s_barrier
    s_lshl_b32 s17, s13, 16
    s_lshl_b32 s18, s14, 10
    s_add_u32 s17, s17, s18
    buffer_load_dwordx4 v[96:99], v7, s[8:11], s17 offen sc1
    s_lshl_b32 s17, s13, 13
    s_lshl_b32 s18, s14, 7
    s_add_u32 s17, s17, s18
    s_add_u32 s17, s17, 2097152
    v_and_b32 v2, 31, v0
    v_lshlrev_b32 v2, 2, v2
    buffer_load_dword v6, v2, s[8:11], s17 offen sc1
    s_lshr_b32 s17, s13, 3
    s_lshl_b32 s17, s17, 13
    s_and_b32 s18, s13, 7
    s_lshl_b32 s18, s18, 6
    s_add_u32 s17, s17, s18
    s_add_u32 s17, s17, 7208960
    v_lshrrev_b32 v3, 2, v1
    v_lshlrev_b32 v3, 9, v3
    v_and_b32 v4, 3, v1
    v_lshl_add_u32 v3, v4, 4, v3
    buffer_load_dwordx4 v[72:75], v3, s[8:11], s17 offen sc1
    s_lshl_b32 s38, s12, 10
    s_add_u32 s39, s16, s38
    s_add_u32 m0, s38, 0
    s_nop 0
    buffer_load_dwordx4 v7, s[8:11], s39 offen sc1 lds
    s_add_u32 s39, s39, 8192
    s_add_u32 m0, s38, 8192
    s_nop 0
    buffer_load_dwordx4 v7, s[8:11], s39 offen sc1 lds
    s_add_u32 s39, s39, 8192
    s_add_u32 m0, s38, 16384
    s_nop 0
    buffer_load_dwordx4 v7, s[8:11], s39 offen sc1 lds
    s_add_u32 s39, s39, 8192
    s_lshr_b32 s17, s13, 1
    s_lshl_b32 s17, s17, 10
    s_and_b32 s18, s13, 1
    s_lshl_b32 s18, s18, 9
    s_add_u32 s17, s17, s18
    s_mul_i32 s18, s14, 36864
    s_add_u32 s18, s18, 8388608
    s_add_u32 s42, s17, s18
    v_bfe_u32 v3, v1, 4, 1
    v_mul_u32_u24 v3, 18432, v3
    v_and_b32 v4, 15, v1
    v_lshl_add_u32 v2, v4, 4, v3
    v_lshl_add_u32 v139, v4, 2, v3
    v_lshrrev_b32 v4, 5, v1
    v_lshl_add_u32 v138, v4, 8, v2
    s_lshl_b32 s19, s13, 6
    s_add_u32 s19, s19, 16384
    s_add_u32 s43, s19, s18
    v_mov_b32 v118, v7
    v_and_b32 v2, 31, v0
    v_and_b32 v3, 3, v0
    v_or_b32 v4, 4, v3
    v_subrev_u32 v5, 20, v2
    v_cmp_gt_u32 vcc, 8, v5
    s_nop 1
    v_cndmask_b32 v4, v4, v3, vcc
    v_cmp_gt_u32 vcc, 19, v2
    s_nop 1
    v_cndmask_b32 v4, v4, v2, vcc
    v_lshlrev_b32 v4, 4, v4
    v_lshrrev_b32 v3, 5, v1
    v_mul_u32_u24 v3, 304, v3
    s_mov_b32 s17, 9216
    v_add3_u32 v121, v4, v3, s17
    v_add_u32 v119, 56832, v118
    v_add_u32 v122, 56832, v121
    v_add_u32 v120, 113664, v118
    v_add_u32 v123, 113664, v121
    v_mov_b32 v100, 0
    v_mov_b32 v101, 0
    v_mov_b32 v102, 0
    v_mov_b32 v103, 0
    v_mov_b32 v104, 0
    v_mov_b32 v105, 0
    v_mov_b32 v106, 0
    v_mov_b32 v107, 0
    v_mov_b32 v108, 0
    v_mov_b32 v109, 0
    v_mov_b32 v110, 0
    v_mov_b32 v111, 0
    v_mov_b32 v112, 0
    v_mov_b32 v113, 0
    v_mov_b32 v114, 0
    v_mov_b32 v115, 0
    v_mov_b32 v116, 0
    v_mov_b32 v117, 0
    v_mov_b32 v56, 0
    v_mov_b32 v57, 0
    v_mov_b32 v58, 0
    v_mov_b32 v59, 0
    v_mov_b32 v60, 0
    v_mov_b32 v61, 0
    v_mov_b32 v62, 0
    v_mov_b32 v63, 0
    v_mov_b32 v64, 0
    v_mov_b32 v65, 0
    v_mov_b32 v66, 0
    v_mov_b32 v67, 0
    v_mov_b32 v68, 0
    v_mov_b32 v69, 0
    v_mov_b32 v70, 0
    v_mov_b32 v71, 0
    s_mov_b32 s48, s40
    s_mov_b32 s49, s41
    s_mov_b32 s50, 2359296
    s_mov_b32 s51, 0x00020000
    s_lshr_b32 s56, s2, 3
    s_and_b32 s57, s56, 3
    s_cmp_lg_u32 s57, 3
    s_cselect_b32 s54, 1, 0
    s_cmp_lt_u32 s2, 252
    s_cselect_b32 s54, s54, 0
    s_lshr_b32 s57, s56, 2
    s_sub_u32 s56, s56, s57
    s_lshr_b32 s57, s56, 2
    s_mul_i32 s58, s57, 192
    s_mul_i32 s52, s57, 110592
    s_lshl_b32 s53, s12, 10
    s_add_u32 s52, s52, s53
    s_add_u32 s52, s52, 7405568
    s_and_b32 s57, s2, 7
    s_lshl_b32 s57, s57, 2
    s_and_b32 s56, s56, 3
    s_add_u32 s57, s57, s56
    s_lshl_b32 s57, s57, 2
    s_and_b32 s56, s12, 3
    s_add_u32 s57, s57, s56
    s_lshl_b32 s57, s57, 4
    v_and_b32 v2, 15, v1
    v_add_u32 v2, s57, v2
    v_mul_u32_u24 v130, 1152, v2
    v_bfe_u32 v3, v1, 4, 1
    v_lshl_add_u32 v130, v3, 5, v130
    v_lshrrev_b32 v3, 5, v1
    v_lshl_add_u32 v130, v3, 4, v130
    v_lshlrev_b32 v131, 2, v2
    s_mov_b32 s57, 7241728
    s_and_b32 s17, s2, 7
    s_lshr_b32 s18, s2, 3
    s_mul_i32 s19, s17, 31
    s_min_u32 s17, s17, 4
    s_add_u32 s19, s19, s17
    s_add_u32 s19, s19, s18
    s_mul_i32 s19, s19, 9363
    s_lshr_b32 s19, s19, 16
    s_min_u32 s19, s19, 35
    s_lshl_b32 s19, s19, 8
    s_add_u32 s55, s19, 3244032
    v_lshrrev_b32 v2, 4, v0
    v_and_b32 v3, 7, v2
    v_bfe_u32 v4, v0, 1, 3
    v_xor_b32 v3, v3, v4
    v_and_b32 v4, 1, v0
    v_lshl_add_u32 v3, v3, 1, v4
    v_mul_u32_u24 v2, 9216, v2
    v_lshl_add_u32 v132, v3, 4, v2
    v_lshrrev_b32 v2, 2, v1
    v_and_b32 v3, 7, v2
    v_xor_b32 v3, s12, v3
    v_lshlrev_b32 v3, 5, v3
    v_lshl_add_u32 v3, v2, 8, v3
    v_and_b32 v4, 3, v1
    v_lshl_add_u32 v133, v4, 3, v3
    s_mov_b32 s60, s24
    s_mov_b32 s61, s25
    s_mov_b32 s62, 5308416
    s_mov_b32 s63, 0x00020000
    s_waitcnt vmcnt(3)
    v_dot2_f32_bf16 v2, v96, v96, 0
    v_dot2_f32_bf16 v2, v97, v97, v2
    v_dot2_f32_bf16 v2, v98, v98, v2
    v_dot2_f32_bf16 v2, v99, v99, v2
    v_max_f32_dpp v72, v72, v72 row_ror:8 row_mask:0xf bank_mask:0xf
    v_max_f32_dpp v73, v73, v73 row_ror:8 row_mask:0xf bank_mask:0xf
    v_max_f32_dpp v74, v74, v74 row_ror:8 row_mask:0xf bank_mask:0xf
    v_max_f32_dpp v72, v72, v72 row_ror:4 row_mask:0xf bank_mask:0xf
    v_max_f32_dpp v73, v73, v73 row_ror:4 row_mask:0xf bank_mask:0xf
    v_max_f32_dpp v74, v74, v74 row_ror:4 row_mask:0xf bank_mask:0xf
    v_max_f32_dpp v72, v72, v72 row_ror:2 row_mask:0xf bank_mask:0xf
    v_max_f32_dpp v73, v73, v73 row_ror:2 row_mask:0xf bank_mask:0xf
    v_max_f32_dpp v74, v74, v74 row_ror:2 row_mask:0xf bank_mask:0xf
    v_max_f32_dpp v72, v72, v72 row_ror:1 row_mask:0xf bank_mask:0xf
    v_max_f32_dpp v73, v73, v73 row_ror:1 row_mask:0xf bank_mask:0xf
    v_max_f32_dpp v74, v74, v74 row_ror:1 row_mask:0xf bank_mask:0xf
    v_mov_b32 v3, v2
    s_nop 1
    v_permlane32_swap_b32 v2, v3
    v_add_f32 v2, v2, v3
    v_dot2_f32_bf16 v2, v6, v6, v2
    v_mov_b32 v76, v72
    v_mov_b32 v77, v73
    v_mov_b32 v78, v74
    v_permlane32_swap_b32 v72, v76
    v_permlane32_swap_b32 v73, v77
    v_permlane32_swap_b32 v74, v78
    v_max_f32 v72, v72, v76
    v_mov_b32 v76, v72
    v_max_f32 v73, v73, v77
    v_mov_b32 v77, v73
    v_max_f32 v74, v74, v78
    v_mov_b32 v78, v74
    v_permlane16_swap_b32 v72, v76
    v_permlane16_swap_b32 v73, v77
    v_permlane16_swap_b32 v74, v78
    v_max_f32 v72, v72, v76
    v_max_f32 v73, v73, v77
    v_max_f32 v74, v74, v78
    v_add_f32 v72, v72, v73
    v_add_f32 v72, v72, v74
    v_mul_f32 v2, v2, v72
    v_sqrt_f32 v2, v2
    v_cmp_gt_u32 vcc, 32, v1
    v_mul_f32 v2, 0x3f820000, v2
    s_nop 0
    v_cndmask_b32 v102, 0, v6, vcc
    v_cndmask_b32 v107, 0, v6, vcc
    v_cndmask_b32 v110, v6, v100, vcc
    v_cndmask_b32 v115, v6, v100, vcc
    v_mov_b32 v3, 0x42200000
    v_cmp_nle_f32 vcc, v2, v3
    s_nop 0
    s_cmp_eq_u64 vcc, 0
    s_cbranch_scc1 k234_mid_kernel_fast
    v_mov_b32 v2, 0xff800000
    s_mov_b32 s17, s16
    s_mov_b32 s19, 8
k234_mid_kernel_fb:
    s_add_u32 s20, s17, 4096
    s_add_u32 s21, s17, 8192
    buffer_load_dwordx4 v[84:87], v7, s[8:11], s21 offen sc1
    buffer_load_dwordx4 v[56:59], v7, s[8:11], s17 offen offset:0 sc1
    buffer_load_dwordx4 v[60:63], v7, s[8:11], s17 offen offset:1024 sc1
    buffer_load_dwordx4 v[64:67], v7, s[8:11], s17 offen offset:2048 sc1
    buffer_load_dwordx4 v[68:71], v7, s[8:11], s17 offen offset:3072 sc1
    buffer_load_dwordx4 v[88:91], v7, s[8:11], s20 offen offset:0 sc1
    buffer_load_dwordx4 v[92:95], v7, s[8:11], s20 offen offset:1024 sc1
    buffer_load_dwordx4 v[72:75], v7, s[8:11], s20 offen offset:2048 sc1
    buffer_load_dwordx4 v[76:79], v7, s[8:11], s20 offen offset:3072 sc1
    s_waitcnt vmcnt(0)
    v_mfma_f32_32x32x16_bf16 v[8:23], v[56:59], v[96:99], 0
    v_mfma_f32_32x32x16_bf16 v[8:23], v[84:87], v[102:105], v[8:23]
    s_nop 11
    v_max3_f32 v2, v8, v9, v2
    v_max3_f32 v2, v10, v11, v2
    v_max3_f32 v2, v12, v13, v2
    v_max3_f32 v2, v14, v15, v2
    v_max3_f32 v2, v16, v17, v2
    v_max3_f32 v2, v18, v19, v2
    v_max3_f32 v2, v20, v21, v2
    v_max3_f32 v2, v22, v23, v2
    v_mfma_f32_32x32x16_bf16 v[24:39], v[60:63], v[96:99], 0
    v_mfma_f32_32x32x16_bf16 v[24:39], v[84:87], v[106:109], v[24:39]
    s_nop 11
    v_max3_f32 v2, v24, v25, v2
    v_max3_f32 v2, v26, v27, v2
    v_max3_f32 v2, v28, v29, v2
    v_max3_f32 v2, v30, v31, v2
    v_max3_f32 v2, v32, v33, v2
    v_max3_f32 v2, v34, v35, v2
    v_max3_f32 v2, v36, v37, v2
    v_max3_f32 v2, v38, v39, v2
    v_mfma_f32_32x32x16_bf16 v[8:23], v[64:67], v[96:99], 0
    v_mfma_f32_32x32x16_bf16 v[8:23], v[84:87], v[100:103], v[8:23]
    s_nop 11
    v_max3_f32 v2, v8, v9, v2
    v_max3_f32 v2, v10, v11, v2
    v_max3_f32 v2, v12, v13, v2
    v_max3_f32 v2, v14, v15, v2
    v_max3_f32 v2, v16, v17, v2
    v_max3_f32 v2, v18, v19, v2
    v_max3_f32 v2, v20, v21, v2
    v_max3_f32 v2, v22, v23, v2
    v_mfma_f32_32x32x16_bf16 v[24:39], v[68:71], v[96:99], 0
    v_mfma_f32_32x32x16_bf16 v[24:39], v[84:87], v[104:107], v[24:39]
    s_nop 11
    v_max3_f32 v2, v24, v25, v2
    v_max3_f32 v2, v26, v27, v2
    v_max3_f32 v2, v28, v29, v2
    v_max3_f32 v2, v30, v31, v2
    v_max3_f32 v2, v32, v33, v2
    v_max3_f32 v2, v34, v35, v2
    v_max3_f32 v2, v36, v37, v2
    v_max3_f32 v2, v38, v39, v2
    v_mfma_f32_32x32x16_bf16 v[8:23], v[88:91], v[96:99], 0
    v_mfma_f32_32x32x16_bf16 v[8:23], v[84:87], v[110:113], v[8:23]
    s_nop 11
    v_max3_f32 v2, v8, v9, v2
    v_max3_f32 v2, v10, v11, v2
    v_max3_f32 v2, v12, v13, v2
    v_max3_f32 v2, v14, v15, v2
    v_max3_f32 v2, v16, v17, v2
    v_max3_f32 v2, v18, v19, v2
    v_max3_f32 v2, v20, v21, v2
    v_max3_f32 v2, v22, v23, v2
    v_mfma_f32_32x32x16_bf16 v[24:39], v[92:95], v[96:99], 0
    v_mfma_f32_32x32x16_bf16 v[24:39], v[84:87], v[114:117], v[24:39]
    s_nop 11
    v_max3_f32 v2, v24, v25, v2
    v_max3_f32 v2, v26, v27, v2
    v_max3_f32 v2, v28, v29, v2
    v_max3_f32 v2, v30, v31, v2
    v_max3_f32 v2, v32, v33, v2
    v_max3_f32 v2, v34, v35, v2
    v_max3_f32 v2, v36, v37, v2
    v_max3_f32 v2, v38, v39, v2
    v_mfma_f32_32x32x16_bf16 v[8:23], v[72:75], v[96:99], 0
    v_mfma_f32_32x32x16_bf16 v[8:23], v[84:87], v[108:111], v[8:23]
    s_nop 11
    v_max3_f32 v2, v8, v9, v2
    v_max3_f32 v2, v10, v11, v2
    v_max3_f32 v2, v12, v13, v2
    v_max3_f32 v2, v14, v15, v2
    v_max3_f32 v2, v16, v17, v2
    v_max3_f32 v2, v18, v19, v2
    v_max3_f32 v2, v20, v21, v2
    v_max3_f32 v2, v22, v23, v2
    v_mfma_f32_32x32x16_bf16 v[24:39], v[76:79], v[96:99], 0
    v_mfma_f32_32x32x16_bf16 v[24:39], v[84:87], v[112:115], v[24:39]
    s_nop 11
    v_max3_f32 v2, v24, v25, v2
    v_max3_f32 v2, v26, v27, v2
    v_max3_f32 v2, v28, v29, v2
    v_max3_f32 v2, v30, v31, v2
    v_max3_f32 v2, v32, v33, v2
    v_max3_f32 v2, v34, v35, v2
    v_max3_f32 v2, v36, v37, v2
    v_max3_f32 v2, v38, v39, v2
    s_add_u32 s17, s17, 18944
    s_sub_u32 s19, s19, 1
    s_cmp_lg_u32 s19, 0
    s_cbranch_scc1 k234_mid_kernel_fb
    v_mov_b32 v3, v2
    s_nop 1
    v_permlane32_swap_b32 v2, v3
    v_max_f32 v2, v2, v3
    v_mov_b32 v56, 0
    v_mov_b32 v57, 0
    v_mov_b32 v58, 0
    v_mov_b32 v59, 0
    v_mov_b32 v60, 0
    v_mov_b32 v61, 0
    v_mov_b32 v62, 0
    v_mov_b32 v63, 0
    v_mov_b32 v64, 0
    v_mov_b32 v65, 0
    v_mov_b32 v66, 0
    v_mov_b32 v67, 0
    v_mov_b32 v68, 0
    v_mov_b32 v69, 0
    v_mov_b32 v70, 0
    v_mov_b32 v71, 0
k234_mid_kernel_fast:
    s_nop 3
    v_sub_f32 v40, 0, v2
    v_sub_f32 v41, 0, v2
    v_sub_f32 v42, 0, v2
    v_sub_f32 v43, 0, v2
    v_sub_f32 v44, 0, v2
    v_sub_f32 v45, 0, v2
    v_sub_f32 v46, 0, v2
    v_sub_f32 v47, 0, v2
    v_sub_f32 v48, 0, v2
    v_sub_f32 v49, 0, v2
    v_sub_f32 v50, 0, v2
    v_sub_f32 v51, 0, v2
    v_sub_f32 v52, 0, v2
    v_sub_f32 v53, 0, v2
    v_sub_f32 v54, 0, v2
    v_sub_f32 v55, 0, v2
    s_waitcnt vmcnt(0)
    s_barrier
    ds_read_b128 v[80:83], v118 offset:0
    ds_read_b128 v[84:87], v118 offset:8192
    ds_read_b128 v[88:91], v121 offset:0
    s_waitcnt lgkmcnt(2)
    v_mfma_f32_32x32x16_bf16 v[8:23], v[80:83], v[96:99], v[40:55]
    ds_read_b128 v[80:83], v118 offset:1024
    s_waitcnt lgkmcnt(2)
    v_mfma_f32_32x32x16_bf16 v[8:23], v[84:87], v[102:105], v[8:23]
    s_setprio 3
    s_waitcnt lgkmcnt(0)
    v_mfma_f32_32x32x16_bf16 v[24:39], v[80:83], v[96:99], v[40:55]
    ds_read_b128 v[80:83], v118 offset:2048
    s_add_u32 m0, s38, 24576
    s_nop 0
    buffer_load_dwordx4 v7, s[8:11], s39 offen sc1 lds
    s_add_u32 s39, s39, 8192
    s_nop 3
    v_exp_f32 v8, v8
    v_exp_f32 v9, v9
    v_exp_f32 v10, v10
    v_exp_f32 v11, v11
    ds_read_b128 v[92:95], v121 offset:608
    v_cvt_pk_bf16_f32 v72, v8, v9
    v_cvt_pk_bf16_f32 v73, v10, v11
    v_exp_f32 v12, v12
    v_exp_f32 v13, v13
    v_exp_f32 v14, v14
    v_exp_f32 v15, v15
    v_mfma_f32_32x32x16_bf16 v[24:39], v[84:87], v[106:109], v[24:39]
    s_add_u32 m0, s38, 32768
    s_nop 0
    buffer_load_dwordx4 v7, s[8:11], s39 offen sc1 lds
    s_add_u32 s39, s39, 8192
    v_cvt_pk_bf16_f32 v74, v12, v13
    v_cvt_pk_bf16_f32 v75, v14, v15
    v_exp_f32 v16, v16
    v_exp_f32 v17, v17
    v_exp_f32 v18, v18
    v_exp_f32 v19, v19
    v_mfma_f32_32x32x16_bf16 v[56:71], v[88:91], v[72:75], v[56:71]
    ds_read_b128 v[88:91], v121 offset:1216
    v_cvt_pk_bf16_f32 v76, v16, v17
    v_cvt_pk_bf16_f32 v77, v18, v19
    v_exp_f32 v20, v20
    v_exp_f32 v21, v21
    v_exp_f32 v22, v22
    v_exp_f32 v23, v23
    v_cvt_pk_bf16_f32 v78, v20, v21
    v_cvt_pk_bf16_f32 v79, v22, v23
    s_waitcnt lgkmcnt(2)
    v_mfma_f32_32x32x16_bf16 v[8:23], v[80:83], v[96:99], v[40:55]
    ds_read_b128 v[80:83], v118 offset:3072
    s_add_u32 m0, s38, 40960
    s_nop 0
    buffer_load_dwordx4 v7, s[8:11], s39 offen sc1 lds
    s_add_u32 s39, s39, 8192
    v_exp_f32 v24, v24
    v_exp_f32 v25, v25
    v_exp_f32 v26, v26
    v_exp_f32 v27, v27
    s_waitcnt lgkmcnt(2)
    v_mfma_f32_32x32x16_bf16 v[56:71], v[92:95], v[76:79], v[56:71]
    ds_read_b128 v[92:95], v121 offset:1824
    v_cvt_pk_bf16_f32 v72, v24, v25
    v_cvt_pk_bf16_f32 v73, v26, v27
    v_exp_f32 v28, v28
    v_exp_f32 v29, v29
    v_exp_f32 v30, v30
    v_exp_f32 v31, v31
    v_mfma_f32_32x32x16_bf16 v[8:23], v[84:87], v[100:103], v[8:23]
    s_add_u32 m0, s38, 49152
    s_nop 0
    buffer_load_dwordx4 v7, s[8:11], s39 offen sc1 lds
    s_add_u32 s39, s39, 8192
    v_cvt_pk_bf16_f32 v74, v28, v29
    v_cvt_pk_bf16_f32 v75, v30, v31
    v_exp_f32 v32, v32
    v_exp_f32 v33, v33
    v_exp_f32 v34, v34
    v_exp_f32 v35, v35
    s_waitcnt lgkmcnt(2)
    v_mfma_f32_32x32x16_bf16 v[56:71], v[88:91], v[72:75], v[56:71]
    ds_read_b128 v[88:91], v121 offset:2432
    v_cvt_pk_bf16_f32 v76, v32, v33
    v_cvt_pk_bf16_f32 v77, v34, v35
    v_exp_f32 v36, v36
    v_exp_f32 v37, v37
    v_exp_f32 v38, v38
    v_exp_f32 v39, v39
    v_cvt_pk_bf16_f32 v78, v36, v37
    v_cvt_pk_bf16_f32 v79, v38, v39
    s_waitcnt lgkmcnt(2)
    v_mfma_f32_32x32x16_bf16 v[24:39], v[80:83], v[96:99], v[40:55]
    ds_read_b128 v[80:83], v118 offset:4096
    s_add_u32 m0, s38, 57344
    s_nop 0
    buffer_load_dwordx4 v7, s[8:11], s39 offen sc1 lds
    s_add_u32 s39, s39, 8192
    v_exp_f32 v8, v8
    v_exp_f32 v9, v9
    v_exp_f32 v10, v10
    v_exp_f32 v11, v11
    s_waitcnt lgkmcnt(2)
    v_mfma_f32_32x32x16_bf16 v[56:71], v[92:95], v[76:79], v[56:71]
    ds_read_b128 v[92:95], v121 offset:3040
    v_cvt_pk_bf16_f32 v72, v8, v9
    v_cvt_pk_bf16_f32 v73, v10, v11
    v_exp_f32 v12, v12
    v_exp_f32 v13, v13
    v_exp_f32 v14, v14
    v_exp_f32 v15, v15
    v_mfma_f32_32x32x16_bf16 v[24:39], v[84:87], v[104:107], v[24:39]
    s_add_u32 m0, s38, 65536
    s_nop 0
    buffer_load_dwordx4 v7, s[8:11], s39 offen sc1 lds
    s_add_u32 s39, s39, 8192
    v_cvt_pk_bf16_f32 v74, v12, v13
    v_cvt_pk_bf16_f32 v75, v14, v15
    v_exp_f32 v16, v16
    v_exp_f32 v17, v17
    v_exp_f32 v18, v18
    v_exp_f32 v19, v19
    s_waitcnt lgkmcnt(2)
    v_mfma_f32_32x32x16_bf16 v[56:71], v[88:91], v[72:75], v[56:71]
    ds_read_b128 v[88:91], v121 offset:3648
    v_cvt_pk_bf16_f32 v76, v16, v17
    v_cvt_pk_bf16_f32 v77, v18, v19
    v_exp_f32 v20, v20
    v_exp_f32 v21, v21
    v_exp_f32 v22, v22
    v_exp_f32 v23, v23
    v_cvt_pk_bf16_f32 v78, v20, v21
    v_cvt_pk_bf16_f32 v79, v22, v23
    s_waitcnt lgkmcnt(2)
    v_mfma_f32_32x32x16_bf16 v[8:23], v[80:83], v[96:99], v[40:55]
    ds_read_b128 v[80:83], v118 offset:5120
    s_add_u32 m0, s38, 73728
    s_nop 0
    buffer_load_dwordx4 v7, s[8:11], s39 offen sc1 lds
    s_add_u32 s39, s39, 8192
    v_exp_f32 v24, v24
    v_exp_f32 v25, v25
    v_exp_f32 v26, v26
    v_exp_f32 v27, v27
    s_waitcnt lgkmcnt(2)
    v_mfma_f32_32x32x16_bf16 v[56:71], v[92:95], v[76:79], v[56:71]
    ds_read_b128 v[92:95], v121 offset:4256
    v_cvt_pk_bf16_f32 v72, v24, v25
    v_cvt_pk_bf16_f32 v73, v26, v27
    v_exp_f32 v28, v28
    v_exp_f32 v29, v29
    v_exp_f32 v30, v30
    v_exp_f32 v31, v31
    v_mfma_f32_32x32x16_bf16 v[8:23], v[84:87], v[110:113], v[8:23]
    s_add_u32 m0, s38, 81920
    s_nop 0
    buffer_load_dwordx4 v7, s[8:11], s39 offen sc1 lds
    s_add_u32 s39, s39, 8192
    v_cvt_pk_bf16_f32 v74, v28, v29
    v_cvt_pk_bf16_f32 v75, v30, v31
    v_exp_f32 v32, v32
    v_exp_f32 v33, v33
    v_exp_f32 v34, v34
    v_exp_f32 v35, v35
    s_waitcnt lgkmcnt(2)
    v_mfma_f32_32x32x16_bf16 v[56:71], v[88:91], v[72:75], v[56:71]
    ds_read_b128 v[88:91], v121 offset:4864
    v_cvt_pk_bf16_f32 v76, v32, v33
    v_cvt_pk_bf16_f32 v77, v34, v35
    v_exp_f32 v36, v36
    v_exp_f32 v37, v37
    v_exp_f32 v38, v38
    v_exp_f32 v39, v39
    v_cvt_pk_bf16_f32 v78, v36, v37
    v_cvt_pk_bf16_f32 v79, v38, v39
    s_waitcnt lgkmcnt(2)
    v_mfma_f32_32x32x16_bf16 v[24:39], v[80:83], v[96:99], v[40:55]
    ds_read_b128 v[80:83], v118 offset:6144
    s_add_u32 m0, s38, 90112
    s_nop 0
    buffer_load_dwordx4 v7, s[8:11], s39 offen sc1 lds
    s_add_u32 s39, s39, 8192
    v_exp_f32 v8, v8
    v_exp_f32 v9, v9
    v_exp_f32 v10, v10
    v_exp_f32 v11, v11
    s_waitcnt lgkmcnt(2)
    v_mfma_f32_32x32x16_bf16 v[56:71], v[92:95], v[76:79], v[56:71]
    ds_read_b128 v[92:95], v121 offset:5472
    v_cvt_pk_bf16_f32 v72, v8, v9
    v_cvt_pk_bf16_f32 v73, v10, v11
    v_exp_f32 v12, v12
    v_exp_f32 v13, v13
    v_exp_f32 v14, v14
    v_exp_f32 v15, v15
    v_mfma_f32_32x32x16_bf16 v[24:39], v[84:87], v[114:117], v[24:39]
    s_add_u32 m0, s38, 98304
    s_nop 0
    buffer_load_dwordx4 v7, s[8:11], s39 offen sc1 lds
    s_add_u32 s39, s39, 8192
    v_cvt_pk_bf16_f32 v74, v12, v13
    v_cvt_pk_bf16_f32 v75, v14, v15
    v_exp_f32 v16, v16
    v_exp_f32 v17, v17
    v_exp_f32 v18, v18
    v_exp_f32 v19, v19
    s_waitcnt lgkmcnt(2)
    v_mfma_f32_32x32x16_bf16 v[56:71], v[88:91], v[72:75], v[56:71]
    ds_read_b128 v[88:91], v121 offset:6080
    v_cvt_pk_bf16_f32 v76, v16, v17
    v_cvt_pk_bf16_f32 v77, v18, v19
    v_exp_f32 v20, v20
    v_exp_f32 v21, v21
    v_exp_f32 v22, v22
    v_exp_f32 v23, v23
    v_cvt_pk_bf16_f32 v78, v20, v21
    v_cvt_pk_bf16_f32 v79, v22, v23
    s_waitcnt lgkmcnt(2)
    v_mfma_f32_32x32x16_bf16 v[8:23], v[80:83], v[96:99], v[40:55]
    ds_read_b128 v[80:83], v118 offset:7168
    s_add_u32 m0, s38, 106496
    s_nop 0
    buffer_load_dwordx4 v7, s[8:11], s39 offen sc1 lds
    s_add_u32 s39, s39, 8192
    v_exp_f32 v24, v24
    v_exp_f32 v25, v25
    v_exp_f32 v26, v26
    v_exp_f32 v27, v27
    s_waitcnt lgkmcnt(2)
    v_mfma_f32_32x32x16_bf16 v[56:71], v[92:95], v[76:79], v[56:71]
    ds_read_b128 v[92:95], v121 offset:6688
    v_cvt_pk_bf16_f32 v72, v24, v25
    v_cvt_pk_bf16_f32 v73, v26, v27
    v_exp_f32 v28, v28
    v_exp_f32 v29, v29
    v_exp_f32 v30, v30
    v_exp_f32 v31, v31
    v_mfma_f32_32x32x16_bf16 v[8:23], v[84:87], v[108:111], v[8:23]
    s_add_u32 m0, s38, 114688
    s_nop 0
    buffer_load_dwordx4 v7, s[8:11], s39 offen sc1 lds
    s_add_u32 s39, s39, 8192
    v_cvt_pk_bf16_f32 v74, v28, v29
    v_cvt_pk_bf16_f32 v75, v30, v31
    v_exp_f32 v32, v32
    v_exp_f32 v33, v33
    v_exp_f32 v34, v34
    v_exp_f32 v35, v35
    s_waitcnt lgkmcnt(2)
    v_mfma_f32_32x32x16_bf16 v[56:71], v[88:91], v[72:75], v[56:71]
    ds_read_b128 v[88:91], v121 offset:7296
    v_cvt_pk_bf16_f32 v76, v32, v33
    v_cvt_pk_bf16_f32 v77, v34, v35
    v_exp_f32 v36, v36
    v_exp_f32 v37, v37
    v_exp_f32 v38, v38
    v_exp_f32 v39, v39
    v_cvt_pk_bf16_f32 v78, v36, v37
    v_cvt_pk_bf16_f32 v79, v38, v39
    s_waitcnt vmcnt(8)
    s_barrier
    s_waitcnt lgkmcnt(2)
    v_mfma_f32_32x32x16_bf16 v[24:39], v[80:83], v[96:99], v[40:55]
    ds_read_b128 v[80:83], v118 offset:18944
    v_exp_f32 v8, v8
    v_exp_f32 v9, v9
    v_exp_f32 v10, v10
    v_exp_f32 v11, v11
    s_waitcnt lgkmcnt(2)
    v_mfma_f32_32x32x16_bf16 v[56:71], v[92:95], v[76:79], v[56:71]
    ds_read_b128 v[92:95], v121 offset:7904
    v_cvt_pk_bf16_f32 v72, v8, v9
    v_cvt_pk_bf16_f32 v73, v10, v11
    v_exp_f32 v12, v12
    v_exp_f32 v13, v13
    v_exp_f32 v14, v14
    v_exp_f32 v15, v15
    v_mfma_f32_32x32x16_bf16 v[24:39], v[84:87], v[112:115], v[24:39]
    ds_read_b128 v[84:87], v118 offset:27136
    v_cvt_pk_bf16_f32 v74, v12, v13
    v_cvt_pk_bf16_f32 v75, v14, v15
    v_exp_f32 v16, v16
    v_exp_f32 v17, v17
    v_exp_f32 v18, v18
    v_exp_f32 v19, v19
    s_waitcnt lgkmcnt(3)
    v_mfma_f32_32x32x16_bf16 v[56:71], v[88:91], v[72:75], v[56:71]
    ds_read_b128 v[88:91], v121 offset:8512
    v_cvt_pk_bf16_f32 v76, v16, v17
    v_cvt_pk_bf16_f32 v77, v18, v19
    v_exp_f32 v20, v20
    v_exp_f32 v21, v21
    v_exp_f32 v22, v22
    v_exp_f32 v23, v23
    v_cvt_pk_bf16_f32 v78, v20, v21
    v_cvt_pk_bf16_f32 v79, v22, v23
    s_waitcnt lgkmcnt(3)
    v_mfma_f32_32x32x16_bf16 v[8:23], v[80:83], v[96:99], v[40:55]
    ds_read_b128 v[80:83], v118 offset:19968
    s_add_u32 m0, s38, 122880
    s_nop 0
    buffer_load_dwordx4 v7, s[8:11], s39 offen sc1 lds
    s_add_u32 s39, s39, 8192
    v_exp_f32 v24, v24
    v_exp_f32 v25, v25
    v_exp_f32 v26, v26
    v_exp_f32 v27, v27
    s_waitcnt lgkmcnt(3)
    v_mfma_f32_32x32x16_bf16 v[56:71], v[92:95], v[76:79], v[56:71]
    ds_read_b128 v[92:95], v121 offset:9120
    v_cvt_pk_bf16_f32 v72, v24, v25
    v_cvt_pk_bf16_f32 v73, v26, v27
    v_exp_f32 v28, v28
    v_exp_f32 v29, v29
    v_exp_f32 v30, v30
    v_exp_f32 v31, v31
    s_waitcnt lgkmcnt(3)
    v_mfma_f32_32x32x16_bf16 v[8:23], v[84:87], v[102:105], v[8:23]
    s_add_u32 m0, s38, 131072
    s_nop 0
    buffer_load_dwordx4 v7, s[8:11], s39 offen sc1 lds
    s_add_u32 s39, s39, 8192
    v_cvt_pk_bf16_f32 v74, v28, v29
    v_cvt_pk_bf16_f32 v75, v30, v31
    v_exp_f32 v32, v32
    v_exp_f32 v33, v33
    v_exp_f32 v34, v34
    v_exp_f32 v35, v35
    s_waitcnt lgkmcnt(2)
    v_mfma_f32_32x32x16_bf16 v[56:71], v[88:91], v[72:75], v[56:71]
    ds_read_b128 v[88:91], v121 offset:18944
    v_cvt_pk_bf16_f32 v76, v32, v33
    v_cvt_pk_bf16_f32 v77, v34, v35
    v_exp_f32 v36, v36
    v_exp_f32 v37, v37
    v_exp_f32 v38, v38
    v_exp_f32 v39, v39
    v_cvt_pk_bf16_f32 v78, v36, v37
    v_cvt_pk_bf16_f32 v79, v38, v39
    s_waitcnt lgkmcnt(2)
    v_mfma_f32_32x32x16_bf16 v[24:39], v[80:83], v[96:99], v[40:55]
    ds_read_b128 v[80:83], v118 offset:20992
    s_add_u32 m0, s38, 139264
    s_nop 0
    buffer_load_dwordx4 v7, s[8:11], s39 offen sc1 lds
    s_add_u32 s39, s39, 8192
    v_exp_f32 v8, v8
    v_exp_f32 v9, v9
    v_exp_f32 v10, v10
    v_exp_f32 v11, v11
    s_waitcnt lgkmcnt(2)
    v_mfma_f32_32x32x16_bf16 v[56:71], v[92:95], v[76:79], v[56:71]
    ds_read_b128 v[92:95], v121 offset:19552
    v_cvt_pk_bf16_f32 v72, v8, v9
    v_cvt_pk_bf16_f32 v73, v10, v11
    v_exp_f32 v12, v12
    v_exp_f32 v13, v13
    v_exp_f32 v14, v14
    v_exp_f32 v15, v15
    v_mfma_f32_32x32x16_bf16 v[24:39], v[84:87], v[106:109], v[24:39]
    s_cmp_ge_u32 s12, 4
    s_cbranch_scc1 k234_mid_kernel_dskip
    s_add_u32 m0, s38, 147456
    s_nop 0
    buffer_load_dwordx4 v7, s[8:11], s39 offen sc1 lds
k234_mid_kernel_dskip:
    v_cvt_pk_bf16_f32 v74, v12, v13
    v_cvt_pk_bf16_f32 v75, v14, v15
    v_exp_f32 v16, v16
    v_exp_f32 v17, v17
    v_exp_f32 v18, v18
    v_exp_f32 v19, v19
    s_waitcnt lgkmcnt(2)
    v_mfma_f32_32x32x16_bf16 v[56:71], v[88:91], v[72:75], v[56:71]
    ds_read_b128 v[88:91], v121 offset:20160
    v_cvt_pk_bf16_f32 v76, v16, v17
    v_cvt_pk_bf16_f32 v77, v18, v19
    v_exp_f32 v20, v20
    v_exp_f32 v21, v21
    v_exp_f32 v22, v22
    v_exp_f32 v23, v23
    v_cvt_pk_bf16_f32 v78, v20, v21
    v_cvt_pk_bf16_f32 v79, v22, v23
    s_waitcnt lgkmcnt(2)
    v_mfma_f32_32x32x16_bf16 v[8:23], v[80:83], v[96:99], v[40:55]
    ds_read_b128 v[80:83], v118 offset:22016
    v_exp_f32 v24, v24
    v_exp_f32 v25, v25
    v_exp_f32 v26, v26
    v_exp_f32 v27, v27
    s_waitcnt lgkmcnt(2)
    v_mfma_f32_32x32x16_bf16 v[56:71], v[92:95], v[76:79], v[56:71]
    ds_read_b128 v[92:95], v121 offset:20768
    v_cvt_pk_bf16_f32 v72, v24, v25
    v_cvt_pk_bf16_f32 v73, v26, v27
    v_exp_f32 v28, v28
    v_exp_f32 v29, v29
    v_exp_f32 v30, v30
    v_exp_f32 v31, v31
    v_mfma_f32_32x32x16_bf16 v[8:23], v[84:87], v[100:103], v[8:23]
    v_cvt_pk_bf16_f32 v74, v28, v29
    v_cvt_pk_bf16_f32 v75, v30, v31
    v_exp_f32 v32, v32
    v_exp_f32 v33, v33
    v_exp_f32 v34, v34
    v_exp_f32 v35, v35
    s_waitcnt lgkmcnt(2)
    v_mfma_f32_32x32x16_bf16 v[56:71], v[88:91], v[72:75], v[56:71]
    ds_read_b128 v[88:91], v121 offset:21376
    v_cvt_pk_bf16_f32 v76, v32, v33
    v_cvt_pk_bf16_f32 v77, v34, v35
    v_exp_f32 v36, v36
    v_exp_f32 v37, v37
    v_exp_f32 v38, v38
    v_exp_f32 v39, v39
    v_cvt_pk_bf16_f32 v78, v36, v37
    v_cvt_pk_bf16_f32 v79, v38, v39
    s_lshl_b32 s17, s2, 3
    s_add_u32 s17, s17, s12
    s_mul_i32 s18, s17, 2592
    s_mul_i32 s20, s17, 3456
    s_add_u32 s20, s20, 37748736
    v_mov_b32 v124, -1
    v_mov_b32 v125, -1
    v_mov_b32 v126, -1
    v_mov_b32 v127, -1
    buffer_store_dwordx4 v[124:127], v7, s[8:11], s20 offen offset:0 sc1
    buffer_store_dwordx4 v[124:127], v7, s[8:11], s20 offen offset:1024 sc1
    buffer_store_dwordx4 v[124:127], v7, s[8:11], s20 offen offset:2048 sc1
    buffer_store_dwordx4 v[124:127], v7, s[8:11], s20 offen offset:2432 sc1
    buffer_store_dwordx4 v[124:127], v138, s[8:11], s42 offen sc1
    s_waitcnt lgkmcnt(2)
    v_mfma_f32_32x32x16_bf16 v[24:39], v[80:83], v[96:99], v[40:55]
    ds_read_b128 v[80:83], v118 offset:23040
    v_exp_f32 v8, v8
    v_exp_f32 v9, v9
    v_exp_f32 v10, v10
    v_exp_f32 v11, v11
    s_waitcnt lgkmcnt(2)
    v_mfma_f32_32x32x16_bf16 v[56:71], v[92:95], v[76:79], v[56:71]
    ds_read_b128 v[92:95], v121 offset:21984
    v_cvt_pk_bf16_f32 v72, v8, v9
    v_cvt_pk_bf16_f32 v73, v10, v11
    v_exp_f32 v12, v12
    v_exp_f32 v13, v13
    v_exp_f32 v14, v14
    v_exp_f32 v15, v15
    v_mfma_f32_32x32x16_bf16 v[24:39], v[84:87], v[104:107], v[24:39]
    v_cvt_pk_bf16_f32 v74, v12, v13
    v_cvt_pk_bf16_f32 v75, v14, v15
    v_exp_f32 v16, v16
    v_exp_f32 v17, v17
    v_exp_f32 v18, v18
    v_exp_f32 v19, v19
    s_waitcnt lgkmcnt(2)
    v_mfma_f32_32x32x16_bf16 v[56:71], v[88:91], v[72:75], v[56:71]
    ds_read_b128 v[88:91], v121 offset:22592
    v_cvt_pk_bf16_f32 v76, v16, v17
    v_cvt_pk_bf16_f32 v77, v18, v19
    v_exp_f32 v20, v20
    v_exp_f32 v21, v21
    v_exp_f32 v22, v22
    v_exp_f32 v23, v23
    v_cvt_pk_bf16_f32 v78, v20, v21
    v_cvt_pk_bf16_f32 v79, v22, v23
    s_waitcnt lgkmcnt(2)
    v_mfma_f32_32x32x16_bf16 v[8:23], v[80:83], v[96:99], v[40:55]
    ds_read_b128 v[80:83], v118 offset:24064
    v_exp_f32 v24, v24
    v_exp_f32 v25, v25
    v_exp_f32 v26, v26
    v_exp_f32 v27, v27
    s_waitcnt lgkmcnt(2)
    v_mfma_f32_32x32x16_bf16 v[56:71], v[92:95], v[76:79], v[56:71]
    ds_read_b128 v[92:95], v121 offset:23200
    v_cvt_pk_bf16_f32 v72, v24, v25
    v_cvt_pk_bf16_f32 v73, v26, v27
    v_exp_f32 v28, v28
    v_exp_f32 v29, v29
    v_exp_f32 v30, v30
    v_exp_f32 v31, v31
    v_mfma_f32_32x32x16_bf16 v[8:23], v[84:87], v[110:113], v[8:23]
    v_cvt_pk_bf16_f32 v74, v28, v29
    v_cvt_pk_bf16_f32 v75, v30, v31
    v_exp_f32 v32, v32
    v_exp_f32 v33, v33
    v_exp_f32 v34, v34
    v_exp_f32 v35, v35
    s_waitcnt lgkmcnt(2)
    v_mfma_f32_32x32x16_bf16 v[56:71], v[88:91], v[72:75], v[56:71]
    ds_read_b128 v[88:91], v121 offset:23808
    v_cvt_pk_bf16_f32 v76, v32, v33
    v_cvt_pk_bf16_f32 v77, v34, v35
    v_exp_f32 v36, v36
    v_exp_f32 v37, v37
    v_exp_f32 v38, v38
    v_exp_f32 v39, v39
    v_cvt_pk_bf16_f32 v78, v36, v37
    v_cvt_pk_bf16_f32 v79, v38, v39
    s_mov_b32 s32, s28
    s_mov_b32 s33, s29
    s_mov_b32 s34, 5308416
    s_mov_b32 s35, 0x00020000
    buffer_load_dwordx4 v[124:127], v7, s[32:35], s18 offen offset:0
    s_cmp_lg_u32 s12, 6
    s_cbranch_scc1 k234_mid_kernel_cp2
    s_getpc_b64 s[36:37]
k234_mid_kernel_pc2:
    s_lshr_b32 s17, s2, 3
    s_and_b32 s17, s17, 7
    s_lshl_b32 s17, s17, 13
    s_add_u32 s17, s17, k234_mid_kernel_aend-k234_mid_kernel_pc2
    v_lshlrev_b32 v128, 7, v1
    v_add_u32 v128, s17, v128
    v_min_u32 v128, k234_mid_kernel_xend-k234_mid_kernel_pc2, v128
    global_load_dword v128, v128, s[36:37]
k234_mid_kernel_cp2:
    s_waitcnt lgkmcnt(2)
    v_mfma_f32_32x32x16_bf16 v[24:39], v[80:83], v[96:99], v[40:55]
    ds_read_b128 v[80:83], v118 offset:25088
    v_exp_f32 v8, v8
    v_exp_f32 v9, v9
    v_exp_f32 v10, v10
    v_exp_f32 v11, v11
    s_waitcnt lgkmcnt(2)
    v_mfma_f32_32x32x16_bf16 v[56:71], v[92:95], v[76:79], v[56:71]
    ds_read_b128 v[92:95], v121 offset:24416
    v_cvt_pk_bf16_f32 v72, v8, v9
    v_cvt_pk_bf16_f32 v73, v10, v11
    v_exp_f32 v12, v12
    v_exp_f32 v13, v13
    v_exp_f32 v14, v14
    v_exp_f32 v15, v15
    v_mfma_f32_32x32x16_bf16 v[24:39], v[84:87], v[114:117], v[24:39]
    v_cvt_pk_bf16_f32 v74, v12, v13
    v_cvt_pk_bf16_f32 v75, v14, v15
    v_exp_f32 v16, v16
    v_exp_f32 v17, v17
    v_exp_f32 v18, v18
    v_exp_f32 v19, v19
    s_waitcnt lgkmcnt(2)
    v_mfma_f32_32x32x16_bf16 v[56:71], v[88:91], v[72:75], v[56:71]
    ds_read_b128 v[88:91], v121 offset:25024
    v_cvt_pk_bf16_f32 v76, v16, v17
    v_cvt_pk_bf16_f32 v77, v18, v19
    v_exp_f32 v20, v20
    v_exp_f32 v21, v21
    v_exp_f32 v22, v22
    v_exp_f32 v23, v23
    v_cvt_pk_bf16_f32 v78, v20, v21
    v_cvt_pk_bf16_f32 v79, v22, v23
    s_waitcnt lgkmcnt(2)
    v_mfma_f32_32x32x16_bf16 v[8:23], v[80:83], v[96:99], v[40:55]
    ds_read_b128 v[80:83], v118 offset:26112
    v_exp_f32 v24, v24
    v_exp_f32 v25, v25
    v_exp_f32 v26, v26
    v_exp_f32 v27, v27
    s_waitcnt lgkmcnt(2)
    v_mfma_f32_32x32x16_bf16 v[56:71], v[92:95], v[76:79], v[56:71]
    ds_read_b128 v[92:95], v121 offset:25632
    v_cvt_pk_bf16_f32 v72, v24, v25
    v_cvt_pk_bf16_f32 v73, v26, v27
    v_exp_f32 v28, v28
    v_exp_f32 v29, v29
    v_exp_f32 v30, v30
    v_exp_f32 v31, v31
    v_mfma_f32_32x32x16_bf16 v[8:23], v[84:87], v[108:111], v[8:23]
    v_cvt_pk_bf16_f32 v74, v28, v29
    v_cvt_pk_bf16_f32 v75, v30, v31
    v_exp_f32 v32, v32
    v_exp_f32 v33, v33
    v_exp_f32 v34, v34
    v_exp_f32 v35, v35
    s_waitcnt lgkmcnt(2)
    v_mfma_f32_32x32x16_bf16 v[56:71], v[88:91], v[72:75], v[56:71]
    ds_read_b128 v[88:91], v121 offset:26240
    v_cvt_pk_bf16_f32 v76, v32, v33
    v_cvt_pk_bf16_f32 v77, v34, v35
    v_exp_f32 v36, v36
    v_exp_f32 v37, v37
    v_exp_f32 v38, v38
    v_exp_f32 v39, v39
    v_cvt_pk_bf16_f32 v78, v36, v37
    v_cvt_pk_bf16_f32 v79, v38, v39
    s_mov_b32 s32, s28
    s_mov_b32 s33, s29
    s_mov_b32 s34, 5308416
    s_mov_b32 s35, 0x00020000
    buffer_load_dwordx4 v[124:127], v7, s[32:35], s18 offen offset:1024
    s_waitcnt lgkmcnt(2)
    v_mfma_f32_32x32x16_bf16 v[24:39], v[80:83], v[96:99], v[40:55]
    ds_read_b128 v[80:83], v118 offset:37888
    v_exp_f32 v8, v8
    v_exp_f32 v9, v9
    v_exp_f32 v10, v10
    v_exp_f32 v11, v11
    s_waitcnt lgkmcnt(2)
    v_mfma_f32_32x32x16_bf16 v[56:71], v[92:95], v[76:79], v[56:71]
    ds_read_b128 v[92:95], v121 offset:26848
    v_cvt_pk_bf16_f32 v72, v8, v9
    v_cvt_pk_bf16_f32 v73, v10, v11
    v_exp_f32 v12, v12
    v_exp_f32 v13, v13
    v_exp_f32 v14, v14
    v_exp_f32 v15, v15
    v_mfma_f32_32x32x16_bf16 v[24:39], v[84:87], v[112:115], v[24:39]
    ds_read_b128 v[84:87], v118 offset:46080
    v_cvt_pk_bf16_f32 v74, v12, v13
    v_cvt_pk_bf16_f32 v75, v14, v15
    v_exp_f32 v16, v16
    v_exp_f32 v17, v17
    v_exp_f32 v18, v18
    v_exp_f32 v19, v19
    s_waitcnt lgkmcnt(3)
    v_mfma_f32_32x32x16_bf16 v[56:71], v[88:91], v[72:75], v[56:71]
    ds_read_b128 v[88:91], v121 offset:27456
    v_cvt_pk_bf16_f32 v76, v16, v17
    v_cvt_pk_bf16_f32 v77, v18, v19
    v_exp_f32 v20, v20
    v_exp_f32 v21, v21
    v_exp_f32 v22, v22
    v_exp_f32 v23, v23
    v_cvt_pk_bf16_f32 v78, v20, v21
    v_cvt_pk_bf16_f32 v79, v22, v23
    s_waitcnt lgkmcnt(3)
    v_mfma_f32_32x32x16_bf16 v[8:23], v[80:83], v[96:99], v[40:55]
    ds_read_b128 v[80:83], v118 offset:38912
    v_exp_f32 v24, v24
    v_exp_f32 v25, v25
    v_exp_f32 v26, v26
    v_exp_f32 v27, v27
    s_waitcnt lgkmcnt(3)
    v_mfma_f32_32x32x16_bf16 v[56:71], v[92:95], v[76:79], v[56:71]
    ds_read_b128 v[92:95], v121 offset:28064
    v_cvt_pk_bf16_f32 v72, v24, v25
    v_cvt_pk_bf16_f32 v73, v26, v27
    v_exp_f32 v28, v28
    v_exp_f32 v29, v29
    v_exp_f32 v30, v30
    v_exp_f32 v31, v31
    s_waitcnt lgkmcnt(3)
    v_mfma_f32_32x32x16_bf16 v[8:23], v[84:87], v[102:105], v[8:23]
    v_cvt_pk_bf16_f32 v74, v28, v29
    v_cvt_pk_bf16_f32 v75, v30, v31
    v_exp_f32 v32, v32
    v_exp_f32 v33, v33
    v_exp_f32 v34, v34
    v_exp_f32 v35, v35
    s_waitcnt lgkmcnt(2)
    v_mfma_f32_32x32x16_bf16 v[56:71], v[88:91], v[72:75], v[56:71]
    ds_read_b128 v[88:91], v121 offset:37888
    v_cvt_pk_bf16_f32 v76, v32, v33
    v_cvt_pk_bf16_f32 v77, v34, v35
    v_exp_f32 v36, v36
    v_exp_f32 v37, v37
    v_exp_f32 v38, v38
    v_exp_f32 v39, v39
    v_cvt_pk_bf16_f32 v78, v36, v37
    v_cvt_pk_bf16_f32 v79, v38, v39
    s_mov_b32 s32, s28
    s_mov_b32 s33, s29
    s_mov_b32 s34, 5308416
    s_mov_b32 s35, 0x00020000
    buffer_load_dwordx4 v[124:127], v7, s[32:35], s18 offen offset:1568
    s_waitcnt lgkmcnt(2)
    v_mfma_f32_32x32x16_bf16 v[24:39], v[80:83], v[96:99], v[40:55]
    ds_read_b128 v[80:83], v118 offset:39936
    v_exp_f32 v8, v8
    v_exp_f32 v9, v9
    v_exp_f32 v10, v10
    v_exp_f32 v11, v11
    s_waitcnt lgkmcnt(2)
    v_mfma_f32_32x32x16_bf16 v[56:71], v[92:95], v[76:79], v[56:71]
    ds_read_b128 v[92:95], v121 offset:38496
    v_cvt_pk_bf16_f32 v72, v8, v9
    v_cvt_pk_bf16_f32 v73, v10, v11
    v_exp_f32 v12, v12
    v_exp_f32 v13, v13
    v_exp_f32 v14, v14
    v_exp_f32 v15, v15
    v_mfma_f32_32x32x16_bf16 v[24:39], v[84:87], v[106:109], v[24:39]
    v_cvt_pk_bf16_f32 v74, v12, v13
    v_cvt_pk_bf16_f32 v75, v14, v15
    v_exp_f32 v16, v16
    v_exp_f32 v17, v17
    v_exp_f32 v18, v18
    v_exp_f32 v19, v19
    s_waitcnt lgkmcnt(2)
    v_mfma_f32_32x32x16_bf16 v[56:71], v[88:91], v[72:75], v[56:71]
    ds_read_b128 v[88:91], v121 offset:39104
    v_cvt_pk_bf16_f32 v76, v16, v17
    v_cvt_pk_bf16_f32 v77, v18, v19
    v_exp_f32 v20, v20
    v_exp_f32 v21, v21
    v_exp_f32 v22, v22
    v_exp_f32 v23, v23
    v_cvt_pk_bf16_f32 v78, v20, v21
    v_cvt_pk_bf16_f32 v79, v22, v23
    s_waitcnt lgkmcnt(2)
    v_mfma_f32_32x32x16_bf16 v[8:23], v[80:83], v[96:99], v[40:55]
    ds_read_b128 v[80:83], v118 offset:40960
    v_exp_f32 v24, v24
    v_exp_f32 v25, v25
    v_exp_f32 v26, v26
    v_exp_f32 v27, v27
    s_waitcnt lgkmcnt(2)
    v_mfma_f32_32x32x16_bf16 v[56:71], v[92:95], v[76:79], v[56:71]
    ds_read_b128 v[92:95], v121 offset:39712
    v_cvt_pk_bf16_f32 v72, v24, v25
    v_cvt_pk_bf16_f32 v73, v26, v27
    v_exp_f32 v28, v28
    v_exp_f32 v29, v29
    v_exp_f32 v30, v30
    v_exp_f32 v31, v31
    v_mfma_f32_32x32x16_bf16 v[8:23], v[84:87], v[100:103], v[8:23]
    v_cvt_pk_bf16_f32 v74, v28, v29
    v_cvt_pk_bf16_f32 v75, v30, v31
    v_exp_f32 v32, v32
    v_exp_f32 v33, v33
    v_exp_f32 v34, v34
    v_exp_f32 v35, v35
    s_waitcnt lgkmcnt(2)
    v_mfma_f32_32x32x16_bf16 v[56:71], v[88:91], v[72:75], v[56:71]
    ds_read_b128 v[88:91], v121 offset:40320
    v_cvt_pk_bf16_f32 v76, v32, v33
    v_cvt_pk_bf16_f32 v77, v34, v35
    v_exp_f32 v36, v36
    v_exp_f32 v37, v37
    v_exp_f32 v38, v38
    v_exp_f32 v39, v39
    v_cvt_pk_bf16_f32 v78, v36, v37
    v_cvt_pk_bf16_f32 v79, v38, v39
    s_waitcnt lgkmcnt(2)
    v_mfma_f32_32x32x16_bf16 v[24:39], v[80:83], v[96:99], v[40:55]
    ds_read_b128 v[80:83], v118 offset:41984
    v_exp_f32 v8, v8
    v_exp_f32 v9, v9
    v_exp_f32 v10, v10
    v_exp_f32 v11, v11
    s_waitcnt lgkmcnt(2)
    v_mfma_f32_32x32x16_bf16 v[56:71], v[92:95], v[76:79], v[56:71]
    ds_read_b128 v[92:95], v121 offset:40928
    v_cvt_pk_bf16_f32 v72, v8, v9
    v_cvt_pk_bf16_f32 v73, v10, v11
    v_exp_f32 v12, v12
    v_exp_f32 v13, v13
    v_exp_f32 v14, v14
    v_exp_f32 v15, v15
    v_mfma_f32_32x32x16_bf16 v[24:39], v[84:87], v[104:107], v[24:39]
    v_cvt_pk_bf16_f32 v74, v12, v13
    v_cvt_pk_bf16_f32 v75, v14, v15
    v_exp_f32 v16, v16
    v_exp_f32 v17, v17
    v_exp_f32 v18, v18
    v_exp_f32 v19, v19
    s_waitcnt lgkmcnt(2)
    v_mfma_f32_32x32x16_bf16 v[56:71], v[88:91], v[72:75], v[56:71]
    ds_read_b128 v[88:91], v121 offset:41536
    v_cvt_pk_bf16_f32 v76, v16, v17
    v_cvt_pk_bf16_f32 v77, v18, v19
    v_exp_f32 v20, v20
    v_exp_f32 v21, v21
    v_exp_f32 v22, v22
    v_exp_f32 v23, v23
    v_cvt_pk_bf16_f32 v78, v20, v21
    v_cvt_pk_bf16_f32 v79, v22, v23
    s_waitcnt lgkmcnt(2)
    v_mfma_f32_32x32x16_bf16 v[8:23], v[80:83], v[96:99], v[40:55]
    ds_read_b128 v[80:83], v118 offset:43008
    v_exp_f32 v24, v24
    v_exp_f32 v25, v25
    v_exp_f32 v26, v26
    v_exp_f32 v27, v27
    s_waitcnt lgkmcnt(2)
    v_mfma_f32_32x32x16_bf16 v[56:71], v[92:95], v[76:79], v[56:71]
    ds_read_b128 v[92:95], v121 offset:42144
    v_cvt_pk_bf16_f32 v72, v24, v25
    v_cvt_pk_bf16_f32 v73, v26, v27
    v_exp_f32 v28, v28
    v_exp_f32 v29, v29
    v_exp_f32 v30, v30
    v_exp_f32 v31, v31
    v_mfma_f32_32x32x16_bf16 v[8:23], v[84:87], v[110:113], v[8:23]
    v_cvt_pk_bf16_f32 v74, v28, v29
    v_cvt_pk_bf16_f32 v75, v30, v31
    v_exp_f32 v32, v32
    v_exp_f32 v33, v33
    v_exp_f32 v34, v34
    v_exp_f32 v35, v35
    s_waitcnt lgkmcnt(2)
    v_mfma_f32_32x32x16_bf16 v[56:71], v[88:91], v[72:75], v[56:71]
    ds_read_b128 v[88:91], v121 offset:42752
    v_cvt_pk_bf16_f32 v76, v32, v33
    v_cvt_pk_bf16_f32 v77, v34, v35
    v_exp_f32 v36, v36
    v_exp_f32 v37, v37
    v_exp_f32 v38, v38
    v_exp_f32 v39, v39
    v_cvt_pk_bf16_f32 v78, v36, v37
    v_cvt_pk_bf16_f32 v79, v38, v39
    s_waitcnt lgkmcnt(2)
    v_mfma_f32_32x32x16_bf16 v[24:39], v[80:83], v[96:99], v[40:55]
    ds_read_b128 v[80:83], v118 offset:44032
    v_exp_f32 v8, v8
    v_exp_f32 v9, v9
    v_exp_f32 v10, v10
    v_exp_f32 v11, v11
    s_waitcnt lgkmcnt(2)
    v_mfma_f32_32x32x16_bf16 v[56:71], v[92:95], v[76:79], v[56:71]
    ds_read_b128 v[92:95], v121 offset:43360
    v_cvt_pk_bf16_f32 v72, v8, v9
    v_cvt_pk_bf16_f32 v73, v10, v11
    v_exp_f32 v12, v12
    v_exp_f32 v13, v13
    v_exp_f32 v14, v14
    v_exp_f32 v15, v15
    v_mfma_f32_32x32x16_bf16 v[24:39], v[84:87], v[114:117], v[24:39]
    v_cvt_pk_bf16_f32 v74, v12, v13
    v_cvt_pk_bf16_f32 v75, v14, v15
    v_exp_f32 v16, v16
    v_exp_f32 v17, v17
    v_exp_f32 v18, v18
    v_exp_f32 v19, v19
    s_waitcnt lgkmcnt(2)
    v_mfma_f32_32x32x16_bf16 v[56:71], v[88:91], v[72:75], v[56:71]
    ds_read_b128 v[88:91], v121 offset:43968
    v_cvt_pk_bf16_f32 v76, v16, v17
    v_cvt_pk_bf16_f32 v77, v18, v19
    v_exp_f32 v20, v20
    v_exp_f32 v21, v21
    v_exp_f32 v22, v22
    v_exp_f32 v23, v23
    v_cvt_pk_bf16_f32 v78, v20, v21
    v_cvt_pk_bf16_f32 v79, v22, v23
    s_waitcnt lgkmcnt(2)
    v_mfma_f32_32x32x16_bf16 v[8:23], v[80:83], v[96:99], v[40:55]
    ds_read_b128 v[80:83], v118 offset:45056
    v_exp_f32 v24, v24
    v_exp_f32 v25, v25
    v_exp_f32 v26, v26
    v_exp_f32 v27, v27
    s_waitcnt lgkmcnt(2)
    v_mfma_f32_32x32x16_bf16 v[56:71], v[92:95], v[76:79], v[56:71]
    ds_read_b128 v[92:95], v121 offset:44576
    v_cvt_pk_bf16_f32 v72, v24, v25
    v_cvt_pk_bf16_f32 v73, v26, v27
    v_exp_f32 v28, v28
    v_exp_f32 v29, v29
    v_exp_f32 v30, v30
    v_exp_f32 v31, v31
    v_mfma_f32_32x32x16_bf16 v[8:23], v[84:87], v[108:111], v[8:23]
    v_cvt_pk_bf16_f32 v74, v28, v29
    v_cvt_pk_bf16_f32 v75, v30, v31
    v_exp_f32 v32, v32
    v_exp_f32 v33, v33
    v_exp_f32 v34, v34
    v_exp_f32 v35, v35
    s_waitcnt lgkmcnt(2)
    v_mfma_f32_32x32x16_bf16 v[56:71], v[88:91], v[72:75], v[56:71]
    ds_read_b128 v[88:91], v121 offset:45184
    v_cvt_pk_bf16_f32 v76, v32, v33
    v_cvt_pk_bf16_f32 v77, v34, v35
    v_exp_f32 v36, v36
    v_exp_f32 v37, v37
    v_exp_f32 v38, v38
    v_exp_f32 v39, v39
    v_cvt_pk_bf16_f32 v78, v36, v37
    v_cvt_pk_bf16_f32 v79, v38, v39
    s_waitcnt vmcnt(8)
    s_barrier
    s_mov_b32 s32, s26
    s_mov_b32 s33, s27
    s_mov_b32 s34, 5308416
    s_mov_b32 s35, 0x00020000
    v_add_u32 v134, 49152, v133
    s_add_u32 m0, s53, 0
    s_nop 0
    buffer_load_dwordx4 v132, s[60:63], s55 offen lds
    s_add_u32 m0, s53, 8192
    s_nop 0
    buffer_load_dwordx4 v132, s[32:35], s55 offen lds
    s_add_u32 s55, s55, 294912
    s_waitcnt lgkmcnt(2)
    v_mfma_f32_32x32x16_bf16 v[24:39], v[80:83], v[96:99], v[40:55]
    ds_read_b128 v[80:83], v119 offset:0
    v_exp_f32 v8, v8
    v_exp_f32 v9, v9
    v_exp_f32 v10, v10
    v_exp_f32 v11, v11
    s_waitcnt lgkmcnt(2)
    v_mfma_f32_32x32x16_bf16 v[56:71], v[92:95], v[76:79], v[56:71]
    ds_read_b128 v[92:95], v121 offset:45792
    v_cvt_pk_bf16_f32 v72, v8, v9
    v_cvt_pk_bf16_f32 v73, v10, v11
    v_exp_f32 v12, v12
    v_exp_f32 v13, v13
    v_exp_f32 v14, v14
    v_exp_f32 v15, v15
    v_mfma_f32_32x32x16_bf16 v[24:39], v[84:87], v[112:115], v[24:39]
    ds_read_b128 v[84:87], v119 offset:8192
    v_cvt_pk_bf16_f32 v74, v12, v13
    v_cvt_pk_bf16_f32 v75, v14, v15
    v_exp_f32 v16, v16
    v_exp_f32 v17, v17
    v_exp_f32 v18, v18
    v_exp_f32 v19, v19
    s_waitcnt lgkmcnt(3)
    v_mfma_f32_32x32x16_bf16 v[56:71], v[88:91], v[72:75], v[56:71]
    ds_read_b128 v[88:91], v121 offset:46400
    v_cvt_pk_bf16_f32 v76, v16, v17
    v_cvt_pk_bf16_f32 v77, v18, v19
    v_exp_f32 v20, v20
    v_exp_f32 v21, v21
    v_exp_f32 v22, v22
    v_exp_f32 v23, v23
    v_cvt_pk_bf16_f32 v78, v20, v21
    v_cvt_pk_bf16_f32 v79, v22, v23
    s_add_u32 m0, s53, 16384
    s_nop 0
    buffer_load_dwordx4 v132, s[60:63], s55 offen lds
    s_add_u32 m0, s53, 24576
    s_nop 0
    buffer_load_dwordx4 v132, s[32:35], s55 offen lds
    s_add_u32 s55, s55, 294912
    s_waitcnt lgkmcnt(3)
    v_mfma_f32_32x32x16_bf16 v[8:23], v[80:83], v[96:99], v[40:55]
    ds_read_b128 v[80:83], v119 offset:1024
    v_exp_f32 v24, v24
    v_exp_f32 v25, v25
    v_exp_f32 v26, v26
    v_exp_f32 v27, v27
    s_waitcnt lgkmcnt(3)
    v_mfma_f32_32x32x16_bf16 v[56:71], v[92:95], v[76:79], v[56:71]
    ds_read_b128 v[92:95], v121 offset:47008
    v_cvt_pk_bf16_f32 v72, v24, v25
    v_cvt_pk_bf16_f32 v73, v26, v27
    v_exp_f32 v28, v28
    v_exp_f32 v29, v29
    v_exp_f32 v30, v30
    v_exp_f32 v31, v31
    s_waitcnt lgkmcnt(3)
    v_mfma_f32_32x32x16_bf16 v[8:23], v[84:87], v[102:105], v[8:23]
    v_cvt_pk_bf16_f32 v74, v28, v29
    v_cvt_pk_bf16_f32 v75, v30, v31
    v_exp_f32 v32, v32
    v_exp_f32 v33, v33
    v_exp_f32 v34, v34
    v_exp_f32 v35, v35
    s_waitcnt lgkmcnt(2)
    v_mfma_f32_32x32x16_bf16 v[56:71], v[88:91], v[72:75], v[56:71]
    ds_read_b128 v[88:91], v122 offset:0
    v_cvt_pk_bf16_f32 v76, v32, v33
    v_cvt_pk_bf16_f32 v77, v34, v35
    v_exp_f32 v36, v36
    v_exp_f32 v37, v37
    v_exp_f32 v38, v38
    v_exp_f32 v39, v39
    v_cvt_pk_bf16_f32 v78, v36, v37
    v_cvt_pk_bf16_f32 v79, v38, v39
    v_min_u32 v129, 11, v1
    v_lshlrev_b32 v129, 7, v129
    s_lshr_b32 s21, s2, 3
    s_lshl_b32 s22, s12, 5
    s_add_u32 s21, s21, s22
    s_and_b32 s22, s2, 7
    s_cmp_ge_u32 s21, 88
    s_cbranch_scc1 k234_mid_kernel_t1
    s_mov_b32 s44, s24
    s_mov_b32 s45, s25
    s_mov_b32 s46, 5308416
    s_mov_b32 s47, 0x00020000
    s_branch k234_mid_kernel_t0
k234_mid_kernel_t1:
    s_mov_b32 s44, s26
    s_mov_b32 s45, s27
    s_mov_b32 s46, 5308416
    s_mov_b32 s47, 0x00020000
    s_sub_u32 s21, s21, 88
    s_cmp_ge_u32 s21, 88
    s_cselect_b32 s21, 200, s21
k234_mid_kernel_t0:
    s_mul_i32 s21, s21, 36864
    s_mul_i32 s23, s22, 31
    s_min_u32 s22, s22, 4
    s_add_u32 s23, s23, s22
    s_mul_i32 s23, s23, 9363
    s_lshr_b32 s23, s23, 16
    s_lshl_b32 s23, s23, 8
    s_add_u32 s21, s21, s23
    s_mov_b32 s22, 9216
    buffer_load_dword v128, v129, s[44:47], s21 offen
    s_add_u32 s21, s21, s22
    s_waitcnt lgkmcnt(2)
    v_mfma_f32_32x32x16_bf16 v[24:39], v[80:83], v[96:99], v[40:55]
    ds_read_b128 v[80:83], v119 offset:2048
    v_exp_f32 v8, v8
    v_exp_f32 v9, v9
    v_exp_f32 v10, v10
    v_exp_f32 v11, v11
    s_waitcnt lgkmcnt(2)
    v_mfma_f32_32x32x16_bf16 v[56:71], v[92:95], v[76:79], v[56:71]
    ds_read_b128 v[92:95], v122 offset:608
    v_cvt_pk_bf16_f32 v72, v8, v9
    v_cvt_pk_bf16_f32 v73, v10, v11
    v_exp_f32 v12, v12
    v_exp_f32 v13, v13
    v_exp_f32 v14, v14
    v_exp_f32 v15, v15
    v_mfma_f32_32x32x16_bf16 v[24:39], v[84:87], v[106:109], v[24:39]
    v_cvt_pk_bf16_f32 v74, v12, v13
    v_cvt_pk_bf16_f32 v75, v14, v15
    v_exp_f32 v16, v16
    v_exp_f32 v17, v17
    v_exp_f32 v18, v18
    v_exp_f32 v19, v19
    s_waitcnt lgkmcnt(2)
    v_mfma_f32_32x32x16_bf16 v[56:71], v[88:91], v[72:75], v[56:71]
    ds_read_b128 v[88:91], v122 offset:1216
    v_cvt_pk_bf16_f32 v76, v16, v17
    v_cvt_pk_bf16_f32 v77, v18, v19
    v_exp_f32 v20, v20
    v_exp_f32 v21, v21
    v_exp_f32 v22, v22
    v_exp_f32 v23, v23
    v_cvt_pk_bf16_f32 v78, v20, v21
    v_cvt_pk_bf16_f32 v79, v22, v23
    s_waitcnt lgkmcnt(2)
    v_mfma_f32_32x32x16_bf16 v[8:23], v[80:83], v[96:99], v[40:55]
    ds_read_b128 v[80:83], v119 offset:3072
    v_exp_f32 v24, v24
    v_exp_f32 v25, v25
    v_exp_f32 v26, v26
    v_exp_f32 v27, v27
    s_waitcnt lgkmcnt(2)
    v_mfma_f32_32x32x16_bf16 v[56:71], v[92:95], v[76:79], v[56:71]
    ds_read_b128 v[92:95], v122 offset:1824
    v_cvt_pk_bf16_f32 v72, v24, v25
    v_cvt_pk_bf16_f32 v73, v26, v27
    v_exp_f32 v28, v28
    v_exp_f32 v29, v29
    v_exp_f32 v30, v30
    v_exp_f32 v31, v31
    v_mfma_f32_32x32x16_bf16 v[8:23], v[84:87], v[100:103], v[8:23]
    v_cvt_pk_bf16_f32 v74, v28, v29
    v_cvt_pk_bf16_f32 v75, v30, v31
    v_exp_f32 v32, v32
    v_exp_f32 v33, v33
    v_exp_f32 v34, v34
    v_exp_f32 v35, v35
    s_waitcnt lgkmcnt(2)
    v_mfma_f32_32x32x16_bf16 v[56:71], v[88:91], v[72:75], v[56:71]
    ds_read_b128 v[88:91], v122 offset:2432
    v_cvt_pk_bf16_f32 v76, v32, v33
    v_cvt_pk_bf16_f32 v77, v34, v35
    v_exp_f32 v36, v36
    v_exp_f32 v37, v37
    v_exp_f32 v38, v38
    v_exp_f32 v39, v39
    v_cvt_pk_bf16_f32 v78, v36, v37
    v_cvt_pk_bf16_f32 v79, v38, v39
    buffer_load_dword v128, v129, s[44:47], s21 offen
    s_add_u32 s21, s21, s22
    s_waitcnt lgkmcnt(2)
    v_mfma_f32_32x32x16_bf16 v[24:39], v[80:83], v[96:99], v[40:55]
    ds_read_b128 v[80:83], v119 offset:4096
    v_exp_f32 v8, v8
    v_exp_f32 v9, v9
    v_exp_f32 v10, v10
    v_exp_f32 v11, v11
    s_waitcnt lgkmcnt(2)
    v_mfma_f32_32x32x16_bf16 v[56:71], v[92:95], v[76:79], v[56:71]
    ds_read_b128 v[92:95], v122 offset:3040
    v_cvt_pk_bf16_f32 v72, v8, v9
    v_cvt_pk_bf16_f32 v73, v10, v11
    v_exp_f32 v12, v12
    v_exp_f32 v13, v13
    v_exp_f32 v14, v14
    v_exp_f32 v15, v15
    v_mfma_f32_32x32x16_bf16 v[24:39], v[84:87], v[104:107], v[24:39]
    v_cvt_pk_bf16_f32 v74, v12, v13
    v_cvt_pk_bf16_f32 v75, v14, v15
    v_exp_f32 v16, v16
    v_exp_f32 v17, v17
    v_exp_f32 v18, v18
    v_exp_f32 v19, v19
    s_waitcnt lgkmcnt(2)
    v_mfma_f32_32x32x16_bf16 v[56:71], v[88:91], v[72:75], v[56:71]
    ds_read_b128 v[88:91], v122 offset:3648
    v_cvt_pk_bf16_f32 v76, v16, v17
    v_cvt_pk_bf16_f32 v77, v18, v19
    v_exp_f32 v20, v20
    v_exp_f32 v21, v21
    v_exp_f32 v22, v22
    v_exp_f32 v23, v23
    v_cvt_pk_bf16_f32 v78, v20, v21
    v_cvt_pk_bf16_f32 v79, v22, v23
    s_waitcnt lgkmcnt(2)
    v_mfma_f32_32x32x16_bf16 v[8:23], v[80:83], v[96:99], v[40:55]
    ds_read_b128 v[80:83], v119 offset:5120
    v_exp_f32 v24, v24
    v_exp_f32 v25, v25
    v_exp_f32 v26, v26
    v_exp_f32 v27, v27
    s_waitcnt lgkmcnt(2)
    v_mfma_f32_32x32x16_bf16 v[56:71], v[92:95], v[76:79], v[56:71]
    ds_read_b128 v[92:95], v122 offset:4256
    v_cvt_pk_bf16_f32 v72, v24, v25
    v_cvt_pk_bf16_f32 v73, v26, v27
    v_exp_f32 v28, v28
    v_exp_f32 v29, v29
    v_exp_f32 v30, v30
    v_exp_f32 v31, v31
    v_mfma_f32_32x32x16_bf16 v[8:23], v[84:87], v[110:113], v[8:23]
    v_cvt_pk_bf16_f32 v74, v28, v29
    v_cvt_pk_bf16_f32 v75, v30, v31
    v_exp_f32 v32, v32
    v_exp_f32 v33, v33
    v_exp_f32 v34, v34
    v_exp_f32 v35, v35
    s_waitcnt lgkmcnt(2)
    v_mfma_f32_32x32x16_bf16 v[56:71], v[88:91], v[72:75], v[56:71]
    ds_read_b128 v[88:91], v122 offset:4864
    v_cvt_pk_bf16_f32 v76, v32, v33
    v_cvt_pk_bf16_f32 v77, v34, v35
    v_exp_f32 v36, v36
    v_exp_f32 v37, v37
    v_exp_f32 v38, v38
    v_exp_f32 v39, v39
    v_cvt_pk_bf16_f32 v78, v36, v37
    v_cvt_pk_bf16_f32 v79, v38, v39
    buffer_load_dword v128, v129, s[44:47], s21 offen
    s_add_u32 s21, s21, s22
    s_waitcnt lgkmcnt(2)
    v_mfma_f32_32x32x16_bf16 v[24:39], v[80:83], v[96:99], v[40:55]
    ds_read_b128 v[80:83], v119 offset:6144
    v_exp_f32 v8, v8
    v_exp_f32 v9, v9
    v_exp_f32 v10, v10
    v_exp_f32 v11, v11
    s_waitcnt lgkmcnt(2)
    v_mfma_f32_32x32x16_bf16 v[56:71], v[92:95], v[76:79], v[56:71]
    ds_read_b128 v[92:95], v122 offset:5472
    v_cvt_pk_bf16_f32 v72, v8, v9
    v_cvt_pk_bf16_f32 v73, v10, v11
    v_exp_f32 v12, v12
    v_exp_f32 v13, v13
    v_exp_f32 v14, v14
    v_exp_f32 v15, v15
    v_mfma_f32_32x32x16_bf16 v[24:39], v[84:87], v[114:117], v[24:39]
    v_cvt_pk_bf16_f32 v74, v12, v13
    v_cvt_pk_bf16_f32 v75, v14, v15
    v_exp_f32 v16, v16
    v_exp_f32 v17, v17
    v_exp_f32 v18, v18
    v_exp_f32 v19, v19
    s_waitcnt lgkmcnt(2)
    v_mfma_f32_32x32x16_bf16 v[56:71], v[88:91], v[72:75], v[56:71]
    ds_read_b128 v[88:91], v122 offset:6080
    v_cvt_pk_bf16_f32 v76, v16, v17
    v_cvt_pk_bf16_f32 v77, v18, v19
    v_exp_f32 v20, v20
    v_exp_f32 v21, v21
    v_exp_f32 v22, v22
    v_exp_f32 v23, v23
    v_cvt_pk_bf16_f32 v78, v20, v21
    v_cvt_pk_bf16_f32 v79, v22, v23
    s_waitcnt lgkmcnt(2)
    v_mfma_f32_32x32x16_bf16 v[8:23], v[80:83], v[96:99], v[40:55]
    ds_read_b128 v[80:83], v119 offset:7168
    v_exp_f32 v24, v24
    v_exp_f32 v25, v25
    v_exp_f32 v26, v26
    v_exp_f32 v27, v27
    s_waitcnt lgkmcnt(2)
    v_mfma_f32_32x32x16_bf16 v[56:71], v[92:95], v[76:79], v[56:71]
    ds_read_b128 v[92:95], v122 offset:6688
    v_cvt_pk_bf16_f32 v72, v24, v25
    v_cvt_pk_bf16_f32 v73, v26, v27
    v_exp_f32 v28, v28
    v_exp_f32 v29, v29
    v_exp_f32 v30, v30
    v_exp_f32 v31, v31
    v_mfma_f32_32x32x16_bf16 v[8:23], v[84:87], v[108:111], v[8:23]
    v_cvt_pk_bf16_f32 v74, v28, v29
    v_cvt_pk_bf16_f32 v75, v30, v31
    v_exp_f32 v32, v32
    v_exp_f32 v33, v33
    v_exp_f32 v34, v34
    v_exp_f32 v35, v35
    s_waitcnt lgkmcnt(2)
    v_mfma_f32_32x32x16_bf16 v[56:71], v[88:91], v[72:75], v[56:71]
    ds_read_b128 v[88:91], v122 offset:7296
    v_cvt_pk_bf16_f32 v76, v32, v33
    v_cvt_pk_bf16_f32 v77, v34, v35
    v_exp_f32 v36, v36
    v_exp_f32 v37, v37
    v_exp_f32 v38, v38
    v_exp_f32 v39, v39
    v_cvt_pk_bf16_f32 v78, v36, v37
    v_cvt_pk_bf16_f32 v79, v38, v39
    buffer_load_dword v128, v129, s[44:47], s21 offen
    s_add_u32 s21, s21, s22
    s_waitcnt lgkmcnt(2)
    v_mfma_f32_32x32x16_bf16 v[24:39], v[80:83], v[96:99], v[40:55]
    ds_read_b128 v[80:83], v119 offset:18944
    v_exp_f32 v8, v8
    v_exp_f32 v9, v9
    v_exp_f32 v10, v10
    v_exp_f32 v11, v11
    s_waitcnt lgkmcnt(2)
    v_mfma_f32_32x32x16_bf16 v[56:71], v[92:95], v[76:79], v[56:71]
    ds_read_b128 v[92:95], v122 offset:7904
    v_cvt_pk_bf16_f32 v72, v8, v9
    v_cvt_pk_bf16_f32 v73, v10, v11
    v_exp_f32 v12, v12
    v_exp_f32 v13, v13
    v_exp_f32 v14, v14
    v_exp_f32 v15, v15
    v_mfma_f32_32x32x16_bf16 v[24:39], v[84:87], v[112:115], v[24:39]
    ds_read_b128 v[84:87], v119 offset:27136
    v_cvt_pk_bf16_f32 v74, v12, v13
    v_cvt_pk_bf16_f32 v75, v14, v15
    v_exp_f32 v16, v16
    v_exp_f32 v17, v17
    v_exp_f32 v18, v18
    v_exp_f32 v19, v19
    s_waitcnt lgkmcnt(3)
    v_mfma_f32_32x32x16_bf16 v[56:71], v[88:91], v[72:75], v[56:71]
    ds_read_b128 v[88:91], v122 offset:8512
    v_cvt_pk_bf16_f32 v76, v16, v17
    v_cvt_pk_bf16_f32 v77, v18, v19
    v_exp_f32 v20, v20
    v_exp_f32 v21, v21
    v_exp_f32 v22, v22
    v_exp_f32 v23, v23
    v_cvt_pk_bf16_f32 v78, v20, v21
    v_cvt_pk_bf16_f32 v79, v22, v23
    s_waitcnt lgkmcnt(3)
    v_mfma_f32_32x32x16_bf16 v[8:23], v[80:83], v[96:99], v[40:55]
    ds_read_b128 v[80:83], v119 offset:19968
    v_exp_f32 v24, v24
    v_exp_f32 v25, v25
    v_exp_f32 v26, v26
    v_exp_f32 v27, v27
    s_waitcnt lgkmcnt(3)
    v_mfma_f32_32x32x16_bf16 v[56:71], v[92:95], v[76:79], v[56:71]
    ds_read_b128 v[92:95], v122 offset:9120
    v_cvt_pk_bf16_f32 v72, v24, v25
    v_cvt_pk_bf16_f32 v73, v26, v27
    v_exp_f32 v28, v28
    v_exp_f32 v29, v29
    v_exp_f32 v30, v30
    v_exp_f32 v31, v31
    s_waitcnt lgkmcnt(3)
    v_mfma_f32_32x32x16_bf16 v[8:23], v[84:87], v[102:105], v[8:23]
    v_cvt_pk_bf16_f32 v74, v28, v29
    v_cvt_pk_bf16_f32 v75, v30, v31
    v_exp_f32 v32, v32
    v_exp_f32 v33, v33
    v_exp_f32 v34, v34
    v_exp_f32 v35, v35
    s_waitcnt lgkmcnt(2)
    v_mfma_f32_32x32x16_bf16 v[56:71], v[88:91], v[72:75], v[56:71]
    ds_read_b128 v[88:91], v122 offset:18944
    v_cvt_pk_bf16_f32 v76, v32, v33
    v_cvt_pk_bf16_f32 v77, v34, v35
    v_exp_f32 v36, v36
    v_exp_f32 v37, v37
    v_exp_f32 v38, v38
    v_exp_f32 v39, v39
    v_cvt_pk_bf16_f32 v78, v36, v37
    v_cvt_pk_bf16_f32 v79, v38, v39
    s_waitcnt lgkmcnt(2)
    v_mfma_f32_32x32x16_bf16 v[24:39], v[80:83], v[96:99], v[40:55]
    ds_read_b128 v[80:83], v119 offset:20992
    v_exp_f32 v8, v8
    v_exp_f32 v9, v9
    v_exp_f32 v10, v10
    v_exp_f32 v11, v11
    s_waitcnt lgkmcnt(2)
    v_mfma_f32_32x32x16_bf16 v[56:71], v[92:95], v[76:79], v[56:71]
    ds_read_b128 v[92:95], v122 offset:19552
    v_cvt_pk_bf16_f32 v72, v8, v9
    v_cvt_pk_bf16_f32 v73, v10, v11
    v_exp_f32 v12, v12
    v_exp_f32 v13, v13
    v_exp_f32 v14, v14
    v_exp_f32 v15, v15
    v_mfma_f32_32x32x16_bf16 v[24:39], v[84:87], v[106:109], v[24:39]
    v_cvt_pk_bf16_f32 v74, v12, v13
    v_cvt_pk_bf16_f32 v75, v14, v15
    v_exp_f32 v16, v16
    v_exp_f32 v17, v17
    v_exp_f32 v18, v18
    v_exp_f32 v19, v19
    s_waitcnt lgkmcnt(2)
    v_mfma_f32_32x32x16_bf16 v[56:71], v[88:91], v[72:75], v[56:71]
    ds_read_b128 v[88:91], v122 offset:20160
    v_cvt_pk_bf16_f32 v76, v16, v17
    v_cvt_pk_bf16_f32 v77, v18, v19
    v_exp_f32 v20, v20
    v_exp_f32 v21, v21
    v_exp_f32 v22, v22
    v_exp_f32 v23, v23
    v_cvt_pk_bf16_f32 v78, v20, v21
    v_cvt_pk_bf16_f32 v79, v22, v23
    s_waitcnt lgkmcnt(2)
    v_mfma_f32_32x32x16_bf16 v[8:23], v[80:83], v[96:99], v[40:55]
    ds_read_b128 v[80:83], v119 offset:22016
    v_exp_f32 v24, v24
    v_exp_f32 v25, v25
    v_exp_f32 v26, v26
    v_exp_f32 v27, v27
    s_waitcnt lgkmcnt(2)
    v_mfma_f32_32x32x16_bf16 v[56:71], v[92:95], v[76:79], v[56:71]
    ds_read_b128 v[92:95], v122 offset:20768
    v_cvt_pk_bf16_f32 v72, v24, v25
    v_cvt_pk_bf16_f32 v73, v26, v27
    v_exp_f32 v28, v28
    v_exp_f32 v29, v29
    v_exp_f32 v30, v30
    v_exp_f32 v31, v31
    v_mfma_f32_32x32x16_bf16 v[8:23], v[84:87], v[100:103], v[8:23]
    v_cvt_pk_bf16_f32 v74, v28, v29
    v_cvt_pk_bf16_f32 v75, v30, v31
    v_exp_f32 v32, v32
    v_exp_f32 v33, v33
    v_exp_f32 v34, v34
    v_exp_f32 v35, v35
    s_waitcnt lgkmcnt(2)
    v_mfma_f32_32x32x16_bf16 v[56:71], v[88:91], v[72:75], v[56:71]
    ds_read_b128 v[88:91], v122 offset:21376
    v_cvt_pk_bf16_f32 v76, v32, v33
    v_cvt_pk_bf16_f32 v77, v34, v35
    v_exp_f32 v36, v36
    v_exp_f32 v37, v37
    v_exp_f32 v38, v38
    v_exp_f32 v39, v39
    v_cvt_pk_bf16_f32 v78, v36, v37
    v_cvt_pk_bf16_f32 v79, v38, v39
    s_waitcnt vmcnt(4)
    s_barrier
    s_add_u32 m0, s53, 32768
    s_nop 0
    buffer_load_dwordx4 v132, s[60:63], s55 offen lds
    s_add_u32 m0, s53, 40960
    s_nop 0
    buffer_load_dwordx4 v132, s[32:35], s55 offen lds
    s_add_u32 s55, s55, 294912
    ds_read_b64_tr_b16 v[200:201], v133 offset:0
    ds_read_b64_tr_b16 v[202:203], v133 offset:4096
    ds_read_b64_tr_b16 v[204:205], v133 offset:8192
    ds_read_b64_tr_b16 v[206:207], v133 offset:12288
    s_waitcnt lgkmcnt(6)
    v_mfma_f32_32x32x16_bf16 v[24:39], v[80:83], v[96:99], v[40:55]
    ds_read_b128 v[80:83], v119 offset:23040
    v_exp_f32 v8, v8
    v_exp_f32 v9, v9
    v_exp_f32 v10, v10
    v_exp_f32 v11, v11
    s_waitcnt lgkmcnt(6)
    v_mfma_f32_32x32x16_bf16 v[56:71], v[92:95], v[76:79], v[56:71]
    ds_read_b128 v[92:95], v122 offset:21984
    v_cvt_pk_bf16_f32 v72, v8, v9
    v_cvt_pk_bf16_f32 v73, v10, v11
    v_exp_f32 v12, v12
    v_exp_f32 v13, v13
    v_exp_f32 v14, v14
    v_exp_f32 v15, v15
    v_mfma_f32_32x32x16_bf16 v[24:39], v[84:87], v[104:107], v[24:39]
    v_cvt_pk_bf16_f32 v74, v12, v13
    v_cvt_pk_bf16_f32 v75, v14, v15
    v_exp_f32 v16, v16
    v_exp_f32 v17, v17
    v_exp_f32 v18, v18
    v_exp_f32 v19, v19
    s_waitcnt lgkmcnt(6)
    v_mfma_f32_32x32x16_bf16 v[56:71], v[88:91], v[72:75], v[56:71]
    ds_read_b128 v[88:91], v122 offset:22592
    v_cvt_pk_bf16_f32 v76, v16, v17
    v_cvt_pk_bf16_f32 v77, v18, v19
    v_exp_f32 v20, v20
    v_exp_f32 v21, v21
    v_exp_f32 v22, v22
    v_exp_f32 v23, v23
    v_cvt_pk_bf16_f32 v78, v20, v21
    v_cvt_pk_bf16_f32 v79, v22, v23
    s_add_u32 m0, s53, 49152
    s_nop 0
    buffer_load_dwordx4 v132, s[60:63], s55 offen lds
    s_add_u32 m0, s53, 57344
    s_nop 0
    buffer_load_dwordx4 v132, s[32:35], s55 offen lds
    s_add_u32 s55, s55, 294912
    ds_read_b64_tr_b16 v[208:209], v133 offset:16384
    ds_read_b64_tr_b16 v[210:211], v133 offset:20480
    ds_read_b64_tr_b16 v[212:213], v133 offset:24576
    ds_read_b64_tr_b16 v[214:215], v133 offset:28672
    s_waitcnt lgkmcnt(6)
    v_mfma_f32_32x32x16_bf16 v[8:23], v[80:83], v[96:99], v[40:55]
    ds_read_b128 v[80:83], v119 offset:24064
    v_exp_f32 v24, v24
    v_exp_f32 v25, v25
    v_exp_f32 v26, v26
    v_exp_f32 v27, v27
    s_waitcnt lgkmcnt(6)
    v_mfma_f32_32x32x16_bf16 v[56:71], v[92:95], v[76:79], v[56:71]
    ds_read_b128 v[92:95], v122 offset:23200
    v_cvt_pk_bf16_f32 v72, v24, v25
    v_cvt_pk_bf16_f32 v73, v26, v27
    v_exp_f32 v28, v28
    v_exp_f32 v29, v29
    v_exp_f32 v30, v30
    v_exp_f32 v31, v31
    v_mfma_f32_32x32x16_bf16 v[8:23], v[84:87], v[110:113], v[8:23]
    v_cvt_pk_bf16_f32 v74, v28, v29
    v_cvt_pk_bf16_f32 v75, v30, v31
    v_exp_f32 v32, v32
    v_exp_f32 v33, v33
    v_exp_f32 v34, v34
    v_exp_f32 v35, v35
    s_waitcnt lgkmcnt(6)
    v_mfma_f32_32x32x16_bf16 v[56:71], v[88:91], v[72:75], v[56:71]
    ds_read_b128 v[88:91], v122 offset:23808
    v_cvt_pk_bf16_f32 v76, v32, v33
    v_cvt_pk_bf16_f32 v77, v34, v35
    v_exp_f32 v36, v36
    v_exp_f32 v37, v37
    v_exp_f32 v38, v38
    v_exp_f32 v39, v39
    v_cvt_pk_bf16_f32 v78, v36, v37
    v_cvt_pk_bf16_f32 v79, v38, v39
    s_waitcnt lgkmcnt(2)
    v_mfma_f32_32x32x16_bf16 v[24:39], v[80:83], v[96:99], v[40:55]
    ds_read_b128 v[80:83], v119 offset:25088
    v_exp_f32 v8, v8
    v_exp_f32 v9, v9
    v_exp_f32 v10, v10
    v_exp_f32 v11, v11
    s_waitcnt lgkmcnt(2)
    v_mfma_f32_32x32x16_bf16 v[56:71], v[92:95], v[76:79], v[56:71]
    ds_read_b128 v[92:95], v122 offset:24416
    v_cvt_pk_bf16_f32 v72, v8, v9
    v_cvt_pk_bf16_f32 v73, v10, v11
    v_exp_f32 v12, v12
    v_exp_f32 v13, v13
    v_exp_f32 v14, v14
    v_exp_f32 v15, v15
    v_mfma_f32_32x32x16_bf16 v[24:39], v[84:87], v[114:117], v[24:39]
    v_cvt_pk_bf16_f32 v74, v12, v13
    v_cvt_pk_bf16_f32 v75, v14, v15
    v_exp_f32 v16, v16
    v_exp_f32 v17, v17
    v_exp_f32 v18, v18
    v_exp_f32 v19, v19
    s_waitcnt lgkmcnt(2)
    v_mfma_f32_32x32x16_bf16 v[56:71], v[88:91], v[72:75], v[56:71]
    ds_read_b128 v[88:91], v122 offset:25024
    v_cvt_pk_bf16_f32 v76, v16, v17
    v_cvt_pk_bf16_f32 v77, v18, v19
    v_exp_f32 v20, v20
    v_exp_f32 v21, v21
    v_exp_f32 v22, v22
    v_exp_f32 v23, v23
    v_cvt_pk_bf16_f32 v78, v20, v21
    v_cvt_pk_bf16_f32 v79, v22, v23
    s_waitcnt lgkmcnt(2)
    v_mfma_f32_32x32x16_bf16 v[8:23], v[80:83], v[96:99], v[40:55]
    ds_read_b128 v[80:83], v119 offset:26112
    v_exp_f32 v24, v24
    v_exp_f32 v25, v25
    v_exp_f32 v26, v26
    v_exp_f32 v27, v27
    s_waitcnt lgkmcnt(2)
    v_mfma_f32_32x32x16_bf16 v[56:71], v[92:95], v[76:79], v[56:71]
    ds_read_b128 v[92:95], v122 offset:25632
    v_cvt_pk_bf16_f32 v72, v24, v25
    v_cvt_pk_bf16_f32 v73, v26, v27
    v_exp_f32 v28, v28
    v_exp_f32 v29, v29
    v_exp_f32 v30, v30
    v_exp_f32 v31, v31
    v_mfma_f32_32x32x16_bf16 v[8:23], v[84:87], v[108:111], v[8:23]
    v_cvt_pk_bf16_f32 v74, v28, v29
    v_cvt_pk_bf16_f32 v75, v30, v31
    v_exp_f32 v32, v32
    v_exp_f32 v33, v33
    v_exp_f32 v34, v34
    v_exp_f32 v35, v35
    s_waitcnt lgkmcnt(2)
    v_mfma_f32_32x32x16_bf16 v[56:71], v[88:91], v[72:75], v[56:71]
    ds_read_b128 v[88:91], v122 offset:26240
    v_cvt_pk_bf16_f32 v76, v32, v33
    v_cvt_pk_bf16_f32 v77, v34, v35
    v_exp_f32 v36, v36
    v_exp_f32 v37, v37
    v_exp_f32 v38, v38
    v_exp_f32 v39, v39
    v_cvt_pk_bf16_f32 v78, v36, v37
    v_cvt_pk_bf16_f32 v79, v38, v39
    s_waitcnt lgkmcnt(2)
    v_mfma_f32_32x32x16_bf16 v[24:39], v[80:83], v[96:99], v[40:55]
    ds_read_b128 v[80:83], v119 offset:37888
    v_exp_f32 v8, v8
    v_exp_f32 v9, v9
    v_exp_f32 v10, v10
    v_exp_f32 v11, v11
    s_waitcnt lgkmcnt(2)
    v_mfma_f32_32x32x16_bf16 v[56:71], v[92:95], v[76:79], v[56:71]
    ds_read_b128 v[92:95], v122 offset:26848
    v_cvt_pk_bf16_f32 v72, v8, v9
    v_cvt_pk_bf16_f32 v73, v10, v11
    v_exp_f32 v12, v12
    v_exp_f32 v13, v13
    v_exp_f32 v14, v14
    v_exp_f32 v15, v15
    v_mfma_f32_32x32x16_bf16 v[24:39], v[84:87], v[112:115], v[24:39]
    ds_read_b128 v[84:87], v119 offset:46080
    v_cvt_pk_bf16_f32 v74, v12, v13
    v_cvt_pk_bf16_f32 v75, v14, v15
    v_exp_f32 v16, v16
    v_exp_f32 v17, v17
    v_exp_f32 v18, v18
    v_exp_f32 v19, v19
    s_waitcnt lgkmcnt(3)
    v_mfma_f32_32x32x16_bf16 v[56:71], v[88:91], v[72:75], v[56:71]
    ds_read_b128 v[88:91], v122 offset:27456
    v_cvt_pk_bf16_f32 v76, v16, v17
    v_cvt_pk_bf16_f32 v77, v18, v19
    v_exp_f32 v20, v20
    v_exp_f32 v21, v21
    v_exp_f32 v22, v22
    v_exp_f32 v23, v23
    v_cvt_pk_bf16_f32 v78, v20, v21
    v_cvt_pk_bf16_f32 v79, v22, v23
    s_waitcnt lgkmcnt(3)
    v_mfma_f32_32x32x16_bf16 v[8:23], v[80:83], v[96:99], v[40:55]
    ds_read_b128 v[80:83], v119 offset:38912
    v_exp_f32 v24, v24
    v_exp_f32 v25, v25
    v_exp_f32 v26, v26
    v_exp_f32 v27, v27
    s_waitcnt lgkmcnt(3)
    v_mfma_f32_32x32x16_bf16 v[56:71], v[92:95], v[76:79], v[56:71]
    ds_read_b128 v[92:95], v122 offset:28064
    v_cvt_pk_bf16_f32 v72, v24, v25
    v_cvt_pk_bf16_f32 v73, v26, v27
    v_exp_f32 v28, v28
    v_exp_f32 v29, v29
    v_exp_f32 v30, v30
    v_exp_f32 v31, v31
    s_waitcnt lgkmcnt(3)
    v_mfma_f32_32x32x16_bf16 v[8:23], v[84:87], v[102:105], v[8:23]
    v_cvt_pk_bf16_f32 v74, v28, v29
    v_cvt_pk_bf16_f32 v75, v30, v31
    v_exp_f32 v32, v32
    v_exp_f32 v33, v33
    v_exp_f32 v34, v34
    v_exp_f32 v35, v35
    s_waitcnt lgkmcnt(2)
    v_mfma_f32_32x32x16_bf16 v[56:71], v[88:91], v[72:75], v[56:71]
    ds_read_b128 v[88:91], v122 offset:37888
    v_cvt_pk_bf16_f32 v76, v32, v33
    v_cvt_pk_bf16_f32 v77, v34, v35
    v_exp_f32 v36, v36
    v_exp_f32 v37, v37
    v_exp_f32 v38, v38
    v_exp_f32 v39, v39
    v_cvt_pk_bf16_f32 v78, v36, v37
    v_cvt_pk_bf16_f32 v79, v38, v39
    s_setprio 2
    s_waitcnt lgkmcnt(2)
    v_mfma_f32_32x32x16_bf16 v[24:39], v[80:83], v[96:99], v[40:55]
    ds_read_b128 v[80:83], v119 offset:39936
    v_exp_f32 v8, v8
    v_exp_f32 v9, v9
    v_exp_f32 v10, v10
    v_exp_f32 v11, v11
    s_waitcnt lgkmcnt(2)
    v_mfma_f32_32x32x16_bf16 v[56:71], v[92:95], v[76:79], v[56:71]
    ds_read_b128 v[92:95], v122 offset:38496
    v_cvt_pk_bf16_f32 v72, v8, v9
    v_cvt_pk_bf16_f32 v73, v10, v11
    v_exp_f32 v12, v12
    v_exp_f32 v13, v13
    v_exp_f32 v14, v14
    v_exp_f32 v15, v15
    v_mfma_f32_32x32x16_bf16 v[24:39], v[84:87], v[106:109], v[24:39]
    v_cvt_pk_bf16_f32 v74, v12, v13
    v_cvt_pk_bf16_f32 v75, v14, v15
    v_exp_f32 v16, v16
    v_exp_f32 v17, v17
    v_exp_f32 v18, v18
    v_exp_f32 v19, v19
    s_waitcnt lgkmcnt(2)
    v_mfma_f32_32x32x16_bf16 v[56:71], v[88:91], v[72:75], v[56:71]
    ds_read_b128 v[88:91], v122 offset:39104
    v_cvt_pk_bf16_f32 v76, v16, v17
    v_cvt_pk_bf16_f32 v77, v18, v19
    v_exp_f32 v20, v20
    v_exp_f32 v21, v21
    v_exp_f32 v22, v22
    v_exp_f32 v23, v23
    v_cvt_pk_bf16_f32 v78, v20, v21
    v_cvt_pk_bf16_f32 v79, v22, v23
    s_waitcnt lgkmcnt(2)
    v_mfma_f32_32x32x16_bf16 v[8:23], v[80:83], v[96:99], v[40:55]
    ds_read_b128 v[80:83], v119 offset:40960
    v_exp_f32 v24, v24
    v_exp_f32 v25, v25
    v_exp_f32 v26, v26
    v_exp_f32 v27, v27
    s_waitcnt lgkmcnt(2)
    v_mfma_f32_32x32x16_bf16 v[56:71], v[92:95], v[76:79], v[56:71]
    ds_read_b128 v[92:95], v122 offset:39712
    v_cvt_pk_bf16_f32 v72, v24, v25
    v_cvt_pk_bf16_f32 v73, v26, v27
    v_exp_f32 v28, v28
    v_exp_f32 v29, v29
    v_exp_f32 v30, v30
    v_exp_f32 v31, v31
    v_mfma_f32_32x32x16_bf16 v[8:23], v[84:87], v[100:103], v[8:23]
    v_cvt_pk_bf16_f32 v74, v28, v29
    v_cvt_pk_bf16_f32 v75, v30, v31
    v_exp_f32 v32, v32
    v_exp_f32 v33, v33
    v_exp_f32 v34, v34
    v_exp_f32 v35, v35
    s_waitcnt lgkmcnt(2)
    v_mfma_f32_32x32x16_bf16 v[56:71], v[88:91], v[72:75], v[56:71]
    ds_read_b128 v[88:91], v122 offset:40320
    v_cvt_pk_bf16_f32 v76, v32, v33
    v_cvt_pk_bf16_f32 v77, v34, v35
    v_exp_f32 v36, v36
    v_exp_f32 v37, v37
    v_exp_f32 v38, v38
    v_exp_f32 v39, v39
    v_cvt_pk_bf16_f32 v78, v36, v37
    v_cvt_pk_bf16_f32 v79, v38, v39
    s_waitcnt vmcnt(0)
    s_barrier
    s_add_u32 m0, s53, 0
    s_nop 0
    buffer_load_dwordx4 v132, s[60:63], s55 offen lds
    s_add_u32 m0, s53, 8192
    s_nop 0
    buffer_load_dwordx4 v132, s[32:35], s55 offen lds
    s_add_u32 s55, s55, 294912
    ds_read_b64_tr_b16 v[216:217], v133 offset:32768
    ds_read_b64_tr_b16 v[218:219], v133 offset:36864
    ds_read_b64_tr_b16 v[220:221], v133 offset:40960
    ds_read_b64_tr_b16 v[222:223], v133 offset:45056
    s_waitcnt lgkmcnt(6)
    v_mfma_f32_32x32x16_bf16 v[24:39], v[80:83], v[96:99], v[40:55]
    ds_read_b128 v[80:83], v119 offset:41984
    v_exp_f32 v8, v8
    v_exp_f32 v9, v9
    v_exp_f32 v10, v10
    v_exp_f32 v11, v11
    s_waitcnt lgkmcnt(6)
    v_mfma_f32_32x32x16_bf16 v[56:71], v[92:95], v[76:79], v[56:71]
    ds_read_b128 v[92:95], v122 offset:40928
    v_cvt_pk_bf16_f32 v72, v8, v9
    v_cvt_pk_bf16_f32 v73, v10, v11
    v_exp_f32 v12, v12
    v_exp_f32 v13, v13
    v_exp_f32 v14, v14
    v_exp_f32 v15, v15
    v_mfma_f32_32x32x16_bf16 v[24:39], v[84:87], v[104:107], v[24:39]
    v_cvt_pk_bf16_f32 v74, v12, v13
    v_cvt_pk_bf16_f32 v75, v14, v15
    v_exp_f32 v16, v16
    v_exp_f32 v17, v17
    v_exp_f32 v18, v18
    v_exp_f32 v19, v19
    s_waitcnt lgkmcnt(6)
    v_mfma_f32_32x32x16_bf16 v[56:71], v[88:91], v[72:75], v[56:71]
    ds_read_b128 v[88:91], v122 offset:41536
    v_cvt_pk_bf16_f32 v76, v16, v17
    v_cvt_pk_bf16_f32 v77, v18, v19
    v_exp_f32 v20, v20
    v_exp_f32 v21, v21
    v_exp_f32 v22, v22
    v_exp_f32 v23, v23
    v_cvt_pk_bf16_f32 v78, v20, v21
    v_cvt_pk_bf16_f32 v79, v22, v23
    v_lshlrev_b32 v135, 7, v1
    s_cmp_lg_u32 s12, 7
    s_cbranch_scc1 k234_mid_kernel_ax0
    s_mov_b32 s17, 8323072
    buffer_load_dword v136, v135, s[8:11], s17 offen sc1
k234_mid_kernel_ax0:
    s_add_u32 m0, s53, 16384
    s_nop 0
    buffer_load_dwordx4 v132, s[60:63], s55 offen lds
    s_add_u32 m0, s53, 24576
    s_nop 0
    buffer_load_dwordx4 v132, s[32:35], s55 offen lds
    s_add_u32 s55, s55, 294912
    ds_read_b64_tr_b16 v[224:225], v134 offset:0
    ds_read_b64_tr_b16 v[226:227], v134 offset:4096
    ds_read_b64_tr_b16 v[228:229], v134 offset:8192
    ds_read_b64_tr_b16 v[230:231], v134 offset:12288
    s_waitcnt lgkmcnt(6)
    v_mfma_f32_32x32x16_bf16 v[8:23], v[80:83], v[96:99], v[40:55]
    ds_read_b128 v[80:83], v119 offset:43008
    v_exp_f32 v24, v24
    v_exp_f32 v25, v25
    v_exp_f32 v26, v26
    v_exp_f32 v27, v27
    s_waitcnt lgkmcnt(6)
    v_mfma_f32_32x32x16_bf16 v[56:71], v[92:95], v[76:79], v[56:71]
    ds_read_b128 v[92:95], v122 offset:42144
    v_cvt_pk_bf16_f32 v72, v24, v25
    v_cvt_pk_bf16_f32 v73, v26, v27
    v_exp_f32 v28, v28
    v_exp_f32 v29, v29
    v_exp_f32 v30, v30
    v_exp_f32 v31, v31
    v_mfma_f32_32x32x16_bf16 v[8:23], v[84:87], v[110:113], v[8:23]
    v_cvt_pk_bf16_f32 v74, v28, v29
    v_cvt_pk_bf16_f32 v75, v30, v31
    v_exp_f32 v32, v32
    v_exp_f32 v33, v33
    v_exp_f32 v34, v34
    v_exp_f32 v35, v35
    s_waitcnt lgkmcnt(6)
    v_mfma_f32_32x32x16_bf16 v[56:71], v[88:91], v[72:75], v[56:71]
    ds_read_b128 v[88:91], v122 offset:42752
    v_cvt_pk_bf16_f32 v76, v32, v33
    v_cvt_pk_bf16_f32 v77, v34, v35
    v_exp_f32 v36, v36
    v_exp_f32 v37, v37
    v_exp_f32 v38, v38
    v_exp_f32 v39, v39
    v_cvt_pk_bf16_f32 v78, v36, v37
    v_cvt_pk_bf16_f32 v79, v38, v39
    s_add_u32 m0, s53, 65536
    s_nop 0
    buffer_load_dwordx4 v132, s[60:63], s55 offen lds
    s_add_u32 m0, s53, 73728
    s_nop 0
    buffer_load_dwordx4 v132, s[32:35], s55 offen lds
    s_add_u32 s55, s55, 294912
    s_waitcnt lgkmcnt(2)
    v_mfma_f32_32x32x16_bf16 v[24:39], v[80:83], v[96:99], v[40:55]
    ds_read_b128 v[80:83], v119 offset:44032
    v_exp_f32 v8, v8
    v_exp_f32 v9, v9
    v_exp_f32 v10, v10
    v_exp_f32 v11, v11
    s_waitcnt lgkmcnt(2)
    v_mfma_f32_32x32x16_bf16 v[56:71], v[92:95], v[76:79], v[56:71]
    ds_read_b128 v[92:95], v122 offset:43360
    v_cvt_pk_bf16_f32 v72, v8, v9
    v_cvt_pk_bf16_f32 v73, v10, v11
    v_exp_f32 v12, v12
    v_exp_f32 v13, v13
    v_exp_f32 v14, v14
    v_exp_f32 v15, v15
    v_mfma_f32_32x32x16_bf16 v[24:39], v[84:87], v[114:117], v[24:39]
    v_cvt_pk_bf16_f32 v74, v12, v13
    v_cvt_pk_bf16_f32 v75, v14, v15
    v_exp_f32 v16, v16
    v_exp_f32 v17, v17
    v_exp_f32 v18, v18
    v_exp_f32 v19, v19
    s_waitcnt lgkmcnt(2)
    v_mfma_f32_32x32x16_bf16 v[56:71], v[88:91], v[72:75], v[56:71]
    ds_read_b128 v[88:91], v122 offset:43968
    v_cvt_pk_bf16_f32 v76, v16, v17
    v_cvt_pk_bf16_f32 v77, v18, v19
    v_exp_f32 v20, v20
    v_exp_f32 v21, v21
    v_exp_f32 v22, v22
    v_exp_f32 v23, v23
    v_cvt_pk_bf16_f32 v78, v20, v21
    v_cvt_pk_bf16_f32 v79, v22, v23
    s_waitcnt lgkmcnt(2)
    v_mfma_f32_32x32x16_bf16 v[8:23], v[80:83], v[96:99], v[40:55]
    ds_read_b128 v[80:83], v119 offset:45056
    v_exp_f32 v24, v24
    v_exp_f32 v25, v25
    v_exp_f32 v26, v26
    v_exp_f32 v27, v27
    s_waitcnt lgkmcnt(2)
    v_mfma_f32_32x32x16_bf16 v[56:71], v[92:95], v[76:79], v[56:71]
    ds_read_b128 v[92:95], v122 offset:44576
    v_cvt_pk_bf16_f32 v72, v24, v25
    v_cvt_pk_bf16_f32 v73, v26, v27
    v_exp_f32 v28, v28
    v_exp_f32 v29, v29
    v_exp_f32 v30, v30
    v_exp_f32 v31, v31
    v_mfma_f32_32x32x16_bf16 v[8:23], v[84:87], v[108:111], v[8:23]
    v_cvt_pk_bf16_f32 v74, v28, v29
    v_cvt_pk_bf16_f32 v75, v30, v31
    v_exp_f32 v32, v32
    v_exp_f32 v33, v33
    v_exp_f32 v34, v34
    v_exp_f32 v35, v35
    s_waitcnt lgkmcnt(2)
    v_mfma_f32_32x32x16_bf16 v[56:71], v[88:91], v[72:75], v[56:71]
    ds_read_b128 v[88:91], v122 offset:45184
    v_cvt_pk_bf16_f32 v76, v32, v33
    v_cvt_pk_bf16_f32 v77, v34, v35
    v_exp_f32 v36, v36
    v_exp_f32 v37, v37
    v_exp_f32 v38, v38
    v_exp_f32 v39, v39
    v_cvt_pk_bf16_f32 v78, v36, v37
    v_cvt_pk_bf16_f32 v79, v38, v39
    s_waitcnt lgkmcnt(2)
    v_mfma_f32_32x32x16_bf16 v[24:39], v[80:83], v[96:99], v[40:55]
    ds_read_b128 v[80:83], v120 offset:0
    v_exp_f32 v8, v8
    v_exp_f32 v9, v9
    v_exp_f32 v10, v10
    v_exp_f32 v11, v11
    s_waitcnt lgkmcnt(2)
    v_mfma_f32_32x32x16_bf16 v[56:71], v[92:95], v[76:79], v[56:71]
    ds_read_b128 v[92:95], v122 offset:45792
    v_cvt_pk_bf16_f32 v72, v8, v9
    v_cvt_pk_bf16_f32 v73, v10, v11
    v_exp_f32 v12, v12
    v_exp_f32 v13, v13
    v_exp_f32 v14, v14
    v_exp_f32 v15, v15
    v_mfma_f32_32x32x16_bf16 v[24:39], v[84:87], v[112:115], v[24:39]
    ds_read_b128 v[84:87], v120 offset:8192
    v_cvt_pk_bf16_f32 v74, v12, v13
    v_cvt_pk_bf16_f32 v75, v14, v15
    v_exp_f32 v16, v16
    v_exp_f32 v17, v17
    v_exp_f32 v18, v18
    v_exp_f32 v19, v19
    s_waitcnt lgkmcnt(3)
    v_mfma_f32_32x32x16_bf16 v[56:71], v[88:91], v[72:75], v[56:71]
    ds_read_b128 v[88:91], v122 offset:46400
    v_cvt_pk_bf16_f32 v76, v16, v17
    v_cvt_pk_bf16_f32 v77, v18, v19
    v_exp_f32 v20, v20
    v_exp_f32 v21, v21
    v_exp_f32 v22, v22
    v_exp_f32 v23, v23
    v_cvt_pk_bf16_f32 v78, v20, v21
    v_cvt_pk_bf16_f32 v79, v22, v23
    s_waitcnt lgkmcnt(3)
    v_mfma_f32_32x32x16_bf16 v[8:23], v[80:83], v[96:99], v[40:55]
    ds_read_b128 v[80:83], v120 offset:1024
    v_exp_f32 v24, v24
    v_exp_f32 v25, v25
    v_exp_f32 v26, v26
    v_exp_f32 v27, v27
    s_waitcnt lgkmcnt(3)
    v_mfma_f32_32x32x16_bf16 v[56:71], v[92:95], v[76:79], v[56:71]
    ds_read_b128 v[92:95], v122 offset:47008
    v_cvt_pk_bf16_f32 v72, v24, v25
    v_cvt_pk_bf16_f32 v73, v26, v27
    v_exp_f32 v28, v28
    v_exp_f32 v29, v29
    v_exp_f32 v30, v30
    v_exp_f32 v31, v31
    s_waitcnt lgkmcnt(3)
    v_mfma_f32_32x32x16_bf16 v[8:23], v[84:87], v[102:105], v[8:23]
    v_cvt_pk_bf16_f32 v74, v28, v29
    v_cvt_pk_bf16_f32 v75, v30, v31
    v_exp_f32 v32, v32
    v_exp_f32 v33, v33
    v_exp_f32 v34, v34
    v_exp_f32 v35, v35
    s_waitcnt lgkmcnt(2)
    v_mfma_f32_32x32x16_bf16 v[56:71], v[88:91], v[72:75], v[56:71]
    ds_read_b128 v[88:91], v123 offset:0
    v_cvt_pk_bf16_f32 v76, v32, v33
    v_cvt_pk_bf16_f32 v77, v34, v35
    v_exp_f32 v36, v36
    v_exp_f32 v37, v37
    v_exp_f32 v38, v38
    v_exp_f32 v39, v39
    v_cvt_pk_bf16_f32 v78, v36, v37
    v_cvt_pk_bf16_f32 v79, v38, v39
    s_waitcnt lgkmcnt(2)
    v_mfma_f32_32x32x16_bf16 v[24:39], v[80:83], v[96:99], v[40:55]
    ds_read_b128 v[80:83], v120 offset:2048
    v_exp_f32 v8, v8
    v_exp_f32 v9, v9
    v_exp_f32 v10, v10
    v_exp_f32 v11, v11
    s_waitcnt lgkmcnt(2)
    v_mfma_f32_32x32x16_bf16 v[56:71], v[92:95], v[76:79], v[56:71]
    ds_read_b128 v[92:95], v123 offset:608
    v_cvt_pk_bf16_f32 v72, v8, v9
    v_cvt_pk_bf16_f32 v73, v10, v11
    v_exp_f32 v12, v12
    v_exp_f32 v13, v13
    v_exp_f32 v14, v14
    v_exp_f32 v15, v15
    v_mfma_f32_32x32x16_bf16 v[24:39], v[84:87], v[106:109], v[24:39]
    v_cvt_pk_bf16_f32 v74, v12, v13
    v_cvt_pk_bf16_f32 v75, v14, v15
    v_exp_f32 v16, v16
    v_exp_f32 v17, v17
    v_exp_f32 v18, v18
    v_exp_f32 v19, v19
    s_waitcnt lgkmcnt(2)
    v_mfma_f32_32x32x16_bf16 v[56:71], v[88:91], v[72:75], v[56:71]
    ds_read_b128 v[88:91], v123 offset:1216
    v_cvt_pk_bf16_f32 v76, v16, v17
    v_cvt_pk_bf16_f32 v77, v18, v19
    v_exp_f32 v20, v20
    v_exp_f32 v21, v21
    v_exp_f32 v22, v22
    v_exp_f32 v23, v23
    v_cvt_pk_bf16_f32 v78, v20, v21
    v_cvt_pk_bf16_f32 v79, v22, v23
    s_cmp_lg_u32 s12, 7
    s_cbranch_scc1 k234_mid_kernel_ax2
    s_mov_b32 s19, 100000
    s_mov_b32 s17, 8323072
    s_waitcnt vmcnt(4)
k234_mid_kernel_ax1:
    v_cmp_ne_u32 vcc, 0, v136
    s_sub_u32 s19, s19, 1
    s_cmp_le_i32 s19, 0
    s_cbranch_scc1 k234_mid_kernel_ax2
    s_nop 1
    s_cbranch_vccz k234_mid_kernel_ax2
    s_sleep 8
    buffer_load_dword v136, v135, s[8:11], s17 offen sc1
    s_waitcnt vmcnt(0)
    s_branch k234_mid_kernel_ax1
k234_mid_kernel_ax2:
    s_waitcnt vmcnt(0)
    s_barrier
    s_cmp_eq_u32 s54, 0
    s_cbranch_scc1 k234_mid_kernel_wk1
    s_add_u32 m0, s53, 32768
    s_add_u32 s56, s52, 32768
    buffer_load_dwordx4 v7, s[8:11], s56 offen sc1 lds
k234_mid_kernel_wk1:
    s_cmp_eq_u32 s54, 0
    s_cbranch_scc1 k234_mid_kernel_wk2
    s_add_u32 m0, s53, 40960
    s_add_u32 s56, s52, 40960
    buffer_load_dwordx4 v7, s[8:11], s56 offen sc1 lds
k234_mid_kernel_wk2:
    ds_read_b64_tr_b16 v[232:233], v133 offset:0
    ds_read_b64_tr_b16 v[234:235], v133 offset:4096
    ds_read_b64_tr_b16 v[236:237], v133 offset:8192
    ds_read_b64_tr_b16 v[238:239], v133 offset:12288
    s_waitcnt lgkmcnt(6)
    v_mfma_f32_32x32x16_bf16 v[8:23], v[80:83], v[96:99], v[40:55]
    ds_read_b128 v[80:83], v120 offset:3072
    v_exp_f32 v24, v24
    v_exp_f32 v25, v25
    v_exp_f32 v26, v26
    v_exp_f32 v27, v27
    s_waitcnt lgkmcnt(6)
    v_mfma_f32_32x32x16_bf16 v[56:71], v[92:95], v[76:79], v[56:71]
    ds_read_b128 v[92:95], v123 offset:1824
    v_cvt_pk_bf16_f32 v72, v24, v25
    v_cvt_pk_bf16_f32 v73, v26, v27
    v_exp_f32 v28, v28
    v_exp_f32 v29, v29
    v_exp_f32 v30, v30
    v_exp_f32 v31, v31
    v_mfma_f32_32x32x16_bf16 v[8:23], v[84:87], v[100:103], v[8:23]
    v_cvt_pk_bf16_f32 v74, v28, v29
    v_cvt_pk_bf16_f32 v75, v30, v31
    v_exp_f32 v32, v32
    v_exp_f32 v33, v33
    v_exp_f32 v34, v34
    v_exp_f32 v35, v35
    s_waitcnt lgkmcnt(6)
    v_mfma_f32_32x32x16_bf16 v[56:71], v[88:91], v[72:75], v[56:71]
    ds_read_b128 v[88:91], v123 offset:2432
    v_cvt_pk_bf16_f32 v76, v32, v33
    v_cvt_pk_bf16_f32 v77, v34, v35
    v_exp_f32 v36, v36
    v_exp_f32 v37, v37
    v_exp_f32 v38, v38
    v_exp_f32 v39, v39
    v_cvt_pk_bf16_f32 v78, v36, v37
    v_cvt_pk_bf16_f32 v79, v38, v39
    s_cmp_eq_u32 s54, 0
    s_cbranch_scc1 k234_mid_kernel_wk3
    s_add_u32 m0, s53, 49152
    s_add_u32 s56, s52, 49152
    buffer_load_dwordx4 v7, s[8:11], s56 offen sc1 lds
k234_mid_kernel_wk3:
    s_cmp_eq_u32 s54, 0
    s_cbranch_scc1 k234_mid_kernel_wk4
    s_add_u32 m0, s53, 57344
    s_add_u32 s56, s52, 57344
    buffer_load_dwordx4 v7, s[8:11], s56 offen sc1 lds
k234_mid_kernel_wk4:
    ds_read_b64_tr_b16 v[240:241], v133 offset:16384
    ds_read_b64_tr_b16 v[242:243], v133 offset:20480
    ds_read_b64_tr_b16 v[244:245], v133 offset:24576
    ds_read_b64_tr_b16 v[246:247], v133 offset:28672
    s_waitcnt lgkmcnt(6)
    v_mfma_f32_32x32x16_bf16 v[24:39], v[80:83], v[96:99], v[40:55]
    ds_read_b128 v[80:83], v120 offset:4096
    v_exp_f32 v8, v8
    v_exp_f32 v9, v9
    v_exp_f32 v10, v10
    v_exp_f32 v11, v11
    s_waitcnt lgkmcnt(6)
    v_mfma_f32_32x32x16_bf16 v[56:71], v[92:95], v[76:79], v[56:71]
    ds_read_b128 v[92:95], v123 offset:3040
    v_cvt_pk_bf16_f32 v72, v8, v9
    v_cvt_pk_bf16_f32 v73, v10, v11
    v_exp_f32 v12, v12
    v_exp_f32 v13, v13
    v_exp_f32 v14, v14
    v_exp_f32 v15, v15
    v_mfma_f32_32x32x16_bf16 v[24:39], v[84:87], v[104:107], v[24:39]
    v_cvt_pk_bf16_f32 v74, v12, v13
    v_cvt_pk_bf16_f32 v75, v14, v15
    v_exp_f32 v16, v16
    v_exp_f32 v17, v17
    v_exp_f32 v18, v18
    v_exp_f32 v19, v19
    s_waitcnt lgkmcnt(6)
    v_mfma_f32_32x32x16_bf16 v[56:71], v[88:91], v[72:75], v[56:71]
    ds_read_b128 v[88:91], v123 offset:3648
    v_cvt_pk_bf16_f32 v76, v16, v17
    v_cvt_pk_bf16_f32 v77, v18, v19
    v_exp_f32 v20, v20
    v_exp_f32 v21, v21
    v_exp_f32 v22, v22
    v_exp_f32 v23, v23
    v_cvt_pk_bf16_f32 v78, v20, v21
    v_cvt_pk_bf16_f32 v79, v22, v23
    s_cmp_eq_u32 s54, 0
    s_cbranch_scc1 k234_mid_kernel_wk5
    s_add_u32 m0, s53, 81920
    s_add_u32 s56, s52, 81920
    buffer_load_dwordx4 v7, s[8:11], s56 offen sc1 lds
k234_mid_kernel_wk5:
    s_cmp_eq_u32 s54, 0
    s_cbranch_scc1 k234_mid_kernel_wk6
    s_add_u32 m0, s53, 90112
    s_add_u32 s56, s52, 90112
    buffer_load_dwordx4 v7, s[8:11], s56 offen sc1 lds
k234_mid_kernel_wk6:
    ds_read_b64_tr_b16 v[248:249], v134 offset:16384
    ds_read_b64_tr_b16 v[250:251], v134 offset:20480
    ds_read_b64_tr_b16 v[252:253], v134 offset:24576
    ds_read_b64_tr_b16 v[254:255], v134 offset:28672
    s_waitcnt lgkmcnt(6)
    v_mfma_f32_32x32x16_bf16 v[8:23], v[80:83], v[96:99], v[40:55]
    ds_read_b128 v[80:83], v120 offset:5120
    v_exp_f32 v24, v24
    v_exp_f32 v25, v25
    v_exp_f32 v26, v26
    v_exp_f32 v27, v27
    s_waitcnt lgkmcnt(6)
    v_mfma_f32_32x32x16_bf16 v[56:71], v[92:95], v[76:79], v[56:71]
    ds_read_b128 v[92:95], v123 offset:4256
    v_cvt_pk_bf16_f32 v72, v24, v25
    v_cvt_pk_bf16_f32 v73, v26, v27
    v_exp_f32 v28, v28
    v_exp_f32 v29, v29
    v_exp_f32 v30, v30
    v_exp_f32 v31, v31
    v_mfma_f32_32x32x16_bf16 v[8:23], v[84:87], v[110:113], v[8:23]
    v_cvt_pk_bf16_f32 v74, v28, v29
    v_cvt_pk_bf16_f32 v75, v30, v31
    v_exp_f32 v32, v32
    v_exp_f32 v33, v33
    v_exp_f32 v34, v34
    v_exp_f32 v35, v35
    s_waitcnt lgkmcnt(6)
    v_mfma_f32_32x32x16_bf16 v[56:71], v[88:91], v[72:75], v[56:71]
    ds_read_b128 v[88:91], v123 offset:4864
    v_cvt_pk_bf16_f32 v76, v32, v33
    v_cvt_pk_bf16_f32 v77, v34, v35
    v_exp_f32 v36, v36
    v_exp_f32 v37, v37
    v_exp_f32 v38, v38
    v_exp_f32 v39, v39
    v_cvt_pk_bf16_f32 v78, v36, v37
    v_cvt_pk_bf16_f32 v79, v38, v39
    s_cmp_eq_u32 s54, 0
    s_cbranch_scc1 k234_mid_kernel_wk7
    s_add_u32 m0, s53, 98304
    s_add_u32 s56, s52, 98304
    buffer_load_dwordx4 v7, s[8:11], s56 offen sc1 lds
k234_mid_kernel_wk7:
    s_cmp_eq_u32 s54, 0
    s_cbranch_scc1 k234_mid_kernel_wk8
    s_cmp_ge_u32 s12, 4
    s_cbranch_scc1 k234_mid_kernel_wk8
    s_add_u32 m0, s53, 106496
    s_add_u32 s56, s52, 106496
    buffer_load_dwordx4 v7, s[8:11], s56 offen sc1 lds
k234_mid_kernel_wk8:
    s_waitcnt lgkmcnt(2)
    v_mfma_f32_32x32x16_bf16 v[24:39], v[80:83], v[96:99], v[40:55]
    ds_read_b128 v[80:83], v120 offset:6144
    v_exp_f32 v8, v8
    v_exp_f32 v9, v9
    v_exp_f32 v10, v10
    v_exp_f32 v11, v11
    s_waitcnt lgkmcnt(2)
    v_mfma_f32_32x32x16_bf16 v[56:71], v[92:95], v[76:79], v[56:71]
    ds_read_b128 v[92:95], v123 offset:5472
    v_cvt_pk_bf16_f32 v72, v8, v9
    v_cvt_pk_bf16_f32 v73, v10, v11
    v_exp_f32 v12, v12
    v_exp_f32 v13, v13
    v_exp_f32 v14, v14
    v_exp_f32 v15, v15
    v_mfma_f32_32x32x16_bf16 v[24:39], v[84:87], v[114:117], v[24:39]
    v_cvt_pk_bf16_f32 v74, v12, v13
    v_cvt_pk_bf16_f32 v75, v14, v15
    v_exp_f32 v16, v16
    v_exp_f32 v17, v17
    v_exp_f32 v18, v18
    v_exp_f32 v19, v19
    s_waitcnt lgkmcnt(2)
    v_mfma_f32_32x32x16_bf16 v[56:71], v[88:91], v[72:75], v[56:71]
    ds_read_b128 v[88:91], v123 offset:6080
    v_cvt_pk_bf16_f32 v76, v16, v17
    v_cvt_pk_bf16_f32 v77, v18, v19
    v_exp_f32 v20, v20
    v_exp_f32 v21, v21
    v_exp_f32 v22, v22
    v_exp_f32 v23, v23
    v_cvt_pk_bf16_f32 v78, v20, v21
    v_cvt_pk_bf16_f32 v79, v22, v23
    s_cmp_eq_u32 s54, 0
    s_cbranch_scc1 k234_mid_kernel_wk9
    s_sub_u32 s56, s12, 4
    s_cmp_ge_u32 s56, 3
    s_cbranch_scc1 k234_mid_kernel_wk9
    s_sub_u32 s56, s53, 4096
    s_add_u32 m0, s56, 110592
    s_add_u32 s56, s56, 7323648
    buffer_load_dwordx4 v7, s[8:11], s56 offen sc1 lds
k234_mid_kernel_wk9:
    s_cmp_eq_u32 s54, 0
    s_cbranch_scc1 k234_mid_kernel_wk10
    s_cmp_ge_u32 s12, 4
    s_cbranch_scc1 k234_mid_kernel_wk10
    buffer_load_dwordx4 v[176:179], v130, s[48:51], s58 offen offset:0
    buffer_load_dwordx4 v[180:183], v130, s[48:51], s58 offen offset:64
    buffer_load_dwordx4 v[184:187], v130, s[48:51], s58 offen offset:128
    buffer_load_dword v188, v131, s[8:11], s57 offen sc1
k234_mid_kernel_wk10:
    s_waitcnt lgkmcnt(2)
    v_mfma_f32_32x32x16_bf16 v[8:23], v[80:83], v[96:99], v[40:55]
    ds_read_b128 v[80:83], v120 offset:7168
    v_exp_f32 v24, v24
    v_exp_f32 v25, v25
    v_exp_f32 v26, v26
    v_exp_f32 v27, v27
    s_waitcnt lgkmcnt(2)
    v_mfma_f32_32x32x16_bf16 v[56:71], v[92:95], v[76:79], v[56:71]
    ds_read_b128 v[92:95], v123 offset:6688
    v_cvt_pk_bf16_f32 v72, v24, v25
    v_cvt_pk_bf16_f32 v73, v26, v27
    v_exp_f32 v28, v28
    v_exp_f32 v29, v29
    v_exp_f32 v30, v30
    v_exp_f32 v31, v31
    v_mfma_f32_32x32x16_bf16 v[8:23], v[84:87], v[108:111], v[8:23]
    v_cvt_pk_bf16_f32 v74, v28, v29
    v_cvt_pk_bf16_f32 v75, v30, v31
    v_exp_f32 v32, v32
    v_exp_f32 v33, v33
    v_exp_f32 v34, v34
    v_exp_f32 v35, v35
    s_waitcnt lgkmcnt(2)
    v_mfma_f32_32x32x16_bf16 v[56:71], v[88:91], v[72:75], v[56:71]
    ds_read_b128 v[88:91], v123 offset:7296
    v_cvt_pk_bf16_f32 v76, v32, v33
    v_cvt_pk_bf16_f32 v77, v34, v35
    v_exp_f32 v36, v36
    v_exp_f32 v37, v37
    v_exp_f32 v38, v38
    v_exp_f32 v39, v39
    v_cvt_pk_bf16_f32 v78, v36, v37
    v_cvt_pk_bf16_f32 v79, v38, v39
    s_setprio 1
    s_barrier
    s_cmp_eq_u32 s54, 0
    s_cbranch_scc1 k234_mid_kernel_wk11
    s_add_u32 m0, s53, 0
    s_add_u32 s56, s52, 0
    buffer_load_dwordx4 v7, s[8:11], s56 offen sc1 lds
k234_mid_kernel_wk11:
    s_cmp_eq_u32 s54, 0
    s_cbranch_scc1 k234_mid_kernel_wk12
    s_add_u32 m0, s53, 8192
    s_add_u32 s56, s52, 8192
    buffer_load_dwordx4 v7, s[8:11], s56 offen sc1 lds
k234_mid_kernel_wk12:
    s_waitcnt lgkmcnt(2)
    v_mfma_f32_32x32x16_bf16 v[24:39], v[80:83], v[96:99], v[40:55]
    ds_read_b128 v[80:83], v120 offset:18944
    v_exp_f32 v8, v8
    v_exp_f32 v9, v9
    v_exp_f32 v10, v10
    v_exp_f32 v11, v11
    s_waitcnt lgkmcnt(2)
    v_mfma_f32_32x32x16_bf16 v[56:71], v[92:95], v[76:79], v[56:71]
    ds_read_b128 v[92:95], v123 offset:7904
    v_cvt_pk_bf16_f32 v72, v8, v9
    v_cvt_pk_bf16_f32 v73, v10, v11
    v_exp_f32 v12, v12
    v_exp_f32 v13, v13
    v_exp_f32 v14, v14
    v_exp_f32 v15, v15
    v_mfma_f32_32x32x16_bf16 v[24:39], v[84:87], v[112:115], v[24:39]
    ds_read_b128 v[84:87], v120 offset:27136
    v_cvt_pk_bf16_f32 v74, v12, v13
    v_cvt_pk_bf16_f32 v75, v14, v15
    v_exp_f32 v16, v16
    v_exp_f32 v17, v17
    v_exp_f32 v18, v18
    v_exp_f32 v19, v19
    s_waitcnt lgkmcnt(3)
    v_mfma_f32_32x32x16_bf16 v[56:71], v[88:91], v[72:75], v[56:71]
    ds_read_b128 v[88:91], v123 offset:8512
    v_cvt_pk_bf16_f32 v76, v16, v17
    v_cvt_pk_bf16_f32 v77, v18, v19
    v_exp_f32 v20, v20
    v_exp_f32 v21, v21
    v_exp_f32 v22, v22
    v_exp_f32 v23, v23
    v_cvt_pk_bf16_f32 v78, v20, v21
    v_cvt_pk_bf16_f32 v79, v22, v23
    s_cmp_eq_u32 s54, 0
    s_cbranch_scc1 k234_mid_kernel_wk13
    s_add_u32 m0, s53, 16384
    s_add_u32 s56, s52, 16384
    buffer_load_dwordx4 v7, s[8:11], s56 offen sc1 lds
k234_mid_kernel_wk13:
    s_cmp_eq_u32 s54, 0
    s_cbranch_scc1 k234_mid_kernel_wk14
    s_add_u32 m0, s53, 24576
    s_add_u32 s56, s52, 24576
    buffer_load_dwordx4 v7, s[8:11], s56 offen sc1 lds
k234_mid_kernel_wk14:
    s_waitcnt lgkmcnt(3)
    v_mfma_f32_32x32x16_bf16 v[8:23], v[80:83], v[96:99], v[40:55]
    ds_read_b128 v[80:83], v120 offset:19968
    v_exp_f32 v24, v24
    v_exp_f32 v25, v25
    v_exp_f32 v26, v26
    v_exp_f32 v27, v27
    s_waitcnt lgkmcnt(3)
    v_mfma_f32_32x32x16_bf16 v[56:71], v[92:95], v[76:79], v[56:71]
    ds_read_b128 v[92:95], v123 offset:9120
    v_cvt_pk_bf16_f32 v72, v24, v25
    v_cvt_pk_bf16_f32 v73, v26, v27
    v_exp_f32 v28, v28
    v_exp_f32 v29, v29
    v_exp_f32 v30, v30
    v_exp_f32 v31, v31
    s_waitcnt lgkmcnt(3)
    v_mfma_f32_32x32x16_bf16 v[8:23], v[84:87], v[102:105], v[8:23]
    v_cvt_pk_bf16_f32 v74, v28, v29
    v_cvt_pk_bf16_f32 v75, v30, v31
    v_exp_f32 v32, v32
    v_exp_f32 v33, v33
    v_exp_f32 v34, v34
    v_exp_f32 v35, v35
    s_waitcnt lgkmcnt(2)
    v_mfma_f32_32x32x16_bf16 v[56:71], v[88:91], v[72:75], v[56:71]
    ds_read_b128 v[88:91], v123 offset:18944
    v_cvt_pk_bf16_f32 v76, v32, v33
    v_cvt_pk_bf16_f32 v77, v34, v35
    v_exp_f32 v36, v36
    v_exp_f32 v37, v37
    v_exp_f32 v38, v38
    v_exp_f32 v39, v39
    v_cvt_pk_bf16_f32 v78, v36, v37
    v_cvt_pk_bf16_f32 v79, v38, v39
    s_cmp_eq_u32 s54, 0
    s_cbranch_scc1 k234_mid_kernel_wk15
    s_add_u32 m0, s53, 65536
    s_add_u32 s56, s52, 65536
    buffer_load_dwordx4 v7, s[8:11], s56 offen sc1 lds
k234_mid_kernel_wk15:
    s_cmp_eq_u32 s54, 0
    s_cbranch_scc1 k234_mid_kernel_wk16
    s_add_u32 m0, s53, 73728
    s_add_u32 s56, s52, 73728
    buffer_load_dwordx4 v7, s[8:11], s56 offen sc1 lds
k234_mid_kernel_wk16:
    s_waitcnt lgkmcnt(2)
    v_mfma_f32_32x32x16_bf16 v[24:39], v[80:83], v[96:99], v[40:55]
    ds_read_b128 v[80:83], v120 offset:20992
    v_exp_f32 v8, v8
    v_exp_f32 v9, v9
    v_exp_f32 v10, v10
    v_exp_f32 v11, v11
    s_waitcnt lgkmcnt(2)
    v_mfma_f32_32x32x16_bf16 v[56:71], v[92:95], v[76:79], v[56:71]
    ds_read_b128 v[92:95], v123 offset:19552
    v_cvt_pk_bf16_f32 v72, v8, v9
    v_cvt_pk_bf16_f32 v73, v10, v11
    v_exp_f32 v12, v12
    v_exp_f32 v13, v13
    v_exp_f32 v14, v14
    v_exp_f32 v15, v15
    v_mfma_f32_32x32x16_bf16 v[24:39], v[84:87], v[106:109], v[24:39]
    v_cvt_pk_bf16_f32 v74, v12, v13
    v_cvt_pk_bf16_f32 v75, v14, v15
    v_exp_f32 v16, v16
    v_exp_f32 v17, v17
    v_exp_f32 v18, v18
    v_exp_f32 v19, v19
    s_waitcnt lgkmcnt(2)
    v_mfma_f32_32x32x16_bf16 v[56:71], v[88:91], v[72:75], v[56:71]
    ds_read_b128 v[88:91], v123 offset:20160
    v_cvt_pk_bf16_f32 v76, v16, v17
    v_cvt_pk_bf16_f32 v77, v18, v19
    v_exp_f32 v20, v20
    v_exp_f32 v21, v21
    v_exp_f32 v22, v22
    v_exp_f32 v23, v23
    v_cvt_pk_bf16_f32 v78, v20, v21
    v_cvt_pk_bf16_f32 v79, v22, v23
    s_waitcnt lgkmcnt(2)
    v_mfma_f32_32x32x16_bf16 v[8:23], v[80:83], v[96:99], v[40:55]
    ds_read_b128 v[80:83], v120 offset:22016
    v_exp_f32 v24, v24
    v_exp_f32 v25, v25
    v_exp_f32 v26, v26
    v_exp_f32 v27, v27
    s_waitcnt lgkmcnt(2)
    v_mfma_f32_32x32x16_bf16 v[56:71], v[92:95], v[76:79], v[56:71]
    ds_read_b128 v[92:95], v123 offset:20768
    v_cvt_pk_bf16_f32 v72, v24, v25
    v_cvt_pk_bf16_f32 v73, v26, v27
    v_exp_f32 v28, v28
    v_exp_f32 v29, v29
    v_exp_f32 v30, v30
    v_exp_f32 v31, v31
    v_mfma_f32_32x32x16_bf16 v[8:23], v[84:87], v[100:103], v[8:23]
    v_cvt_pk_bf16_f32 v74, v28, v29
    v_cvt_pk_bf16_f32 v75, v30, v31
    v_exp_f32 v32, v32
    v_exp_f32 v33, v33
    v_exp_f32 v34, v34
    v_exp_f32 v35, v35
    s_waitcnt lgkmcnt(2)
    v_mfma_f32_32x32x16_bf16 v[56:71], v[88:91], v[72:75], v[56:71]
    ds_read_b128 v[88:91], v123 offset:21376
    v_cvt_pk_bf16_f32 v76, v32, v33
    v_cvt_pk_bf16_f32 v77, v34, v35
    v_exp_f32 v36, v36
    v_exp_f32 v37, v37
    v_exp_f32 v38, v38
    v_exp_f32 v39, v39
    v_cvt_pk_bf16_f32 v78, v36, v37
    v_cvt_pk_bf16_f32 v79, v38, v39
    s_waitcnt lgkmcnt(2)
    v_mfma_f32_32x32x16_bf16 v[24:39], v[80:83], v[96:99], v[40:55]
    ds_read_b128 v[80:83], v120 offset:23040
    v_exp_f32 v8, v8
    v_exp_f32 v9, v9
    v_exp_f32 v10, v10
    v_exp_f32 v11, v11
    s_waitcnt lgkmcnt(2)
    v_mfma_f32_32x32x16_bf16 v[56:71], v[92:95], v[76:79], v[56:71]
    ds_read_b128 v[92:95], v123 offset:21984
    v_cvt_pk_bf16_f32 v72, v8, v9
    v_cvt_pk_bf16_f32 v73, v10, v11
    v_exp_f32 v12, v12
    v_exp_f32 v13, v13
    v_exp_f32 v14, v14
    v_exp_f32 v15, v15
    v_mfma_f32_32x32x16_bf16 v[24:39], v[84:87], v[104:107], v[24:39]
    v_cvt_pk_bf16_f32 v74, v12, v13
    v_cvt_pk_bf16_f32 v75, v14, v15
    v_exp_f32 v16, v16
    v_exp_f32 v17, v17
    v_exp_f32 v18, v18
    v_exp_f32 v19, v19
    s_waitcnt lgkmcnt(2)
    v_mfma_f32_32x32x16_bf16 v[56:71], v[88:91], v[72:75], v[56:71]
    ds_read_b128 v[88:91], v123 offset:22592
    v_cvt_pk_bf16_f32 v76, v16, v17
    v_cvt_pk_bf16_f32 v77, v18, v19
    v_exp_f32 v20, v20
    v_exp_f32 v21, v21
    v_exp_f32 v22, v22
    v_exp_f32 v23, v23
    v_cvt_pk_bf16_f32 v78, v20, v21
    v_cvt_pk_bf16_f32 v79, v22, v23
    s_waitcnt lgkmcnt(2)
    v_mfma_f32_32x32x16_bf16 v[8:23], v[80:83], v[96:99], v[40:55]
    ds_read_b128 v[80:83], v120 offset:24064
    v_exp_f32 v24, v24
    v_exp_f32 v25, v25
    v_exp_f32 v26, v26
    v_exp_f32 v27, v27
    s_waitcnt lgkmcnt(2)
    v_mfma_f32_32x32x16_bf16 v[56:71], v[92:95], v[76:79], v[56:71]
    ds_read_b128 v[92:95], v123 offset:23200
    v_cvt_pk_bf16_f32 v72, v24, v25
    v_cvt_pk_bf16_f32 v73, v26, v27
    v_exp_f32 v28, v28
    v_exp_f32 v29, v29
    v_exp_f32 v30, v30
    v_exp_f32 v31, v31
    v_mfma_f32_32x32x16_bf16 v[8:23], v[84:87], v[110:113], v[8:23]
    v_cvt_pk_bf16_f32 v74, v28, v29
    v_cvt_pk_bf16_f32 v75, v30, v31
    v_exp_f32 v32, v32
    v_exp_f32 v33, v33
    v_exp_f32 v34, v34
    v_exp_f32 v35, v35
    s_waitcnt lgkmcnt(2)
    v_mfma_f32_32x32x16_bf16 v[56:71], v[88:91], v[72:75], v[56:71]
    ds_read_b128 v[88:91], v123 offset:23808
    v_cvt_pk_bf16_f32 v76, v32, v33
    v_cvt_pk_bf16_f32 v77, v34, v35
    v_exp_f32 v36, v36
    v_exp_f32 v37, v37
    v_exp_f32 v38, v38
    v_exp_f32 v39, v39
    v_cvt_pk_bf16_f32 v78, v36, v37
    v_cvt_pk_bf16_f32 v79, v38, v39
    s_waitcnt lgkmcnt(2)
    v_mfma_f32_32x32x16_bf16 v[24:39], v[80:83], v[96:99], v[40:55]
    ds_read_b128 v[80:83], v120 offset:25088
    v_exp_f32 v8, v8
    v_exp_f32 v9, v9
    v_exp_f32 v10, v10
    v_exp_f32 v11, v11
    s_waitcnt lgkmcnt(2)
    v_mfma_f32_32x32x16_bf16 v[56:71], v[92:95], v[76:79], v[56:71]
    ds_read_b128 v[92:95], v123 offset:24416
    v_cvt_pk_bf16_f32 v72, v8, v9
    v_cvt_pk_bf16_f32 v73, v10, v11
    v_exp_f32 v12, v12
    v_exp_f32 v13, v13
    v_exp_f32 v14, v14
    v_exp_f32 v15, v15
    v_mfma_f32_32x32x16_bf16 v[24:39], v[84:87], v[114:117], v[24:39]
    v_cvt_pk_bf16_f32 v74, v12, v13
    v_cvt_pk_bf16_f32 v75, v14, v15
    v_exp_f32 v16, v16
    v_exp_f32 v17, v17
    v_exp_f32 v18, v18
    v_exp_f32 v19, v19
    s_waitcnt lgkmcnt(2)
    v_mfma_f32_32x32x16_bf16 v[56:71], v[88:91], v[72:75], v[56:71]
    ds_read_b128 v[88:91], v123 offset:25024
    v_cvt_pk_bf16_f32 v76, v16, v17
    v_cvt_pk_bf16_f32 v77, v18, v19
    v_exp_f32 v20, v20
    v_exp_f32 v21, v21
    v_exp_f32 v22, v22
    v_exp_f32 v23, v23
    v_cvt_pk_bf16_f32 v78, v20, v21
    v_cvt_pk_bf16_f32 v79, v22, v23
    s_setprio 0
    s_waitcnt lgkmcnt(2)
    v_mfma_f32_32x32x16_bf16 v[8:23], v[80:83], v[96:99], v[40:55]
    ds_read_b128 v[80:83], v120 offset:26112
    v_exp_f32 v24, v24
    v_exp_f32 v25, v25
    v_exp_f32 v26, v26
    v_exp_f32 v27, v27
    s_waitcnt lgkmcnt(2)
    v_mfma_f32_32x32x16_bf16 v[56:71], v[92:95], v[76:79], v[56:71]
    ds_read_b128 v[92:95], v123 offset:25632
    v_cvt_pk_bf16_f32 v72, v24, v25
    v_cvt_pk_bf16_f32 v73, v26, v27
    v_exp_f32 v28, v28
    v_exp_f32 v29, v29
    v_exp_f32 v30, v30
    v_exp_f32 v31, v31
    v_mfma_f32_32x32x16_bf16 v[8:23], v[84:87], v[108:111], v[8:23]
    v_cvt_pk_bf16_f32 v74, v28, v29
    v_cvt_pk_bf16_f32 v75, v30, v31
    v_exp_f32 v32, v32
    v_exp_f32 v33, v33
    v_exp_f32 v34, v34
    v_exp_f32 v35, v35
    s_waitcnt lgkmcnt(2)
    v_mfma_f32_32x32x16_bf16 v[56:71], v[88:91], v[72:75], v[56:71]
    ds_read_b128 v[88:91], v123 offset:26240
    v_cvt_pk_bf16_f32 v76, v32, v33
    v_cvt_pk_bf16_f32 v77, v34, v35
    v_exp_f32 v36, v36
    v_exp_f32 v37, v37
    v_exp_f32 v38, v38
    v_exp_f32 v39, v39
    v_cvt_pk_bf16_f32 v78, v36, v37
    v_cvt_pk_bf16_f32 v79, v38, v39
    s_waitcnt lgkmcnt(2)
    v_mfma_f32_32x32x16_bf16 v[24:39], v[80:83], v[96:99], v[40:55]
    v_exp_f32 v8, v8
    v_exp_f32 v9, v9
    v_exp_f32 v10, v10
    v_exp_f32 v11, v11
    s_waitcnt lgkmcnt(1)
    v_mfma_f32_32x32x16_bf16 v[56:71], v[92:95], v[76:79], v[56:71]
    ds_read_b128 v[92:95], v123 offset:26848
    v_cvt_pk_bf16_f32 v72, v8, v9
    v_cvt_pk_bf16_f32 v73, v10, v11
    v_exp_f32 v12, v12
    v_exp_f32 v13, v13
    v_exp_f32 v14, v14
    v_exp_f32 v15, v15
    v_mfma_f32_32x32x16_bf16 v[24:39], v[84:87], v[112:115], v[24:39]
    v_cvt_pk_bf16_f32 v74, v12, v13
    v_cvt_pk_bf16_f32 v75, v14, v15
    v_exp_f32 v16, v16
    v_exp_f32 v17, v17
    v_exp_f32 v18, v18
    v_exp_f32 v19, v19
    s_waitcnt lgkmcnt(1)
    v_mfma_f32_32x32x16_bf16 v[56:71], v[88:91], v[72:75], v[56:71]
    ds_read_b128 v[88:91], v123 offset:27456
    v_cvt_pk_bf16_f32 v76, v16, v17
    v_cvt_pk_bf16_f32 v77, v18, v19
    v_exp_f32 v20, v20
    v_exp_f32 v21, v21
    v_exp_f32 v22, v22
    v_exp_f32 v23, v23
    v_cvt_pk_bf16_f32 v78, v20, v21
    v_cvt_pk_bf16_f32 v79, v22, v23
    v_exp_f32 v24, v24
    v_exp_f32 v25, v25
    v_exp_f32 v26, v26
    v_exp_f32 v27, v27
    s_waitcnt lgkmcnt(1)
    v_mfma_f32_32x32x16_bf16 v[56:71], v[92:95], v[76:79], v[56:71]
    ds_read_b128 v[92:95], v123 offset:28064
    v_cvt_pk_bf16_f32 v72, v24, v25
    v_cvt_pk_bf16_f32 v73, v26, v27
    v_exp_f32 v28, v28
    v_exp_f32 v29, v29
    v_exp_f32 v30, v30
    v_exp_f32 v31, v31
    v_cvt_pk_bf16_f32 v74, v28, v29
    v_cvt_pk_bf16_f32 v75, v30, v31
    v_exp_f32 v32, v32
    v_exp_f32 v33, v33
    v_exp_f32 v34, v34
    v_exp_f32 v35, v35
    s_waitcnt lgkmcnt(1)
    v_mfma_f32_32x32x16_bf16 v[56:71], v[88:91], v[72:75], v[56:71]
    v_cvt_pk_bf16_f32 v76, v32, v33
    v_cvt_pk_bf16_f32 v77, v34, v35
    v_exp_f32 v36, v36
    v_exp_f32 v37, v37
    v_exp_f32 v38, v38
    v_exp_f32 v39, v39
    v_cvt_pk_bf16_f32 v78, v36, v37
    v_cvt_pk_bf16_f32 v79, v38, v39
    s_waitcnt lgkmcnt(0)
    s_nop 0
    v_mfma_f32_32x32x16_bf16 v[56:71], v[92:95], v[76:79], v[56:71]
    s_nop 11
    v_mov_b32 v5, v66
    s_nop 1
    v_permlane32_swap_b32 v66, v5
    v_rcp_f32 v5, v66
    s_nop 0
    v_mul_f32 v56, v56, v5
    v_mul_f32 v57, v57, v5
    v_mul_f32 v58, v58, v5
    v_mul_f32 v59, v59, v5
    v_mul_f32 v60, v60, v5
    v_mul_f32 v61, v61, v5
    v_mul_f32 v62, v62, v5
    v_mul_f32 v63, v63, v5
    v_mul_f32 v64, v64, v5
    v_mul_f32 v65, v65, v5
    v_cvt_pk_bf16_f32 v72, v56, v57
    v_cvt_pk_bf16_f32 v73, v58, v59
    v_cvt_pk_bf16_f32 v74, v60, v61
    v_cvt_pk_bf16_f32 v75, v62, v63
    v_cvt_pk_bf16_f32 v76, v64, v65
    buffer_store_dwordx4 v[72:75], v138, s[8:11], s42 offen sc1
    s_mov_b32 exec_hi, 0
    buffer_store_dword v76, v139, s[8:11], s43 offen sc1
    s_mov_b32 exec_hi, -1
k234_mid_kernel_aend:
    s_cmp_ge_u32 s2, 252
    s_cbranch_scc1 k234_mid_kernel_k5
    s_load_dwordx4 s[4:7], s[0:1], 32
    s_load_dwordx2 s[28:29], s[0:1], 72
    s_load_dwordx2 s[44:45], s[0:1], 0
    s_load_dwordx2 s[46:47], s[0:1], 16
    v_lshrrev_b32 v12, 6, v0
    s_nop 0
    v_readfirstlane_b32 s20, v12
    s_and_b32 s30, s2, 7
    s_lshr_b32 s31, s2, 3
    s_mul_i32 s32, s30, 31
    s_min_u32 s30, s30, 4
    s_add_u32 s32, s32, s30
    s_add_u32 s32, s32, s31
    s_mul_i32 s21, s32, 9363
    s_lshr_b32 s21, s21, 16
    s_mul_i32 s30, s21, 7
    s_sub_u32 s22, s32, s30
    s_mul_i32 s23, s22, 18
    s_min_u32 s30, s22, 2
    s_add_u32 s23, s23, s30
    s_lshl_b32 s24, s21, 8
    s_lshl_b32 s26, s20, 10
    s_lshr_b32 s59, s31, 2
    s_sub_u32 s35, s31, s59
    s_and_b32 s58, s31, 3
    s_cmp_lt_u32 s20, 4
    s_cbranch_scc1 k234_mid_kernel_lo
    s_cmp_lg_u32 s58, 3
    s_cbranch_scc1 k234_mid_kernel_hi
    v_subrev_u32 v15, 0, v0
    v_lshrrev_b32 v12, 4, v15
    v_and_b32 v13, 7, v12
    v_bfe_u32 v14, v0, 1, 3
    v_xor_b32 v13, v13, v14
    v_and_b32 v14, 1, v0
    v_lshl_add_u32 v13, v13, 1, v14
    v_mul_u32_u24 v12, 9216, v12
    v_lshl_add_u32 v1, v13, 4, v12
    v_subrev_u32 v15, 256, v0
    v_lshrrev_b32 v12, 4, v15
    v_and_b32 v13, 7, v12
    v_bfe_u32 v14, v0, 1, 3
    v_xor_b32 v13, v13, v14
    v_and_b32 v14, 1, v0
    v_lshl_add_u32 v13, v13, 1, v14
    v_mul_u32_u24 v12, 9216, v12
    v_lshl_add_u32 v10, v13, 4, v12
    s_waitcnt lgkmcnt(0)
    s_mov_b32 s12, s4
    s_mov_b32 s13, s5
    s_mov_b32 s14, 5308416
    s_mov_b32 s15, 0x00020000
    s_mov_b32 s16, s6
    s_mov_b32 s17, s7
    s_mov_b32 s18, 5308416
    s_mov_b32 s19, 0x00020000
    s_mov_b32 s8, s28
    s_mov_b32 s9, s29
    s_mov_b32 s10, 67108864
    s_mov_b32 s11, 0x00020000
    s_mov_b32 s40, s44
    s_mov_b32 s41, s45
    s_mov_b32 s42, 2359296
    s_mov_b32 s43, 0x00020000
    s_mov_b32 s36, s46
    s_mov_b32 s37, s47
    s_mov_b32 s38, 663552
    s_mov_b32 s39, 0x00020000
    s_barrier
    s_add_u32 m0, s26, 110592
    s_nop 0
    buffer_load_dwordx4 v10, s[12:15], s24 offen lds
    s_add_u32 m0, s26, 114688
    s_nop 0
    buffer_load_dwordx4 v1, s[12:15], s24 offen lds
    s_add_u32 m0, s26, 118784
    s_nop 0
    buffer_load_dwordx4 v10, s[16:19], s24 offen lds
    s_add_u32 m0, s26, 122880
    s_nop 0
    buffer_load_dwordx4 v1, s[16:19], s24 offen lds
    s_add_u32 s24, s24, 294912
    s_add_u32 m0, s26, 126976
    s_nop 0
    buffer_load_dwordx4 v10, s[12:15], s24 offen lds
    s_add_u32 m0, s26, 131072
    s_nop 0
    buffer_load_dwordx4 v1, s[12:15], s24 offen lds
    s_add_u32 m0, s26, 135168
    s_nop 0
    buffer_load_dwordx4 v10, s[16:19], s24 offen lds
    s_add_u32 m0, s26, 139264
    s_nop 0
    buffer_load_dwordx4 v1, s[16:19], s24 offen lds
    s_add_u32 s24, s24, 294912
    s_add_u32 m0, s26, 143360
    s_nop 0
    buffer_load_dwordx4 v10, s[12:15], s24 offen lds
    s_add_u32 m0, s26, 147456
    s_nop 0
    buffer_load_dwordx4 v1, s[12:15], s24 offen lds
    s_add_u32 m0, s26, 151552
    s_nop 0
    buffer_load_dwordx4 v10, s[16:19], s24 offen lds
    s_add_u32 m0, s26, 155648
    s_nop 0
    buffer_load_dwordx4 v1, s[16:19], s24 offen lds
    s_add_u32 s24, s24, 294912
    s_sub_u32 m0, s26, 4096
    s_nop 0
    buffer_load_dwordx4 v10, s[12:15], s24 offen lds
    s_add_u32 m0, s26, 0
    s_nop 0
    buffer_load_dwordx4 v1, s[12:15], s24 offen lds
    s_add_u32 m0, s26, 4096
    s_nop 0
    buffer_load_dwordx4 v10, s[16:19], s24 offen lds
    s_add_u32 m0, s26, 8192
    s_nop 0
    buffer_load_dwordx4 v1, s[16:19], s24 offen lds
    s_add_u32 s24, s24, 294912
    s_add_u32 m0, s26, 12288
    s_nop 0
    buffer_load_dwordx4 v10, s[12:15], s24 offen lds
    s_add_u32 m0, s26, 16384
    s_nop 0
    buffer_load_dwordx4 v1, s[12:15], s24 offen lds
    s_add_u32 m0, s26, 20480
    s_nop 0
    buffer_load_dwordx4 v10, s[16:19], s24 offen lds
    s_add_u32 m0, s26, 24576
    s_nop 0
    buffer_load_dwordx4 v1, s[16:19], s24 offen lds
    s_add_u32 s24, s24, 294912
    s_add_u32 m0, s26, 32768
    s_nop 0
    buffer_load_dwordx4 v10, s[12:15], s24 offen lds
    s_add_u32 m0, s26, 36864
    s_nop 0
    buffer_load_dwordx4 v1, s[12:15], s24 offen lds
    s_add_u32 m0, s26, 40960
    s_nop 0
    buffer_load_dwordx4 v10, s[16:19], s24 offen lds
    s_add_u32 m0, s26, 45056
    s_nop 0
    buffer_load_dwordx4 v1, s[16:19], s24 offen lds
    s_add_u32 s24, s24, 294912
    s_add_u32 m0, s26, 49152
    s_nop 0
    buffer_load_dwordx4 v10, s[12:15], s24 offen lds
    s_add_u32 m0, s26, 53248
    s_nop 0
    buffer_load_dwordx4 v1, s[12:15], s24 offen lds
    s_add_u32 m0, s26, 57344
    s_nop 0
    buffer_load_dwordx4 v10, s[16:19], s24 offen lds
    s_add_u32 m0, s26, 61440
    s_nop 0
    buffer_load_dwordx4 v1, s[16:19], s24 offen lds
    s_add_u32 s24, s24, 294912
    s_branch k234_mid_kernel_B
k234_mid_kernel_hi:
    v_subrev_u32 v15, 0, v0
    v_lshrrev_b32 v12, 4, v15
    v_and_b32 v13, 7, v12
    v_bfe_u32 v14, v0, 1, 3
    v_xor_b32 v13, v13, v14
    v_and_b32 v14, 1, v0
    v_lshl_add_u32 v13, v13, 1, v14
    v_mul_u32_u24 v12, 9216, v12
    v_lshl_add_u32 v1, v13, 4, v12
    v_subrev_u32 v15, 256, v0
    v_lshrrev_b32 v12, 4, v15
    v_and_b32 v13, 7, v12
    v_bfe_u32 v14, v0, 1, 3
    v_xor_b32 v13, v13, v14
    v_and_b32 v14, 1, v0
    v_lshl_add_u32 v13, v13, 1, v14
    v_mul_u32_u24 v12, 9216, v12
    v_lshl_add_u32 v10, v13, 4, v12
    s_waitcnt lgkmcnt(0)
    s_mov_b32 s12, s4
    s_mov_b32 s13, s5
    s_mov_b32 s14, 5308416
    s_mov_b32 s15, 0x00020000
    s_mov_b32 s16, s6
    s_mov_b32 s17, s7
    s_mov_b32 s18, 5308416
    s_mov_b32 s19, 0x00020000
    s_mov_b32 s8, s28
    s_mov_b32 s9, s29
    s_mov_b32 s10, 67108864
    s_mov_b32 s11, 0x00020000
    s_mov_b32 s40, s44
    s_mov_b32 s41, s45
    s_mov_b32 s42, 2359296
    s_mov_b32 s43, 0x00020000
    s_mov_b32 s36, s46
    s_mov_b32 s37, s47
    s_mov_b32 s38, 663552
    s_mov_b32 s39, 0x00020000
    s_waitcnt vmcnt(2)
    s_barrier
    s_add_u32 m0, s26, 110592
    s_nop 0
    buffer_load_dwordx4 v10, s[12:15], s24 offen lds
    s_add_u32 m0, s26, 114688
    s_nop 0
    buffer_load_dwordx4 v1, s[12:15], s24 offen lds
    s_add_u32 m0, s26, 118784
    s_nop 0
    buffer_load_dwordx4 v10, s[16:19], s24 offen lds
    s_add_u32 m0, s26, 122880
    s_nop 0
    buffer_load_dwordx4 v1, s[16:19], s24 offen lds
    s_add_u32 s24, s24, 294912
    s_add_u32 m0, s26, 126976
    s_nop 0
    buffer_load_dwordx4 v10, s[12:15], s24 offen lds
    s_add_u32 m0, s26, 131072
    s_nop 0
    buffer_load_dwordx4 v1, s[12:15], s24 offen lds
    s_add_u32 m0, s26, 135168
    s_nop 0
    buffer_load_dwordx4 v10, s[16:19], s24 offen lds
    s_add_u32 m0, s26, 139264
    s_nop 0
    buffer_load_dwordx4 v1, s[16:19], s24 offen lds
    s_add_u32 s24, s24, 294912
    s_add_u32 m0, s26, 143360
    s_nop 0
    buffer_load_dwordx4 v10, s[12:15], s24 offen lds
    s_add_u32 m0, s26, 147456
    s_nop 0
    buffer_load_dwordx4 v1, s[12:15], s24 offen lds
    s_add_u32 m0, s26, 151552
    s_nop 0
    buffer_load_dwordx4 v10, s[16:19], s24 offen lds
    s_add_u32 m0, s26, 155648
    s_nop 0
    buffer_load_dwordx4 v1, s[16:19], s24 offen lds
    s_add_u32 s24, s24, 294912
    s_barrier
    s_sub_u32 m0, s26, 4096
    s_nop 0
    buffer_load_dwordx4 v10, s[12:15], s24 offen lds
    s_add_u32 m0, s26, 0
    s_nop 0
    buffer_load_dwordx4 v1, s[12:15], s24 offen lds
    s_add_u32 m0, s26, 4096
    s_nop 0
    buffer_load_dwordx4 v10, s[16:19], s24 offen lds
    s_add_u32 m0, s26, 8192
    s_nop 0
    buffer_load_dwordx4 v1, s[16:19], s24 offen lds
    s_add_u32 s24, s24, 294912
    s_add_u32 m0, s26, 12288
    s_nop 0
    buffer_load_dwordx4 v10, s[12:15], s24 offen lds
    s_add_u32 m0, s26, 16384
    s_nop 0
    buffer_load_dwordx4 v1, s[12:15], s24 offen lds
    s_add_u32 m0, s26, 20480
    s_nop 0
    buffer_load_dwordx4 v10, s[16:19], s24 offen lds
    s_add_u32 m0, s26, 24576
    s_nop 0
    buffer_load_dwordx4 v1, s[16:19], s24 offen lds
    s_add_u32 s24, s24, 294912
    s_barrier
    s_add_u32 m0, s26, 32768
    s_nop 0
    buffer_load_dwordx4 v10, s[12:15], s24 offen lds
    s_add_u32 m0, s26, 36864
    s_nop 0
    buffer_load_dwordx4 v1, s[12:15], s24 offen lds
    s_add_u32 m0, s26, 40960
    s_nop 0
    buffer_load_dwordx4 v10, s[16:19], s24 offen lds
    s_add_u32 m0, s26, 45056
    s_nop 0
    buffer_load_dwordx4 v1, s[16:19], s24 offen lds
    s_add_u32 s24, s24, 294912
    s_add_u32 m0, s26, 49152
    s_nop 0
    buffer_load_dwordx4 v10, s[12:15], s24 offen lds
    s_add_u32 m0, s26, 53248
    s_nop 0
    buffer_load_dwordx4 v1, s[12:15], s24 offen lds
    s_add_u32 m0, s26, 57344
    s_nop 0
    buffer_load_dwordx4 v10, s[16:19], s24 offen lds
    s_add_u32 m0, s26, 61440
    s_nop 0
    buffer_load_dwordx4 v1, s[16:19], s24 offen lds
    s_add_u32 s24, s24, 294912
    s_branch k234_mid_kernel_B
k234_mid_kernel_lo:
    s_add_u32 s24, s24, 2064384
    s_cmp_eq_u32 s58, 3
    s_cbranch_scc1 k234_mid_kernel_help
    v_and_b32 v1, 63, v0
    v_and_b32 v6, 15, v0
    v_bfe_u32 v7, v0, 4, 2
    v_lshlrev_b32 v8, 4, v1
    s_and_b32 s54, s2, 7
    s_lshl_b32 s48, s54, 2
    s_and_b32 s54, s35, 3
    s_add_u32 s48, s48, s54
    s_lshr_b32 s49, s35, 2
    s_lshl_b32 s50, s48, 2
    s_add_u32 s50, s50, s20
    s_mul_i32 s51, s50, 18432
    s_add_u32 s51, s51, 8388608
    s_mul_i32 s52, s49, 192
    s_lshl_b32 s54, s50, 4
    v_add_u32 v2, s54, v6
    v_mul_u32_u24 v11, 1152, v2
    v_and_b32 v3, 1, v7
    v_lshl_add_u32 v11, v3, 5, v11
    v_lshrrev_b32 v3, 1, v7
    v_lshl_add_u32 v11, v3, 4, v11
    v_lshlrev_b32 v9, 2, v2
    v_lshlrev_b32 v10, 2, v6
    s_mov_b32 s57, 7241728
    s_waitcnt lgkmcnt(0)
    s_mov_b32 s12, s4
    s_mov_b32 s13, s5
    s_mov_b32 s14, 5308416
    s_mov_b32 s15, 0x00020000
    s_mov_b32 s16, s6
    s_mov_b32 s17, s7
    s_mov_b32 s18, 5308416
    s_mov_b32 s19, 0x00020000
    s_mov_b32 s8, s28
    s_mov_b32 s9, s29
    s_mov_b32 s10, 67108864
    s_mov_b32 s11, 0x00020000
    s_mov_b32 s40, s44
    s_mov_b32 s41, s45
    s_mov_b32 s42, 2359296
    s_mov_b32 s43, 0x00020000
    s_mov_b32 s36, s46
    s_mov_b32 s37, s47
    s_mov_b32 s38, 663552
    s_mov_b32 s39, 0x00020000
    s_add_u32 s61, s51, 16384
    v_lshlrev_b32 v196, 8, v7
    v_lshl_add_u32 v196, v6, 2, v196
    s_mov_b32 s59, 100000
    s_add_u32 s36, s51, 0
    s_add_u32 s37, s51, 2048
    s_add_u32 s38, s51, 4096
    s_add_u32 s39, s51, 6144
    s_add_u32 s40, s51, 8192
    s_add_u32 s41, s51, 10240
    s_add_u32 s42, s51, 12288
    s_add_u32 s43, s51, 14336
    s_mul_i32 s34, s48, 6
    s_add_u32 s34, s34, s49
    s_lshl_b32 s34, s34, 7
    s_add_u32 s34, s34, 8331264
    v_lshrrev_b32 v2, 2, v1
    v_mul_u32_u24 v2, 192, v2
    v_and_b32 v3, 3, v1
    v_lshl_add_u32 v2, v3, 3, v2
    v_bfe_u32 v3, v1, 4, 1
    v_lshl_add_u32 v189, v3, 5, v2
    v_xor_b32 v3, 1, v3
    v_lshl_add_u32 v190, v3, 5, v2
    v_add_u32 v191, 55296, v8
    v_add_u32 v192, 55296, v190
    v_and_b32 v3, 1, v1
    v_lshlrev_b32 v3, 4, v3
    v_lshl_add_u32 v3, v7, 5, v3
    v_add_u32 v193, 110592, v3
    s_mul_i32 s54, s50, 18432
    s_mul_i32 s55, s49, 3072
    s_add_u32 s54, s54, s55
    s_add_u32 s54, s54, 10747904
    s_lshl_b32 s56, s50, 3
    s_add_u32 s56, s56, s49
    s_lshl_b32 s56, s56, 6
    s_add_u32 s56, s56, 7258112
    s_mov_b32 s55, 7249920
    v_mov_b32 v4, 0
    v_mov_b32 v5, 0
    s_waitcnt vmcnt(2)
    s_barrier
    ds_read_b128 v[88:91], v193 offset:0
    ds_read_b128 v[92:95], v8 offset:0
    ds_read_b128 v[96:99], v8 offset:1024
    ds_read_b128 v[100:103], v8 offset:2048
    ds_read_b128 v[104:107], v8 offset:3072
    ds_read_b128 v[108:111], v8 offset:4096
    ds_read_b128 v[112:115], v8 offset:5120
    ds_read_b128 v[116:119], v193 offset:128
    ds_read_b128 v[120:123], v8 offset:6144
    ds_read_b128 v[124:127], v8 offset:7168
    ds_read_b128 v[128:131], v8 offset:8192
    ds_read_b128 v[132:135], v8 offset:9216
    ds_read_b128 v[136:139], v8 offset:10240
    ds_read_b128 v[140:143], v8 offset:11264
    s_sleep 16
    s_mov_b32 s53, 0
    s_mov_b32 s63, 255
k234_mid_kernel_ol:
    buffer_load_dword v80, v196, s[8:11], s61 offen offset:0 sc1
    buffer_load_dword v81, v196, s[8:11], s61 offen offset:64 sc1
    buffer_load_dword v82, v196, s[8:11], s61 offen offset:128 sc1
    buffer_load_dword v83, v196, s[8:11], s61 offen offset:192 sc1
    buffer_load_dword v84, v196, s[8:11], s61 offen offset:1024 sc1
    buffer_load_dword v85, v196, s[8:11], s61 offen offset:1088 sc1
    buffer_load_dword v86, v196, s[8:11], s61 offen offset:1152 sc1
    buffer_load_dword v87, v196, s[8:11], s61 offen offset:1216 sc1
    s_bitcmp0_b32 s63, 0
    s_cbranch_scc1 k234_mid_kernel_os0
    buffer_load_dwordx4 v[16:19], v8, s[8:11], s36 offen offset:0 sc1
    buffer_load_dwordx4 v[20:23], v8, s[8:11], s36 offen offset:1024 sc1
k234_mid_kernel_os0:
    s_bitcmp0_b32 s63, 1
    s_cbranch_scc1 k234_mid_kernel_os1
    buffer_load_dwordx4 v[24:27], v8, s[8:11], s37 offen offset:0 sc1
    buffer_load_dwordx4 v[28:31], v8, s[8:11], s37 offen offset:1024 sc1
k234_mid_kernel_os1:
    s_bitcmp0_b32 s63, 2
    s_cbranch_scc1 k234_mid_kernel_os2
    buffer_load_dwordx4 v[32:35], v8, s[8:11], s38 offen offset:0 sc1
    buffer_load_dwordx4 v[36:39], v8, s[8:11], s38 offen offset:1024 sc1
k234_mid_kernel_os2:
    s_bitcmp0_b32 s63, 3
    s_cbranch_scc1 k234_mid_kernel_os3
    buffer_load_dwordx4 v[40:43], v8, s[8:11], s39 offen offset:0 sc1
    buffer_load_dwordx4 v[44:47], v8, s[8:11], s39 offen offset:1024 sc1
k234_mid_kernel_os3:
    s_bitcmp0_b32 s63, 4
    s_cbranch_scc1 k234_mid_kernel_os4
    buffer_load_dwordx4 v[48:51], v8, s[8:11], s40 offen offset:0 sc1
    buffer_load_dwordx4 v[52:55], v8, s[8:11], s40 offen offset:1024 sc1
k234_mid_kernel_os4:
    s_bitcmp0_b32 s63, 5
    s_cbranch_scc1 k234_mid_kernel_os5
    buffer_load_dwordx4 v[56:59], v8, s[8:11], s41 offen offset:0 sc1
    buffer_load_dwordx4 v[60:63], v8, s[8:11], s41 offen offset:1024 sc1
k234_mid_kernel_os5:
    s_bitcmp0_b32 s63, 6
    s_cbranch_scc1 k234_mid_kernel_os6
    buffer_load_dwordx4 v[64:67], v8, s[8:11], s42 offen offset:0 sc1
    buffer_load_dwordx4 v[68:71], v8, s[8:11], s42 offen offset:1024 sc1
k234_mid_kernel_os6:
    s_bitcmp0_b32 s63, 7
    s_cbranch_scc1 k234_mid_kernel_os7
    buffer_load_dwordx4 v[72:75], v8, s[8:11], s43 offen offset:0 sc1
    buffer_load_dwordx4 v[76:79], v8, s[8:11], s43 offen offset:1024 sc1
k234_mid_kernel_os7:
    s_cmp_lg_u32 s59, 100000
    s_cbranch_scc1 k234_mid_kernel_ox
    v_permlane16_swap_b32 v176, v178
    v_permlane16_swap_b32 v177, v179
    v_permlane16_swap_b32 v180, v182
    v_permlane16_swap_b32 v181, v183
    v_permlane16_swap_b32 v184, v186
    v_permlane16_swap_b32 v185, v187
    v_lshlrev_b32 v148, 16, v176
    v_and_b32 v149, 0xffff0000, v176
    v_lshlrev_b32 v150, 16, v177
    v_and_b32 v151, 0xffff0000, v177
    v_lshlrev_b32 v152, 16, v178
    v_and_b32 v153, 0xffff0000, v178
    v_lshlrev_b32 v154, 16, v179
    v_and_b32 v155, 0xffff0000, v179
    v_lshlrev_b32 v156, 16, v180
    v_and_b32 v157, 0xffff0000, v180
    v_lshlrev_b32 v158, 16, v181
    v_and_b32 v159, 0xffff0000, v181
    v_lshlrev_b32 v160, 16, v182
    v_and_b32 v161, 0xffff0000, v182
    v_lshlrev_b32 v162, 16, v183
    v_and_b32 v163, 0xffff0000, v183
    v_lshlrev_b32 v164, 16, v184
    v_and_b32 v165, 0xffff0000, v184
    v_lshlrev_b32 v166, 16, v185
    v_and_b32 v167, 0xffff0000, v185
    v_lshlrev_b32 v168, 16, v186
    v_and_b32 v169, 0xffff0000, v186
    v_lshlrev_b32 v170, 16, v187
    v_and_b32 v171, 0xffff0000, v187
k234_mid_kernel_ox:
    s_sub_u32 s59, s59, 1
    s_waitcnt vmcnt(0)
k234_mid_kernel_onw:
    v_max3_u32 v198, v16, v17, v18
    v_max3_u32 v199, v19, v20, v21
    v_max3_u32 v198, v22, v23, v198
    v_max3_u32 v199, v24, v25, v199
    v_max3_u32 v198, v26, v27, v198
    v_max3_u32 v199, v28, v29, v199
    v_max3_u32 v198, v30, v31, v198
    v_max3_u32 v199, v32, v33, v199
    v_max3_u32 v198, v34, v35, v198
    v_max3_u32 v199, v36, v37, v199
    v_max3_u32 v198, v38, v39, v198
    v_max3_u32 v199, v40, v41, v199
    v_max3_u32 v198, v42, v43, v198
    v_max3_u32 v199, v44, v45, v199
    v_max3_u32 v198, v46, v47, v198
    v_max3_u32 v199, v48, v49, v199
    v_max3_u32 v198, v50, v51, v198
    v_max3_u32 v199, v52, v53, v199
    v_max3_u32 v198, v54, v55, v198
    v_max3_u32 v199, v56, v57, v199
    v_max3_u32 v198, v58, v59, v198
    v_max3_u32 v199, v60, v61, v199
    v_max3_u32 v198, v62, v63, v198
    v_max3_u32 v199, v64, v65, v199
    v_max3_u32 v198, v66, v67, v198
    v_max3_u32 v199, v68, v69, v199
    v_max3_u32 v198, v70, v71, v198
    v_max3_u32 v199, v72, v73, v199
    v_max3_u32 v198, v74, v75, v198
    v_max3_u32 v199, v76, v77, v199
    v_max3_u32 v198, v78, v79, v198
    v_max3_u32 v199, v80, v81, v199
    v_max3_u32 v198, v82, v83, v198
    v_max3_u32 v199, v84, v85, v199
    v_max3_u32 v198, v86, v87, v198
    v_max_u32 v198, v198, v199
    v_cmp_eq_u32 vcc, -1, v198
    s_or_b32 s30, s53, s63
    s_cmp_lg_u32 s30, 0xff
    s_cbranch_scc1 k234_mid_kernel_oslow
    s_cbranch_vccnz k234_mid_kernel_oslow
k234_mid_kernel_ogo:
    ds_read_b128 v[144:147], v193 offset:256
    s_waitcnt lgkmcnt(14)
    v_mfma_f32_16x16x32_bf16 v[172:175], v[88:91], v[16:19], 0
    ds_read_b128 v[88:91], v8 offset:12288
    s_waitcnt lgkmcnt(14)
    v_mfma_f32_16x16x32_bf16 v[148:151], v[92:95], v[16:19], v[148:151]
    ds_read_b128 v[92:95], v8 offset:13312
    s_waitcnt lgkmcnt(14)
    v_mfma_f32_16x16x32_bf16 v[152:155], v[96:99], v[16:19], v[152:155]
    ds_read_b128 v[96:99], v8 offset:14336
    s_waitcnt lgkmcnt(14)
    v_mfma_f32_16x16x32_bf16 v[156:159], v[100:103], v[16:19], v[156:159]
    ds_read_b128 v[100:103], v8 offset:15360
    s_waitcnt lgkmcnt(14)
    v_mfma_f32_16x16x32_bf16 v[160:163], v[104:107], v[16:19], v[160:163]
    ds_read_b128 v[104:107], v8 offset:16384
    s_waitcnt lgkmcnt(14)
    v_mfma_f32_16x16x32_bf16 v[164:167], v[108:111], v[16:19], v[164:167]
    ds_read_b128 v[108:111], v8 offset:17408
    s_waitcnt lgkmcnt(14)
    v_mfma_f32_16x16x32_bf16 v[168:171], v[112:115], v[16:19], v[168:171]
    ds_read_b128 v[112:115], v193 offset:384
    s_waitcnt lgkmcnt(14)
    v_mfma_f32_16x16x32_bf16 v[172:175], v[116:119], v[20:23], v[172:175]
    ds_read_b128 v[116:119], v8 offset:18432
    s_waitcnt lgkmcnt(14)
    v_mfma_f32_16x16x32_bf16 v[148:151], v[120:123], v[20:23], v[148:151]
    ds_read_b128 v[120:123], v8 offset:19456
    s_waitcnt lgkmcnt(14)
    v_mfma_f32_16x16x32_bf16 v[152:155], v[124:127], v[20:23], v[152:155]
    ds_read_b128 v[124:127], v8 offset:20480
    s_waitcnt lgkmcnt(14)
    v_mfma_f32_16x16x32_bf16 v[156:159], v[128:131], v[20:23], v[156:159]
    ds_read_b128 v[128:131], v8 offset:21504
    s_waitcnt lgkmcnt(14)
    v_mfma_f32_16x16x32_bf16 v[160:163], v[132:135], v[20:23], v[160:163]
    ds_read_b128 v[132:135], v8 offset:22528
    s_waitcnt lgkmcnt(14)
    v_mfma_f32_16x16x32_bf16 v[164:167], v[136:139], v[20:23], v[164:167]
    ds_read_b128 v[136:139], v8 offset:23552
    s_waitcnt lgkmcnt(14)
    v_mfma_f32_16x16x32_bf16 v[168:171], v[140:143], v[20:23], v[168:171]
    ds_read_b128 v[140:143], v193 offset:512
    s_waitcnt lgkmcnt(14)
    v_mfma_f32_16x16x32_bf16 v[172:175], v[144:147], v[24:27], v[172:175]
    ds_read_b128 v[144:147], v8 offset:24576
    s_waitcnt lgkmcnt(14)
    v_mfma_f32_16x16x32_bf16 v[148:151], v[88:91], v[24:27], v[148:151]
    ds_read_b128 v[88:91], v8 offset:25600
    s_waitcnt lgkmcnt(14)
    v_mfma_f32_16x16x32_bf16 v[152:155], v[92:95], v[24:27], v[152:155]
    ds_read_b128 v[92:95], v8 offset:26624
    s_waitcnt lgkmcnt(14)
    v_mfma_f32_16x16x32_bf16 v[156:159], v[96:99], v[24:27], v[156:159]
    ds_read_b128 v[96:99], v8 offset:27648
    s_waitcnt lgkmcnt(14)
    v_mfma_f32_16x16x32_bf16 v[160:163], v[100:103], v[24:27], v[160:163]
    ds_read_b128 v[100:103], v8 offset:28672
    s_waitcnt lgkmcnt(14)
    v_mfma_f32_16x16x32_bf16 v[164:167], v[104:107], v[24:27], v[164:167]
    ds_read_b128 v[104:107], v8 offset:29696
    s_waitcnt lgkmcnt(14)
    v_mfma_f32_16x16x32_bf16 v[168:171], v[108:111], v[24:27], v[168:171]
    ds_read_b128 v[108:111], v193 offset:640
    s_waitcnt lgkmcnt(14)
    v_mfma_f32_16x16x32_bf16 v[172:175], v[112:115], v[28:31], v[172:175]
    ds_read_b128 v[112:115], v8 offset:30720
    s_waitcnt lgkmcnt(14)
    v_mfma_f32_16x16x32_bf16 v[148:151], v[116:119], v[28:31], v[148:151]
    ds_read_b128 v[116:119], v8 offset:31744
    s_waitcnt lgkmcnt(14)
    v_mfma_f32_16x16x32_bf16 v[152:155], v[120:123], v[28:31], v[152:155]
    ds_read_b128 v[120:123], v8 offset:32768
    s_waitcnt lgkmcnt(14)
    v_mfma_f32_16x16x32_bf16 v[156:159], v[124:127], v[28:31], v[156:159]
    ds_read_b128 v[124:127], v8 offset:33792
    s_waitcnt lgkmcnt(14)
    v_mfma_f32_16x16x32_bf16 v[160:163], v[128:131], v[28:31], v[160:163]
    ds_read_b128 v[128:131], v8 offset:34816
    s_waitcnt lgkmcnt(14)
    v_mfma_f32_16x16x32_bf16 v[164:167], v[132:135], v[28:31], v[164:167]
    ds_read_b128 v[132:135], v8 offset:35840
    s_waitcnt lgkmcnt(14)
    v_mfma_f32_16x16x32_bf16 v[168:171], v[136:139], v[28:31], v[168:171]
    ds_read_b128 v[136:139], v193 offset:768
    s_waitcnt lgkmcnt(14)
    v_mfma_f32_16x16x32_bf16 v[172:175], v[140:143], v[32:35], v[172:175]
    ds_read_b128 v[140:143], v8 offset:36864
    s_waitcnt lgkmcnt(14)
    v_mfma_f32_16x16x32_bf16 v[148:151], v[144:147], v[32:35], v[148:151]
    ds_read_b128 v[144:147], v8 offset:37888
    s_waitcnt lgkmcnt(14)
    v_mfma_f32_16x16x32_bf16 v[152:155], v[88:91], v[32:35], v[152:155]
    ds_read_b128 v[88:91], v8 offset:38912
    s_waitcnt lgkmcnt(14)
    v_mfma_f32_16x16x32_bf16 v[156:159], v[92:95], v[32:35], v[156:159]
    ds_read_b128 v[92:95], v8 offset:39936
    s_waitcnt lgkmcnt(14)
    v_mfma_f32_16x16x32_bf16 v[160:163], v[96:99], v[32:35], v[160:163]
    ds_read_b128 v[96:99], v8 offset:40960
    s_waitcnt lgkmcnt(14)
    v_mfma_f32_16x16x32_bf16 v[164:167], v[100:103], v[32:35], v[164:167]
    ds_read_b128 v[100:103], v8 offset:41984
    s_waitcnt lgkmcnt(14)
    v_mfma_f32_16x16x32_bf16 v[168:171], v[104:107], v[32:35], v[168:171]
    ds_read_b128 v[104:107], v193 offset:896
    s_waitcnt lgkmcnt(14)
    v_mfma_f32_16x16x32_bf16 v[172:175], v[108:111], v[36:39], v[172:175]
    ds_read_b128 v[108:111], v8 offset:43008
    s_waitcnt lgkmcnt(14)
    v_mfma_f32_16x16x32_bf16 v[148:151], v[112:115], v[36:39], v[148:151]
    ds_read_b128 v[112:115], v8 offset:44032
    s_waitcnt lgkmcnt(14)
    v_mfma_f32_16x16x32_bf16 v[152:155], v[116:119], v[36:39], v[152:155]
    ds_read_b128 v[116:119], v8 offset:45056
    s_waitcnt lgkmcnt(14)
    v_mfma_f32_16x16x32_bf16 v[156:159], v[120:123], v[36:39], v[156:159]
    ds_read_b128 v[120:123], v8 offset:46080
    s_waitcnt lgkmcnt(14)
    v_mfma_f32_16x16x32_bf16 v[160:163], v[124:127], v[36:39], v[160:163]
    ds_read_b128 v[124:127], v8 offset:47104
    s_waitcnt lgkmcnt(14)
    v_mfma_f32_16x16x32_bf16 v[164:167], v[128:131], v[36:39], v[164:167]
    ds_read_b128 v[128:131], v8 offset:48128
    s_waitcnt lgkmcnt(14)
    v_mfma_f32_16x16x32_bf16 v[168:171], v[132:135], v[36:39], v[168:171]
    s_barrier
    ds_read_b128 v[132:135], v193 offset:1024
    s_waitcnt lgkmcnt(14)
    v_mfma_f32_16x16x32_bf16 v[172:175], v[136:139], v[40:43], v[172:175]
    ds_read_b128 v[136:139], v8 offset:49152
    s_waitcnt lgkmcnt(14)
    v_mfma_f32_16x16x32_bf16 v[148:151], v[140:143], v[40:43], v[148:151]
    ds_read_b128 v[140:143], v8 offset:50176
    s_waitcnt lgkmcnt(14)
    v_mfma_f32_16x16x32_bf16 v[152:155], v[144:147], v[40:43], v[152:155]
    ds_read_b128 v[144:147], v8 offset:51200
    s_waitcnt lgkmcnt(14)
    v_mfma_f32_16x16x32_bf16 v[156:159], v[88:91], v[40:43], v[156:159]
    ds_read_b128 v[88:91], v8 offset:52224
    s_waitcnt lgkmcnt(14)
    v_mfma_f32_16x16x32_bf16 v[160:163], v[92:95], v[40:43], v[160:163]
    ds_read_b128 v[92:95], v8 offset:53248
    s_waitcnt lgkmcnt(14)
    v_mfma_f32_16x16x32_bf16 v[164:167], v[96:99], v[40:43], v[164:167]
    ds_read_b128 v[96:99], v8 offset:54272
    s_waitcnt lgkmcnt(14)
    v_mfma_f32_16x16x32_bf16 v[168:171], v[100:103], v[40:43], v[168:171]
    ds_read_b128 v[100:103], v193 offset:1152
    s_waitcnt lgkmcnt(14)
    v_mfma_f32_16x16x32_bf16 v[172:175], v[104:107], v[44:47], v[172:175]
    ds_read_b128 v[104:107], v191 offset:0
    s_waitcnt lgkmcnt(14)
    v_mfma_f32_16x16x32_bf16 v[148:151], v[108:111], v[44:47], v[148:151]
    ds_read_b128 v[108:111], v191 offset:1024
    s_waitcnt lgkmcnt(14)
    v_mfma_f32_16x16x32_bf16 v[152:155], v[112:115], v[44:47], v[152:155]
    ds_read_b128 v[112:115], v191 offset:2048
    s_waitcnt lgkmcnt(14)
    v_mfma_f32_16x16x32_bf16 v[156:159], v[116:119], v[44:47], v[156:159]
    ds_read_b128 v[116:119], v191 offset:3072
    s_waitcnt lgkmcnt(14)
    v_mfma_f32_16x16x32_bf16 v[160:163], v[120:123], v[44:47], v[160:163]
    ds_read_b128 v[120:123], v191 offset:4096
    s_waitcnt lgkmcnt(14)
    v_mfma_f32_16x16x32_bf16 v[164:167], v[124:127], v[44:47], v[164:167]
    ds_read_b128 v[124:127], v191 offset:5120
    s_waitcnt lgkmcnt(14)
    v_mfma_f32_16x16x32_bf16 v[168:171], v[128:131], v[44:47], v[168:171]
    ds_read_b128 v[128:131], v193 offset:1280
    s_waitcnt lgkmcnt(14)
    v_mfma_f32_16x16x32_bf16 v[172:175], v[132:135], v[48:51], v[172:175]
    ds_read_b128 v[132:135], v191 offset:6144
    s_waitcnt lgkmcnt(14)
    v_mfma_f32_16x16x32_bf16 v[148:151], v[136:139], v[48:51], v[148:151]
    ds_read_b128 v[136:139], v191 offset:7168
    s_waitcnt lgkmcnt(14)
    v_mfma_f32_16x16x32_bf16 v[152:155], v[140:143], v[48:51], v[152:155]
    ds_read_b128 v[140:143], v191 offset:8192
    s_waitcnt lgkmcnt(14)
    v_mfma_f32_16x16x32_bf16 v[156:159], v[144:147], v[48:51], v[156:159]
    ds_read_b128 v[144:147], v191 offset:9216
    s_waitcnt lgkmcnt(14)
    v_mfma_f32_16x16x32_bf16 v[160:163], v[88:91], v[48:51], v[160:163]
    ds_read_b128 v[88:91], v191 offset:10240
    s_waitcnt lgkmcnt(14)
    v_mfma_f32_16x16x32_bf16 v[164:167], v[92:95], v[48:51], v[164:167]
    ds_read_b128 v[92:95], v191 offset:11264
    s_waitcnt lgkmcnt(14)
    v_mfma_f32_16x16x32_bf16 v[168:171], v[96:99], v[48:51], v[168:171]
    ds_read_b128 v[96:99], v193 offset:1408
    s_waitcnt lgkmcnt(14)
    v_mfma_f32_16x16x32_bf16 v[172:175], v[100:103], v[52:55], v[172:175]
    ds_read_b128 v[100:103], v191 offset:12288
    s_waitcnt lgkmcnt(14)
    v_mfma_f32_16x16x32_bf16 v[148:151], v[104:107], v[52:55], v[148:151]
    ds_read_b128 v[104:107], v191 offset:13312
    s_waitcnt lgkmcnt(14)
    v_mfma_f32_16x16x32_bf16 v[152:155], v[108:111], v[52:55], v[152:155]
    ds_read_b128 v[108:111], v191 offset:14336
    s_waitcnt lgkmcnt(14)
    v_mfma_f32_16x16x32_bf16 v[156:159], v[112:115], v[52:55], v[156:159]
    ds_read_b128 v[112:115], v191 offset:15360
    s_waitcnt lgkmcnt(14)
    v_mfma_f32_16x16x32_bf16 v[160:163], v[116:119], v[52:55], v[160:163]
    ds_read_b128 v[116:119], v191 offset:16384
    s_waitcnt lgkmcnt(14)
    v_mfma_f32_16x16x32_bf16 v[164:167], v[120:123], v[52:55], v[164:167]
    ds_read_b128 v[120:123], v191 offset:17408
    s_waitcnt lgkmcnt(14)
    v_mfma_f32_16x16x32_bf16 v[168:171], v[124:127], v[52:55], v[168:171]
    ds_read_b128 v[124:127], v193 offset:1536
    s_waitcnt lgkmcnt(14)
    v_mfma_f32_16x16x32_bf16 v[172:175], v[128:131], v[56:59], v[172:175]
    ds_read_b128 v[128:131], v191 offset:18432
    s_waitcnt lgkmcnt(14)
    v_mfma_f32_16x16x32_bf16 v[148:151], v[132:135], v[56:59], v[148:151]
    ds_read_b128 v[132:135], v191 offset:19456
    s_waitcnt lgkmcnt(14)
    v_mfma_f32_16x16x32_bf16 v[152:155], v[136:139], v[56:59], v[152:155]
    ds_read_b128 v[136:139], v191 offset:20480
    s_waitcnt lgkmcnt(14)
    v_mfma_f32_16x16x32_bf16 v[156:159], v[140:143], v[56:59], v[156:159]
    ds_read_b128 v[140:143], v191 offset:21504
    s_waitcnt lgkmcnt(14)
    v_mfma_f32_16x16x32_bf16 v[160:163], v[144:147], v[56:59], v[160:163]
    ds_read_b128 v[144:147], v191 offset:22528
    s_waitcnt lgkmcnt(14)
    v_mfma_f32_16x16x32_bf16 v[164:167], v[88:91], v[56:59], v[164:167]
    ds_read_b128 v[88:91], v191 offset:23552
    s_waitcnt lgkmcnt(14)
    v_mfma_f32_16x16x32_bf16 v[168:171], v[92:95], v[56:59], v[168:171]
    ds_read_b128 v[92:95], v193 offset:1664
    s_waitcnt lgkmcnt(14)
    v_mfma_f32_16x16x32_bf16 v[172:175], v[96:99], v[60:63], v[172:175]
    ds_read_b128 v[96:99], v191 offset:24576
    s_waitcnt lgkmcnt(14)
    v_mfma_f32_16x16x32_bf16 v[148:151], v[100:103], v[60:63], v[148:151]
    ds_read_b128 v[100:103], v191 offset:25600
    s_waitcnt lgkmcnt(14)
    v_mfma_f32_16x16x32_bf16 v[152:155], v[104:107], v[60:63], v[152:155]
    ds_read_b128 v[104:107], v191 offset:26624
    s_waitcnt lgkmcnt(14)
    v_mfma_f32_16x16x32_bf16 v[156:159], v[108:111], v[60:63], v[156:159]
    ds_read_b128 v[108:111], v191 offset:27648
    s_waitcnt lgkmcnt(14)
    v_mfma_f32_16x16x32_bf16 v[160:163], v[112:115], v[60:63], v[160:163]
    ds_read_b128 v[112:115], v191 offset:28672
    s_waitcnt lgkmcnt(14)
    v_mfma_f32_16x16x32_bf16 v[164:167], v[116:119], v[60:63], v[164:167]
    ds_read_b128 v[116:119], v191 offset:29696
    s_waitcnt lgkmcnt(14)
    v_mfma_f32_16x16x32_bf16 v[168:171], v[120:123], v[60:63], v[168:171]
    s_barrier
    ds_read_b128 v[120:123], v193 offset:1792
    s_waitcnt lgkmcnt(14)
    v_mfma_f32_16x16x32_bf16 v[172:175], v[124:127], v[64:67], v[172:175]
    ds_read_b128 v[124:127], v191 offset:30720
    s_waitcnt lgkmcnt(14)
    v_mfma_f32_16x16x32_bf16 v[148:151], v[128:131], v[64:67], v[148:151]
    ds_read_b128 v[128:131], v191 offset:31744
    s_waitcnt lgkmcnt(14)
    v_mfma_f32_16x16x32_bf16 v[152:155], v[132:135], v[64:67], v[152:155]
    ds_read_b128 v[132:135], v191 offset:32768
    s_waitcnt lgkmcnt(14)
    v_mfma_f32_16x16x32_bf16 v[156:159], v[136:139], v[64:67], v[156:159]
    ds_read_b128 v[136:139], v191 offset:33792
    s_waitcnt lgkmcnt(14)
    v_mfma_f32_16x16x32_bf16 v[160:163], v[140:143], v[64:67], v[160:163]
    ds_read_b128 v[140:143], v191 offset:34816
    s_waitcnt lgkmcnt(14)
    v_mfma_f32_16x16x32_bf16 v[164:167], v[144:147], v[64:67], v[164:167]
    ds_read_b128 v[144:147], v191 offset:35840
    s_waitcnt lgkmcnt(14)
    v_mfma_f32_16x16x32_bf16 v[168:171], v[88:91], v[64:67], v[168:171]
    ds_read_b128 v[88:91], v193 offset:1920
    s_waitcnt lgkmcnt(14)
    v_mfma_f32_16x16x32_bf16 v[172:175], v[92:95], v[68:71], v[172:175]
    ds_read_b128 v[92:95], v191 offset:36864
    s_waitcnt lgkmcnt(14)
    v_mfma_f32_16x16x32_bf16 v[148:151], v[96:99], v[68:71], v[148:151]
    ds_read_b128 v[96:99], v191 offset:37888
    s_waitcnt lgkmcnt(14)
    v_mfma_f32_16x16x32_bf16 v[152:155], v[100:103], v[68:71], v[152:155]
    ds_read_b128 v[100:103], v191 offset:38912
    s_waitcnt lgkmcnt(14)
    v_mfma_f32_16x16x32_bf16 v[156:159], v[104:107], v[68:71], v[156:159]
    ds_read_b128 v[104:107], v191 offset:39936
    s_waitcnt lgkmcnt(14)
    v_mfma_f32_16x16x32_bf16 v[160:163], v[108:111], v[68:71], v[160:163]
    ds_read_b128 v[108:111], v191 offset:40960
    s_waitcnt lgkmcnt(14)
    v_mfma_f32_16x16x32_bf16 v[164:167], v[112:115], v[68:71], v[164:167]
    ds_read_b128 v[112:115], v191 offset:41984
    s_waitcnt lgkmcnt(14)
    v_mfma_f32_16x16x32_bf16 v[168:171], v[116:119], v[68:71], v[168:171]
    ds_read_b128 v[116:119], v193 offset:2048
    s_waitcnt lgkmcnt(14)
    v_mfma_f32_16x16x32_bf16 v[172:175], v[120:123], v[72:75], v[172:175]
    ds_read_b128 v[120:123], v191 offset:43008
    s_waitcnt lgkmcnt(14)
    v_mfma_f32_16x16x32_bf16 v[148:151], v[124:127], v[72:75], v[148:151]
    ds_read_b128 v[124:127], v191 offset:44032
    s_waitcnt lgkmcnt(14)
    v_mfma_f32_16x16x32_bf16 v[152:155], v[128:131], v[72:75], v[152:155]
    ds_read_b128 v[128:131], v191 offset:45056
    s_waitcnt lgkmcnt(14)
    v_mfma_f32_16x16x32_bf16 v[156:159], v[132:135], v[72:75], v[156:159]
    ds_read_b128 v[132:135], v191 offset:46080
    s_waitcnt lgkmcnt(14)
    v_mfma_f32_16x16x32_bf16 v[160:163], v[136:139], v[72:75], v[160:163]
    ds_read_b128 v[136:139], v191 offset:47104
    s_waitcnt lgkmcnt(14)
    v_mfma_f32_16x16x32_bf16 v[164:167], v[140:143], v[72:75], v[164:167]
    ds_read_b128 v[140:143], v191 offset:48128
    s_waitcnt lgkmcnt(14)
    v_mfma_f32_16x16x32_bf16 v[168:171], v[144:147], v[72:75], v[168:171]
    ds_read_b128 v[144:147], v193 offset:2176
    s_waitcnt lgkmcnt(14)
    v_mfma_f32_16x16x32_bf16 v[172:175], v[88:91], v[76:79], v[172:175]
    ds_read_b128 v[88:91], v191 offset:49152
    s_waitcnt lgkmcnt(14)
    v_mfma_f32_16x16x32_bf16 v[148:151], v[92:95], v[76:79], v[148:151]
    ds_read_b128 v[92:95], v191 offset:50176
    s_waitcnt lgkmcnt(14)
    v_mfma_f32_16x16x32_bf16 v[152:155], v[96:99], v[76:79], v[152:155]
    ds_read_b128 v[96:99], v191 offset:51200
    s_waitcnt lgkmcnt(14)
    v_mfma_f32_16x16x32_bf16 v[156:159], v[100:103], v[76:79], v[156:159]
    ds_read_b128 v[100:103], v191 offset:52224
    s_waitcnt lgkmcnt(14)
    v_mfma_f32_16x16x32_bf16 v[160:163], v[104:107], v[76:79], v[160:163]
    ds_read_b128 v[104:107], v191 offset:53248
    s_waitcnt lgkmcnt(14)
    v_mfma_f32_16x16x32_bf16 v[164:167], v[108:111], v[76:79], v[164:167]
    ds_read_b128 v[108:111], v191 offset:54272
    s_waitcnt lgkmcnt(14)
    v_mfma_f32_16x16x32_bf16 v[168:171], v[112:115], v[76:79], v[168:171]
    s_waitcnt lgkmcnt(13)
    v_mfma_f32_16x16x32_bf16 v[172:175], v[116:119], v[80:83], v[172:175]
    s_waitcnt lgkmcnt(12)
    v_mfma_f32_16x16x32_bf16 v[148:151], v[120:123], v[80:83], v[148:151]
    s_waitcnt lgkmcnt(11)
    v_mfma_f32_16x16x32_bf16 v[152:155], v[124:127], v[80:83], v[152:155]
    s_waitcnt lgkmcnt(10)
    v_mfma_f32_16x16x32_bf16 v[156:159], v[128:131], v[80:83], v[156:159]
    s_waitcnt lgkmcnt(9)
    v_mfma_f32_16x16x32_bf16 v[160:163], v[132:135], v[80:83], v[160:163]
    s_waitcnt lgkmcnt(8)
    v_mfma_f32_16x16x32_bf16 v[164:167], v[136:139], v[80:83], v[164:167]
    s_waitcnt lgkmcnt(7)
    v_mfma_f32_16x16x32_bf16 v[168:171], v[140:143], v[80:83], v[168:171]
    s_waitcnt lgkmcnt(6)
    v_mfma_f32_16x16x32_bf16 v[172:175], v[144:147], v[84:87], v[172:175]
    s_waitcnt lgkmcnt(5)
    v_mfma_f32_16x16x32_bf16 v[148:151], v[88:91], v[84:87], v[148:151]
    s_waitcnt lgkmcnt(4)
    v_mfma_f32_16x16x32_bf16 v[152:155], v[92:95], v[84:87], v[152:155]
    s_waitcnt lgkmcnt(3)
    v_mfma_f32_16x16x32_bf16 v[156:159], v[96:99], v[84:87], v[156:159]
    s_waitcnt lgkmcnt(2)
    v_mfma_f32_16x16x32_bf16 v[160:163], v[100:103], v[84:87], v[160:163]
    s_waitcnt lgkmcnt(1)
    v_mfma_f32_16x16x32_bf16 v[164:167], v[104:107], v[84:87], v[164:167]
    s_waitcnt lgkmcnt(0)
    v_mfma_f32_16x16x32_bf16 v[168:171], v[108:111], v[84:87], v[168:171]
    v_add_f32 v2, v172, v173
    v_mov_b32 v3, 0x3ae38e39
    v_fma_f32 v188, v2, v3, v188
    v_sub_f32 v194, 0, v188
    v_sub_f32 v195, 0, v188
    v_pk_add_f32 v[148:149], v[148:149], v[194:195]
    v_pk_add_f32 v[150:151], v[150:151], v[194:195]
    v_cvt_pk_bf16_f32 v88, v148, v149
    v_cvt_pk_bf16_f32 v89, v150, v151
    v_pk_add_f32 v[152:153], v[152:153], v[194:195]
    v_pk_add_f32 v[154:155], v[154:155], v[194:195]
    v_cvt_pk_bf16_f32 v90, v152, v153
    v_cvt_pk_bf16_f32 v91, v154, v155
    buffer_store_dwordx4 v[88:91], v8, s[8:11], s54 offen offset:0 sc1
    v_pk_add_f32 v[156:157], v[156:157], v[194:195]
    v_pk_add_f32 v[158:159], v[158:159], v[194:195]
    v_cvt_pk_bf16_f32 v92, v156, v157
    v_cvt_pk_bf16_f32 v93, v158, v159
    v_pk_add_f32 v[160:161], v[160:161], v[194:195]
    v_pk_add_f32 v[162:163], v[162:163], v[194:195]
    v_cvt_pk_bf16_f32 v94, v160, v161
    v_cvt_pk_bf16_f32 v95, v162, v163
    buffer_store_dwordx4 v[92:95], v8, s[8:11], s54 offen offset:1024 sc1
    v_pk_add_f32 v[164:165], v[164:165], v[194:195]
    v_pk_add_f32 v[166:167], v[166:167], v[194:195]
    v_cvt_pk_bf16_f32 v96, v164, v165
    v_cvt_pk_bf16_f32 v97, v166, v167
    v_pk_add_f32 v[168:169], v[168:169], v[194:195]
    v_pk_add_f32 v[170:171], v[170:171], v[194:195]
    v_cvt_pk_bf16_f32 v98, v168, v169
    v_cvt_pk_bf16_f32 v99, v170, v171
    buffer_store_dwordx4 v[96:99], v8, s[8:11], s54 offen offset:2048 sc1
    v_dot2_f32_bf16 v4, v88, v88, v4
    v_dot2_f32_bf16 v5, v89, v89, v5
    v_dot2_f32_bf16 v4, v90, v90, v4
    v_dot2_f32_bf16 v5, v91, v91, v5
    v_dot2_f32_bf16 v4, v92, v92, v4
    v_dot2_f32_bf16 v5, v93, v93, v5
    v_dot2_f32_bf16 v4, v94, v94, v4
    v_dot2_f32_bf16 v5, v95, v95, v5
    v_dot2_f32_bf16 v4, v96, v96, v4
    v_dot2_f32_bf16 v5, v97, v97, v5
    v_dot2_f32_bf16 v4, v98, v98, v4
    v_dot2_f32_bf16 v5, v99, v99, v5
    s_nop 2
    v_add_f32 v4, v4, v5
    v_mov_b32 v3, v4
    s_nop 1
    v_permlane32_swap_b32 v4, v3
    v_add_f32 v4, v4, v3
    v_mov_b32 v3, v4
    s_nop 1
    v_permlane16_swap_b32 v4, v3
    v_add_f32 v4, v4, v3
    s_mov_b64 exec, 0xffff
    s_cmp_lg_u32 s49, 0
    s_cbranch_scc1 k234_mid_kernel_a3
    buffer_store_dword v188, v9, s[8:11], s55 offen sc1
k234_mid_kernel_a3:
    buffer_store_dword v4, v10, s[8:11], s56 offen sc1
    s_mov_b64 exec, -1
    s_branch k234_mid_kernel_B
k234_mid_kernel_help:
    s_waitcnt lgkmcnt(0)
    s_mov_b32 s12, s4
    s_mov_b32 s13, s5
    s_mov_b32 s14, 5308416
    s_mov_b32 s15, 0x00020000
    s_mov_b32 s16, s6
    s_mov_b32 s17, s7
    s_mov_b32 s18, 5308416
    s_mov_b32 s19, 0x00020000
    s_mov_b32 s8, s28
    s_mov_b32 s9, s29
    s_mov_b32 s10, 67108864
    s_mov_b32 s11, 0x00020000
    s_mov_b32 s40, s44
    s_mov_b32 s41, s45
    s_mov_b32 s42, 2359296
    s_mov_b32 s43, 0x00020000
    s_mov_b32 s36, s46
    s_mov_b32 s37, s47
    s_mov_b32 s38, 663552
    s_mov_b32 s39, 0x00020000
    s_barrier
k234_mid_kernel_B:
    s_nop 1
    v_and_b32 v15, 63, v0
    v_lshrrev_b32 v12, 2, v15
    v_and_b32 v13, 7, v12
    v_xor_b32 v13, s20, v13
    v_lshlrev_b32 v13, 5, v13
    v_lshl_add_u32 v13, v12, 8, v13
    v_and_b32 v14, 3, v15
    v_lshl_add_u32 v4, v14, 3, v13
    v_add_u32 v3, 114688, v4
    v_lshlrev_b32 v2, 4, v15
    v_subrev_u32 v15, 0, v0
    v_lshrrev_b32 v12, 4, v15
    v_and_b32 v13, 7, v12
    v_bfe_u32 v14, v0, 1, 3
    v_xor_b32 v13, v13, v14
    v_and_b32 v14, 1, v0
    v_lshl_add_u32 v13, v13, 1, v14
    v_mul_u32_u24 v12, 9216, v12
    v_lshl_add_u32 v1, v13, 4, v12
    s_waitcnt vmcnt(24)
    s_barrier
    ds_read_b64_tr_b16 v[112:113], v3 offset:0
    ds_read_b64_tr_b16 v[114:115], v3 offset:4096
    ds_read_b64_tr_b16 v[116:117], v3 offset:8192
    ds_read_b64_tr_b16 v[118:119], v3 offset:12288
    s_add_u32 m0, s26, 73728
    s_nop 0
    buffer_load_dwordx4 v1, s[12:15], s24 offen lds
    s_add_u32 m0, s26, 81920
    s_nop 0
    buffer_load_dwordx4 v1, s[16:19], s24 offen lds
    s_add_u32 s24, s24, 294912
    s_add_u32 m0, s26, 90112
    s_nop 0
    buffer_load_dwordx4 v1, s[12:15], s24 offen lds
    s_add_u32 m0, s26, 98304
    s_nop 0
    buffer_load_dwordx4 v1, s[16:19], s24 offen lds
    s_add_u32 s24, s24, 294912
    v_add_u32 v11, 53248, v4
    v_add_u32 v5, 49152, v2
    v_add_u32 v6, 98304, v2
    v_and_b32 v12, 15, v0
    v_lshlrev_b32 v13, 3, v12
    v_add_u32 v8, 110592, v13
    v_lshlrev_b32 v13, 2, v12
    v_add_u32 v9, 113152, v13
    v_lshlrev_b32 v12, 4, v12
    v_bfe_u32 v13, v0, 4, 1
    v_mul_u32_u24 v13, 147456, v13
    v_add_u32 v12, v12, v13
    v_bfe_u32 v13, v0, 5, 1
    v_lshl_add_u32 v7, v13, 8, v12
    s_mul_i32 s27, s23, 147456
    s_lshl_b32 s30, s21, 12
    s_add_u32 s27, s27, s30
    s_lshl_b32 s30, s20, 9
    s_add_u32 s27, s27, s30
    s_add_u32 s27, s27, 16777216
    s_mul_i32 s25, s23, 18432
    s_add_u32 s25, s25, 10747904
    s_add_u32 s33, s25, s26
    s_and_b32 s32, s21, 3
    s_lshl_b32 s32, s32, 13
    s_add_u32 s32, s32, s26
    s_cmp_lt_u32 s22, 2
    s_cselect_b32 s30, 18, 17
    s_add_u32 s30, s30, s23
    s_lshr_b32 s30, s30, 2
    s_lshr_b32 s60, s23, 2
    s_sub_u32 s30, s30, s60
    s_mul_i32 s30, s30, 6
    s_add_u32 s30, s30, 5
    v_and_b32 v12, 63, v0
    v_min_u32 v12, s30, v12
    v_lshlrev_b32 v22, 7, v12
    s_mul_i32 s60, s60, 768
    s_add_u32 s60, s60, 8331264
    s_cmp_ge_u32 s20, 4
    s_cbranch_scc1 k234_mid_kernel_nw
    s_waitcnt vmcnt(4)
k234_mid_kernel_nw:
    s_waitcnt vmcnt(24)
    s_waitcnt lgkmcnt(0)
    s_barrier
    s_cmp_lg_u32 s20, 0
    s_cbranch_scc1 k234_mid_kernel_nf
    s_cmp_eq_u32 s58, 3
    s_cbranch_scc1 k234_mid_kernel_nf
    v_mov_b32 v12, 0
    s_mov_b64 exec, 1
    buffer_store_dword v12, v12, s[8:11], s34 offen sc1
    s_mov_b64 exec, -1
k234_mid_kernel_nf:
    ds_read_b64_tr_b16 v[120:121], v3 offset:16384
    ds_read_b64_tr_b16 v[122:123], v3 offset:20480
    ds_read_b64_tr_b16 v[124:125], v3 offset:24576
    ds_read_b64_tr_b16 v[126:127], v3 offset:28672
    s_add_u32 m0, s26, 114688
    s_nop 0
    buffer_load_dwordx4 v1, s[12:15], s24 offen lds
    s_add_u32 m0, s26, 122880
    s_nop 0
    buffer_load_dwordx4 v1, s[16:19], s24 offen lds
    s_add_u32 s24, s24, 294912
    s_waitcnt vmcnt(22)
    s_waitcnt lgkmcnt(0)
    s_barrier
    ds_read_b64_tr_b16 v[128:129], v3 offset:32768
    ds_read_b64_tr_b16 v[130:131], v3 offset:36864
    ds_read_b64_tr_b16 v[132:133], v3 offset:40960
    ds_read_b64_tr_b16 v[134:135], v3 offset:45056
    s_add_u32 m0, s26, 131072
    s_nop 0
    buffer_load_dwordx4 v1, s[12:15], s24 offen lds
    s_add_u32 m0, s26, 139264
    s_nop 0
    buffer_load_dwordx4 v1, s[16:19], s24 offen lds
    s_add_u32 s24, s24, 294912
    s_waitcnt vmcnt(20)
    s_waitcnt lgkmcnt(0)
    s_barrier
    ds_read_b64_tr_b16 v[136:137], v4 offset:0
    ds_read_b64_tr_b16 v[138:139], v4 offset:4096
    ds_read_b64_tr_b16 v[140:141], v4 offset:8192
    ds_read_b64_tr_b16 v[142:143], v4 offset:12288
    s_waitcnt vmcnt(16)
    s_waitcnt lgkmcnt(0)
    s_barrier
    ds_read_b64_tr_b16 v[144:145], v4 offset:16384
    ds_read_b64_tr_b16 v[146:147], v4 offset:20480
    ds_read_b64_tr_b16 v[148:149], v4 offset:24576
    ds_read_b64_tr_b16 v[150:151], v4 offset:28672
    s_waitcnt vmcnt(12)
    s_waitcnt lgkmcnt(0)
    s_barrier
    ds_read_b64_tr_b16 v[152:153], v4 offset:36864
    ds_read_b64_tr_b16 v[154:155], v4 offset:40960
    ds_read_b64_tr_b16 v[156:157], v4 offset:45056
    ds_read_b64_tr_b16 v[158:159], v4 offset:49152
    s_waitcnt vmcnt(8)
    s_waitcnt lgkmcnt(0)
    s_barrier
    ds_read_b64_tr_b16 v[160:161], v11 offset:0
    ds_read_b64_tr_b16 v[162:163], v11 offset:4096
    ds_read_b64_tr_b16 v[164:165], v11 offset:8192
    ds_read_b64_tr_b16 v[166:167], v11 offset:12288
    s_cmp_lg_u32 s20, 7
    s_cbranch_scc1 k234_mid_kernel_ns6
    buffer_load_dword v16, v22, s[8:11], s60 offen sc1
k234_mid_kernel_ns6:
    s_waitcnt vmcnt(6)
    s_waitcnt lgkmcnt(0)
    s_barrier
    ds_read_b64_tr_b16 v[168:169], v11 offset:20480
    ds_read_b64_tr_b16 v[170:171], v11 offset:24576
    ds_read_b64_tr_b16 v[172:173], v11 offset:28672
    ds_read_b64_tr_b16 v[174:175], v11 offset:32768
    s_cmp_lg_u32 s20, 7
    s_cbranch_scc1 k234_mid_kernel_ns7
    buffer_load_dword v17, v22, s[8:11], s60 offen sc1
k234_mid_kernel_ns7:
    s_waitcnt vmcnt(4)
    s_waitcnt lgkmcnt(0)
    s_barrier
    ds_read_b64_tr_b16 v[176:177], v11 offset:36864
    ds_read_b64_tr_b16 v[178:179], v11 offset:40960
    ds_read_b64_tr_b16 v[180:181], v11 offset:45056
    ds_read_b64_tr_b16 v[182:183], v11 offset:49152
    s_cmp_lg_u32 s20, 7
    s_cbranch_scc1 k234_mid_kernel_ns8
    buffer_load_dword v18, v22, s[8:11], s60 offen sc1
k234_mid_kernel_ns8:
    s_waitcnt vmcnt(2)
    s_waitcnt lgkmcnt(0)
    s_barrier
    ds_read_b64_tr_b16 v[184:185], v3 offset:0
    ds_read_b64_tr_b16 v[186:187], v3 offset:4096
    ds_read_b64_tr_b16 v[188:189], v3 offset:8192
    ds_read_b64_tr_b16 v[190:191], v3 offset:12288
    s_cmp_lg_u32 s20, 7
    s_cbranch_scc1 k234_mid_kernel_np
    v_cmp_ne_u32 vcc, 0, v16
    s_nop 4
    s_cbranch_vccz k234_mid_kernel_np
    s_waitcnt vmcnt(1)
    v_cmp_ne_u32 vcc, 0, v17
    s_nop 4
    s_cbranch_vccz k234_mid_kernel_np
    s_waitcnt vmcnt(0)
    v_cmp_ne_u32 vcc, 0, v18
    s_nop 4
    s_cbranch_vccz k234_mid_kernel_np
    s_mov_b32 s31, 100000
k234_mid_kernel_poll:
    buffer_load_dword v14, v22, s[8:11], s60 offen sc1
    s_waitcnt vmcnt(0)
    v_cmp_ne_u32 vcc, 0, v14
    s_sub_u32 s31, s31, 1
    s_cmp_eq_u32 s31, 0
    s_cbranch_scc1 k234_mid_kernel_np
    s_cbranch_vccz k234_mid_kernel_np
    s_sleep 4
    s_branch k234_mid_kernel_poll
k234_mid_kernel_np:
    s_waitcnt vmcnt(0)
    s_waitcnt lgkmcnt(0)
    s_barrier
    s_add_u32 s30, s32, 0
    s_sub_u32 s31, s30, 36864
    s_cmp_ge_u32 s30, 36864
    s_cselect_b32 s30, s31, s30
    s_add_u32 m0, s30, 36864
    s_add_u32 s30, s30, s25
    buffer_load_dwordx4 v2, s[8:11], s30 offen sc1 lds
    s_add_u32 s30, s32, 8192
    s_sub_u32 s31, s30, 36864
    s_cmp_ge_u32 s30, 36864
    s_cselect_b32 s30, s31, s30
    s_add_u32 m0, s30, 36864
    s_add_u32 s30, s30, s25
    buffer_load_dwordx4 v2, s[8:11], s30 offen sc1 lds
    s_add_u32 s30, s32, 16384
    s_sub_u32 s31, s30, 36864
    s_cmp_ge_u32 s30, 36864
    s_cselect_b32 s30, s31, s30
    s_add_u32 m0, s30, 36864
    s_add_u32 s30, s30, s25
    buffer_load_dwordx4 v2, s[8:11], s30 offen sc1 lds
    s_add_u32 s30, s32, 24576
    s_sub_u32 s31, s30, 36864
    s_cmp_ge_u32 s30, 36864
    s_cselect_b32 s30, s31, s30
    s_add_u32 m0, s30, 36864
    s_add_u32 s30, s30, s25
    buffer_load_dwordx4 v2, s[8:11], s30 offen sc1 lds
    s_cmp_ge_u32 s20, 4
    s_cbranch_scc1 k234_mid_kernel_sk1
    s_add_u32 s30, s32, 32768
    s_sub_u32 s31, s30, 36864
    s_cmp_ge_u32 s30, 36864
    s_cselect_b32 s30, s31, s30
    s_add_u32 m0, s30, 36864
    s_add_u32 s30, s30, s25
    buffer_load_dwordx4 v2, s[8:11], s30 offen sc1 lds
k234_mid_kernel_sk1:
    ds_read_b64_tr_b16 v[192:193], v3 offset:16384
    ds_read_b64_tr_b16 v[194:195], v3 offset:20480
    ds_read_b64_tr_b16 v[196:197], v3 offset:24576
    ds_read_b64_tr_b16 v[198:199], v3 offset:28672
    s_waitcnt vmcnt(0)
    s_waitcnt lgkmcnt(0)
    s_barrier
    ds_read_b128 v[24:27], v2 offset:36864
    ds_read_b128 v[28:31], v5 offset:6144
    ds_read_b128 v[32:35], v2 offset:37888
    ds_read_b128 v[36:39], v5 offset:7168
    ds_read_b128 v[40:43], v2 offset:38912
    ds_read_b128 v[44:47], v5 offset:8192
    s_waitcnt lgkmcnt(5)
    v_mfma_f32_16x16x32_bf16 v[48:51], v[112:115], v[24:27], 0
    v_mfma_f32_16x16x32_bf16 v[52:55], v[116:119], v[24:27], 0
    s_add_u32 s30, s32, 0
    s_sub_u32 s31, s30, 36864
    s_cmp_ge_u32 s30, 36864
    s_cselect_b32 s30, s31, s30
    s_add_u32 m0, s30, 73728
    s_add_u32 s30, s30, s25
    s_add_u32 s30, s30, 36864
    buffer_load_dwordx4 v2, s[8:11], s30 offen sc1 lds
    ds_read_b128 v[24:27], v2 offset:39936
    s_waitcnt lgkmcnt(5)
    v_mfma_f32_16x16x32_bf16 v[56:59], v[112:115], v[28:31], 0
    s_add_u32 s30, s32, 8192
    s_sub_u32 s31, s30, 36864
    s_cmp_ge_u32 s30, 36864
    s_cselect_b32 s30, s31, s30
    s_add_u32 m0, s30, 73728
    s_add_u32 s30, s30, s25
    s_add_u32 s30, s30, 36864
    buffer_load_dwordx4 v2, s[8:11], s30 offen sc1 lds
    v_mfma_f32_16x16x32_bf16 v[60:63], v[116:119], v[28:31], 0
    s_add_u32 s30, s32, 16384
    s_sub_u32 s31, s30, 36864
    s_cmp_ge_u32 s30, 36864
    s_cselect_b32 s30, s31, s30
    s_add_u32 m0, s30, 73728
    s_add_u32 s30, s30, s25
    s_add_u32 s30, s30, 36864
    buffer_load_dwordx4 v2, s[8:11], s30 offen sc1 lds
    ds_read_b128 v[28:31], v5 offset:9216
    s_waitcnt lgkmcnt(5)
    v_mfma_f32_16x16x32_bf16 v[48:51], v[120:123], v[32:35], v[48:51]
    v_mfma_f32_16x16x32_bf16 v[52:55], v[124:127], v[32:35], v[52:55]
    s_add_u32 s30, s32, 24576
    s_sub_u32 s31, s30, 36864
    s_cmp_ge_u32 s30, 36864
    s_cselect_b32 s30, s31, s30
    s_add_u32 m0, s30, 73728
    s_add_u32 s30, s30, s25
    s_add_u32 s30, s30, 36864
    buffer_load_dwordx4 v2, s[8:11], s30 offen sc1 lds
    ds_read_b128 v[32:35], v2 offset:40960
    s_waitcnt lgkmcnt(5)
    v_mfma_f32_16x16x32_bf16 v[56:59], v[120:123], v[36:39], v[56:59]
    v_mfma_f32_16x16x32_bf16 v[60:63], v[124:127], v[36:39], v[60:63]
    s_cmp_ge_u32 s20, 4
    s_cbranch_scc1 k234_mid_kernel_sk2
    s_add_u32 s30, s32, 32768
    s_sub_u32 s31, s30, 36864
    s_cmp_ge_u32 s30, 36864
    s_cselect_b32 s30, s31, s30
    s_add_u32 m0, s30, 73728
    s_add_u32 s30, s30, s25
    s_add_u32 s30, s30, 36864
    buffer_load_dwordx4 v2, s[8:11], s30 offen sc1 lds
k234_mid_kernel_sk2:
    ds_read_b128 v[36:39], v5 offset:10240
    s_waitcnt lgkmcnt(5)
    v_mfma_f32_16x16x32_bf16 v[48:51], v[128:131], v[40:43], v[48:51]
    s_cmp_ge_u32 s20, 5
    s_cbranch_scc1 k234_mid_kernel_nq
    s_lshl_b32 s30, s23, 9
    s_add_u32 s30, s30, 7258112
    v_lshrrev_b32 v12, 4, v0
    v_lshlrev_b32 v12, 9, v12
    v_and_b32 v13, 15, v0
    v_lshl_add_u32 v12, v13, 2, v12
    buffer_load_dword v16, v12, s[8:11], s30 offen offset:0 sc1
    buffer_load_dword v17, v12, s[8:11], s30 offen offset:64 sc1
    buffer_load_dword v18, v12, s[8:11], s30 offen offset:128 sc1
    buffer_load_dword v19, v12, s[8:11], s30 offen offset:192 sc1
    buffer_load_dword v20, v12, s[8:11], s30 offen offset:256 sc1
    buffer_load_dword v21, v12, s[8:11], s30 offen offset:320 sc1
k234_mid_kernel_nq:
    v_mfma_f32_16x16x32_bf16 v[52:55], v[132:135], v[40:43], v[52:55]
    ds_read_b128 v[40:43], v2 offset:41984
    s_waitcnt lgkmcnt(5)
    v_mfma_f32_16x16x32_bf16 v[56:59], v[128:131], v[44:47], v[56:59]
    v_mfma_f32_16x16x32_bf16 v[60:63], v[132:135], v[44:47], v[60:63]
    ds_read_b128 v[44:47], v5 offset:11264
    s_waitcnt lgkmcnt(5)
    v_mfma_f32_16x16x32_bf16 v[48:51], v[136:139], v[24:27], v[48:51]
    v_mfma_f32_16x16x32_bf16 v[52:55], v[140:143], v[24:27], v[52:55]
    ds_read_b128 v[24:27], v2 offset:43008
    s_waitcnt lgkmcnt(5)
    v_mfma_f32_16x16x32_bf16 v[56:59], v[136:139], v[28:31], v[56:59]
    v_mfma_f32_16x16x32_bf16 v[60:63], v[140:143], v[28:31], v[60:63]
    ds_read_b128 v[28:31], v5 offset:12288
    s_waitcnt lgkmcnt(5)
    v_mfma_f32_16x16x32_bf16 v[48:51], v[144:147], v[32:35], v[48:51]
    v_mfma_f32_16x16x32_bf16 v[52:55], v[148:151], v[32:35], v[52:55]
    ds_read_b128 v[32:35], v2 offset:44032
    s_waitcnt lgkmcnt(5)
    v_mfma_f32_16x16x32_bf16 v[56:59], v[144:147], v[36:39], v[56:59]
    v_mfma_f32_16x16x32_bf16 v[60:63], v[148:151], v[36:39], v[60:63]
    ds_read_b128 v[36:39], v5 offset:13312
    s_waitcnt lgkmcnt(5)
    v_mfma_f32_16x16x32_bf16 v[48:51], v[152:155], v[40:43], v[48:51]
    v_mfma_f32_16x16x32_bf16 v[52:55], v[156:159], v[40:43], v[52:55]
    ds_read_b128 v[40:43], v2 offset:45056
    s_waitcnt lgkmcnt(5)
    v_mfma_f32_16x16x32_bf16 v[56:59], v[152:155], v[44:47], v[56:59]
    v_mfma_f32_16x16x32_bf16 v[60:63], v[156:159], v[44:47], v[60:63]
    ds_read_b128 v[44:47], v5 offset:14336
    s_waitcnt lgkmcnt(5)
    v_mfma_f32_16x16x32_bf16 v[48:51], v[160:163], v[24:27], v[48:51]
    v_mfma_f32_16x16x32_bf16 v[52:55], v[164:167], v[24:27], v[52:55]
    ds_read_b128 v[24:27], v2 offset:46080
    s_waitcnt lgkmcnt(5)
    v_mfma_f32_16x16x32_bf16 v[56:59], v[160:163], v[28:31], v[56:59]
    v_mfma_f32_16x16x32_bf16 v[60:63], v[164:167], v[28:31], v[60:63]
    ds_read_b128 v[28:31], v5 offset:15360
    s_waitcnt lgkmcnt(5)
    v_mfma_f32_16x16x32_bf16 v[48:51], v[168:171], v[32:35], v[48:51]
    v_mfma_f32_16x16x32_bf16 v[52:55], v[172:175], v[32:35], v[52:55]
    ds_read_b128 v[32:35], v2 offset:47104
    s_waitcnt lgkmcnt(5)
    v_mfma_f32_16x16x32_bf16 v[56:59], v[168:171], v[36:39], v[56:59]
    v_mfma_f32_16x16x32_bf16 v[60:63], v[172:175], v[36:39], v[60:63]
    ds_read_b128 v[36:39], v5 offset:16384
    s_waitcnt lgkmcnt(5)
    v_mfma_f32_16x16x32_bf16 v[48:51], v[176:179], v[40:43], v[48:51]
    v_mfma_f32_16x16x32_bf16 v[52:55], v[180:183], v[40:43], v[52:55]
    ds_read_b128 v[40:43], v2 offset:48128
    s_waitcnt lgkmcnt(5)
    v_mfma_f32_16x16x32_bf16 v[56:59], v[176:179], v[44:47], v[56:59]
    v_mfma_f32_16x16x32_bf16 v[60:63], v[180:183], v[44:47], v[60:63]
    ds_read_b128 v[44:47], v5 offset:17408
    s_waitcnt lgkmcnt(5)
    v_mfma_f32_16x16x32_bf16 v[48:51], v[184:187], v[24:27], v[48:51]
    v_mfma_f32_16x16x32_bf16 v[52:55], v[188:191], v[24:27], v[52:55]
    ds_read_b128 v[24:27], v5 offset:0
    s_waitcnt lgkmcnt(5)
    v_mfma_f32_16x16x32_bf16 v[56:59], v[184:187], v[28:31], v[56:59]
    v_mfma_f32_16x16x32_bf16 v[60:63], v[188:191], v[28:31], v[60:63]
    ds_read_b128 v[28:31], v5 offset:18432
    s_waitcnt lgkmcnt(5)
    v_mfma_f32_16x16x32_bf16 v[48:51], v[192:195], v[32:35], v[48:51]
    v_mfma_f32_16x16x32_bf16 v[52:55], v[196:199], v[32:35], v[52:55]
    ds_read_b128 v[32:35], v5 offset:1024
    s_waitcnt lgkmcnt(5)
    v_mfma_f32_16x16x32_bf16 v[56:59], v[192:195], v[36:39], v[56:59]
    v_mfma_f32_16x16x32_bf16 v[60:63], v[196:199], v[36:39], v[60:63]
    ds_read_b128 v[36:39], v5 offset:19456
    s_waitcnt lgkmcnt(5)
    v_mfma_f32_16x16x32_bf16 v[48:51], v[200:203], v[40:43], v[48:51]
    v_mfma_f32_16x16x32_bf16 v[52:55], v[204:207], v[40:43], v[52:55]
    ds_read_b128 v[40:43], v5 offset:2048
    s_waitcnt lgkmcnt(5)
    v_mfma_f32_16x16x32_bf16 v[56:59], v[200:203], v[44:47], v[56:59]
    v_mfma_f32_16x16x32_bf16 v[60:63], v[204:207], v[44:47], v[60:63]
    ds_read_b128 v[44:47], v5 offset:20480
    s_waitcnt vmcnt(0)
    v_add_f32 v16, v16, v17
    v_add_f32 v18, v18, v19
    v_add_f32 v20, v20, v21
    v_add_f32 v16, v16, v18
    v_add_f32 v16, v16, v20
    v_mov_b32 v12, 0x3727c5ac
    v_mov_b32 v13, 0x3ae38e39
    v_fma_f32 v18, v16, v13, v12
    v_rsq_f32 v12, v18
    s_nop 0
    v_mul_f32 v16, 0xc0135761, v12
    v_mul_f32 v13, v12, v12
    v_mul_f32 v13, v13, v12
    v_mul_f32 v17, 0xbdd2d3e8, v13
    v_lshlrev_b32 v12, 3, v0
    v_add_u32 v12, 110592, v12
    v_lshlrev_b32 v13, 2, v0
    v_add_u32 v13, 113152, v13
    v_cmp_gt_u32 vcc, 304, v0
    s_nop 0
    s_and_saveexec_b64 s[30:31], vcc
    ds_write_b64 v12, v[16:17]
    ds_write_b32 v13, v18
    s_mov_b64 exec, s[30:31]
    s_waitcnt lgkmcnt(0)
    s_barrier
    v_mfma_f32_16x16x32_bf16 v[48:51], v[208:211], v[24:27], v[48:51]
    v_mfma_f32_16x16x32_bf16 v[52:55], v[212:215], v[24:27], v[52:55]
    ds_read_b128 v[24:27], v5 offset:3072
    v_mfma_f32_16x16x32_bf16 v[56:59], v[208:211], v[28:31], v[56:59]
    s_add_u32 m0, s26, 0
    s_add_u32 s30, s33, 73728
    buffer_load_dwordx4 v2, s[8:11], s30 offen sc1 lds
    v_mfma_f32_16x16x32_bf16 v[60:63], v[212:215], v[28:31], v[60:63]
    ds_read_b128 v[28:31], v5 offset:21504
    v_mfma_f32_16x16x32_bf16 v[48:51], v[216:219], v[32:35], v[48:51]
    v_mfma_f32_16x16x32_bf16 v[52:55], v[220:223], v[32:35], v[52:55]
    ds_read_b128 v[32:35], v5 offset:4096
    v_mfma_f32_16x16x32_bf16 v[56:59], v[216:219], v[36:39], v[56:59]
    v_mfma_f32_16x16x32_bf16 v[60:63], v[220:223], v[36:39], v[60:63]
    ds_read_b128 v[36:39], v5 offset:22528
    v_mfma_f32_16x16x32_bf16 v[48:51], v[224:227], v[40:43], v[48:51]
    s_add_u32 m0, s26, 8192
    s_add_u32 s30, s33, 81920
    buffer_load_dwordx4 v2, s[8:11], s30 offen sc1 lds
    v_mfma_f32_16x16x32_bf16 v[52:55], v[228:231], v[40:43], v[52:55]
    ds_read_b128 v[40:43], v5 offset:5120
    v_mfma_f32_16x16x32_bf16 v[56:59], v[224:227], v[44:47], v[56:59]
    v_mfma_f32_16x16x32_bf16 v[60:63], v[228:231], v[44:47], v[60:63]
    ds_read_b128 v[44:47], v5 offset:23552
    s_waitcnt lgkmcnt(5)
    v_mfma_f32_16x16x32_bf16 v[48:51], v[232:235], v[24:27], v[48:51]
    v_mfma_f32_16x16x32_bf16 v[52:55], v[236:239], v[24:27], v[52:55]
    ds_read_b128 v[24:27], v5 offset:24576
    s_waitcnt lgkmcnt(5)
    v_mfma_f32_16x16x32_bf16 v[56:59], v[232:235], v[28:31], v[56:59]
    s_add_u32 m0, s26, 16384
    s_add_u32 s30, s33, 90112
    buffer_load_dwordx4 v2, s[8:11], s30 offen sc1 lds
    v_mfma_f32_16x16x32_bf16 v[60:63], v[236:239], v[28:31], v[60:63]
    ds_read_b128 v[28:31], v5 offset:43008
    s_waitcnt lgkmcnt(5)
    v_mfma_f32_16x16x32_bf16 v[48:51], v[240:243], v[32:35], v[48:51]
    v_mfma_f32_16x16x32_bf16 v[52:55], v[244:247], v[32:35], v[52:55]
    ds_read_b128 v[32:35], v5 offset:25600
    s_waitcnt lgkmcnt(5)
    v_mfma_f32_16x16x32_bf16 v[56:59], v[240:243], v[36:39], v[56:59]
    v_mfma_f32_16x16x32_bf16 v[60:63], v[244:247], v[36:39], v[60:63]
    ds_read_b128 v[36:39], v5 offset:44032
    s_waitcnt lgkmcnt(5)
    v_mfma_f32_16x16x32_bf16 v[48:51], v[248:251], v[40:43], v[48:51]
    s_add_u32 m0, s26, 24576
    s_add_u32 s30, s33, 98304
    buffer_load_dwordx4 v2, s[8:11], s30 offen sc1 lds
    v_mfma_f32_16x16x32_bf16 v[52:55], v[252:255], v[40:43], v[52:55]
    ds_read_b128 v[40:43], v5 offset:26624
    s_waitcnt lgkmcnt(5)
    v_mfma_f32_16x16x32_bf16 v[56:59], v[248:251], v[44:47], v[56:59]
    v_mfma_f32_16x16x32_bf16 v[60:63], v[252:255], v[44:47], v[60:63]
    ds_read_b128 v[44:47], v5 offset:45056
    s_waitcnt lgkmcnt(5)
    v_mfma_f32_16x16x32_bf16 v[64:67], v[112:115], v[24:27], 0
    ds_read_b64 v[16:17], v8 offset:0
    ds_read_b32 v18, v9 offset:0
    ds_read_b64 v[20:21], v8 offset:128
    ds_read_b32 v22, v9 offset:64
    v_mul_f32 v52, v48, v52
    v_mfma_f32_16x16x32_bf16 v[68:71], v[116:119], v[24:27], 0
    v_mul_f32 v53, v49, v53
    v_mul_f32 v54, v50, v54
    ds_read_b128 v[24:27], v5 offset:27648
    s_waitcnt lgkmcnt(9)
    v_mfma_f32_16x16x32_bf16 v[72:75], v[112:115], v[28:31], 0
    v_mul_f32 v55, v51, v55
    s_cmp_ge_u32 s20, 4
    s_cbranch_scc1 k234_mid_kernel_sk3
    s_add_u32 m0, s26, 32768
    s_add_u32 s30, s33, 106496
    buffer_load_dwordx4 v2, s[8:11], s30 offen sc1 lds
k234_mid_kernel_sk3:
    v_mfma_f32_16x16x32_bf16 v[76:79], v[116:119], v[28:31], 0
    v_mul_f32 v12, v48, v48
    v_mul_f32 v13, v49, v49
    ds_read_b128 v[28:31], v5 offset:46080
    s_waitcnt lgkmcnt(9)
    v_mfma_f32_16x16x32_bf16 v[64:67], v[120:123], v[32:35], v[64:67]
    v_mul_f32 v14, v50, v50
    v_mul_f32 v15, v51, v51
    s_waitcnt lgkmcnt(4)
    v_mfma_f32_16x16x32_bf16 v[68:71], v[124:127], v[32:35], v[68:71]
    v_fma_f32 v12, v12, v17, v16
    ds_read_b128 v[32:35], v5 offset:28672
    v_mfma_f32_16x16x32_bf16 v[72:75], v[120:123], v[36:39], v[72:75]
    v_fma_f32 v13, v13, v17, v16
    v_fma_f32 v14, v14, v17, v16
    v_mfma_f32_16x16x32_bf16 v[76:79], v[124:127], v[36:39], v[76:79]
    v_fma_f32 v15, v15, v17, v16
    v_mul_f32 v48, v48, v12
    ds_read_b128 v[36:39], v5 offset:47104
    v_mfma_f32_16x16x32_bf16 v[64:67], v[128:131], v[40:43], v[64:67]
    v_mul_f32 v49, v49, v13
    v_mfma_f32_16x16x32_bf16 v[68:71], v[132:135], v[40:43], v[68:71]
    v_mul_f32 v50, v50, v14
    v_mul_f32 v51, v51, v15
    ds_read_b128 v[40:43], v5 offset:29696
    v_mfma_f32_16x16x32_bf16 v[72:75], v[128:131], v[44:47], v[72:75]
    v_mfma_f32_16x16x32_bf16 v[76:79], v[132:135], v[44:47], v[76:79]
    v_exp_f32 v48, v48
    ds_read_b128 v[44:47], v5 offset:48128
    s_waitcnt lgkmcnt(5)
    v_mfma_f32_16x16x32_bf16 v[64:67], v[136:139], v[24:27], v[64:67]
    v_exp_f32 v49, v49
    v_mfma_f32_16x16x32_bf16 v[68:71], v[140:143], v[24:27], v[68:71]
    v_exp_f32 v50, v50
    ds_read_b128 v[24:27], v5 offset:30720
    s_waitcnt lgkmcnt(5)
    v_mfma_f32_16x16x32_bf16 v[72:75], v[136:139], v[28:31], v[72:75]
    v_mfma_f32_16x16x32_bf16 v[76:79], v[140:143], v[28:31], v[76:79]
    v_exp_f32 v51, v51
    v_fma_f32 v48, v48, v18, v18
    ds_read_b128 v[28:31], v6 offset:0
    s_waitcnt lgkmcnt(5)
    v_mfma_f32_16x16x32_bf16 v[64:67], v[144:147], v[32:35], v[64:67]
    v_fma_f32 v49, v49, v18, v18
    v_mfma_f32_16x16x32_bf16 v[68:71], v[148:151], v[32:35], v[68:71]
    v_fma_f32 v50, v50, v18, v18
    v_fma_f32 v51, v51, v18, v18
    ds_read_b128 v[32:35], v5 offset:31744
    s_waitcnt lgkmcnt(5)
    v_mfma_f32_16x16x32_bf16 v[72:75], v[144:147], v[36:39], v[72:75]
    v_mfma_f32_16x16x32_bf16 v[76:79], v[148:151], v[36:39], v[76:79]
    v_rcp_f32 v48, v48
    ds_read_b128 v[36:39], v6 offset:1024
    s_waitcnt lgkmcnt(5)
    v_mfma_f32_16x16x32_bf16 v[64:67], v[152:155], v[40:43], v[64:67]
    v_rcp_f32 v49, v49
    v_mfma_f32_16x16x32_bf16 v[68:71], v[156:159], v[40:43], v[68:71]
    v_rcp_f32 v50, v50
    ds_read_b128 v[40:43], v5 offset:32768
    s_waitcnt lgkmcnt(5)
    v_mfma_f32_16x16x32_bf16 v[72:75], v[152:155], v[44:47], v[72:75]
    v_mfma_f32_16x16x32_bf16 v[76:79], v[156:159], v[44:47], v[76:79]
    v_rcp_f32 v51, v51
    v_mul_f32 v52, v52, v48
    ds_read_b128 v[44:47], v6 offset:2048
    s_waitcnt lgkmcnt(5)
    v_mfma_f32_16x16x32_bf16 v[64:67], v[160:163], v[24:27], v[64:67]
    v_mul_f32 v53, v53, v49
    v_mfma_f32_16x16x32_bf16 v[68:71], v[164:167], v[24:27], v[68:71]
    v_mul_f32 v54, v54, v50
    v_mul_f32 v55, v55, v51
    ds_read_b128 v[24:27], v5 offset:33792
    s_waitcnt lgkmcnt(5)
    v_mfma_f32_16x16x32_bf16 v[72:75], v[160:163], v[28:31], v[72:75]
    v_mul_f32 v60, v56, v60
    v_mfma_f32_16x16x32_bf16 v[76:79], v[164:167], v[28:31], v[76:79]
    v_mul_f32 v61, v57, v61
    v_mul_f32 v62, v58, v62
    ds_read_b128 v[28:31], v6 offset:3072
    s_waitcnt lgkmcnt(5)
    v_mfma_f32_16x16x32_bf16 v[64:67], v[168:171], v[32:35], v[64:67]
    v_mul_f32 v63, v59, v63
    v_mul_f32 v12, v56, v56
    v_mfma_f32_16x16x32_bf16 v[68:71], v[172:175], v[32:35], v[68:71]
    v_mul_f32 v13, v57, v57
    ds_read_b128 v[32:35], v5 offset:34816
    s_waitcnt lgkmcnt(5)
    v_mfma_f32_16x16x32_bf16 v[72:75], v[168:171], v[36:39], v[72:75]
    v_mul_f32 v14, v58, v58
    v_mul_f32 v15, v59, v59
    v_mfma_f32_16x16x32_bf16 v[76:79], v[172:175], v[36:39], v[76:79]
    v_fma_f32 v12, v12, v21, v20
    v_fma_f32 v13, v13, v21, v20
    ds_read_b128 v[36:39], v6 offset:4096
    s_waitcnt lgkmcnt(5)
    v_mfma_f32_16x16x32_bf16 v[64:67], v[176:179], v[40:43], v[64:67]
    v_fma_f32 v14, v14, v21, v20
    v_mfma_f32_16x16x32_bf16 v[68:71], v[180:183], v[40:43], v[68:71]
    v_fma_f32 v15, v15, v21, v20
    v_mul_f32 v56, v56, v12
    ds_read_b128 v[40:43], v5 offset:35840
    s_waitcnt lgkmcnt(5)
    v_mfma_f32_16x16x32_bf16 v[72:75], v[176:179], v[44:47], v[72:75]
    v_mul_f32 v57, v57, v13
    v_mfma_f32_16x16x32_bf16 v[76:79], v[180:183], v[44:47], v[76:79]
    v_mul_f32 v58, v58, v14
    v_mul_f32 v59, v59, v15
    ds_read_b128 v[44:47], v6 offset:5120
    s_waitcnt lgkmcnt(5)
    v_mfma_f32_16x16x32_bf16 v[64:67], v[184:187], v[24:27], v[64:67]
    v_exp_f32 v56, v56
    v_mfma_f32_16x16x32_bf16 v[68:71], v[188:191], v[24:27], v[68:71]
    ds_read_b128 v[24:27], v5 offset:36864
    s_waitcnt lgkmcnt(5)
    v_mfma_f32_16x16x32_bf16 v[72:75], v[184:187], v[28:31], v[72:75]
    v_exp_f32 v57, v57
    v_mfma_f32_16x16x32_bf16 v[76:79], v[188:191], v[28:31], v[76:79]
    v_exp_f32 v58, v58
    ds_read_b128 v[28:31], v6 offset:6144
    s_waitcnt lgkmcnt(5)
    v_mfma_f32_16x16x32_bf16 v[64:67], v[192:195], v[32:35], v[64:67]
    v_exp_f32 v59, v59
    v_mfma_f32_16x16x32_bf16 v[68:71], v[196:199], v[32:35], v[68:71]
    v_fma_f32 v56, v56, v22, v22
    ds_read_b128 v[32:35], v5 offset:37888
    s_waitcnt lgkmcnt(5)
    v_mfma_f32_16x16x32_bf16 v[72:75], v[192:195], v[36:39], v[72:75]
    v_fma_f32 v57, v57, v22, v22
    v_fma_f32 v58, v58, v22, v22
    v_mfma_f32_16x16x32_bf16 v[76:79], v[196:199], v[36:39], v[76:79]
    v_fma_f32 v59, v59, v22, v22
    ds_read_b128 v[36:39], v6 offset:7168
    s_waitcnt lgkmcnt(5)
    v_mfma_f32_16x16x32_bf16 v[64:67], v[200:203], v[40:43], v[64:67]
    v_rcp_f32 v56, v56
    v_mfma_f32_16x16x32_bf16 v[68:71], v[204:207], v[40:43], v[68:71]
    v_rcp_f32 v57, v57
    ds_read_b128 v[40:43], v5 offset:38912
    s_waitcnt lgkmcnt(5)
    v_mfma_f32_16x16x32_bf16 v[72:75], v[200:203], v[44:47], v[72:75]
    v_rcp_f32 v58, v58
    v_mfma_f32_16x16x32_bf16 v[76:79], v[204:207], v[44:47], v[76:79]
    ds_read_b128 v[44:47], v6 offset:8192
    s_waitcnt vmcnt(0)
    s_barrier
    s_waitcnt lgkmcnt(5)
    v_mfma_f32_16x16x32_bf16 v[64:67], v[208:211], v[24:27], v[64:67]
    v_rcp_f32 v59, v59
    v_mul_f32 v60, v60, v56
    v_mfma_f32_16x16x32_bf16 v[68:71], v[212:215], v[24:27], v[68:71]
    v_mul_f32 v61, v61, v57
    ds_read_b128 v[24:27], v5 offset:39936
    s_waitcnt lgkmcnt(5)
    v_mfma_f32_16x16x32_bf16 v[72:75], v[208:211], v[28:31], v[72:75]
    v_mul_f32 v62, v62, v58
    v_mul_f32 v63, v63, v59
    s_add_u32 m0, s26, 36864
    s_add_u32 s30, s33, 110592
    buffer_load_dwordx4 v2, s[8:11], s30 offen sc1 lds
    v_mfma_f32_16x16x32_bf16 v[76:79], v[212:215], v[28:31], v[76:79]
    v_cvt_pk_bf16_f32 v48, v52, v53
    ds_read_b128 v[28:31], v6 offset:9216
    s_waitcnt lgkmcnt(5)
    v_mfma_f32_16x16x32_bf16 v[64:67], v[216:219], v[32:35], v[64:67]
    v_cvt_pk_bf16_f32 v49, v54, v55
    v_cvt_pk_bf16_f32 v50, v60, v61
    v_mfma_f32_16x16x32_bf16 v[68:71], v[220:223], v[32:35], v[68:71]
    v_cvt_pk_bf16_f32 v51, v62, v63
    s_add_u32 s31, s27, 0
    v_permlane16_swap_b32 v48, v50
    ds_read_b128 v[32:35], v5 offset:40960
    s_waitcnt lgkmcnt(5)
    v_mfma_f32_16x16x32_bf16 v[72:75], v[216:219], v[36:39], v[72:75]
    v_permlane16_swap_b32 v49, v51
    buffer_store_dwordx4 v[48:51], v7, s[8:11], s31 offen sc1
    v_mfma_f32_16x16x32_bf16 v[76:79], v[220:223], v[36:39], v[76:79]
    ds_read_b128 v[36:39], v6 offset:10240
    s_waitcnt lgkmcnt(5)
    v_mfma_f32_16x16x32_bf16 v[64:67], v[224:227], v[40:43], v[64:67]
    s_add_u32 m0, s26, 45056
    s_add_u32 s30, s33, 118784
    buffer_load_dwordx4 v2, s[8:11], s30 offen sc1 lds
    v_mfma_f32_16x16x32_bf16 v[68:71], v[228:231], v[40:43], v[68:71]
    ds_read_b128 v[40:43], v5 offset:41984
    s_waitcnt lgkmcnt(5)
    v_mfma_f32_16x16x32_bf16 v[72:75], v[224:227], v[44:47], v[72:75]
    v_mfma_f32_16x16x32_bf16 v[76:79], v[228:231], v[44:47], v[76:79]
    ds_read_b128 v[44:47], v6 offset:11264
    s_waitcnt lgkmcnt(5)
    v_mfma_f32_16x16x32_bf16 v[64:67], v[232:235], v[24:27], v[64:67]
    v_mfma_f32_16x16x32_bf16 v[68:71], v[236:239], v[24:27], v[68:71]
    ds_read_b128 v[24:27], v2 offset:0
    s_waitcnt lgkmcnt(5)
    v_mfma_f32_16x16x32_bf16 v[72:75], v[232:235], v[28:31], v[72:75]
    s_add_u32 m0, s26, 53248
    s_add_u32 s30, s33, 126976
    buffer_load_dwordx4 v2, s[8:11], s30 offen sc1 lds
    v_mfma_f32_16x16x32_bf16 v[76:79], v[236:239], v[28:31], v[76:79]
    ds_read_b128 v[28:31], v2 offset:18432
    s_waitcnt lgkmcnt(5)
    v_mfma_f32_16x16x32_bf16 v[64:67], v[240:243], v[32:35], v[64:67]
    v_mfma_f32_16x16x32_bf16 v[68:71], v[244:247], v[32:35], v[68:71]
    ds_read_b128 v[32:35], v2 offset:1024
    s_waitcnt lgkmcnt(5)
    v_mfma_f32_16x16x32_bf16 v[72:75], v[240:243], v[36:39], v[72:75]
    v_mfma_f32_16x16x32_bf16 v[76:79], v[244:247], v[36:39], v[76:79]
    ds_read_b128 v[36:39], v2 offset:19456
    s_waitcnt lgkmcnt(5)
    v_mfma_f32_16x16x32_bf16 v[64:67], v[248:251], v[40:43], v[64:67]
    s_add_u32 m0, s26, 61440
    s_add_u32 s30, s33, 135168
    buffer_load_dwordx4 v2, s[8:11], s30 offen sc1 lds
    v_mfma_f32_16x16x32_bf16 v[68:71], v[252:255], v[40:43], v[68:71]
    ds_read_b128 v[40:43], v2 offset:2048
    s_waitcnt lgkmcnt(5)
    v_mfma_f32_16x16x32_bf16 v[72:75], v[248:251], v[44:47], v[72:75]
    v_mfma_f32_16x16x32_bf16 v[76:79], v[252:255], v[44:47], v[76:79]
    ds_read_b128 v[44:47], v2 offset:20480
    s_waitcnt lgkmcnt(5)
    v_mfma_f32_16x16x32_bf16 v[80:83], v[112:115], v[24:27], 0
    ds_read_b64 v[16:17], v8 offset:256
    ds_read_b32 v18, v9 offset:128
    ds_read_b64 v[20:21], v8 offset:384
    ds_read_b32 v22, v9 offset:192
    v_mul_f32 v68, v64, v68
    v_mfma_f32_16x16x32_bf16 v[84:87], v[116:119], v[24:27], 0
    v_mul_f32 v69, v65, v69
    v_mul_f32 v70, v66, v70
    ds_read_b128 v[24:27], v2 offset:3072
    s_waitcnt lgkmcnt(9)
    v_mfma_f32_16x16x32_bf16 v[88:91], v[112:115], v[28:31], 0
    v_mul_f32 v71, v67, v71
    s_cmp_ge_u32 s20, 4
    s_cbranch_scc1 k234_mid_kernel_sk4
    s_add_u32 m0, s26, 69632
    s_add_u32 s30, s33, 143360
    buffer_load_dwordx4 v2, s[8:11], s30 offen sc1 lds
k234_mid_kernel_sk4:
    v_mfma_f32_16x16x32_bf16 v[92:95], v[116:119], v[28:31], 0
    v_mul_f32 v12, v64, v64
    v_mul_f32 v13, v65, v65
    ds_read_b128 v[28:31], v2 offset:21504
    s_waitcnt lgkmcnt(9)
    v_mfma_f32_16x16x32_bf16 v[80:83], v[120:123], v[32:35], v[80:83]
    v_mul_f32 v14, v66, v66
    v_mul_f32 v15, v67, v67
    s_waitcnt lgkmcnt(4)
    v_mfma_f32_16x16x32_bf16 v[84:87], v[124:127], v[32:35], v[84:87]
    v_fma_f32 v12, v12, v17, v16
    ds_read_b128 v[32:35], v2 offset:4096
    v_mfma_f32_16x16x32_bf16 v[88:91], v[120:123], v[36:39], v[88:91]
    v_fma_f32 v13, v13, v17, v16
    v_fma_f32 v14, v14, v17, v16
    v_mfma_f32_16x16x32_bf16 v[92:95], v[124:127], v[36:39], v[92:95]
    v_fma_f32 v15, v15, v17, v16
    v_mul_f32 v64, v64, v12
    ds_read_b128 v[36:39], v2 offset:22528
    v_mfma_f32_16x16x32_bf16 v[80:83], v[128:131], v[40:43], v[80:83]
    v_mul_f32 v65, v65, v13
    v_mfma_f32_16x16x32_bf16 v[84:87], v[132:135], v[40:43], v[84:87]
    v_mul_f32 v66, v66, v14
    v_mul_f32 v67, v67, v15
    ds_read_b128 v[40:43], v2 offset:5120
    v_mfma_f32_16x16x32_bf16 v[88:91], v[128:131], v[44:47], v[88:91]
    v_mfma_f32_16x16x32_bf16 v[92:95], v[132:135], v[44:47], v[92:95]
    v_exp_f32 v64, v64
    ds_read_b128 v[44:47], v2 offset:23552
    s_waitcnt lgkmcnt(5)
    v_mfma_f32_16x16x32_bf16 v[80:83], v[136:139], v[24:27], v[80:83]
    v_exp_f32 v65, v65
    v_mfma_f32_16x16x32_bf16 v[84:87], v[140:143], v[24:27], v[84:87]
    v_exp_f32 v66, v66
    ds_read_b128 v[24:27], v2 offset:6144
    s_waitcnt lgkmcnt(5)
    v_mfma_f32_16x16x32_bf16 v[88:91], v[136:139], v[28:31], v[88:91]
    v_mfma_f32_16x16x32_bf16 v[92:95], v[140:143], v[28:31], v[92:95]
    v_exp_f32 v67, v67
    v_fma_f32 v64, v64, v18, v18
    ds_read_b128 v[28:31], v2 offset:24576
    s_waitcnt lgkmcnt(5)
    v_mfma_f32_16x16x32_bf16 v[80:83], v[144:147], v[32:35], v[80:83]
    v_fma_f32 v65, v65, v18, v18
    v_mfma_f32_16x16x32_bf16 v[84:87], v[148:151], v[32:35], v[84:87]
    v_fma_f32 v66, v66, v18, v18
    v_fma_f32 v67, v67, v18, v18
    ds_read_b128 v[32:35], v2 offset:7168
    s_waitcnt lgkmcnt(5)
    v_mfma_f32_16x16x32_bf16 v[88:91], v[144:147], v[36:39], v[88:91]
    v_mfma_f32_16x16x32_bf16 v[92:95], v[148:151], v[36:39], v[92:95]
    v_rcp_f32 v64, v64
    ds_read_b128 v[36:39], v2 offset:25600
    s_waitcnt lgkmcnt(5)
    v_mfma_f32_16x16x32_bf16 v[80:83], v[152:155], v[40:43], v[80:83]
    v_rcp_f32 v65, v65
    v_mfma_f32_16x16x32_bf16 v[84:87], v[156:159], v[40:43], v[84:87]
    v_rcp_f32 v66, v66
    ds_read_b128 v[40:43], v2 offset:8192
    s_waitcnt lgkmcnt(5)
    v_mfma_f32_16x16x32_bf16 v[88:91], v[152:155], v[44:47], v[88:91]
    v_mfma_f32_16x16x32_bf16 v[92:95], v[156:159], v[44:47], v[92:95]
    v_rcp_f32 v67, v67
    v_mul_f32 v68, v68, v64
    ds_read_b128 v[44:47], v2 offset:26624
    s_waitcnt lgkmcnt(5)
    v_mfma_f32_16x16x32_bf16 v[80:83], v[160:163], v[24:27], v[80:83]
    v_mul_f32 v69, v69, v65
    v_mfma_f32_16x16x32_bf16 v[84:87], v[164:167], v[24:27], v[84:87]
    v_mul_f32 v70, v70, v66
    v_mul_f32 v71, v71, v67
    ds_read_b128 v[24:27], v2 offset:9216
    s_waitcnt lgkmcnt(5)
    v_mfma_f32_16x16x32_bf16 v[88:91], v[160:163], v[28:31], v[88:91]
    v_mul_f32 v76, v72, v76
    v_mfma_f32_16x16x32_bf16 v[92:95], v[164:167], v[28:31], v[92:95]
    v_mul_f32 v77, v73, v77
    v_mul_f32 v78, v74, v78
    ds_read_b128 v[28:31], v2 offset:27648
    s_waitcnt lgkmcnt(5)
    v_mfma_f32_16x16x32_bf16 v[80:83], v[168:171], v[32:35], v[80:83]
    v_mul_f32 v79, v75, v79
    v_mul_f32 v12, v72, v72
    v_mfma_f32_16x16x32_bf16 v[84:87], v[172:175], v[32:35], v[84:87]
    v_mul_f32 v13, v73, v73
    ds_read_b128 v[32:35], v2 offset:10240
    s_waitcnt lgkmcnt(5)
    v_mfma_f32_16x16x32_bf16 v[88:91], v[168:171], v[36:39], v[88:91]
    v_mul_f32 v14, v74, v74
    v_mul_f32 v15, v75, v75
    v_mfma_f32_16x16x32_bf16 v[92:95], v[172:175], v[36:39], v[92:95]
    v_fma_f32 v12, v12, v21, v20
    v_fma_f32 v13, v13, v21, v20
    ds_read_b128 v[36:39], v2 offset:28672
    s_waitcnt lgkmcnt(5)
    v_mfma_f32_16x16x32_bf16 v[80:83], v[176:179], v[40:43], v[80:83]
    v_fma_f32 v14, v14, v21, v20
    v_mfma_f32_16x16x32_bf16 v[84:87], v[180:183], v[40:43], v[84:87]
    v_fma_f32 v15, v15, v21, v20
    v_mul_f32 v72, v72, v12
    ds_read_b128 v[40:43], v2 offset:11264
    s_waitcnt lgkmcnt(5)
    v_mfma_f32_16x16x32_bf16 v[88:91], v[176:179], v[44:47], v[88:91]
    v_mul_f32 v73, v73, v13
    v_mfma_f32_16x16x32_bf16 v[92:95], v[180:183], v[44:47], v[92:95]
    v_mul_f32 v74, v74, v14
    v_mul_f32 v75, v75, v15
    ds_read_b128 v[44:47], v2 offset:29696
    s_waitcnt lgkmcnt(5)
    v_mfma_f32_16x16x32_bf16 v[80:83], v[184:187], v[24:27], v[80:83]
    v_exp_f32 v72, v72
    v_mfma_f32_16x16x32_bf16 v[84:87], v[188:191], v[24:27], v[84:87]
    ds_read_b128 v[24:27], v2 offset:12288
    s_waitcnt lgkmcnt(5)
    v_mfma_f32_16x16x32_bf16 v[88:91], v[184:187], v[28:31], v[88:91]
    v_exp_f32 v73, v73
    v_mfma_f32_16x16x32_bf16 v[92:95], v[188:191], v[28:31], v[92:95]
    v_exp_f32 v74, v74
    ds_read_b128 v[28:31], v2 offset:30720
    s_waitcnt lgkmcnt(5)
    v_mfma_f32_16x16x32_bf16 v[80:83], v[192:195], v[32:35], v[80:83]
    v_exp_f32 v75, v75
    v_mfma_f32_16x16x32_bf16 v[84:87], v[196:199], v[32:35], v[84:87]
    v_fma_f32 v72, v72, v22, v22
    ds_read_b128 v[32:35], v2 offset:13312
    s_waitcnt lgkmcnt(5)
    v_mfma_f32_16x16x32_bf16 v[88:91], v[192:195], v[36:39], v[88:91]
    v_fma_f32 v73, v73, v22, v22
    v_fma_f32 v74, v74, v22, v22
    v_mfma_f32_16x16x32_bf16 v[92:95], v[196:199], v[36:39], v[92:95]
    v_fma_f32 v75, v75, v22, v22
    ds_read_b128 v[36:39], v2 offset:31744
    s_waitcnt lgkmcnt(5)
    v_mfma_f32_16x16x32_bf16 v[80:83], v[200:203], v[40:43], v[80:83]
    v_rcp_f32 v72, v72
    v_mfma_f32_16x16x32_bf16 v[84:87], v[204:207], v[40:43], v[84:87]
    v_rcp_f32 v73, v73
    ds_read_b128 v[40:43], v2 offset:14336
    s_waitcnt lgkmcnt(5)
    v_mfma_f32_16x16x32_bf16 v[88:91], v[200:203], v[44:47], v[88:91]
    v_rcp_f32 v74, v74
    v_mfma_f32_16x16x32_bf16 v[92:95], v[204:207], v[44:47], v[92:95]
    ds_read_b128 v[44:47], v2 offset:32768
    s_waitcnt vmcnt(0)
    s_barrier
    s_waitcnt lgkmcnt(5)
    v_mfma_f32_16x16x32_bf16 v[80:83], v[208:211], v[24:27], v[80:83]
    v_rcp_f32 v75, v75
    v_mul_f32 v76, v76, v72
    v_mfma_f32_16x16x32_bf16 v[84:87], v[212:215], v[24:27], v[84:87]
    v_mul_f32 v77, v77, v73
    ds_read_b128 v[24:27], v2 offset:15360
    s_waitcnt lgkmcnt(5)
    v_mfma_f32_16x16x32_bf16 v[88:91], v[208:211], v[28:31], v[88:91]
    v_mul_f32 v78, v78, v74
    v_mul_f32 v79, v79, v75
    s_add_u32 m0, s26, 73728
    s_add_u32 s30, s33, 147456
    buffer_load_dwordx4 v2, s[8:11], s30 offen sc1 lds
    v_mfma_f32_16x16x32_bf16 v[92:95], v[212:215], v[28:31], v[92:95]
    v_cvt_pk_bf16_f32 v64, v68, v69
    ds_read_b128 v[28:31], v2 offset:33792
    s_waitcnt lgkmcnt(5)
    v_mfma_f32_16x16x32_bf16 v[80:83], v[216:219], v[32:35], v[80:83]
    v_cvt_pk_bf16_f32 v65, v70, v71
    v_cvt_pk_bf16_f32 v66, v76, v77
    v_mfma_f32_16x16x32_bf16 v[84:87], v[220:223], v[32:35], v[84:87]
    v_cvt_pk_bf16_f32 v67, v78, v79
    s_add_u32 s31, s27, 294912
    v_permlane16_swap_b32 v64, v66
    ds_read_b128 v[32:35], v2 offset:16384
    s_waitcnt lgkmcnt(5)
    v_mfma_f32_16x16x32_bf16 v[88:91], v[216:219], v[36:39], v[88:91]
    v_permlane16_swap_b32 v65, v67
    buffer_store_dwordx4 v[64:67], v7, s[8:11], s31 offen sc1
    v_mfma_f32_16x16x32_bf16 v[92:95], v[220:223], v[36:39], v[92:95]
    ds_read_b128 v[36:39], v2 offset:34816
    s_waitcnt lgkmcnt(5)
    v_mfma_f32_16x16x32_bf16 v[80:83], v[224:227], v[40:43], v[80:83]
    s_add_u32 m0, s26, 81920
    s_add_u32 s30, s33, 155648
    buffer_load_dwordx4 v2, s[8:11], s30 offen sc1 lds
    v_mfma_f32_16x16x32_bf16 v[84:87], v[228:231], v[40:43], v[84:87]
    ds_read_b128 v[40:43], v2 offset:17408
    s_waitcnt lgkmcnt(5)
    v_mfma_f32_16x16x32_bf16 v[88:91], v[224:227], v[44:47], v[88:91]
    v_mfma_f32_16x16x32_bf16 v[92:95], v[228:231], v[44:47], v[92:95]
    ds_read_b128 v[44:47], v2 offset:35840
    s_waitcnt lgkmcnt(5)
    v_mfma_f32_16x16x32_bf16 v[80:83], v[232:235], v[24:27], v[80:83]
    v_mfma_f32_16x16x32_bf16 v[84:87], v[236:239], v[24:27], v[84:87]
    ds_read_b128 v[24:27], v2 offset:36864
    s_waitcnt lgkmcnt(5)
    v_mfma_f32_16x16x32_bf16 v[88:91], v[232:235], v[28:31], v[88:91]
    s_add_u32 m0, s26, 90112
    s_add_u32 s30, s33, 163840
    buffer_load_dwordx4 v2, s[8:11], s30 offen sc1 lds
    v_mfma_f32_16x16x32_bf16 v[92:95], v[236:239], v[28:31], v[92:95]
    ds_read_b128 v[28:31], v5 offset:6144
    s_waitcnt lgkmcnt(5)
    v_mfma_f32_16x16x32_bf16 v[80:83], v[240:243], v[32:35], v[80:83]
    v_mfma_f32_16x16x32_bf16 v[84:87], v[244:247], v[32:35], v[84:87]
    ds_read_b128 v[32:35], v2 offset:37888
    s_waitcnt lgkmcnt(5)
    v_mfma_f32_16x16x32_bf16 v[88:91], v[240:243], v[36:39], v[88:91]
    v_mfma_f32_16x16x32_bf16 v[92:95], v[244:247], v[36:39], v[92:95]
    ds_read_b128 v[36:39], v5 offset:7168
    s_waitcnt lgkmcnt(5)
    v_mfma_f32_16x16x32_bf16 v[80:83], v[248:251], v[40:43], v[80:83]
    s_add_u32 m0, s26, 98304
    s_add_u32 s30, s33, 172032
    buffer_load_dwordx4 v2, s[8:11], s30 offen sc1 lds
    v_mfma_f32_16x16x32_bf16 v[84:87], v[252:255], v[40:43], v[84:87]
    ds_read_b128 v[40:43], v2 offset:38912
    s_waitcnt lgkmcnt(5)
    v_mfma_f32_16x16x32_bf16 v[88:91], v[248:251], v[44:47], v[88:91]
    v_mfma_f32_16x16x32_bf16 v[92:95], v[252:255], v[44:47], v[92:95]
    ds_read_b128 v[44:47], v5 offset:8192
    s_waitcnt lgkmcnt(5)
    v_mfma_f32_16x16x32_bf16 v[96:99], v[112:115], v[24:27], 0
    ds_read_b64 v[16:17], v8 offset:512
    ds_read_b32 v18, v9 offset:256
    ds_read_b64 v[20:21], v8 offset:640
    ds_read_b32 v22, v9 offset:320
    v_mul_f32 v84, v80, v84
    v_mfma_f32_16x16x32_bf16 v[100:103], v[116:119], v[24:27], 0
    v_mul_f32 v85, v81, v85
    v_mul_f32 v86, v82, v86
    ds_read_b128 v[24:27], v2 offset:39936
    s_waitcnt lgkmcnt(9)
    v_mfma_f32_16x16x32_bf16 v[104:107], v[112:115], v[28:31], 0
    v_mul_f32 v87, v83, v87
    s_cmp_ge_u32 s20, 4
    s_cbranch_scc1 k234_mid_kernel_sk5
    s_add_u32 m0, s26, 106496
    s_add_u32 s30, s33, 180224
    buffer_load_dwordx4 v2, s[8:11], s30 offen sc1 lds
k234_mid_kernel_sk5:
    v_mfma_f32_16x16x32_bf16 v[108:111], v[116:119], v[28:31], 0
    v_mul_f32 v12, v80, v80
    v_mul_f32 v13, v81, v81
    ds_read_b128 v[28:31], v5 offset:9216
    s_waitcnt lgkmcnt(9)
    v_mfma_f32_16x16x32_bf16 v[96:99], v[120:123], v[32:35], v[96:99]
    v_mul_f32 v14, v82, v82
    v_mul_f32 v15, v83, v83
    s_waitcnt lgkmcnt(4)
    v_mfma_f32_16x16x32_bf16 v[100:103], v[124:127], v[32:35], v[100:103]
    v_fma_f32 v12, v12, v17, v16
    ds_read_b128 v[32:35], v2 offset:40960
    v_mfma_f32_16x16x32_bf16 v[104:107], v[120:123], v[36:39], v[104:107]
    v_fma_f32 v13, v13, v17, v16
    v_fma_f32 v14, v14, v17, v16
    v_mfma_f32_16x16x32_bf16 v[108:111], v[124:127], v[36:39], v[108:111]
    v_fma_f32 v15, v15, v17, v16
    v_mul_f32 v80, v80, v12
    ds_read_b128 v[36:39], v5 offset:10240
    v_mfma_f32_16x16x32_bf16 v[96:99], v[128:131], v[40:43], v[96:99]
    v_mul_f32 v81, v81, v13
    v_mfma_f32_16x16x32_bf16 v[100:103], v[132:135], v[40:43], v[100:103]
    v_mul_f32 v82, v82, v14
    v_mul_f32 v83, v83, v15
    ds_read_b128 v[40:43], v2 offset:41984
    v_mfma_f32_16x16x32_bf16 v[104:107], v[128:131], v[44:47], v[104:107]
    v_mfma_f32_16x16x32_bf16 v[108:111], v[132:135], v[44:47], v[108:111]
    v_exp_f32 v80, v80
    ds_read_b128 v[44:47], v5 offset:11264
    s_waitcnt lgkmcnt(5)
    v_mfma_f32_16x16x32_bf16 v[96:99], v[136:139], v[24:27], v[96:99]
    v_exp_f32 v81, v81
    v_mfma_f32_16x16x32_bf16 v[100:103], v[140:143], v[24:27], v[100:103]
    v_exp_f32 v82, v82
    ds_read_b128 v[24:27], v2 offset:43008
    s_waitcnt lgkmcnt(5)
    v_mfma_f32_16x16x32_bf16 v[104:107], v[136:139], v[28:31], v[104:107]
    v_mfma_f32_16x16x32_bf16 v[108:111], v[140:143], v[28:31], v[108:111]
    v_exp_f32 v83, v83
    v_fma_f32 v80, v80, v18, v18
    ds_read_b128 v[28:31], v5 offset:12288
    s_waitcnt lgkmcnt(5)
    v_mfma_f32_16x16x32_bf16 v[96:99], v[144:147], v[32:35], v[96:99]
    v_fma_f32 v81, v81, v18, v18
    v_mfma_f32_16x16x32_bf16 v[100:103], v[148:151], v[32:35], v[100:103]
    v_fma_f32 v82, v82, v18, v18
    v_fma_f32 v83, v83, v18, v18
    ds_read_b128 v[32:35], v2 offset:44032
    s_waitcnt lgkmcnt(5)
    v_mfma_f32_16x16x32_bf16 v[104:107], v[144:147], v[36:39], v[104:107]
    v_mfma_f32_16x16x32_bf16 v[108:111], v[148:151], v[36:39], v[108:111]
    v_rcp_f32 v80, v80
    ds_read_b128 v[36:39], v5 offset:13312
    s_waitcnt lgkmcnt(5)
    v_mfma_f32_16x16x32_bf16 v[96:99], v[152:155], v[40:43], v[96:99]
    v_rcp_f32 v81, v81
    v_mfma_f32_16x16x32_bf16 v[100:103], v[156:159], v[40:43], v[100:103]
    v_rcp_f32 v82, v82
    ds_read_b128 v[40:43], v2 offset:45056
    s_waitcnt lgkmcnt(5)
    v_mfma_f32_16x16x32_bf16 v[104:107], v[152:155], v[44:47], v[104:107]
    v_mfma_f32_16x16x32_bf16 v[108:111], v[156:159], v[44:47], v[108:111]
    v_rcp_f32 v83, v83
    v_mul_f32 v84, v84, v80
    ds_read_b128 v[44:47], v5 offset:14336
    s_waitcnt lgkmcnt(5)
    v_mfma_f32_16x16x32_bf16 v[96:99], v[160:163], v[24:27], v[96:99]
    v_mul_f32 v85, v85, v81
    v_mfma_f32_16x16x32_bf16 v[100:103], v[164:167], v[24:27], v[100:103]
    v_mul_f32 v86, v86, v82
    v_mul_f32 v87, v87, v83
    ds_read_b128 v[24:27], v2 offset:46080
    s_waitcnt lgkmcnt(5)
    v_mfma_f32_16x16x32_bf16 v[104:107], v[160:163], v[28:31], v[104:107]
    v_mul_f32 v92, v88, v92
    v_mfma_f32_16x16x32_bf16 v[108:111], v[164:167], v[28:31], v[108:111]
    v_mul_f32 v93, v89, v93
    v_mul_f32 v94, v90, v94
    ds_read_b128 v[28:31], v5 offset:15360
    s_waitcnt lgkmcnt(5)
    v_mfma_f32_16x16x32_bf16 v[96:99], v[168:171], v[32:35], v[96:99]
    v_mul_f32 v95, v91, v95
    v_mul_f32 v12, v88, v88
    v_mfma_f32_16x16x32_bf16 v[100:103], v[172:175], v[32:35], v[100:103]
    v_mul_f32 v13, v89, v89
    ds_read_b128 v[32:35], v2 offset:47104
    s_waitcnt lgkmcnt(5)
    v_mfma_f32_16x16x32_bf16 v[104:107], v[168:171], v[36:39], v[104:107]
    v_mul_f32 v14, v90, v90
    v_mul_f32 v15, v91, v91
    v_mfma_f32_16x16x32_bf16 v[108:111], v[172:175], v[36:39], v[108:111]
    v_fma_f32 v12, v12, v21, v20
    v_fma_f32 v13, v13, v21, v20
    ds_read_b128 v[36:39], v5 offset:16384
    s_waitcnt lgkmcnt(5)
    v_mfma_f32_16x16x32_bf16 v[96:99], v[176:179], v[40:43], v[96:99]
    v_fma_f32 v14, v14, v21, v20
    v_mfma_f32_16x16x32_bf16 v[100:103], v[180:183], v[40:43], v[100:103]
    v_fma_f32 v15, v15, v21, v20
    v_mul_f32 v88, v88, v12
    ds_read_b128 v[40:43], v2 offset:48128
    s_waitcnt lgkmcnt(5)
    v_mfma_f32_16x16x32_bf16 v[104:107], v[176:179], v[44:47], v[104:107]
    v_mul_f32 v89, v89, v13
    v_mfma_f32_16x16x32_bf16 v[108:111], v[180:183], v[44:47], v[108:111]
    v_mul_f32 v90, v90, v14
    v_mul_f32 v91, v91, v15
    ds_read_b128 v[44:47], v5 offset:17408
    s_waitcnt lgkmcnt(5)
    v_mfma_f32_16x16x32_bf16 v[96:99], v[184:187], v[24:27], v[96:99]
    v_exp_f32 v88, v88
    v_mfma_f32_16x16x32_bf16 v[100:103], v[188:191], v[24:27], v[100:103]
    ds_read_b128 v[24:27], v5 offset:0
    s_waitcnt lgkmcnt(5)
    v_mfma_f32_16x16x32_bf16 v[104:107], v[184:187], v[28:31], v[104:107]
    v_exp_f32 v89, v89
    v_mfma_f32_16x16x32_bf16 v[108:111], v[188:191], v[28:31], v[108:111]
    v_exp_f32 v90, v90
    ds_read_b128 v[28:31], v5 offset:18432
    s_waitcnt lgkmcnt(5)
    v_mfma_f32_16x16x32_bf16 v[96:99], v[192:195], v[32:35], v[96:99]
    v_exp_f32 v91, v91
    v_mfma_f32_16x16x32_bf16 v[100:103], v[196:199], v[32:35], v[100:103]
    v_fma_f32 v88, v88, v22, v22
    ds_read_b128 v[32:35], v5 offset:1024
    s_waitcnt lgkmcnt(5)
    v_mfma_f32_16x16x32_bf16 v[104:107], v[192:195], v[36:39], v[104:107]
    v_fma_f32 v89, v89, v22, v22
    v_fma_f32 v90, v90, v22, v22
    v_mfma_f32_16x16x32_bf16 v[108:111], v[196:199], v[36:39], v[108:111]
    v_fma_f32 v91, v91, v22, v22
    ds_read_b128 v[36:39], v5 offset:19456
    s_waitcnt lgkmcnt(5)
    v_mfma_f32_16x16x32_bf16 v[96:99], v[200:203], v[40:43], v[96:99]
    v_rcp_f32 v88, v88
    v_mfma_f32_16x16x32_bf16 v[100:103], v[204:207], v[40:43], v[100:103]
    v_rcp_f32 v89, v89
    ds_read_b128 v[40:43], v5 offset:2048
    s_waitcnt lgkmcnt(5)
    v_mfma_f32_16x16x32_bf16 v[104:107], v[200:203], v[44:47], v[104:107]
    v_rcp_f32 v90, v90
    v_mfma_f32_16x16x32_bf16 v[108:111], v[204:207], v[44:47], v[108:111]
    ds_read_b128 v[44:47], v5 offset:20480
    s_waitcnt vmcnt(0)
    s_barrier
    s_waitcnt lgkmcnt(5)
    v_mfma_f32_16x16x32_bf16 v[96:99], v[208:211], v[24:27], v[96:99]
    v_rcp_f32 v91, v91
    v_mul_f32 v92, v92, v88
    v_mfma_f32_16x16x32_bf16 v[100:103], v[212:215], v[24:27], v[100:103]
    v_mul_f32 v93, v93, v89
    ds_read_b128 v[24:27], v5 offset:3072
    s_waitcnt lgkmcnt(5)
    v_mfma_f32_16x16x32_bf16 v[104:107], v[208:211], v[28:31], v[104:107]
    v_mul_f32 v94, v94, v90
    v_mul_f32 v95, v95, v91
    s_add_u32 m0, s26, 0
    s_add_u32 s30, s33, 184320
    buffer_load_dwordx4 v2, s[8:11], s30 offen sc1 lds
    v_mfma_f32_16x16x32_bf16 v[108:111], v[212:215], v[28:31], v[108:111]
    v_cvt_pk_bf16_f32 v80, v84, v85
    ds_read_b128 v[28:31], v5 offset:21504
    s_waitcnt lgkmcnt(5)
    v_mfma_f32_16x16x32_bf16 v[96:99], v[216:219], v[32:35], v[96:99]
    v_cvt_pk_bf16_f32 v81, v86, v87
    v_cvt_pk_bf16_f32 v82, v92, v93
    v_mfma_f32_16x16x32_bf16 v[100:103], v[220:223], v[32:35], v[100:103]
    v_cvt_pk_bf16_f32 v83, v94, v95
    s_add_u32 s31, s27, 589824
    v_permlane16_swap_b32 v80, v82
    ds_read_b128 v[32:35], v5 offset:4096
    s_waitcnt lgkmcnt(5)
    v_mfma_f32_16x16x32_bf16 v[104:107], v[216:219], v[36:39], v[104:107]
    v_permlane16_swap_b32 v81, v83
    buffer_store_dwordx4 v[80:83], v7, s[8:11], s31 offen sc1
    v_mfma_f32_16x16x32_bf16 v[108:111], v[220:223], v[36:39], v[108:111]
    ds_read_b128 v[36:39], v5 offset:22528
    s_waitcnt lgkmcnt(5)
    v_mfma_f32_16x16x32_bf16 v[96:99], v[224:227], v[40:43], v[96:99]
    s_add_u32 m0, s26, 8192
    s_add_u32 s30, s33, 192512
    buffer_load_dwordx4 v2, s[8:11], s30 offen sc1 lds
    v_mfma_f32_16x16x32_bf16 v[100:103], v[228:231], v[40:43], v[100:103]
    ds_read_b128 v[40:43], v5 offset:5120
    s_waitcnt lgkmcnt(5)
    v_mfma_f32_16x16x32_bf16 v[104:107], v[224:227], v[44:47], v[104:107]
    v_mfma_f32_16x16x32_bf16 v[108:111], v[228:231], v[44:47], v[108:111]
    ds_read_b128 v[44:47], v5 offset:23552
    s_waitcnt lgkmcnt(5)
    v_mfma_f32_16x16x32_bf16 v[96:99], v[232:235], v[24:27], v[96:99]
    v_mfma_f32_16x16x32_bf16 v[100:103], v[236:239], v[24:27], v[100:103]
    ds_read_b128 v[24:27], v5 offset:24576
    s_waitcnt lgkmcnt(5)
    v_mfma_f32_16x16x32_bf16 v[104:107], v[232:235], v[28:31], v[104:107]
    s_add_u32 m0, s26, 16384
    s_add_u32 s30, s33, 200704
    buffer_load_dwordx4 v2, s[8:11], s30 offen sc1 lds
    v_mfma_f32_16x16x32_bf16 v[108:111], v[236:239], v[28:31], v[108:111]
    ds_read_b128 v[28:31], v5 offset:43008
    s_waitcnt lgkmcnt(5)
    v_mfma_f32_16x16x32_bf16 v[96:99], v[240:243], v[32:35], v[96:99]
    v_mfma_f32_16x16x32_bf16 v[100:103], v[244:247], v[32:35], v[100:103]
    ds_read_b128 v[32:35], v5 offset:25600
    s_waitcnt lgkmcnt(5)
    v_mfma_f32_16x16x32_bf16 v[104:107], v[240:243], v[36:39], v[104:107]
    v_mfma_f32_16x16x32_bf16 v[108:111], v[244:247], v[36:39], v[108:111]
    ds_read_b128 v[36:39], v5 offset:44032
    s_waitcnt lgkmcnt(5)
    v_mfma_f32_16x16x32_bf16 v[96:99], v[248:251], v[40:43], v[96:99]
    s_add_u32 m0, s26, 24576
    s_add_u32 s30, s33, 208896
    buffer_load_dwordx4 v2, s[8:11], s30 offen sc1 lds
    v_mfma_f32_16x16x32_bf16 v[100:103], v[252:255], v[40:43], v[100:103]
    ds_read_b128 v[40:43], v5 offset:26624
    s_waitcnt lgkmcnt(5)
    v_mfma_f32_16x16x32_bf16 v[104:107], v[248:251], v[44:47], v[104:107]
    v_mfma_f32_16x16x32_bf16 v[108:111], v[252:255], v[44:47], v[108:111]
    ds_read_b128 v[44:47], v5 offset:45056
    s_waitcnt lgkmcnt(5)
    v_mfma_f32_16x16x32_bf16 v[48:51], v[112:115], v[24:27], 0
    ds_read_b64 v[16:17], v8 offset:768
    ds_read_b32 v18, v9 offset:384
    ds_read_b64 v[20:21], v8 offset:896
    ds_read_b32 v22, v9 offset:448
    v_mul_f32 v100, v96, v100
    v_mfma_f32_16x16x32_bf16 v[52:55], v[116:119], v[24:27], 0
    v_mul_f32 v101, v97, v101
    v_mul_f32 v102, v98, v102
    ds_read_b128 v[24:27], v5 offset:27648
    s_waitcnt lgkmcnt(9)
    v_mfma_f32_16x16x32_bf16 v[56:59], v[112:115], v[28:31], 0
    v_mul_f32 v103, v99, v103
    s_cmp_ge_u32 s20, 4
    s_cbranch_scc1 k234_mid_kernel_sk6
    s_add_u32 m0, s26, 32768
    s_add_u32 s30, s33, 217088
    buffer_load_dwordx4 v2, s[8:11], s30 offen sc1 lds
k234_mid_kernel_sk6:
    v_mfma_f32_16x16x32_bf16 v[60:63], v[116:119], v[28:31], 0
    v_mul_f32 v12, v96, v96
    v_mul_f32 v13, v97, v97
    ds_read_b128 v[28:31], v5 offset:46080
    s_waitcnt lgkmcnt(9)
    v_mfma_f32_16x16x32_bf16 v[48:51], v[120:123], v[32:35], v[48:51]
    v_mul_f32 v14, v98, v98
    v_mul_f32 v15, v99, v99
    s_waitcnt lgkmcnt(4)
    v_mfma_f32_16x16x32_bf16 v[52:55], v[124:127], v[32:35], v[52:55]
    v_fma_f32 v12, v12, v17, v16
    ds_read_b128 v[32:35], v5 offset:28672
    v_mfma_f32_16x16x32_bf16 v[56:59], v[120:123], v[36:39], v[56:59]
    v_fma_f32 v13, v13, v17, v16
    v_fma_f32 v14, v14, v17, v16
    v_mfma_f32_16x16x32_bf16 v[60:63], v[124:127], v[36:39], v[60:63]
    v_fma_f32 v15, v15, v17, v16
    v_mul_f32 v96, v96, v12
    ds_read_b128 v[36:39], v5 offset:47104
    v_mfma_f32_16x16x32_bf16 v[48:51], v[128:131], v[40:43], v[48:51]
    v_mul_f32 v97, v97, v13
    v_mfma_f32_16x16x32_bf16 v[52:55], v[132:135], v[40:43], v[52:55]
    v_mul_f32 v98, v98, v14
    v_mul_f32 v99, v99, v15
    ds_read_b128 v[40:43], v5 offset:29696
    v_mfma_f32_16x16x32_bf16 v[56:59], v[128:131], v[44:47], v[56:59]
    v_mfma_f32_16x16x32_bf16 v[60:63], v[132:135], v[44:47], v[60:63]
    v_exp_f32 v96, v96
    ds_read_b128 v[44:47], v5 offset:48128
    s_waitcnt lgkmcnt(5)
    v_mfma_f32_16x16x32_bf16 v[48:51], v[136:139], v[24:27], v[48:51]
    v_exp_f32 v97, v97
    v_mfma_f32_16x16x32_bf16 v[52:55], v[140:143], v[24:27], v[52:55]
    v_exp_f32 v98, v98
    ds_read_b128 v[24:27], v5 offset:30720
    s_waitcnt lgkmcnt(5)
    v_mfma_f32_16x16x32_bf16 v[56:59], v[136:139], v[28:31], v[56:59]
    v_mfma_f32_16x16x32_bf16 v[60:63], v[140:143], v[28:31], v[60:63]
    v_exp_f32 v99, v99
    v_fma_f32 v96, v96, v18, v18
    ds_read_b128 v[28:31], v6 offset:0
    s_waitcnt lgkmcnt(5)
    v_mfma_f32_16x16x32_bf16 v[48:51], v[144:147], v[32:35], v[48:51]
    v_fma_f32 v97, v97, v18, v18
    v_mfma_f32_16x16x32_bf16 v[52:55], v[148:151], v[32:35], v[52:55]
    v_fma_f32 v98, v98, v18, v18
    v_fma_f32 v99, v99, v18, v18
    ds_read_b128 v[32:35], v5 offset:31744
    s_waitcnt lgkmcnt(5)
    v_mfma_f32_16x16x32_bf16 v[56:59], v[144:147], v[36:39], v[56:59]
    v_mfma_f32_16x16x32_bf16 v[60:63], v[148:151], v[36:39], v[60:63]
    v_rcp_f32 v96, v96
    ds_read_b128 v[36:39], v6 offset:1024
    s_waitcnt lgkmcnt(5)
    v_mfma_f32_16x16x32_bf16 v[48:51], v[152:155], v[40:43], v[48:51]
    v_rcp_f32 v97, v97
    v_mfma_f32_16x16x32_bf16 v[52:55], v[156:159], v[40:43], v[52:55]
    v_rcp_f32 v98, v98
    ds_read_b128 v[40:43], v5 offset:32768
    s_waitcnt lgkmcnt(5)
    v_mfma_f32_16x16x32_bf16 v[56:59], v[152:155], v[44:47], v[56:59]
    v_mfma_f32_16x16x32_bf16 v[60:63], v[156:159], v[44:47], v[60:63]
    v_rcp_f32 v99, v99
    v_mul_f32 v100, v100, v96
    ds_read_b128 v[44:47], v6 offset:2048
    s_waitcnt lgkmcnt(5)
    v_mfma_f32_16x16x32_bf16 v[48:51], v[160:163], v[24:27], v[48:51]
    v_mul_f32 v101, v101, v97
    v_mfma_f32_16x16x32_bf16 v[52:55], v[164:167], v[24:27], v[52:55]
    v_mul_f32 v102, v102, v98
    v_mul_f32 v103, v103, v99
    ds_read_b128 v[24:27], v5 offset:33792
    s_waitcnt lgkmcnt(5)
    v_mfma_f32_16x16x32_bf16 v[56:59], v[160:163], v[28:31], v[56:59]
    v_mul_f32 v108, v104, v108
    v_mfma_f32_16x16x32_bf16 v[60:63], v[164:167], v[28:31], v[60:63]
    v_mul_f32 v109, v105, v109
    v_mul_f32 v110, v106, v110
    ds_read_b128 v[28:31], v6 offset:3072
    s_waitcnt lgkmcnt(5)
    v_mfma_f32_16x16x32_bf16 v[48:51], v[168:171], v[32:35], v[48:51]
    v_mul_f32 v111, v107, v111
    v_mul_f32 v12, v104, v104
    v_mfma_f32_16x16x32_bf16 v[52:55], v[172:175], v[32:35], v[52:55]
    v_mul_f32 v13, v105, v105
    ds_read_b128 v[32:35], v5 offset:34816
    s_waitcnt lgkmcnt(5)
    v_mfma_f32_16x16x32_bf16 v[56:59], v[168:171], v[36:39], v[56:59]
    v_mul_f32 v14, v106, v106
    v_mul_f32 v15, v107, v107
    v_mfma_f32_16x16x32_bf16 v[60:63], v[172:175], v[36:39], v[60:63]
    v_fma_f32 v12, v12, v21, v20
    v_fma_f32 v13, v13, v21, v20
    ds_read_b128 v[36:39], v6 offset:4096
    s_waitcnt lgkmcnt(5)
    v_mfma_f32_16x16x32_bf16 v[48:51], v[176:179], v[40:43], v[48:51]
    v_fma_f32 v14, v14, v21, v20
    v_mfma_f32_16x16x32_bf16 v[52:55], v[180:183], v[40:43], v[52:55]
    v_fma_f32 v15, v15, v21, v20
    v_mul_f32 v104, v104, v12
    ds_read_b128 v[40:43], v5 offset:35840
    s_waitcnt lgkmcnt(5)
    v_mfma_f32_16x16x32_bf16 v[56:59], v[176:179], v[44:47], v[56:59]
    v_mul_f32 v105, v105, v13
    v_mfma_f32_16x16x32_bf16 v[60:63], v[180:183], v[44:47], v[60:63]
    v_mul_f32 v106, v106, v14
    v_mul_f32 v107, v107, v15
    ds_read_b128 v[44:47], v6 offset:5120
    s_waitcnt lgkmcnt(5)
    v_mfma_f32_16x16x32_bf16 v[48:51], v[184:187], v[24:27], v[48:51]
    v_exp_f32 v104, v104
    v_mfma_f32_16x16x32_bf16 v[52:55], v[188:191], v[24:27], v[52:55]
    ds_read_b128 v[24:27], v5 offset:36864
    s_waitcnt lgkmcnt(5)
    v_mfma_f32_16x16x32_bf16 v[56:59], v[184:187], v[28:31], v[56:59]
    v_exp_f32 v105, v105
    v_mfma_f32_16x16x32_bf16 v[60:63], v[188:191], v[28:31], v[60:63]
    v_exp_f32 v106, v106
    ds_read_b128 v[28:31], v6 offset:6144
    s_waitcnt lgkmcnt(5)
    v_mfma_f32_16x16x32_bf16 v[48:51], v[192:195], v[32:35], v[48:51]
    v_exp_f32 v107, v107
    v_mfma_f32_16x16x32_bf16 v[52:55], v[196:199], v[32:35], v[52:55]
    v_fma_f32 v104, v104, v22, v22
    ds_read_b128 v[32:35], v5 offset:37888
    s_waitcnt lgkmcnt(5)
    v_mfma_f32_16x16x32_bf16 v[56:59], v[192:195], v[36:39], v[56:59]
    v_fma_f32 v105, v105, v22, v22
    v_fma_f32 v106, v106, v22, v22
    v_mfma_f32_16x16x32_bf16 v[60:63], v[196:199], v[36:39], v[60:63]
    v_fma_f32 v107, v107, v22, v22
    ds_read_b128 v[36:39], v6 offset:7168
    s_waitcnt lgkmcnt(5)
    v_mfma_f32_16x16x32_bf16 v[48:51], v[200:203], v[40:43], v[48:51]
    v_rcp_f32 v104, v104
    v_mfma_f32_16x16x32_bf16 v[52:55], v[204:207], v[40:43], v[52:55]
    v_rcp_f32 v105, v105
    ds_read_b128 v[40:43], v5 offset:38912
    s_waitcnt lgkmcnt(5)
    v_mfma_f32_16x16x32_bf16 v[56:59], v[200:203], v[44:47], v[56:59]
    v_rcp_f32 v106, v106
    v_mfma_f32_16x16x32_bf16 v[60:63], v[204:207], v[44:47], v[60:63]
    ds_read_b128 v[44:47], v6 offset:8192
    s_waitcnt vmcnt(0)
    s_barrier
    s_waitcnt lgkmcnt(5)
    v_mfma_f32_16x16x32_bf16 v[48:51], v[208:211], v[24:27], v[48:51]
    v_rcp_f32 v107, v107
    v_mul_f32 v108, v108, v104
    v_mfma_f32_16x16x32_bf16 v[52:55], v[212:215], v[24:27], v[52:55]
    v_mul_f32 v109, v109, v105
    ds_read_b128 v[24:27], v5 offset:39936
    s_waitcnt lgkmcnt(5)
    v_mfma_f32_16x16x32_bf16 v[56:59], v[208:211], v[28:31], v[56:59]
    v_mul_f32 v110, v110, v106
    v_mul_f32 v111, v111, v107
    s_add_u32 m0, s26, 36864
    s_add_u32 s30, s33, 221184
    buffer_load_dwordx4 v2, s[8:11], s30 offen sc1 lds
    v_mfma_f32_16x16x32_bf16 v[60:63], v[212:215], v[28:31], v[60:63]
    v_cvt_pk_bf16_f32 v96, v100, v101
    ds_read_b128 v[28:31], v6 offset:9216
    s_waitcnt lgkmcnt(5)
    v_mfma_f32_16x16x32_bf16 v[48:51], v[216:219], v[32:35], v[48:51]
    v_cvt_pk_bf16_f32 v97, v102, v103
    v_cvt_pk_bf16_f32 v98, v108, v109
    v_mfma_f32_16x16x32_bf16 v[52:55], v[220:223], v[32:35], v[52:55]
    v_cvt_pk_bf16_f32 v99, v110, v111
    s_add_u32 s31, s27, 884736
    v_permlane16_swap_b32 v96, v98
    ds_read_b128 v[32:35], v5 offset:40960
    s_waitcnt lgkmcnt(5)
    v_mfma_f32_16x16x32_bf16 v[56:59], v[216:219], v[36:39], v[56:59]
    v_permlane16_swap_b32 v97, v99
    buffer_store_dwordx4 v[96:99], v7, s[8:11], s31 offen sc1
    v_mfma_f32_16x16x32_bf16 v[60:63], v[220:223], v[36:39], v[60:63]
    ds_read_b128 v[36:39], v6 offset:10240
    s_waitcnt lgkmcnt(5)
    v_mfma_f32_16x16x32_bf16 v[48:51], v[224:227], v[40:43], v[48:51]
    s_add_u32 m0, s26, 45056
    s_add_u32 s30, s33, 229376
    buffer_load_dwordx4 v2, s[8:11], s30 offen sc1 lds
    v_mfma_f32_16x16x32_bf16 v[52:55], v[228:231], v[40:43], v[52:55]
    ds_read_b128 v[40:43], v5 offset:41984
    s_waitcnt lgkmcnt(5)
    v_mfma_f32_16x16x32_bf16 v[56:59], v[224:227], v[44:47], v[56:59]
    v_mfma_f32_16x16x32_bf16 v[60:63], v[228:231], v[44:47], v[60:63]
    ds_read_b128 v[44:47], v6 offset:11264
    s_waitcnt lgkmcnt(5)
    v_mfma_f32_16x16x32_bf16 v[48:51], v[232:235], v[24:27], v[48:51]
    v_mfma_f32_16x16x32_bf16 v[52:55], v[236:239], v[24:27], v[52:55]
    ds_read_b128 v[24:27], v2 offset:0
    s_waitcnt lgkmcnt(5)
    v_mfma_f32_16x16x32_bf16 v[56:59], v[232:235], v[28:31], v[56:59]
    s_add_u32 m0, s26, 53248
    s_add_u32 s30, s33, 237568
    buffer_load_dwordx4 v2, s[8:11], s30 offen sc1 lds
    v_mfma_f32_16x16x32_bf16 v[60:63], v[236:239], v[28:31], v[60:63]
    ds_read_b128 v[28:31], v2 offset:18432
    s_waitcnt lgkmcnt(5)
    v_mfma_f32_16x16x32_bf16 v[48:51], v[240:243], v[32:35], v[48:51]
    v_mfma_f32_16x16x32_bf16 v[52:55], v[244:247], v[32:35], v[52:55]
    ds_read_b128 v[32:35], v2 offset:1024
    s_waitcnt lgkmcnt(5)
    v_mfma_f32_16x16x32_bf16 v[56:59], v[240:243], v[36:39], v[56:59]
    v_mfma_f32_16x16x32_bf16 v[60:63], v[244:247], v[36:39], v[60:63]
    ds_read_b128 v[36:39], v2 offset:19456
    s_waitcnt lgkmcnt(5)
    v_mfma_f32_16x16x32_bf16 v[48:51], v[248:251], v[40:43], v[48:51]
    s_add_u32 m0, s26, 61440
    s_add_u32 s30, s33, 245760
    buffer_load_dwordx4 v2, s[8:11], s30 offen sc1 lds
    v_mfma_f32_16x16x32_bf16 v[52:55], v[252:255], v[40:43], v[52:55]
    ds_read_b128 v[40:43], v2 offset:2048
    s_waitcnt lgkmcnt(5)
    v_mfma_f32_16x16x32_bf16 v[56:59], v[248:251], v[44:47], v[56:59]
    v_mfma_f32_16x16x32_bf16 v[60:63], v[252:255], v[44:47], v[60:63]
    ds_read_b128 v[44:47], v2 offset:20480
    s_waitcnt lgkmcnt(5)
    v_mfma_f32_16x16x32_bf16 v[64:67], v[112:115], v[24:27], 0
    ds_read_b64 v[16:17], v8 offset:1024
    ds_read_b32 v18, v9 offset:512
    ds_read_b64 v[20:21], v8 offset:1152
    ds_read_b32 v22, v9 offset:576
    v_mul_f32 v52, v48, v52
    v_mfma_f32_16x16x32_bf16 v[68:71], v[116:119], v[24:27], 0
    v_mul_f32 v53, v49, v53
    v_mul_f32 v54, v50, v54
    ds_read_b128 v[24:27], v2 offset:3072
    s_waitcnt lgkmcnt(9)
    v_mfma_f32_16x16x32_bf16 v[72:75], v[112:115], v[28:31], 0
    v_mul_f32 v55, v51, v55
    s_cmp_ge_u32 s20, 4
    s_cbranch_scc1 k234_mid_kernel_sk7
    s_add_u32 m0, s26, 69632
    s_add_u32 s30, s33, 253952
    buffer_load_dwordx4 v2, s[8:11], s30 offen sc1 lds
k234_mid_kernel_sk7:
    v_mfma_f32_16x16x32_bf16 v[76:79], v[116:119], v[28:31], 0
    v_mul_f32 v12, v48, v48
    v_mul_f32 v13, v49, v49
    ds_read_b128 v[28:31], v2 offset:21504
    s_waitcnt lgkmcnt(9)
    v_mfma_f32_16x16x32_bf16 v[64:67], v[120:123], v[32:35], v[64:67]
    v_mul_f32 v14, v50, v50
    v_mul_f32 v15, v51, v51
    s_waitcnt lgkmcnt(4)
    v_mfma_f32_16x16x32_bf16 v[68:71], v[124:127], v[32:35], v[68:71]
    v_fma_f32 v12, v12, v17, v16
    ds_read_b128 v[32:35], v2 offset:4096
    v_mfma_f32_16x16x32_bf16 v[72:75], v[120:123], v[36:39], v[72:75]
    v_fma_f32 v13, v13, v17, v16
    v_fma_f32 v14, v14, v17, v16
    v_mfma_f32_16x16x32_bf16 v[76:79], v[124:127], v[36:39], v[76:79]
    v_fma_f32 v15, v15, v17, v16
    v_mul_f32 v48, v48, v12
    ds_read_b128 v[36:39], v2 offset:22528
    v_mfma_f32_16x16x32_bf16 v[64:67], v[128:131], v[40:43], v[64:67]
    v_mul_f32 v49, v49, v13
    v_mfma_f32_16x16x32_bf16 v[68:71], v[132:135], v[40:43], v[68:71]
    v_mul_f32 v50, v50, v14
    v_mul_f32 v51, v51, v15
    ds_read_b128 v[40:43], v2 offset:5120
    v_mfma_f32_16x16x32_bf16 v[72:75], v[128:131], v[44:47], v[72:75]
    v_mfma_f32_16x16x32_bf16 v[76:79], v[132:135], v[44:47], v[76:79]
    v_exp_f32 v48, v48
    ds_read_b128 v[44:47], v2 offset:23552
    s_waitcnt lgkmcnt(5)
    v_mfma_f32_16x16x32_bf16 v[64:67], v[136:139], v[24:27], v[64:67]
    v_exp_f32 v49, v49
    v_mfma_f32_16x16x32_bf16 v[68:71], v[140:143], v[24:27], v[68:71]
    v_exp_f32 v50, v50
    ds_read_b128 v[24:27], v2 offset:6144
    s_waitcnt lgkmcnt(5)
    v_mfma_f32_16x16x32_bf16 v[72:75], v[136:139], v[28:31], v[72:75]
    v_mfma_f32_16x16x32_bf16 v[76:79], v[140:143], v[28:31], v[76:79]
    v_exp_f32 v51, v51
    v_fma_f32 v48, v48, v18, v18
    ds_read_b128 v[28:31], v2 offset:24576
    s_waitcnt lgkmcnt(5)
    v_mfma_f32_16x16x32_bf16 v[64:67], v[144:147], v[32:35], v[64:67]
    v_fma_f32 v49, v49, v18, v18
    v_mfma_f32_16x16x32_bf16 v[68:71], v[148:151], v[32:35], v[68:71]
    v_fma_f32 v50, v50, v18, v18
    v_fma_f32 v51, v51, v18, v18
    ds_read_b128 v[32:35], v2 offset:7168
    s_waitcnt lgkmcnt(5)
    v_mfma_f32_16x16x32_bf16 v[72:75], v[144:147], v[36:39], v[72:75]
    v_mfma_f32_16x16x32_bf16 v[76:79], v[148:151], v[36:39], v[76:79]
    v_rcp_f32 v48, v48
    ds_read_b128 v[36:39], v2 offset:25600
    s_waitcnt lgkmcnt(5)
    v_mfma_f32_16x16x32_bf16 v[64:67], v[152:155], v[40:43], v[64:67]
    v_rcp_f32 v49, v49
    v_mfma_f32_16x16x32_bf16 v[68:71], v[156:159], v[40:43], v[68:71]
    v_rcp_f32 v50, v50
    ds_read_b128 v[40:43], v2 offset:8192
    s_waitcnt lgkmcnt(5)
    v_mfma_f32_16x16x32_bf16 v[72:75], v[152:155], v[44:47], v[72:75]
    v_mfma_f32_16x16x32_bf16 v[76:79], v[156:159], v[44:47], v[76:79]
    v_rcp_f32 v51, v51
    v_mul_f32 v52, v52, v48
    ds_read_b128 v[44:47], v2 offset:26624
    s_waitcnt lgkmcnt(5)
    v_mfma_f32_16x16x32_bf16 v[64:67], v[160:163], v[24:27], v[64:67]
    v_mul_f32 v53, v53, v49
    v_mfma_f32_16x16x32_bf16 v[68:71], v[164:167], v[24:27], v[68:71]
    v_mul_f32 v54, v54, v50
    v_mul_f32 v55, v55, v51
    ds_read_b128 v[24:27], v2 offset:9216
    s_waitcnt lgkmcnt(5)
    v_mfma_f32_16x16x32_bf16 v[72:75], v[160:163], v[28:31], v[72:75]
    v_mul_f32 v60, v56, v60
    v_mfma_f32_16x16x32_bf16 v[76:79], v[164:167], v[28:31], v[76:79]
    v_mul_f32 v61, v57, v61
    v_mul_f32 v62, v58, v62
    ds_read_b128 v[28:31], v2 offset:27648
    s_waitcnt lgkmcnt(5)
    v_mfma_f32_16x16x32_bf16 v[64:67], v[168:171], v[32:35], v[64:67]
    v_mul_f32 v63, v59, v63
    v_mul_f32 v12, v56, v56
    v_mfma_f32_16x16x32_bf16 v[68:71], v[172:175], v[32:35], v[68:71]
    v_mul_f32 v13, v57, v57
    ds_read_b128 v[32:35], v2 offset:10240
    s_waitcnt lgkmcnt(5)
    v_mfma_f32_16x16x32_bf16 v[72:75], v[168:171], v[36:39], v[72:75]
    v_mul_f32 v14, v58, v58
    v_mul_f32 v15, v59, v59
    v_mfma_f32_16x16x32_bf16 v[76:79], v[172:175], v[36:39], v[76:79]
    v_fma_f32 v12, v12, v21, v20
    v_fma_f32 v13, v13, v21, v20
    ds_read_b128 v[36:39], v2 offset:28672
    s_waitcnt lgkmcnt(5)
    v_mfma_f32_16x16x32_bf16 v[64:67], v[176:179], v[40:43], v[64:67]
    v_fma_f32 v14, v14, v21, v20
    v_mfma_f32_16x16x32_bf16 v[68:71], v[180:183], v[40:43], v[68:71]
    v_fma_f32 v15, v15, v21, v20
    v_mul_f32 v56, v56, v12
    ds_read_b128 v[40:43], v2 offset:11264
    s_waitcnt lgkmcnt(5)
    v_mfma_f32_16x16x32_bf16 v[72:75], v[176:179], v[44:47], v[72:75]
    v_mul_f32 v57, v57, v13
    v_mfma_f32_16x16x32_bf16 v[76:79], v[180:183], v[44:47], v[76:79]
    v_mul_f32 v58, v58, v14
    v_mul_f32 v59, v59, v15
    ds_read_b128 v[44:47], v2 offset:29696
    s_waitcnt lgkmcnt(5)
    v_mfma_f32_16x16x32_bf16 v[64:67], v[184:187], v[24:27], v[64:67]
    v_exp_f32 v56, v56
    v_mfma_f32_16x16x32_bf16 v[68:71], v[188:191], v[24:27], v[68:71]
    ds_read_b128 v[24:27], v2 offset:12288
    s_waitcnt lgkmcnt(5)
    v_mfma_f32_16x16x32_bf16 v[72:75], v[184:187], v[28:31], v[72:75]
    v_exp_f32 v57, v57
    v_mfma_f32_16x16x32_bf16 v[76:79], v[188:191], v[28:31], v[76:79]
    v_exp_f32 v58, v58
    ds_read_b128 v[28:31], v2 offset:30720
    s_waitcnt lgkmcnt(5)
    v_mfma_f32_16x16x32_bf16 v[64:67], v[192:195], v[32:35], v[64:67]
    v_exp_f32 v59, v59
    v_mfma_f32_16x16x32_bf16 v[68:71], v[196:199], v[32:35], v[68:71]
    v_fma_f32 v56, v56, v22, v22
    ds_read_b128 v[32:35], v2 offset:13312
    s_waitcnt lgkmcnt(5)
    v_mfma_f32_16x16x32_bf16 v[72:75], v[192:195], v[36:39], v[72:75]
    v_fma_f32 v57, v57, v22, v22
    v_fma_f32 v58, v58, v22, v22
    v_mfma_f32_16x16x32_bf16 v[76:79], v[196:199], v[36:39], v[76:79]
    v_fma_f32 v59, v59, v22, v22
    ds_read_b128 v[36:39], v2 offset:31744
    s_waitcnt lgkmcnt(5)
    v_mfma_f32_16x16x32_bf16 v[64:67], v[200:203], v[40:43], v[64:67]
    v_rcp_f32 v56, v56
    v_mfma_f32_16x16x32_bf16 v[68:71], v[204:207], v[40:43], v[68:71]
    v_rcp_f32 v57, v57
    ds_read_b128 v[40:43], v2 offset:14336
    s_waitcnt lgkmcnt(5)
    v_mfma_f32_16x16x32_bf16 v[72:75], v[200:203], v[44:47], v[72:75]
    v_rcp_f32 v58, v58
    v_mfma_f32_16x16x32_bf16 v[76:79], v[204:207], v[44:47], v[76:79]
    ds_read_b128 v[44:47], v2 offset:32768
    s_waitcnt vmcnt(0)
    s_barrier
    s_waitcnt lgkmcnt(5)
    v_mfma_f32_16x16x32_bf16 v[64:67], v[208:211], v[24:27], v[64:67]
    v_rcp_f32 v59, v59
    v_mul_f32 v60, v60, v56
    v_mfma_f32_16x16x32_bf16 v[68:71], v[212:215], v[24:27], v[68:71]
    v_mul_f32 v61, v61, v57
    ds_read_b128 v[24:27], v2 offset:15360
    s_waitcnt lgkmcnt(5)
    v_mfma_f32_16x16x32_bf16 v[72:75], v[208:211], v[28:31], v[72:75]
    v_mul_f32 v62, v62, v58
    v_mul_f32 v63, v63, v59
    s_add_u32 m0, s26, 73728
    s_add_u32 s30, s33, 258048
    buffer_load_dwordx4 v2, s[8:11], s30 offen sc1 lds
    v_mfma_f32_16x16x32_bf16 v[76:79], v[212:215], v[28:31], v[76:79]
    v_cvt_pk_bf16_f32 v48, v52, v53
    ds_read_b128 v[28:31], v2 offset:33792
    s_waitcnt lgkmcnt(5)
    v_mfma_f32_16x16x32_bf16 v[64:67], v[216:219], v[32:35], v[64:67]
    v_cvt_pk_bf16_f32 v49, v54, v55
    v_cvt_pk_bf16_f32 v50, v60, v61
    v_mfma_f32_16x16x32_bf16 v[68:71], v[220:223], v[32:35], v[68:71]
    v_cvt_pk_bf16_f32 v51, v62, v63
    s_add_u32 s31, s27, 1179648
    v_permlane16_swap_b32 v48, v50
    ds_read_b128 v[32:35], v2 offset:16384
    s_waitcnt lgkmcnt(5)
    v_mfma_f32_16x16x32_bf16 v[72:75], v[216:219], v[36:39], v[72:75]
    v_permlane16_swap_b32 v49, v51
    buffer_store_dwordx4 v[48:51], v7, s[8:11], s31 offen sc1
    v_mfma_f32_16x16x32_bf16 v[76:79], v[220:223], v[36:39], v[76:79]
    ds_read_b128 v[36:39], v2 offset:34816
    s_waitcnt lgkmcnt(5)
    v_mfma_f32_16x16x32_bf16 v[64:67], v[224:227], v[40:43], v[64:67]
    s_add_u32 m0, s26, 81920
    s_add_u32 s30, s33, 266240
    buffer_load_dwordx4 v2, s[8:11], s30 offen sc1 lds
    v_mfma_f32_16x16x32_bf16 v[68:71], v[228:231], v[40:43], v[68:71]
    ds_read_b128 v[40:43], v2 offset:17408
    s_waitcnt lgkmcnt(5)
    v_mfma_f32_16x16x32_bf16 v[72:75], v[224:227], v[44:47], v[72:75]
    v_mfma_f32_16x16x32_bf16 v[76:79], v[228:231], v[44:47], v[76:79]
    ds_read_b128 v[44:47], v2 offset:35840
    s_waitcnt lgkmcnt(5)
    v_mfma_f32_16x16x32_bf16 v[64:67], v[232:235], v[24:27], v[64:67]
    v_mfma_f32_16x16x32_bf16 v[68:71], v[236:239], v[24:27], v[68:71]
    ds_read_b128 v[24:27], v2 offset:36864
    s_waitcnt lgkmcnt(5)
    v_mfma_f32_16x16x32_bf16 v[72:75], v[232:235], v[28:31], v[72:75]
    s_add_u32 m0, s26, 90112
    s_add_u32 s30, s33, 274432
    buffer_load_dwordx4 v2, s[8:11], s30 offen sc1 lds
    v_mfma_f32_16x16x32_bf16 v[76:79], v[236:239], v[28:31], v[76:79]
    ds_read_b128 v[28:31], v5 offset:6144
    s_waitcnt lgkmcnt(5)
    v_mfma_f32_16x16x32_bf16 v[64:67], v[240:243], v[32:35], v[64:67]
    v_mfma_f32_16x16x32_bf16 v[68:71], v[244:247], v[32:35], v[68:71]
    ds_read_b128 v[32:35], v2 offset:37888
    s_waitcnt lgkmcnt(5)
    v_mfma_f32_16x16x32_bf16 v[72:75], v[240:243], v[36:39], v[72:75]
    v_mfma_f32_16x16x32_bf16 v[76:79], v[244:247], v[36:39], v[76:79]
    ds_read_b128 v[36:39], v5 offset:7168
    s_waitcnt lgkmcnt(5)
    v_mfma_f32_16x16x32_bf16 v[64:67], v[248:251], v[40:43], v[64:67]
    s_add_u32 m0, s26, 98304
    s_add_u32 s30, s33, 282624
    buffer_load_dwordx4 v2, s[8:11], s30 offen sc1 lds
    v_mfma_f32_16x16x32_bf16 v[68:71], v[252:255], v[40:43], v[68:71]
    ds_read_b128 v[40:43], v2 offset:38912
    s_waitcnt lgkmcnt(5)
    v_mfma_f32_16x16x32_bf16 v[72:75], v[248:251], v[44:47], v[72:75]
    v_mfma_f32_16x16x32_bf16 v[76:79], v[252:255], v[44:47], v[76:79]
    ds_read_b128 v[44:47], v5 offset:8192
    s_waitcnt lgkmcnt(5)
    v_mfma_f32_16x16x32_bf16 v[80:83], v[112:115], v[24:27], 0
    ds_read_b64 v[16:17], v8 offset:1280
    ds_read_b32 v18, v9 offset:640
    ds_read_b64 v[20:21], v8 offset:1408
    ds_read_b32 v22, v9 offset:704
    v_mul_f32 v68, v64, v68
    v_mfma_f32_16x16x32_bf16 v[84:87], v[116:119], v[24:27], 0
    v_mul_f32 v69, v65, v69
    v_mul_f32 v70, v66, v70
    ds_read_b128 v[24:27], v2 offset:39936
    s_waitcnt lgkmcnt(9)
    v_mfma_f32_16x16x32_bf16 v[88:91], v[112:115], v[28:31], 0
    v_mul_f32 v71, v67, v71
    s_cmp_ge_u32 s20, 4
    s_cbranch_scc1 k234_mid_kernel_sk8
    s_add_u32 m0, s26, 106496
    s_add_u32 s30, s33, 290816
    buffer_load_dwordx4 v2, s[8:11], s30 offen sc1 lds
k234_mid_kernel_sk8:
    v_mfma_f32_16x16x32_bf16 v[92:95], v[116:119], v[28:31], 0
    v_mul_f32 v12, v64, v64
    v_mul_f32 v13, v65, v65
    ds_read_b128 v[28:31], v5 offset:9216
    s_waitcnt lgkmcnt(9)
    v_mfma_f32_16x16x32_bf16 v[80:83], v[120:123], v[32:35], v[80:83]
    v_mul_f32 v14, v66, v66
    v_mul_f32 v15, v67, v67
    s_waitcnt lgkmcnt(4)
    v_mfma_f32_16x16x32_bf16 v[84:87], v[124:127], v[32:35], v[84:87]
    v_fma_f32 v12, v12, v17, v16
    ds_read_b128 v[32:35], v2 offset:40960
    v_mfma_f32_16x16x32_bf16 v[88:91], v[120:123], v[36:39], v[88:91]
    v_fma_f32 v13, v13, v17, v16
    v_fma_f32 v14, v14, v17, v16
    v_mfma_f32_16x16x32_bf16 v[92:95], v[124:127], v[36:39], v[92:95]
    v_fma_f32 v15, v15, v17, v16
    v_mul_f32 v64, v64, v12
    ds_read_b128 v[36:39], v5 offset:10240
    v_mfma_f32_16x16x32_bf16 v[80:83], v[128:131], v[40:43], v[80:83]
    v_mul_f32 v65, v65, v13
    v_mfma_f32_16x16x32_bf16 v[84:87], v[132:135], v[40:43], v[84:87]
    v_mul_f32 v66, v66, v14
    v_mul_f32 v67, v67, v15
    ds_read_b128 v[40:43], v2 offset:41984
    v_mfma_f32_16x16x32_bf16 v[88:91], v[128:131], v[44:47], v[88:91]
    v_mfma_f32_16x16x32_bf16 v[92:95], v[132:135], v[44:47], v[92:95]
    v_exp_f32 v64, v64
    ds_read_b128 v[44:47], v5 offset:11264
    s_waitcnt lgkmcnt(5)
    v_mfma_f32_16x16x32_bf16 v[80:83], v[136:139], v[24:27], v[80:83]
    v_exp_f32 v65, v65
    v_mfma_f32_16x16x32_bf16 v[84:87], v[140:143], v[24:27], v[84:87]
    v_exp_f32 v66, v66
    ds_read_b128 v[24:27], v2 offset:43008
    s_waitcnt lgkmcnt(5)
    v_mfma_f32_16x16x32_bf16 v[88:91], v[136:139], v[28:31], v[88:91]
    v_mfma_f32_16x16x32_bf16 v[92:95], v[140:143], v[28:31], v[92:95]
    v_exp_f32 v67, v67
    v_fma_f32 v64, v64, v18, v18
    ds_read_b128 v[28:31], v5 offset:12288
    s_waitcnt lgkmcnt(5)
    v_mfma_f32_16x16x32_bf16 v[80:83], v[144:147], v[32:35], v[80:83]
    v_fma_f32 v65, v65, v18, v18
    v_mfma_f32_16x16x32_bf16 v[84:87], v[148:151], v[32:35], v[84:87]
    v_fma_f32 v66, v66, v18, v18
    v_fma_f32 v67, v67, v18, v18
    ds_read_b128 v[32:35], v2 offset:44032
    s_waitcnt lgkmcnt(5)
    v_mfma_f32_16x16x32_bf16 v[88:91], v[144:147], v[36:39], v[88:91]
    v_mfma_f32_16x16x32_bf16 v[92:95], v[148:151], v[36:39], v[92:95]
    v_rcp_f32 v64, v64
    ds_read_b128 v[36:39], v5 offset:13312
    s_waitcnt lgkmcnt(5)
    v_mfma_f32_16x16x32_bf16 v[80:83], v[152:155], v[40:43], v[80:83]
    v_rcp_f32 v65, v65
    v_mfma_f32_16x16x32_bf16 v[84:87], v[156:159], v[40:43], v[84:87]
    v_rcp_f32 v66, v66
    ds_read_b128 v[40:43], v2 offset:45056
    s_waitcnt lgkmcnt(5)
    v_mfma_f32_16x16x32_bf16 v[88:91], v[152:155], v[44:47], v[88:91]
    v_mfma_f32_16x16x32_bf16 v[92:95], v[156:159], v[44:47], v[92:95]
    v_rcp_f32 v67, v67
    v_mul_f32 v68, v68, v64
    ds_read_b128 v[44:47], v5 offset:14336
    s_waitcnt lgkmcnt(5)
    v_mfma_f32_16x16x32_bf16 v[80:83], v[160:163], v[24:27], v[80:83]
    v_mul_f32 v69, v69, v65
    v_mfma_f32_16x16x32_bf16 v[84:87], v[164:167], v[24:27], v[84:87]
    v_mul_f32 v70, v70, v66
    v_mul_f32 v71, v71, v67
    ds_read_b128 v[24:27], v2 offset:46080
    s_waitcnt lgkmcnt(5)
    v_mfma_f32_16x16x32_bf16 v[88:91], v[160:163], v[28:31], v[88:91]
    v_mul_f32 v76, v72, v76
    v_mfma_f32_16x16x32_bf16 v[92:95], v[164:167], v[28:31], v[92:95]
    v_mul_f32 v77, v73, v77
    v_mul_f32 v78, v74, v78
    ds_read_b128 v[28:31], v5 offset:15360
    s_waitcnt lgkmcnt(5)
    v_mfma_f32_16x16x32_bf16 v[80:83], v[168:171], v[32:35], v[80:83]
    v_mul_f32 v79, v75, v79
    v_mul_f32 v12, v72, v72
    v_mfma_f32_16x16x32_bf16 v[84:87], v[172:175], v[32:35], v[84:87]
    v_mul_f32 v13, v73, v73
    ds_read_b128 v[32:35], v2 offset:47104
    s_waitcnt lgkmcnt(5)
    v_mfma_f32_16x16x32_bf16 v[88:91], v[168:171], v[36:39], v[88:91]
    v_mul_f32 v14, v74, v74
    v_mul_f32 v15, v75, v75
    v_mfma_f32_16x16x32_bf16 v[92:95], v[172:175], v[36:39], v[92:95]
    v_fma_f32 v12, v12, v21, v20
    v_fma_f32 v13, v13, v21, v20
    ds_read_b128 v[36:39], v5 offset:16384
    s_waitcnt lgkmcnt(5)
    v_mfma_f32_16x16x32_bf16 v[80:83], v[176:179], v[40:43], v[80:83]
    v_fma_f32 v14, v14, v21, v20
    v_mfma_f32_16x16x32_bf16 v[84:87], v[180:183], v[40:43], v[84:87]
    v_fma_f32 v15, v15, v21, v20
    v_mul_f32 v72, v72, v12
    ds_read_b128 v[40:43], v2 offset:48128
    s_waitcnt lgkmcnt(5)
    v_mfma_f32_16x16x32_bf16 v[88:91], v[176:179], v[44:47], v[88:91]
    v_mul_f32 v73, v73, v13
    v_mfma_f32_16x16x32_bf16 v[92:95], v[180:183], v[44:47], v[92:95]
    v_mul_f32 v74, v74, v14
    v_mul_f32 v75, v75, v15
    ds_read_b128 v[44:47], v5 offset:17408
    s_waitcnt lgkmcnt(5)
    v_mfma_f32_16x16x32_bf16 v[80:83], v[184:187], v[24:27], v[80:83]
    v_exp_f32 v72, v72
    v_mfma_f32_16x16x32_bf16 v[84:87], v[188:191], v[24:27], v[84:87]
    ds_read_b128 v[24:27], v5 offset:0
    s_waitcnt lgkmcnt(5)
    v_mfma_f32_16x16x32_bf16 v[88:91], v[184:187], v[28:31], v[88:91]
    v_exp_f32 v73, v73
    v_mfma_f32_16x16x32_bf16 v[92:95], v[188:191], v[28:31], v[92:95]
    v_exp_f32 v74, v74
    ds_read_b128 v[28:31], v5 offset:18432
    s_waitcnt lgkmcnt(5)
    v_mfma_f32_16x16x32_bf16 v[80:83], v[192:195], v[32:35], v[80:83]
    v_exp_f32 v75, v75
    v_mfma_f32_16x16x32_bf16 v[84:87], v[196:199], v[32:35], v[84:87]
    v_fma_f32 v72, v72, v22, v22
    ds_read_b128 v[32:35], v5 offset:1024
    s_waitcnt lgkmcnt(5)
    v_mfma_f32_16x16x32_bf16 v[88:91], v[192:195], v[36:39], v[88:91]
    v_fma_f32 v73, v73, v22, v22
    v_fma_f32 v74, v74, v22, v22
    v_mfma_f32_16x16x32_bf16 v[92:95], v[196:199], v[36:39], v[92:95]
    v_fma_f32 v75, v75, v22, v22
    ds_read_b128 v[36:39], v5 offset:19456
    s_waitcnt lgkmcnt(5)
    v_mfma_f32_16x16x32_bf16 v[80:83], v[200:203], v[40:43], v[80:83]
    v_rcp_f32 v72, v72
    v_mfma_f32_16x16x32_bf16 v[84:87], v[204:207], v[40:43], v[84:87]
    v_rcp_f32 v73, v73
    ds_read_b128 v[40:43], v5 offset:2048
    s_waitcnt lgkmcnt(5)
    v_mfma_f32_16x16x32_bf16 v[88:91], v[200:203], v[44:47], v[88:91]
    v_rcp_f32 v74, v74
    v_mfma_f32_16x16x32_bf16 v[92:95], v[204:207], v[44:47], v[92:95]
    ds_read_b128 v[44:47], v5 offset:20480
    s_waitcnt vmcnt(0)
    s_barrier
    s_waitcnt lgkmcnt(5)
    v_mfma_f32_16x16x32_bf16 v[80:83], v[208:211], v[24:27], v[80:83]
    v_rcp_f32 v75, v75
    v_mul_f32 v76, v76, v72
    v_mfma_f32_16x16x32_bf16 v[84:87], v[212:215], v[24:27], v[84:87]
    v_mul_f32 v77, v77, v73
    ds_read_b128 v[24:27], v5 offset:3072
    s_waitcnt lgkmcnt(5)
    v_mfma_f32_16x16x32_bf16 v[88:91], v[208:211], v[28:31], v[88:91]
    v_mul_f32 v78, v78, v74
    v_mul_f32 v79, v79, v75
    s_add_u32 m0, s26, 0
    s_add_u32 s30, s33, 294912
    buffer_load_dwordx4 v2, s[8:11], s30 offen sc1 lds
    v_mfma_f32_16x16x32_bf16 v[92:95], v[212:215], v[28:31], v[92:95]
    v_cvt_pk_bf16_f32 v64, v68, v69
    ds_read_b128 v[28:31], v5 offset:21504
    s_waitcnt lgkmcnt(5)
    v_mfma_f32_16x16x32_bf16 v[80:83], v[216:219], v[32:35], v[80:83]
    v_cvt_pk_bf16_f32 v65, v70, v71
    v_cvt_pk_bf16_f32 v66, v76, v77
    v_mfma_f32_16x16x32_bf16 v[84:87], v[220:223], v[32:35], v[84:87]
    v_cvt_pk_bf16_f32 v67, v78, v79
    s_add_u32 s31, s27, 1474560
    v_permlane16_swap_b32 v64, v66
    ds_read_b128 v[32:35], v5 offset:4096
    s_waitcnt lgkmcnt(5)
    v_mfma_f32_16x16x32_bf16 v[88:91], v[216:219], v[36:39], v[88:91]
    v_permlane16_swap_b32 v65, v67
    buffer_store_dwordx4 v[64:67], v7, s[8:11], s31 offen sc1
    v_mfma_f32_16x16x32_bf16 v[92:95], v[220:223], v[36:39], v[92:95]
    ds_read_b128 v[36:39], v5 offset:22528
    s_waitcnt lgkmcnt(5)
    v_mfma_f32_16x16x32_bf16 v[80:83], v[224:227], v[40:43], v[80:83]
    s_add_u32 m0, s26, 8192
    s_add_u32 s30, s33, 303104
    buffer_load_dwordx4 v2, s[8:11], s30 offen sc1 lds
    v_mfma_f32_16x16x32_bf16 v[84:87], v[228:231], v[40:43], v[84:87]
    ds_read_b128 v[40:43], v5 offset:5120
    s_waitcnt lgkmcnt(5)
    v_mfma_f32_16x16x32_bf16 v[88:91], v[224:227], v[44:47], v[88:91]
    v_mfma_f32_16x16x32_bf16 v[92:95], v[228:231], v[44:47], v[92:95]
    ds_read_b128 v[44:47], v5 offset:23552
    s_waitcnt lgkmcnt(5)
    v_mfma_f32_16x16x32_bf16 v[80:83], v[232:235], v[24:27], v[80:83]
    v_mfma_f32_16x16x32_bf16 v[84:87], v[236:239], v[24:27], v[84:87]
    ds_read_b128 v[24:27], v5 offset:24576
    s_waitcnt lgkmcnt(5)
    v_mfma_f32_16x16x32_bf16 v[88:91], v[232:235], v[28:31], v[88:91]
    s_add_u32 m0, s26, 16384
    s_add_u32 s30, s33, 311296
    buffer_load_dwordx4 v2, s[8:11], s30 offen sc1 lds
    v_mfma_f32_16x16x32_bf16 v[92:95], v[236:239], v[28:31], v[92:95]
    ds_read_b128 v[28:31], v5 offset:43008
    s_waitcnt lgkmcnt(5)
    v_mfma_f32_16x16x32_bf16 v[80:83], v[240:243], v[32:35], v[80:83]
    v_mfma_f32_16x16x32_bf16 v[84:87], v[244:247], v[32:35], v[84:87]
    ds_read_b128 v[32:35], v5 offset:25600
    s_waitcnt lgkmcnt(5)
    v_mfma_f32_16x16x32_bf16 v[88:91], v[240:243], v[36:39], v[88:91]
    v_mfma_f32_16x16x32_bf16 v[92:95], v[244:247], v[36:39], v[92:95]
    ds_read_b128 v[36:39], v5 offset:44032
    s_waitcnt lgkmcnt(5)
    v_mfma_f32_16x16x32_bf16 v[80:83], v[248:251], v[40:43], v[80:83]
    s_add_u32 m0, s26, 24576
    s_add_u32 s30, s33, 319488
    buffer_load_dwordx4 v2, s[8:11], s30 offen sc1 lds
    v_mfma_f32_16x16x32_bf16 v[84:87], v[252:255], v[40:43], v[84:87]
    ds_read_b128 v[40:43], v5 offset:26624
    s_waitcnt lgkmcnt(5)
    v_mfma_f32_16x16x32_bf16 v[88:91], v[248:251], v[44:47], v[88:91]
    v_mfma_f32_16x16x32_bf16 v[92:95], v[252:255], v[44:47], v[92:95]
    ds_read_b128 v[44:47], v5 offset:45056
    s_waitcnt lgkmcnt(5)
    v_mfma_f32_16x16x32_bf16 v[96:99], v[112:115], v[24:27], 0
    ds_read_b64 v[16:17], v8 offset:1536
    ds_read_b32 v18, v9 offset:768
    ds_read_b64 v[20:21], v8 offset:1664
    ds_read_b32 v22, v9 offset:832
    v_mul_f32 v84, v80, v84
    v_mfma_f32_16x16x32_bf16 v[100:103], v[116:119], v[24:27], 0
    v_mul_f32 v85, v81, v85
    v_mul_f32 v86, v82, v86
    ds_read_b128 v[24:27], v5 offset:27648
    s_waitcnt lgkmcnt(9)
    v_mfma_f32_16x16x32_bf16 v[104:107], v[112:115], v[28:31], 0
    v_mul_f32 v87, v83, v87
    s_cmp_ge_u32 s20, 4
    s_cbranch_scc1 k234_mid_kernel_sk9
    s_add_u32 m0, s26, 32768
    s_add_u32 s30, s33, 327680
    buffer_load_dwordx4 v2, s[8:11], s30 offen sc1 lds
k234_mid_kernel_sk9:
    v_mfma_f32_16x16x32_bf16 v[108:111], v[116:119], v[28:31], 0
    v_mul_f32 v12, v80, v80
    v_mul_f32 v13, v81, v81
    ds_read_b128 v[28:31], v5 offset:46080
    s_waitcnt lgkmcnt(9)
    v_mfma_f32_16x16x32_bf16 v[96:99], v[120:123], v[32:35], v[96:99]
    v_mul_f32 v14, v82, v82
    v_mul_f32 v15, v83, v83
    s_waitcnt lgkmcnt(4)
    v_mfma_f32_16x16x32_bf16 v[100:103], v[124:127], v[32:35], v[100:103]
    v_fma_f32 v12, v12, v17, v16
    ds_read_b128 v[32:35], v5 offset:28672
    v_mfma_f32_16x16x32_bf16 v[104:107], v[120:123], v[36:39], v[104:107]
    v_fma_f32 v13, v13, v17, v16
    v_fma_f32 v14, v14, v17, v16
    v_mfma_f32_16x16x32_bf16 v[108:111], v[124:127], v[36:39], v[108:111]
    v_fma_f32 v15, v15, v17, v16
    v_mul_f32 v80, v80, v12
    ds_read_b128 v[36:39], v5 offset:47104
    v_mfma_f32_16x16x32_bf16 v[96:99], v[128:131], v[40:43], v[96:99]
    v_mul_f32 v81, v81, v13
    v_mfma_f32_16x16x32_bf16 v[100:103], v[132:135], v[40:43], v[100:103]
    v_mul_f32 v82, v82, v14
    v_mul_f32 v83, v83, v15
    ds_read_b128 v[40:43], v5 offset:29696
    v_mfma_f32_16x16x32_bf16 v[104:107], v[128:131], v[44:47], v[104:107]
    v_mfma_f32_16x16x32_bf16 v[108:111], v[132:135], v[44:47], v[108:111]
    v_exp_f32 v80, v80
    ds_read_b128 v[44:47], v5 offset:48128
    s_waitcnt lgkmcnt(5)
    v_mfma_f32_16x16x32_bf16 v[96:99], v[136:139], v[24:27], v[96:99]
    v_exp_f32 v81, v81
    v_mfma_f32_16x16x32_bf16 v[100:103], v[140:143], v[24:27], v[100:103]
    v_exp_f32 v82, v82
    ds_read_b128 v[24:27], v5 offset:30720
    s_waitcnt lgkmcnt(5)
    v_mfma_f32_16x16x32_bf16 v[104:107], v[136:139], v[28:31], v[104:107]
    v_mfma_f32_16x16x32_bf16 v[108:111], v[140:143], v[28:31], v[108:111]
    v_exp_f32 v83, v83
    v_fma_f32 v80, v80, v18, v18
    ds_read_b128 v[28:31], v6 offset:0
    s_waitcnt lgkmcnt(5)
    v_mfma_f32_16x16x32_bf16 v[96:99], v[144:147], v[32:35], v[96:99]
    v_fma_f32 v81, v81, v18, v18
    v_mfma_f32_16x16x32_bf16 v[100:103], v[148:151], v[32:35], v[100:103]
    v_fma_f32 v82, v82, v18, v18
    v_fma_f32 v83, v83, v18, v18
    ds_read_b128 v[32:35], v5 offset:31744
    s_waitcnt lgkmcnt(5)
    v_mfma_f32_16x16x32_bf16 v[104:107], v[144:147], v[36:39], v[104:107]
    v_mfma_f32_16x16x32_bf16 v[108:111], v[148:151], v[36:39], v[108:111]
    v_rcp_f32 v80, v80
    ds_read_b128 v[36:39], v6 offset:1024
    s_waitcnt lgkmcnt(5)
    v_mfma_f32_16x16x32_bf16 v[96:99], v[152:155], v[40:43], v[96:99]
    v_rcp_f32 v81, v81
    v_mfma_f32_16x16x32_bf16 v[100:103], v[156:159], v[40:43], v[100:103]
    v_rcp_f32 v82, v82
    ds_read_b128 v[40:43], v5 offset:32768
    s_waitcnt lgkmcnt(5)
    v_mfma_f32_16x16x32_bf16 v[104:107], v[152:155], v[44:47], v[104:107]
    v_mfma_f32_16x16x32_bf16 v[108:111], v[156:159], v[44:47], v[108:111]
    v_rcp_f32 v83, v83
    v_mul_f32 v84, v84, v80
    ds_read_b128 v[44:47], v6 offset:2048
    s_waitcnt lgkmcnt(5)
    v_mfma_f32_16x16x32_bf16 v[96:99], v[160:163], v[24:27], v[96:99]
    v_mul_f32 v85, v85, v81
    v_mfma_f32_16x16x32_bf16 v[100:103], v[164:167], v[24:27], v[100:103]
    v_mul_f32 v86, v86, v82
    v_mul_f32 v87, v87, v83
    ds_read_b128 v[24:27], v5 offset:33792
    s_waitcnt lgkmcnt(5)
    v_mfma_f32_16x16x32_bf16 v[104:107], v[160:163], v[28:31], v[104:107]
    v_mul_f32 v92, v88, v92
    v_mfma_f32_16x16x32_bf16 v[108:111], v[164:167], v[28:31], v[108:111]
    v_mul_f32 v93, v89, v93
    v_mul_f32 v94, v90, v94
    ds_read_b128 v[28:31], v6 offset:3072
    s_waitcnt lgkmcnt(5)
    v_mfma_f32_16x16x32_bf16 v[96:99], v[168:171], v[32:35], v[96:99]
    v_mul_f32 v95, v91, v95
    v_mul_f32 v12, v88, v88
    v_mfma_f32_16x16x32_bf16 v[100:103], v[172:175], v[32:35], v[100:103]
    v_mul_f32 v13, v89, v89
    ds_read_b128 v[32:35], v5 offset:34816
    s_waitcnt lgkmcnt(5)
    v_mfma_f32_16x16x32_bf16 v[104:107], v[168:171], v[36:39], v[104:107]
    v_mul_f32 v14, v90, v90
    v_mul_f32 v15, v91, v91
    v_mfma_f32_16x16x32_bf16 v[108:111], v[172:175], v[36:39], v[108:111]
    v_fma_f32 v12, v12, v21, v20
    v_fma_f32 v13, v13, v21, v20
    ds_read_b128 v[36:39], v6 offset:4096
    s_waitcnt lgkmcnt(5)
    v_mfma_f32_16x16x32_bf16 v[96:99], v[176:179], v[40:43], v[96:99]
    v_fma_f32 v14, v14, v21, v20
    v_mfma_f32_16x16x32_bf16 v[100:103], v[180:183], v[40:43], v[100:103]
    v_fma_f32 v15, v15, v21, v20
    v_mul_f32 v88, v88, v12
    ds_read_b128 v[40:43], v5 offset:35840
    s_waitcnt lgkmcnt(5)
    v_mfma_f32_16x16x32_bf16 v[104:107], v[176:179], v[44:47], v[104:107]
    v_mul_f32 v89, v89, v13
    v_mfma_f32_16x16x32_bf16 v[108:111], v[180:183], v[44:47], v[108:111]
    v_mul_f32 v90, v90, v14
    v_mul_f32 v91, v91, v15
    ds_read_b128 v[44:47], v6 offset:5120
    s_waitcnt lgkmcnt(5)
    v_mfma_f32_16x16x32_bf16 v[96:99], v[184:187], v[24:27], v[96:99]
    v_exp_f32 v88, v88
    v_mfma_f32_16x16x32_bf16 v[100:103], v[188:191], v[24:27], v[100:103]
    ds_read_b128 v[24:27], v5 offset:36864
    s_waitcnt lgkmcnt(5)
    v_mfma_f32_16x16x32_bf16 v[104:107], v[184:187], v[28:31], v[104:107]
    v_exp_f32 v89, v89
    v_mfma_f32_16x16x32_bf16 v[108:111], v[188:191], v[28:31], v[108:111]
    v_exp_f32 v90, v90
    ds_read_b128 v[28:31], v6 offset:6144
    s_waitcnt lgkmcnt(5)
    v_mfma_f32_16x16x32_bf16 v[96:99], v[192:195], v[32:35], v[96:99]
    v_exp_f32 v91, v91
    v_mfma_f32_16x16x32_bf16 v[100:103], v[196:199], v[32:35], v[100:103]
    v_fma_f32 v88, v88, v22, v22
    ds_read_b128 v[32:35], v5 offset:37888
    s_waitcnt lgkmcnt(5)
    v_mfma_f32_16x16x32_bf16 v[104:107], v[192:195], v[36:39], v[104:107]
    v_fma_f32 v89, v89, v22, v22
    v_fma_f32 v90, v90, v22, v22
    v_mfma_f32_16x16x32_bf16 v[108:111], v[196:199], v[36:39], v[108:111]
    v_fma_f32 v91, v91, v22, v22
    ds_read_b128 v[36:39], v6 offset:7168
    s_waitcnt lgkmcnt(5)
    v_mfma_f32_16x16x32_bf16 v[96:99], v[200:203], v[40:43], v[96:99]
    v_rcp_f32 v88, v88
    v_mfma_f32_16x16x32_bf16 v[100:103], v[204:207], v[40:43], v[100:103]
    v_rcp_f32 v89, v89
    ds_read_b128 v[40:43], v5 offset:38912
    s_waitcnt lgkmcnt(5)
    v_mfma_f32_16x16x32_bf16 v[104:107], v[200:203], v[44:47], v[104:107]
    v_rcp_f32 v90, v90
    v_mfma_f32_16x16x32_bf16 v[108:111], v[204:207], v[44:47], v[108:111]
    ds_read_b128 v[44:47], v6 offset:8192
    s_waitcnt vmcnt(0)
    s_barrier
    s_waitcnt lgkmcnt(5)
    v_mfma_f32_16x16x32_bf16 v[96:99], v[208:211], v[24:27], v[96:99]
    v_rcp_f32 v91, v91
    v_mul_f32 v92, v92, v88
    v_mfma_f32_16x16x32_bf16 v[100:103], v[212:215], v[24:27], v[100:103]
    v_mul_f32 v93, v93, v89
    ds_read_b128 v[24:27], v5 offset:39936
    s_waitcnt lgkmcnt(5)
    v_mfma_f32_16x16x32_bf16 v[104:107], v[208:211], v[28:31], v[104:107]
    v_mul_f32 v94, v94, v90
    v_mul_f32 v95, v95, v91
    s_add_u32 m0, s26, 36864
    s_add_u32 s30, s33, 331776
    buffer_load_dwordx4 v2, s[8:11], s30 offen sc1 lds
    v_mfma_f32_16x16x32_bf16 v[108:111], v[212:215], v[28:31], v[108:111]
    v_cvt_pk_bf16_f32 v80, v84, v85
    ds_read_b128 v[28:31], v6 offset:9216
    s_waitcnt lgkmcnt(5)
    v_mfma_f32_16x16x32_bf16 v[96:99], v[216:219], v[32:35], v[96:99]
    v_cvt_pk_bf16_f32 v81, v86, v87
    v_cvt_pk_bf16_f32 v82, v92, v93
    v_mfma_f32_16x16x32_bf16 v[100:103], v[220:223], v[32:35], v[100:103]
    v_cvt_pk_bf16_f32 v83, v94, v95
    s_add_u32 s31, s27, 1769472
    v_permlane16_swap_b32 v80, v82
    ds_read_b128 v[32:35], v5 offset:40960
    s_waitcnt lgkmcnt(5)
    v_mfma_f32_16x16x32_bf16 v[104:107], v[216:219], v[36:39], v[104:107]
    v_permlane16_swap_b32 v81, v83
    buffer_store_dwordx4 v[80:83], v7, s[8:11], s31 offen sc1
    v_mfma_f32_16x16x32_bf16 v[108:111], v[220:223], v[36:39], v[108:111]
    ds_read_b128 v[36:39], v6 offset:10240
    s_waitcnt lgkmcnt(5)
    v_mfma_f32_16x16x32_bf16 v[96:99], v[224:227], v[40:43], v[96:99]
    s_add_u32 m0, s26, 45056
    s_add_u32 s30, s33, 339968
    buffer_load_dwordx4 v2, s[8:11], s30 offen sc1 lds
    v_mfma_f32_16x16x32_bf16 v[100:103], v[228:231], v[40:43], v[100:103]
    ds_read_b128 v[40:43], v5 offset:41984
    s_waitcnt lgkmcnt(5)
    v_mfma_f32_16x16x32_bf16 v[104:107], v[224:227], v[44:47], v[104:107]
    v_mfma_f32_16x16x32_bf16 v[108:111], v[228:231], v[44:47], v[108:111]
    ds_read_b128 v[44:47], v6 offset:11264
    s_waitcnt lgkmcnt(5)
    v_mfma_f32_16x16x32_bf16 v[96:99], v[232:235], v[24:27], v[96:99]
    v_mfma_f32_16x16x32_bf16 v[100:103], v[236:239], v[24:27], v[100:103]
    ds_read_b128 v[24:27], v2 offset:0
    s_waitcnt lgkmcnt(5)
    v_mfma_f32_16x16x32_bf16 v[104:107], v[232:235], v[28:31], v[104:107]
    s_cmp_ge_u32 s20, 2
    s_cbranch_scc1 k234_mid_kernel_sk10
    s_add_u32 m0, s26, 53248
    s_add_u32 s30, s33, 348160
    buffer_load_dwordx4 v2, s[8:11], s30 offen sc1 lds
k234_mid_kernel_sk10:
    v_mfma_f32_16x16x32_bf16 v[108:111], v[236:239], v[28:31], v[108:111]
    ds_read_b128 v[28:31], v2 offset:18432
    s_waitcnt lgkmcnt(5)
    v_mfma_f32_16x16x32_bf16 v[96:99], v[240:243], v[32:35], v[96:99]
    v_mfma_f32_16x16x32_bf16 v[100:103], v[244:247], v[32:35], v[100:103]
    ds_read_b128 v[32:35], v2 offset:1024
    s_waitcnt lgkmcnt(5)
    v_mfma_f32_16x16x32_bf16 v[104:107], v[240:243], v[36:39], v[104:107]
    v_mfma_f32_16x16x32_bf16 v[108:111], v[244:247], v[36:39], v[108:111]
    ds_read_b128 v[36:39], v2 offset:19456
    s_waitcnt lgkmcnt(5)
    v_mfma_f32_16x16x32_bf16 v[96:99], v[248:251], v[40:43], v[96:99]
    v_mfma_f32_16x16x32_bf16 v[100:103], v[252:255], v[40:43], v[100:103]
    ds_read_b128 v[40:43], v2 offset:2048
    s_waitcnt lgkmcnt(5)
    v_mfma_f32_16x16x32_bf16 v[104:107], v[248:251], v[44:47], v[104:107]
    v_mfma_f32_16x16x32_bf16 v[108:111], v[252:255], v[44:47], v[108:111]
    ds_read_b128 v[44:47], v2 offset:20480
    s_cmp_lt_u32 s22, 2
    s_cbranch_scc1 k234_mid_kernel_long
    s_waitcnt lgkmcnt(5)
    v_mfma_f32_16x16x32_bf16 v[48:51], v[112:115], v[24:27], 0
    ds_read_b64 v[16:17], v8 offset:1792
    ds_read_b32 v18, v9 offset:896
    ds_read_b64 v[20:21], v8 offset:1920
    ds_read_b32 v22, v9 offset:960
    v_mul_f32 v100, v96, v100
    v_mfma_f32_16x16x32_bf16 v[52:55], v[116:119], v[24:27], 0
    v_mul_f32 v101, v97, v101
    v_mul_f32 v102, v98, v102
    ds_read_b128 v[24:27], v2 offset:3072
    s_waitcnt lgkmcnt(9)
    v_mfma_f32_16x16x32_bf16 v[56:59], v[112:115], v[28:31], 0
    v_mul_f32 v103, v99, v103
    v_mfma_f32_16x16x32_bf16 v[60:63], v[116:119], v[28:31], 0
    v_mul_f32 v12, v96, v96
    v_mul_f32 v13, v97, v97
    ds_read_b128 v[28:31], v2 offset:21504
    s_waitcnt lgkmcnt(9)
    v_mfma_f32_16x16x32_bf16 v[48:51], v[120:123], v[32:35], v[48:51]
    v_mul_f32 v14, v98, v98
    v_mul_f32 v15, v99, v99
    s_waitcnt lgkmcnt(4)
    v_mfma_f32_16x16x32_bf16 v[52:55], v[124:127], v[32:35], v[52:55]
    v_fma_f32 v12, v12, v17, v16
    ds_read_b128 v[32:35], v2 offset:4096
    v_mfma_f32_16x16x32_bf16 v[56:59], v[120:123], v[36:39], v[56:59]
    v_fma_f32 v13, v13, v17, v16
    v_fma_f32 v14, v14, v17, v16
    v_mfma_f32_16x16x32_bf16 v[60:63], v[124:127], v[36:39], v[60:63]
    v_fma_f32 v15, v15, v17, v16
    v_mul_f32 v96, v96, v12
    ds_read_b128 v[36:39], v2 offset:22528
    v_mfma_f32_16x16x32_bf16 v[48:51], v[128:131], v[40:43], v[48:51]
    v_mul_f32 v97, v97, v13
    v_mfma_f32_16x16x32_bf16 v[52:55], v[132:135], v[40:43], v[52:55]
    v_mul_f32 v98, v98, v14
    v_mul_f32 v99, v99, v15
    ds_read_b128 v[40:43], v2 offset:5120
    v_mfma_f32_16x16x32_bf16 v[56:59], v[128:131], v[44:47], v[56:59]
    v_mfma_f32_16x16x32_bf16 v[60:63], v[132:135], v[44:47], v[60:63]
    v_exp_f32 v96, v96
    ds_read_b128 v[44:47], v2 offset:23552
    s_waitcnt lgkmcnt(5)
    v_mfma_f32_16x16x32_bf16 v[48:51], v[136:139], v[24:27], v[48:51]
    v_exp_f32 v97, v97
    v_mfma_f32_16x16x32_bf16 v[52:55], v[140:143], v[24:27], v[52:55]
    v_exp_f32 v98, v98
    ds_read_b128 v[24:27], v2 offset:6144
    s_waitcnt lgkmcnt(5)
    v_mfma_f32_16x16x32_bf16 v[56:59], v[136:139], v[28:31], v[56:59]
    v_mfma_f32_16x16x32_bf16 v[60:63], v[140:143], v[28:31], v[60:63]
    v_exp_f32 v99, v99
    v_fma_f32 v96, v96, v18, v18
    ds_read_b128 v[28:31], v2 offset:24576
    s_waitcnt lgkmcnt(5)
    v_mfma_f32_16x16x32_bf16 v[48:51], v[144:147], v[32:35], v[48:51]
    v_fma_f32 v97, v97, v18, v18
    v_mfma_f32_16x16x32_bf16 v[52:55], v[148:151], v[32:35], v[52:55]
    v_fma_f32 v98, v98, v18, v18
    v_fma_f32 v99, v99, v18, v18
    ds_read_b128 v[32:35], v2 offset:7168
    s_waitcnt lgkmcnt(5)
    v_mfma_f32_16x16x32_bf16 v[56:59], v[144:147], v[36:39], v[56:59]
    v_mfma_f32_16x16x32_bf16 v[60:63], v[148:151], v[36:39], v[60:63]
    v_rcp_f32 v96, v96
    ds_read_b128 v[36:39], v2 offset:25600
    s_waitcnt lgkmcnt(5)
    v_mfma_f32_16x16x32_bf16 v[48:51], v[152:155], v[40:43], v[48:51]
    v_rcp_f32 v97, v97
    v_mfma_f32_16x16x32_bf16 v[52:55], v[156:159], v[40:43], v[52:55]
    v_rcp_f32 v98, v98
    ds_read_b128 v[40:43], v2 offset:8192
    s_waitcnt lgkmcnt(5)
    v_mfma_f32_16x16x32_bf16 v[56:59], v[152:155], v[44:47], v[56:59]
    v_mfma_f32_16x16x32_bf16 v[60:63], v[156:159], v[44:47], v[60:63]
    v_rcp_f32 v99, v99
    v_mul_f32 v100, v100, v96
    ds_read_b128 v[44:47], v2 offset:26624
    s_waitcnt lgkmcnt(5)
    v_mfma_f32_16x16x32_bf16 v[48:51], v[160:163], v[24:27], v[48:51]
    v_mul_f32 v101, v101, v97
    v_mfma_f32_16x16x32_bf16 v[52:55], v[164:167], v[24:27], v[52:55]
    v_mul_f32 v102, v102, v98
    v_mul_f32 v103, v103, v99
    ds_read_b128 v[24:27], v2 offset:9216
    s_waitcnt lgkmcnt(5)
    v_mfma_f32_16x16x32_bf16 v[56:59], v[160:163], v[28:31], v[56:59]
    v_mul_f32 v108, v104, v108
    v_mfma_f32_16x16x32_bf16 v[60:63], v[164:167], v[28:31], v[60:63]
    v_mul_f32 v109, v105, v109
    v_mul_f32 v110, v106, v110
    ds_read_b128 v[28:31], v2 offset:27648
    s_waitcnt lgkmcnt(5)
    v_mfma_f32_16x16x32_bf16 v[48:51], v[168:171], v[32:35], v[48:51]
    v_mul_f32 v111, v107, v111
    v_mul_f32 v12, v104, v104
    v_mfma_f32_16x16x32_bf16 v[52:55], v[172:175], v[32:35], v[52:55]
    v_mul_f32 v13, v105, v105
    ds_read_b128 v[32:35], v2 offset:10240
    s_waitcnt lgkmcnt(5)
    v_mfma_f32_16x16x32_bf16 v[56:59], v[168:171], v[36:39], v[56:59]
    v_mul_f32 v14, v106, v106
    v_mul_f32 v15, v107, v107
    v_mfma_f32_16x16x32_bf16 v[60:63], v[172:175], v[36:39], v[60:63]
    v_fma_f32 v12, v12, v21, v20
    v_fma_f32 v13, v13, v21, v20
    ds_read_b128 v[36:39], v2 offset:28672
    s_waitcnt lgkmcnt(5)
    v_mfma_f32_16x16x32_bf16 v[48:51], v[176:179], v[40:43], v[48:51]
    v_fma_f32 v14, v14, v21, v20
    v_mfma_f32_16x16x32_bf16 v[52:55], v[180:183], v[40:43], v[52:55]
    v_fma_f32 v15, v15, v21, v20
    v_mul_f32 v104, v104, v12
    ds_read_b128 v[40:43], v2 offset:11264
    s_waitcnt lgkmcnt(5)
    v_mfma_f32_16x16x32_bf16 v[56:59], v[176:179], v[44:47], v[56:59]
    v_mul_f32 v105, v105, v13
    v_mfma_f32_16x16x32_bf16 v[60:63], v[180:183], v[44:47], v[60:63]
    v_mul_f32 v106, v106, v14
    v_mul_f32 v107, v107, v15
    ds_read_b128 v[44:47], v2 offset:29696
    s_waitcnt lgkmcnt(5)
    v_mfma_f32_16x16x32_bf16 v[48:51], v[184:187], v[24:27], v[48:51]
    v_exp_f32 v104, v104
    v_mfma_f32_16x16x32_bf16 v[52:55], v[188:191], v[24:27], v[52:55]
    ds_read_b128 v[24:27], v2 offset:12288
    s_waitcnt lgkmcnt(5)
    v_mfma_f32_16x16x32_bf16 v[56:59], v[184:187], v[28:31], v[56:59]
    v_exp_f32 v105, v105
    v_mfma_f32_16x16x32_bf16 v[60:63], v[188:191], v[28:31], v[60:63]
    v_exp_f32 v106, v106
    ds_read_b128 v[28:31], v2 offset:30720
    s_waitcnt lgkmcnt(5)
    v_mfma_f32_16x16x32_bf16 v[48:51], v[192:195], v[32:35], v[48:51]
    v_exp_f32 v107, v107
    v_mfma_f32_16x16x32_bf16 v[52:55], v[196:199], v[32:35], v[52:55]
    v_fma_f32 v104, v104, v22, v22
    ds_read_b128 v[32:35], v2 offset:13312
    s_waitcnt lgkmcnt(5)
    v_mfma_f32_16x16x32_bf16 v[56:59], v[192:195], v[36:39], v[56:59]
    v_fma_f32 v105, v105, v22, v22
    v_fma_f32 v106, v106, v22, v22
    v_mfma_f32_16x16x32_bf16 v[60:63], v[196:199], v[36:39], v[60:63]
    v_fma_f32 v107, v107, v22, v22
    ds_read_b128 v[36:39], v2 offset:31744
    s_waitcnt lgkmcnt(5)
    v_mfma_f32_16x16x32_bf16 v[48:51], v[200:203], v[40:43], v[48:51]
    v_rcp_f32 v104, v104
    v_mfma_f32_16x16x32_bf16 v[52:55], v[204:207], v[40:43], v[52:55]
    v_rcp_f32 v105, v105
    ds_read_b128 v[40:43], v2 offset:14336
    s_waitcnt lgkmcnt(5)
    v_mfma_f32_16x16x32_bf16 v[56:59], v[200:203], v[44:47], v[56:59]
    v_rcp_f32 v106, v106
    v_mfma_f32_16x16x32_bf16 v[60:63], v[204:207], v[44:47], v[60:63]
    ds_read_b128 v[44:47], v2 offset:32768
    s_waitcnt lgkmcnt(5)
    v_mfma_f32_16x16x32_bf16 v[48:51], v[208:211], v[24:27], v[48:51]
    v_rcp_f32 v107, v107
    v_mul_f32 v108, v108, v104
    v_mfma_f32_16x16x32_bf16 v[52:55], v[212:215], v[24:27], v[52:55]
    v_mul_f32 v109, v109, v105
    ds_read_b128 v[24:27], v2 offset:15360
    s_waitcnt lgkmcnt(5)
    v_mfma_f32_16x16x32_bf16 v[56:59], v[208:211], v[28:31], v[56:59]
    v_mul_f32 v110, v110, v106
    v_mul_f32 v111, v111, v107
    v_mfma_f32_16x16x32_bf16 v[60:63], v[212:215], v[28:31], v[60:63]
    v_cvt_pk_bf16_f32 v96, v100, v101
    ds_read_b128 v[28:31], v2 offset:33792
    s_waitcnt lgkmcnt(5)
    v_mfma_f32_16x16x32_bf16 v[48:51], v[216:219], v[32:35], v[48:51]
    v_cvt_pk_bf16_f32 v97, v102, v103
    v_cvt_pk_bf16_f32 v98, v108, v109
    v_mfma_f32_16x16x32_bf16 v[52:55], v[220:223], v[32:35], v[52:55]
    v_cvt_pk_bf16_f32 v99, v110, v111
    s_add_u32 s31, s27, 2064384
    v_permlane16_swap_b32 v96, v98
    ds_read_b128 v[32:35], v2 offset:16384
    s_waitcnt lgkmcnt(5)
    v_mfma_f32_16x16x32_bf16 v[56:59], v[216:219], v[36:39], v[56:59]
    v_permlane16_swap_b32 v97, v99
    buffer_store_dwordx4 v[96:99], v7, s[8:11], s31 offen sc1
    v_mfma_f32_16x16x32_bf16 v[60:63], v[220:223], v[36:39], v[60:63]
    ds_read_b128 v[36:39], v2 offset:34816
    s_waitcnt lgkmcnt(5)
    v_mfma_f32_16x16x32_bf16 v[48:51], v[224:227], v[40:43], v[48:51]
    v_mfma_f32_16x16x32_bf16 v[52:55], v[228:231], v[40:43], v[52:55]
    ds_read_b128 v[40:43], v2 offset:17408
    s_waitcnt lgkmcnt(5)
    v_mfma_f32_16x16x32_bf16 v[56:59], v[224:227], v[44:47], v[56:59]
    v_mfma_f32_16x16x32_bf16 v[60:63], v[228:231], v[44:47], v[60:63]
    ds_read_b128 v[44:47], v2 offset:35840
    s_waitcnt lgkmcnt(5)
    v_mfma_f32_16x16x32_bf16 v[48:51], v[232:235], v[24:27], v[48:51]
    v_mfma_f32_16x16x32_bf16 v[52:55], v[236:239], v[24:27], v[52:55]
    s_waitcnt lgkmcnt(4)
    v_mfma_f32_16x16x32_bf16 v[56:59], v[232:235], v[28:31], v[56:59]
    v_mfma_f32_16x16x32_bf16 v[60:63], v[236:239], v[28:31], v[60:63]
    s_waitcnt lgkmcnt(3)
    v_mfma_f32_16x16x32_bf16 v[48:51], v[240:243], v[32:35], v[48:51]
    v_mfma_f32_16x16x32_bf16 v[52:55], v[244:247], v[32:35], v[52:55]
    s_waitcnt lgkmcnt(2)
    v_mfma_f32_16x16x32_bf16 v[56:59], v[240:243], v[36:39], v[56:59]
    v_mfma_f32_16x16x32_bf16 v[60:63], v[244:247], v[36:39], v[60:63]
    s_waitcnt lgkmcnt(1)
    v_mfma_f32_16x16x32_bf16 v[48:51], v[248:251], v[40:43], v[48:51]
    v_mfma_f32_16x16x32_bf16 v[52:55], v[252:255], v[40:43], v[52:55]
    s_waitcnt lgkmcnt(0)
    v_mfma_f32_16x16x32_bf16 v[56:59], v[248:251], v[44:47], v[56:59]
    v_mfma_f32_16x16x32_bf16 v[60:63], v[252:255], v[44:47], v[60:63]
    ds_read_b64 v[16:17], v8 offset:2048
    ds_read_b32 v18, v9 offset:1024
    ds_read_b64 v[20:21], v8 offset:2176
    ds_read_b32 v22, v9 offset:1088
    s_nop 0
    v_mul_f32 v52, v48, v52
    v_mul_f32 v53, v49, v53
    v_mul_f32 v54, v50, v54
    v_mul_f32 v55, v51, v55
    v_mul_f32 v12, v48, v48
    v_mul_f32 v13, v49, v49
    v_mul_f32 v14, v50, v50
    v_mul_f32 v15, v51, v51
    s_waitcnt lgkmcnt(2)
    v_fma_f32 v12, v12, v17, v16
    v_fma_f32 v13, v13, v17, v16
    v_fma_f32 v14, v14, v17, v16
    v_fma_f32 v15, v15, v17, v16
    v_mul_f32 v48, v48, v12
    v_mul_f32 v49, v49, v13
    v_mul_f32 v50, v50, v14
    v_mul_f32 v51, v51, v15
    v_exp_f32 v48, v48
    v_exp_f32 v49, v49
    v_exp_f32 v50, v50
    v_exp_f32 v51, v51
    v_fma_f32 v48, v48, v18, v18
    v_fma_f32 v49, v49, v18, v18
    v_fma_f32 v50, v50, v18, v18
    v_fma_f32 v51, v51, v18, v18
    v_rcp_f32 v48, v48
    v_rcp_f32 v49, v49
    v_rcp_f32 v50, v50
    v_rcp_f32 v51, v51
    v_mul_f32 v52, v52, v48
    v_mul_f32 v53, v53, v49
    v_mul_f32 v54, v54, v50
    v_mul_f32 v55, v55, v51
    v_mul_f32 v60, v56, v60
    v_mul_f32 v61, v57, v61
    v_mul_f32 v62, v58, v62
    v_mul_f32 v63, v59, v63
    v_mul_f32 v12, v56, v56
    v_mul_f32 v13, v57, v57
    v_mul_f32 v14, v58, v58
    v_mul_f32 v15, v59, v59
    s_waitcnt lgkmcnt(0)
    v_fma_f32 v12, v12, v21, v20
    v_fma_f32 v13, v13, v21, v20
    v_fma_f32 v14, v14, v21, v20
    v_fma_f32 v15, v15, v21, v20
    v_mul_f32 v56, v56, v12
    v_mul_f32 v57, v57, v13
    v_mul_f32 v58, v58, v14
    v_mul_f32 v59, v59, v15
    v_exp_f32 v56, v56
    v_exp_f32 v57, v57
    v_exp_f32 v58, v58
    v_exp_f32 v59, v59
    v_fma_f32 v56, v56, v22, v22
    v_fma_f32 v57, v57, v22, v22
    v_fma_f32 v58, v58, v22, v22
    v_fma_f32 v59, v59, v22, v22
    v_rcp_f32 v56, v56
    v_rcp_f32 v57, v57
    v_rcp_f32 v58, v58
    v_rcp_f32 v59, v59
    v_mul_f32 v60, v60, v56
    v_mul_f32 v61, v61, v57
    v_mul_f32 v62, v62, v58
    v_mul_f32 v63, v63, v59
    v_cvt_pk_bf16_f32 v48, v52, v53
    v_cvt_pk_bf16_f32 v49, v54, v55
    v_cvt_pk_bf16_f32 v50, v60, v61
    v_cvt_pk_bf16_f32 v51, v62, v63
    s_add_u32 s31, s27, 2359296
    v_permlane16_swap_b32 v48, v50
    v_permlane16_swap_b32 v49, v51
    buffer_store_dwordx4 v[48:51], v7, s[8:11], s31 offen sc1
    s_branch k234_mid_kernel_done
k234_mid_kernel_long:
    s_waitcnt lgkmcnt(5)
    v_mfma_f32_16x16x32_bf16 v[48:51], v[112:115], v[24:27], 0
    ds_read_b64 v[16:17], v8 offset:1792
    ds_read_b32 v18, v9 offset:896
    ds_read_b64 v[20:21], v8 offset:1920
    ds_read_b32 v22, v9 offset:960
    v_mul_f32 v100, v96, v100
    v_mfma_f32_16x16x32_bf16 v[52:55], v[116:119], v[24:27], 0
    v_mul_f32 v101, v97, v101
    v_mul_f32 v102, v98, v102
    ds_read_b128 v[24:27], v2 offset:3072
    s_waitcnt lgkmcnt(9)
    v_mfma_f32_16x16x32_bf16 v[56:59], v[112:115], v[28:31], 0
    v_mul_f32 v103, v99, v103
    v_mfma_f32_16x16x32_bf16 v[60:63], v[116:119], v[28:31], 0
    v_mul_f32 v12, v96, v96
    v_mul_f32 v13, v97, v97
    ds_read_b128 v[28:31], v2 offset:21504
    s_waitcnt lgkmcnt(9)
    v_mfma_f32_16x16x32_bf16 v[48:51], v[120:123], v[32:35], v[48:51]
    v_mul_f32 v14, v98, v98
    v_mul_f32 v15, v99, v99
    s_waitcnt lgkmcnt(4)
    v_mfma_f32_16x16x32_bf16 v[52:55], v[124:127], v[32:35], v[52:55]
    v_fma_f32 v12, v12, v17, v16
    ds_read_b128 v[32:35], v2 offset:4096
    v_mfma_f32_16x16x32_bf16 v[56:59], v[120:123], v[36:39], v[56:59]
    v_fma_f32 v13, v13, v17, v16
    v_fma_f32 v14, v14, v17, v16
    v_mfma_f32_16x16x32_bf16 v[60:63], v[124:127], v[36:39], v[60:63]
    v_fma_f32 v15, v15, v17, v16
    v_mul_f32 v96, v96, v12
    ds_read_b128 v[36:39], v2 offset:22528
    v_mfma_f32_16x16x32_bf16 v[48:51], v[128:131], v[40:43], v[48:51]
    v_mul_f32 v97, v97, v13
    v_mfma_f32_16x16x32_bf16 v[52:55], v[132:135], v[40:43], v[52:55]
    v_mul_f32 v98, v98, v14
    v_mul_f32 v99, v99, v15
    ds_read_b128 v[40:43], v2 offset:5120
    v_mfma_f32_16x16x32_bf16 v[56:59], v[128:131], v[44:47], v[56:59]
    v_mfma_f32_16x16x32_bf16 v[60:63], v[132:135], v[44:47], v[60:63]
    v_exp_f32 v96, v96
    ds_read_b128 v[44:47], v2 offset:23552
    s_waitcnt lgkmcnt(5)
    v_mfma_f32_16x16x32_bf16 v[48:51], v[136:139], v[24:27], v[48:51]
    v_exp_f32 v97, v97
    v_mfma_f32_16x16x32_bf16 v[52:55], v[140:143], v[24:27], v[52:55]
    v_exp_f32 v98, v98
    ds_read_b128 v[24:27], v2 offset:6144
    s_waitcnt lgkmcnt(5)
    v_mfma_f32_16x16x32_bf16 v[56:59], v[136:139], v[28:31], v[56:59]
    v_mfma_f32_16x16x32_bf16 v[60:63], v[140:143], v[28:31], v[60:63]
    v_exp_f32 v99, v99
    v_fma_f32 v96, v96, v18, v18
    ds_read_b128 v[28:31], v2 offset:24576
    s_waitcnt lgkmcnt(5)
    v_mfma_f32_16x16x32_bf16 v[48:51], v[144:147], v[32:35], v[48:51]
    v_fma_f32 v97, v97, v18, v18
    v_mfma_f32_16x16x32_bf16 v[52:55], v[148:151], v[32:35], v[52:55]
    v_fma_f32 v98, v98, v18, v18
    v_fma_f32 v99, v99, v18, v18
    ds_read_b128 v[32:35], v2 offset:7168
    s_waitcnt lgkmcnt(5)
    v_mfma_f32_16x16x32_bf16 v[56:59], v[144:147], v[36:39], v[56:59]
    v_mfma_f32_16x16x32_bf16 v[60:63], v[148:151], v[36:39], v[60:63]
    v_rcp_f32 v96, v96
    ds_read_b128 v[36:39], v2 offset:25600
    s_waitcnt lgkmcnt(5)
    v_mfma_f32_16x16x32_bf16 v[48:51], v[152:155], v[40:43], v[48:51]
    v_rcp_f32 v97, v97
    v_mfma_f32_16x16x32_bf16 v[52:55], v[156:159], v[40:43], v[52:55]
    v_rcp_f32 v98, v98
    ds_read_b128 v[40:43], v2 offset:8192
    s_waitcnt lgkmcnt(5)
    v_mfma_f32_16x16x32_bf16 v[56:59], v[152:155], v[44:47], v[56:59]
    v_mfma_f32_16x16x32_bf16 v[60:63], v[156:159], v[44:47], v[60:63]
    v_rcp_f32 v99, v99
    v_mul_f32 v100, v100, v96
    ds_read_b128 v[44:47], v2 offset:26624
    s_waitcnt lgkmcnt(5)
    v_mfma_f32_16x16x32_bf16 v[48:51], v[160:163], v[24:27], v[48:51]
    v_mul_f32 v101, v101, v97
    v_mfma_f32_16x16x32_bf16 v[52:55], v[164:167], v[24:27], v[52:55]
    v_mul_f32 v102, v102, v98
    v_mul_f32 v103, v103, v99
    ds_read_b128 v[24:27], v2 offset:9216
    s_waitcnt lgkmcnt(5)
    v_mfma_f32_16x16x32_bf16 v[56:59], v[160:163], v[28:31], v[56:59]
    v_mul_f32 v108, v104, v108
    v_mfma_f32_16x16x32_bf16 v[60:63], v[164:167], v[28:31], v[60:63]
    v_mul_f32 v109, v105, v109
    v_mul_f32 v110, v106, v110
    ds_read_b128 v[28:31], v2 offset:27648
    s_waitcnt lgkmcnt(5)
    v_mfma_f32_16x16x32_bf16 v[48:51], v[168:171], v[32:35], v[48:51]
    v_mul_f32 v111, v107, v111
    v_mul_f32 v12, v104, v104
    v_mfma_f32_16x16x32_bf16 v[52:55], v[172:175], v[32:35], v[52:55]
    v_mul_f32 v13, v105, v105
    ds_read_b128 v[32:35], v2 offset:10240
    s_waitcnt lgkmcnt(5)
    v_mfma_f32_16x16x32_bf16 v[56:59], v[168:171], v[36:39], v[56:59]
    v_mul_f32 v14, v106, v106
    v_mul_f32 v15, v107, v107
    v_mfma_f32_16x16x32_bf16 v[60:63], v[172:175], v[36:39], v[60:63]
    v_fma_f32 v12, v12, v21, v20
    v_fma_f32 v13, v13, v21, v20
    ds_read_b128 v[36:39], v2 offset:28672
    s_waitcnt lgkmcnt(5)
    v_mfma_f32_16x16x32_bf16 v[48:51], v[176:179], v[40:43], v[48:51]
    v_fma_f32 v14, v14, v21, v20
    v_mfma_f32_16x16x32_bf16 v[52:55], v[180:183], v[40:43], v[52:55]
    v_fma_f32 v15, v15, v21, v20
    v_mul_f32 v104, v104, v12
    ds_read_b128 v[40:43], v2 offset:11264
    s_waitcnt lgkmcnt(5)
    v_mfma_f32_16x16x32_bf16 v[56:59], v[176:179], v[44:47], v[56:59]
    v_mul_f32 v105, v105, v13
    v_mfma_f32_16x16x32_bf16 v[60:63], v[180:183], v[44:47], v[60:63]
    v_mul_f32 v106, v106, v14
    v_mul_f32 v107, v107, v15
    ds_read_b128 v[44:47], v2 offset:29696
    s_waitcnt lgkmcnt(5)
    v_mfma_f32_16x16x32_bf16 v[48:51], v[184:187], v[24:27], v[48:51]
    v_exp_f32 v104, v104
    v_mfma_f32_16x16x32_bf16 v[52:55], v[188:191], v[24:27], v[52:55]
    ds_read_b128 v[24:27], v2 offset:12288
    s_waitcnt lgkmcnt(5)
    v_mfma_f32_16x16x32_bf16 v[56:59], v[184:187], v[28:31], v[56:59]
    v_exp_f32 v105, v105
    v_mfma_f32_16x16x32_bf16 v[60:63], v[188:191], v[28:31], v[60:63]
    v_exp_f32 v106, v106
    ds_read_b128 v[28:31], v2 offset:30720
    s_waitcnt lgkmcnt(5)
    v_mfma_f32_16x16x32_bf16 v[48:51], v[192:195], v[32:35], v[48:51]
    v_exp_f32 v107, v107
    v_mfma_f32_16x16x32_bf16 v[52:55], v[196:199], v[32:35], v[52:55]
    v_fma_f32 v104, v104, v22, v22
    ds_read_b128 v[32:35], v2 offset:13312
    s_waitcnt lgkmcnt(5)
    v_mfma_f32_16x16x32_bf16 v[56:59], v[192:195], v[36:39], v[56:59]
    v_fma_f32 v105, v105, v22, v22
    v_fma_f32 v106, v106, v22, v22
    v_mfma_f32_16x16x32_bf16 v[60:63], v[196:199], v[36:39], v[60:63]
    v_fma_f32 v107, v107, v22, v22
    ds_read_b128 v[36:39], v2 offset:31744
    s_waitcnt lgkmcnt(5)
    v_mfma_f32_16x16x32_bf16 v[48:51], v[200:203], v[40:43], v[48:51]
    v_rcp_f32 v104, v104
    v_mfma_f32_16x16x32_bf16 v[52:55], v[204:207], v[40:43], v[52:55]
    v_rcp_f32 v105, v105
    ds_read_b128 v[40:43], v2 offset:14336
    s_waitcnt lgkmcnt(5)
    v_mfma_f32_16x16x32_bf16 v[56:59], v[200:203], v[44:47], v[56:59]
    v_rcp_f32 v106, v106
    v_mfma_f32_16x16x32_bf16 v[60:63], v[204:207], v[44:47], v[60:63]
    ds_read_b128 v[44:47], v2 offset:32768
    s_waitcnt vmcnt(0)
    s_barrier
    s_waitcnt lgkmcnt(5)
    v_mfma_f32_16x16x32_bf16 v[48:51], v[208:211], v[24:27], v[48:51]
    v_rcp_f32 v107, v107
    v_mul_f32 v108, v108, v104
    v_mfma_f32_16x16x32_bf16 v[52:55], v[212:215], v[24:27], v[52:55]
    v_mul_f32 v109, v109, v105
    ds_read_b128 v[24:27], v2 offset:15360
    s_waitcnt lgkmcnt(5)
    v_mfma_f32_16x16x32_bf16 v[56:59], v[208:211], v[28:31], v[56:59]
    v_mul_f32 v110, v110, v106
    v_mul_f32 v111, v111, v107
    v_mfma_f32_16x16x32_bf16 v[60:63], v[212:215], v[28:31], v[60:63]
    v_cvt_pk_bf16_f32 v96, v100, v101
    ds_read_b128 v[28:31], v2 offset:33792
    s_waitcnt lgkmcnt(5)
    v_mfma_f32_16x16x32_bf16 v[48:51], v[216:219], v[32:35], v[48:51]
    v_cvt_pk_bf16_f32 v97, v102, v103
    v_cvt_pk_bf16_f32 v98, v108, v109
    v_mfma_f32_16x16x32_bf16 v[52:55], v[220:223], v[32:35], v[52:55]
    v_cvt_pk_bf16_f32 v99, v110, v111
    s_add_u32 s31, s27, 2064384
    v_permlane16_swap_b32 v96, v98
    ds_read_b128 v[32:35], v2 offset:16384
    s_waitcnt lgkmcnt(5)
    v_mfma_f32_16x16x32_bf16 v[56:59], v[216:219], v[36:39], v[56:59]
    v_permlane16_swap_b32 v97, v99
    buffer_store_dwordx4 v[96:99], v7, s[8:11], s31 offen sc1
    v_mfma_f32_16x16x32_bf16 v[60:63], v[220:223], v[36:39], v[60:63]
    ds_read_b128 v[36:39], v2 offset:34816
    s_waitcnt lgkmcnt(5)
    v_mfma_f32_16x16x32_bf16 v[48:51], v[224:227], v[40:43], v[48:51]
    v_mfma_f32_16x16x32_bf16 v[52:55], v[228:231], v[40:43], v[52:55]
    ds_read_b128 v[40:43], v2 offset:17408
    s_waitcnt lgkmcnt(5)
    v_mfma_f32_16x16x32_bf16 v[56:59], v[224:227], v[44:47], v[56:59]
    v_mfma_f32_16x16x32_bf16 v[60:63], v[228:231], v[44:47], v[60:63]
    ds_read_b128 v[44:47], v2 offset:35840
    s_waitcnt lgkmcnt(5)
    v_mfma_f32_16x16x32_bf16 v[48:51], v[232:235], v[24:27], v[48:51]
    v_mfma_f32_16x16x32_bf16 v[52:55], v[236:239], v[24:27], v[52:55]
    ds_read_b128 v[24:27], v2 offset:36864
    s_waitcnt lgkmcnt(5)
    v_mfma_f32_16x16x32_bf16 v[56:59], v[232:235], v[28:31], v[56:59]
    v_mfma_f32_16x16x32_bf16 v[60:63], v[236:239], v[28:31], v[60:63]
    ds_read_b128 v[28:31], v2 offset:37888
    s_waitcnt lgkmcnt(5)
    v_mfma_f32_16x16x32_bf16 v[48:51], v[240:243], v[32:35], v[48:51]
    v_mfma_f32_16x16x32_bf16 v[52:55], v[244:247], v[32:35], v[52:55]
    ds_read_b128 v[32:35], v2 offset:38912
    s_waitcnt lgkmcnt(5)
    v_mfma_f32_16x16x32_bf16 v[56:59], v[240:243], v[36:39], v[56:59]
    v_mfma_f32_16x16x32_bf16 v[60:63], v[244:247], v[36:39], v[60:63]
    ds_read_b128 v[36:39], v2 offset:39936
    s_waitcnt lgkmcnt(5)
    v_mfma_f32_16x16x32_bf16 v[48:51], v[248:251], v[40:43], v[48:51]
    v_mfma_f32_16x16x32_bf16 v[52:55], v[252:255], v[40:43], v[52:55]
    ds_read_b128 v[40:43], v2 offset:40960
    s_waitcnt lgkmcnt(5)
    v_mfma_f32_16x16x32_bf16 v[56:59], v[248:251], v[44:47], v[56:59]
    v_mfma_f32_16x16x32_bf16 v[60:63], v[252:255], v[44:47], v[60:63]
    ds_read_b128 v[44:47], v2 offset:41984
    s_waitcnt lgkmcnt(5)
    v_mfma_f32_16x16x32_bf16 v[64:67], v[112:115], v[24:27], 0
    ds_read_b64 v[16:17], v8 offset:2048
    ds_read_b32 v18, v9 offset:1024
    ds_read_b64 v[20:21], v8 offset:2176
    ds_read_b32 v22, v9 offset:1088
    v_mul_f32 v52, v48, v52
    v_mfma_f32_16x16x32_bf16 v[68:71], v[116:119], v[24:27], 0
    v_mul_f32 v53, v49, v53
    v_mul_f32 v54, v50, v54
    ds_read_b128 v[24:27], v2 offset:43008
    s_waitcnt lgkmcnt(9)
    v_mfma_f32_16x16x32_bf16 v[64:67], v[120:123], v[28:31], v[64:67]
    v_mul_f32 v55, v51, v55
    v_mfma_f32_16x16x32_bf16 v[68:71], v[124:127], v[28:31], v[68:71]
    v_mul_f32 v12, v48, v48
    v_mul_f32 v13, v49, v49
    ds_read_b128 v[28:31], v2 offset:44032
    s_waitcnt lgkmcnt(9)
    v_mfma_f32_16x16x32_bf16 v[64:67], v[128:131], v[32:35], v[64:67]
    v_mul_f32 v14, v50, v50
    v_mul_f32 v15, v51, v51
    s_waitcnt lgkmcnt(4)
    v_mfma_f32_16x16x32_bf16 v[68:71], v[132:135], v[32:35], v[68:71]
    v_fma_f32 v12, v12, v17, v16
    ds_read_b128 v[32:35], v2 offset:45056
    v_mfma_f32_16x16x32_bf16 v[64:67], v[136:139], v[36:39], v[64:67]
    v_fma_f32 v13, v13, v17, v16
    v_fma_f32 v14, v14, v17, v16
    v_mfma_f32_16x16x32_bf16 v[68:71], v[140:143], v[36:39], v[68:71]
    v_fma_f32 v15, v15, v17, v16
    v_mul_f32 v48, v48, v12
    ds_read_b128 v[36:39], v2 offset:46080
    v_mfma_f32_16x16x32_bf16 v[64:67], v[144:147], v[40:43], v[64:67]
    v_mul_f32 v49, v49, v13
    v_mfma_f32_16x16x32_bf16 v[68:71], v[148:151], v[40:43], v[68:71]
    v_mul_f32 v50, v50, v14
    v_mul_f32 v51, v51, v15
    ds_read_b128 v[40:43], v2 offset:47104
    v_mfma_f32_16x16x32_bf16 v[64:67], v[152:155], v[44:47], v[64:67]
    v_mfma_f32_16x16x32_bf16 v[68:71], v[156:159], v[44:47], v[68:71]
    v_exp_f32 v48, v48
    ds_read_b128 v[44:47], v2 offset:48128
    s_waitcnt lgkmcnt(5)
    v_mfma_f32_16x16x32_bf16 v[64:67], v[160:163], v[24:27], v[64:67]
    v_exp_f32 v49, v49
    v_mfma_f32_16x16x32_bf16 v[68:71], v[164:167], v[24:27], v[68:71]
    v_exp_f32 v50, v50
    ds_read_b128 v[24:27], v5 offset:0
    s_waitcnt lgkmcnt(5)
    v_mfma_f32_16x16x32_bf16 v[64:67], v[168:171], v[28:31], v[64:67]
    v_mfma_f32_16x16x32_bf16 v[68:71], v[172:175], v[28:31], v[68:71]
    v_exp_f32 v51, v51
    v_fma_f32 v48, v48, v18, v18
    ds_read_b128 v[28:31], v5 offset:1024
    s_waitcnt lgkmcnt(5)
    v_mfma_f32_16x16x32_bf16 v[64:67], v[176:179], v[32:35], v[64:67]
    v_fma_f32 v49, v49, v18, v18
    v_mfma_f32_16x16x32_bf16 v[68:71], v[180:183], v[32:35], v[68:71]
    v_fma_f32 v50, v50, v18, v18
    v_fma_f32 v51, v51, v18, v18
    ds_read_b128 v[32:35], v5 offset:2048
    s_waitcnt lgkmcnt(5)
    v_mfma_f32_16x16x32_bf16 v[64:67], v[184:187], v[36:39], v[64:67]
    v_mfma_f32_16x16x32_bf16 v[68:71], v[188:191], v[36:39], v[68:71]
    v_rcp_f32 v48, v48
    ds_read_b128 v[36:39], v5 offset:3072
    s_waitcnt lgkmcnt(5)
    v_mfma_f32_16x16x32_bf16 v[64:67], v[192:195], v[40:43], v[64:67]
    v_rcp_f32 v49, v49
    v_mfma_f32_16x16x32_bf16 v[68:71], v[196:199], v[40:43], v[68:71]
    v_rcp_f32 v50, v50
    ds_read_b128 v[40:43], v5 offset:4096
    s_waitcnt lgkmcnt(5)
    v_mfma_f32_16x16x32_bf16 v[64:67], v[200:203], v[44:47], v[64:67]
    v_mfma_f32_16x16x32_bf16 v[68:71], v[204:207], v[44:47], v[68:71]
    v_rcp_f32 v51, v51
    v_mul_f32 v52, v52, v48
    ds_read_b128 v[44:47], v5 offset:5120
    s_waitcnt lgkmcnt(5)
    v_mfma_f32_16x16x32_bf16 v[64:67], v[208:211], v[24:27], v[64:67]
    v_mul_f32 v53, v53, v49
    v_mfma_f32_16x16x32_bf16 v[68:71], v[212:215], v[24:27], v[68:71]
    v_mul_f32 v54, v54, v50
    v_mul_f32 v55, v55, v51
    s_waitcnt lgkmcnt(4)
    v_mfma_f32_16x16x32_bf16 v[64:67], v[216:219], v[28:31], v[64:67]
    v_mul_f32 v60, v56, v60
    v_mfma_f32_16x16x32_bf16 v[68:71], v[220:223], v[28:31], v[68:71]
    v_mul_f32 v61, v57, v61
    v_mul_f32 v62, v58, v62
    s_waitcnt lgkmcnt(3)
    v_mfma_f32_16x16x32_bf16 v[64:67], v[224:227], v[32:35], v[64:67]
    v_mul_f32 v63, v59, v63
    v_mul_f32 v12, v56, v56
    v_mfma_f32_16x16x32_bf16 v[68:71], v[228:231], v[32:35], v[68:71]
    v_mul_f32 v13, v57, v57
    s_waitcnt lgkmcnt(2)
    v_mfma_f32_16x16x32_bf16 v[64:67], v[232:235], v[36:39], v[64:67]
    v_mul_f32 v14, v58, v58
    v_mul_f32 v15, v59, v59
    v_mfma_f32_16x16x32_bf16 v[68:71], v[236:239], v[36:39], v[68:71]
    v_fma_f32 v12, v12, v21, v20
    v_fma_f32 v13, v13, v21, v20
    s_waitcnt lgkmcnt(1)
    v_mfma_f32_16x16x32_bf16 v[64:67], v[240:243], v[40:43], v[64:67]
    v_fma_f32 v14, v14, v21, v20
    v_mfma_f32_16x16x32_bf16 v[68:71], v[244:247], v[40:43], v[68:71]
    v_fma_f32 v15, v15, v21, v20
    v_mul_f32 v56, v56, v12
    s_waitcnt lgkmcnt(0)
    v_mfma_f32_16x16x32_bf16 v[64:67], v[248:251], v[44:47], v[64:67]
    v_mul_f32 v57, v57, v13
    v_mfma_f32_16x16x32_bf16 v[68:71], v[252:255], v[44:47], v[68:71]
    v_mul_f32 v58, v58, v14
    v_mul_f32 v59, v59, v15
    v_exp_f32 v56, v56
    v_exp_f32 v57, v57
    v_exp_f32 v58, v58
    v_exp_f32 v59, v59
    v_fma_f32 v56, v56, v22, v22
    v_fma_f32 v57, v57, v22, v22
    v_fma_f32 v58, v58, v22, v22
    v_fma_f32 v59, v59, v22, v22
    v_rcp_f32 v56, v56
    v_rcp_f32 v57, v57
    v_rcp_f32 v58, v58
    v_rcp_f32 v59, v59
    v_mul_f32 v60, v60, v56
    v_mul_f32 v61, v61, v57
    v_mul_f32 v62, v62, v58
    v_mul_f32 v63, v63, v59
    v_cvt_pk_bf16_f32 v48, v52, v53
    v_cvt_pk_bf16_f32 v49, v54, v55
    v_cvt_pk_bf16_f32 v50, v60, v61
    v_cvt_pk_bf16_f32 v51, v62, v63
    s_add_u32 s31, s27, 2359296
    v_permlane16_swap_b32 v48, v50
    v_permlane16_swap_b32 v49, v51
    buffer_store_dwordx4 v[48:51], v7, s[8:11], s31 offen sc1
    ds_read_b64 v[16:17], v8 offset:2304
    ds_read_b32 v18, v9 offset:1152
    v_mul_f32 v68, v64, v68
    v_mul_f32 v69, v65, v69
    v_mul_f32 v70, v66, v70
    v_mul_f32 v71, v67, v71
    v_mul_f32 v12, v64, v64
    v_mul_f32 v13, v65, v65
    v_mul_f32 v14, v66, v66
    v_mul_f32 v15, v67, v67
    s_waitcnt lgkmcnt(0)
    v_fma_f32 v12, v12, v17, v16
    v_fma_f32 v13, v13, v17, v16
    v_fma_f32 v14, v14, v17, v16
    v_fma_f32 v15, v15, v17, v16
    v_mul_f32 v64, v64, v12
    v_mul_f32 v65, v65, v13
    v_mul_f32 v66, v66, v14
    v_mul_f32 v67, v67, v15
    v_exp_f32 v64, v64
    v_exp_f32 v65, v65
    v_exp_f32 v66, v66
    v_exp_f32 v67, v67
    v_fma_f32 v64, v64, v18, v18
    v_fma_f32 v65, v65, v18, v18
    v_fma_f32 v66, v66, v18, v18
    v_fma_f32 v67, v67, v18, v18
    v_rcp_f32 v64, v64
    v_rcp_f32 v65, v65
    v_rcp_f32 v66, v66
    v_rcp_f32 v67, v67
    v_mul_f32 v68, v68, v64
    v_mul_f32 v69, v69, v65
    v_mul_f32 v70, v70, v66
    v_mul_f32 v71, v71, v67
    v_cvt_pk_bf16_f32 v64, v68, v69
    v_cvt_pk_bf16_f32 v65, v70, v71
    s_add_u32 s31, s27, 2654208
    v_permlane16_swap_b32 v64, v66
    v_permlane16_swap_b32 v65, v67
    s_mov_b32 exec_lo, 0xffff
    s_mov_b32 exec_hi, 0xffff
    buffer_store_dwordx4 v[64:67], v7, s[8:11], s31 offen sc1
k234_mid_kernel_done:
    s_mul_i32 s52, s21, 7
    s_add_u32 s52, s52, s22
    s_lshl_b32 s52, s52, 7
    s_add_u32 s52, s52, 8355840
k234_mid_kernel_k5:
    s_mov_b64 exec, -1
    s_nop 7
    s_load_dwordx4 s[4:7], s[0:1], 48
    s_load_dwordx2 s[40:41], s[0:1], 72
    v_lshrrev_b32 v12, 6, v0
    v_and_b32 v1, 63, v0
    v_readfirstlane_b32 s20, v12
    v_lshlrev_b32 v2, 4, v1
    s_and_b32 s32, s2, 7
    s_lshr_b32 s33, s2, 3
    s_lshr_b32 s21, s32, 1
    s_and_b32 s22, s32, 1
    s_and_b32 s32, s33, 7
    s_lshl_b32 s32, s32, 1
    s_add_u32 s22, s22, s32
    s_lshr_b32 s23, s33, 3
    s_and_b32 s24, s20, 3
    s_lshr_b32 s25, s20, 2
    s_andn2_b32 s30, s2, 6
    s_lshl_b32 s32, s24, 1
    s_or_b32 s30, s30, s32
    s_mul_i32 s26, s21, 1327104
    s_mul_i32 s32, s23, 288
    s_add_u32 s26, s26, s32
    s_add_u32 s26, s26, 0
    s_lshl_b32 s32, s22, 3
    s_lshr_b32 s33, s20, 1
    s_add_u32 s32, s32, s33
    s_mul_i32 s27, s32, 147456
    s_mul_i32 s33, s21, 36864
    s_add_u32 s27, s27, s33
    s_and_b32 s33, s20, 1
    s_lshl_b32 s33, s33, 10
    s_add_u32 s27, s27, s33
    s_add_u32 s27, s27, 16777216
    s_add_u32 s28, s27, 589824
    s_lshl_b32 s29, s20, 10
    s_mov_b32 s36, 0x00003f80
    s_mov_b32 s37, 0x3f800000
    v_add_u32 v12, 0, v0
    v_mul_u32_u24 v13, 3641, v12
    v_lshrrev_b32 v13, 16, v13
    v_mul_u32_u24 v14, 18, v13
    v_sub_u32 v14, v12, v14
    v_and_b32 v12, 0x63, v13
    v_bfe_u32 v15, v13, 2, 2
    v_lshl_or_b32 v12, v15, 3, v12
    v_bfe_u32 v15, v13, 4, 1
    v_lshl_or_b32 v12, v15, 2, v12
    v_mul_u32_u24 v12, 1152, v12
    v_lshl_add_u32 v3, v14, 4, v12
    v_add_u32 v12, 512, v0
    v_mul_u32_u24 v13, 3641, v12
    v_lshrrev_b32 v13, 16, v13
    v_mul_u32_u24 v14, 18, v13
    v_sub_u32 v14, v12, v14
    v_and_b32 v12, 0x63, v13
    v_bfe_u32 v15, v13, 2, 2
    v_lshl_or_b32 v12, v15, 3, v12
    v_bfe_u32 v15, v13, 4, 1
    v_lshl_or_b32 v12, v15, 2, v12
    v_mul_u32_u24 v12, 1152, v12
    v_lshl_add_u32 v4, v14, 4, v12
    v_add_u32 v12, 1024, v0
    v_mul_u32_u24 v13, 3641, v12
    v_lshrrev_b32 v13, 16, v13
    v_mul_u32_u24 v14, 18, v13
    v_sub_u32 v14, v12, v14
    v_and_b32 v12, 0x63, v13
    v_bfe_u32 v15, v13, 2, 2
    v_lshl_or_b32 v12, v15, 3, v12
    v_bfe_u32 v15, v13, 4, 1
    v_lshl_or_b32 v12, v15, 2, v12
    v_mul_u32_u24 v12, 1152, v12
    v_lshl_add_u32 v5, v14, 4, v12
    s_waitcnt lgkmcnt(0)
    s_mov_b32 s12, s4
    s_mov_b32 s13, s5
    s_mov_b32 s14, 5308416
    s_mov_b32 s15, 0x00020000
    s_mov_b32 s16, s6
    s_mov_b32 s17, s7
    s_mov_b32 s18, 2359296
    s_mov_b32 s19, 0x00020000
    s_mov_b32 s8, s40
    s_mov_b32 s9, s41
    s_mov_b32 s10, 67108864
    s_mov_b32 s11, 0x00020000
    s_lshl_b32 s32, s22, 3
    s_add_u32 s32, s32, 0
    s_mul_i32 s33, s32, 3450
    s_sub_u32 s34, s32, 2
    s_mul_i32 s34, s34, 3641
    s_cmp_lt_u32 s32, 38
    s_cselect_b32 s33, s33, s34
    s_lshr_b32 s42, s33, 16
    s_lshl_b32 s32, s22, 3
    s_add_u32 s32, s32, 7
    s_mul_i32 s33, s32, 3450
    s_sub_u32 s34, s32, 2
    s_mul_i32 s34, s34, 3641
    s_cmp_lt_u32 s32, 38
    s_cselect_b32 s33, s33, s34
    s_lshr_b32 s43, s33, 16
    s_mul_i32 s32, s21, 63
    s_add_u32 s42, s42, s32
    s_add_u32 s43, s43, s32
    s_sub_u32 s43, s43, 63
    v_min_u32 v12, 17, v1
    v_mul_u32_u24 v13, 7, v12
    v_mov_b32 v14, s42
    v_mov_b32 v15, s43
    v_cmp_gt_u32 vcc, 9, v12
    s_nop 1
    v_cndmask_b32 v14, v15, v14, vcc
    v_add_u32 v13, v13, v14
    v_lshlrev_b32 v17, 7, v13
    s_mov_b32 s44, 8355840
    s_mov_b32 s38, 100000
    s_waitcnt vmcnt(0)
    s_barrier
    s_cmp_lg_u32 s20, 0
    s_cbranch_scc1 k234_mid_kernel_f_nf
    s_cmp_ge_u32 s2, 252
    s_cbranch_scc1 k234_mid_kernel_f_nf
    v_mov_b32 v12, 0
    s_mov_b64 exec, 1
    buffer_store_dword v12, v12, s[8:11], s52 offen sc1
    s_mov_b64 exec, -1
k234_mid_kernel_f_nf:
    s_add_u32 m0, s29, 0
    s_nop 0
    buffer_load_dwordx4 v3, s[12:15], s26 offen lds
    s_add_u32 m0, s29, 8192
    s_nop 0
    buffer_load_dwordx4 v4, s[12:15], s26 offen lds
    s_cmp_ge_u32 s20, 2
    s_cbranch_scc1 k234_mid_kernel_f_sk1
    s_add_u32 m0, s29, 16384
    s_nop 0
    buffer_load_dwordx4 v5, s[12:15], s26 offen lds
k234_mid_kernel_f_sk1:
    s_add_u32 s26, s26, 73728
    s_add_u32 m0, s29, 34816
    s_nop 0
    buffer_load_dwordx4 v3, s[12:15], s26 offen lds
    s_add_u32 m0, s29, 43008
    s_nop 0
    buffer_load_dwordx4 v4, s[12:15], s26 offen lds
    s_cmp_ge_u32 s20, 2
    s_cbranch_scc1 k234_mid_kernel_f_sk2
    s_add_u32 m0, s29, 51200
    s_nop 0
    buffer_load_dwordx4 v5, s[12:15], s26 offen lds
k234_mid_kernel_f_sk2:
    s_add_u32 s26, s26, 73728
    buffer_load_dword v143, v2, s[16:19], 0 offen
    s_cmp_lg_u32 s20, 7
    s_cbranch_scc1 k234_mid_kernel_f_np
k234_mid_kernel_f_poll:
    buffer_load_dword v14, v17, s[8:11], s44 offen sc1
    s_waitcnt vmcnt(0)
    v_cmp_ne_u32 vcc, 0, v14
    s_sub_u32 s38, s38, 1
    s_cmp_eq_u32 s38, 0
    s_cbranch_scc1 k234_mid_kernel_f_np
    s_cbranch_vccz k234_mid_kernel_f_np
    s_sleep 6
    s_branch k234_mid_kernel_f_poll
k234_mid_kernel_f_np:
    s_barrier
    s_add_u32 m0, s29, 18432
    s_nop 0
    buffer_load_dwordx4 v2, s[8:11], s27 offen sc1 lds
    s_add_u32 s27, s27, 2048
    s_add_u32 m0, s29, 26624
    s_nop 0
    buffer_load_dwordx4 v2, s[8:11], s28 offen sc1 lds
    s_add_u32 s28, s28, 2048
    s_add_u32 m0, s29, 53248
    s_nop 0
    buffer_load_dwordx4 v2, s[8:11], s27 offen sc1 lds
    s_add_u32 s27, s27, 2048
    s_add_u32 m0, s29, 61440
    s_nop 0
    buffer_load_dwordx4 v2, s[8:11], s28 offen sc1 lds
    s_add_u32 s28, s28, 2048
    v_lshrrev_b32 v12, 2, v1
    v_mul_u32_u24 v12, 288, v12
    v_and_b32 v13, 3, v1
    v_lshl_add_u32 v6, v13, 3, v12
    v_add_u32 v7, 69632, v6
    s_lshl_b32 s32, s24, 12
    v_add_u32 v8, s32, v2
    v_add_u32 v9, 69632, v8
    v_add_u32 v10, 1024, v8
    v_add_u32 v11, 70656, v8
    s_waitcnt vmcnt(2)
    s_barrier
    s_cmp_lg_u32 s25, 0
    s_cbranch_scc1 k234_mid_kernel_f_h1
    ds_read_b128 v[100:103], v8 offset:18432
    ds_read_b128 v[104:107], v8 offset:20480
    ds_read_b64_tr_b16 v[60:61], v6 offset:0
    ds_read_b64_tr_b16 v[62:63], v6 offset:4608
    ds_read_b64_tr_b16 v[64:65], v6 offset:32
    ds_read_b64_tr_b16 v[66:67], v6 offset:4640
    ds_read_b64_tr_b16 v[68:69], v6 offset:64
    ds_read_b64_tr_b16 v[70:71], v6 offset:4672
    ds_read_b64_tr_b16 v[72:73], v6 offset:96
    ds_read_b64_tr_b16 v[74:75], v6 offset:4704
    ds_read_b64_tr_b16 v[76:77], v6 offset:128
    ds_read_b64_tr_b16 v[78:79], v6 offset:4736
    s_waitcnt lgkmcnt(8)
    v_mfma_f32_16x16x32_bf16 v[20:23], v[60:63], v[100:103], 0
    ds_read_b128 v[108:111], v10 offset:18432
    ds_read_b128 v[112:115], v10 offset:20480
    s_add_u32 m0, s29, 69632
    s_nop 0
    buffer_load_dwordx4 v3, s[12:15], s26 offen lds
    v_mfma_f32_16x16x32_bf16 v[24:27], v[60:63], v[104:107], 0
    ds_read_b64_tr_b16 v[80:81], v6 offset:9216
    ds_read_b64_tr_b16 v[82:83], v6 offset:13824
    s_add_u32 m0, s29, 88064
    s_nop 0
    buffer_load_dwordx4 v2, s[8:11], s27 offen sc1 lds
    s_add_u32 s27, s27, 2048
    s_waitcnt lgkmcnt(10)
    v_mfma_f32_16x16x32_bf16 v[28:31], v[64:67], v[100:103], 0
    ds_read_b64_tr_b16 v[84:85], v6 offset:9248
    ds_read_b64_tr_b16 v[86:87], v6 offset:13856
    s_add_u32 m0, s29, 77824
    s_nop 0
    buffer_load_dwordx4 v4, s[12:15], s26 offen lds
    v_mfma_f32_16x16x32_bf16 v[32:35], v[64:67], v[104:107], 0
    ds_read_b64_tr_b16 v[88:89], v6 offset:9280
    ds_read_b64_tr_b16 v[90:91], v6 offset:13888
    s_waitcnt lgkmcnt(12)
    v_mfma_f32_16x16x32_bf16 v[36:39], v[68:71], v[100:103], 0
    ds_read_b64_tr_b16 v[92:93], v6 offset:9312
    ds_read_b64_tr_b16 v[94:95], v6 offset:13920
    s_add_u32 m0, s29, 96256
    s_nop 0
    buffer_load_dwordx4 v2, s[8:11], s28 offen sc1 lds
    s_add_u32 s28, s28, 2048
    v_mfma_f32_16x16x32_bf16 v[40:43], v[68:71], v[104:107], 0
    ds_read_b64_tr_b16 v[96:97], v6 offset:9344
    ds_read_b64_tr_b16 v[98:99], v6 offset:13952
    s_waitcnt lgkmcnt(14)
    v_mfma_f32_16x16x32_bf16 v[44:47], v[72:75], v[100:103], 0
    s_cmp_ge_u32 s20, 2
    s_cbranch_scc1 k234_mid_kernel_f_h0sk3
    s_add_u32 m0, s29, 86016
    s_nop 0
    buffer_load_dwordx4 v5, s[12:15], s26 offen lds
k234_mid_kernel_f_h0sk3:
    s_add_u32 s26, s26, 73728
    v_mfma_f32_16x16x32_bf16 v[48:51], v[72:75], v[104:107], 0
    s_add_u32 m0, s29, 104448
    s_nop 0
    buffer_load_dwordx4 v3, s[12:15], s26 offen lds
    s_waitcnt lgkmcnt(12)
    v_mfma_f32_16x16x32_bf16 v[52:55], v[76:79], v[100:103], 0
    v_mfma_f32_16x16x32_bf16 v[56:59], v[76:79], v[104:107], 0
    s_waitcnt vmcnt(5)
    s_barrier
    s_waitcnt lgkmcnt(8)
    v_mfma_f32_16x16x32_bf16 v[20:23], v[80:83], v[108:111], v[20:23]
    ds_read_b128 v[100:103], v8 offset:53248
    ds_read_b128 v[104:107], v8 offset:55296
    v_mfma_f32_16x16x32_bf16 v[24:27], v[80:83], v[112:115], v[24:27]
    ds_read_b64_tr_b16 v[60:61], v6 offset:34816
    ds_read_b64_tr_b16 v[62:63], v6 offset:39424
    s_add_u32 m0, s29, 122880
    s_nop 0
    buffer_load_dwordx4 v2, s[8:11], s27 offen sc1 lds
    s_add_u32 s27, s27, 2048
    s_waitcnt lgkmcnt(10)
    v_mfma_f32_16x16x32_bf16 v[28:31], v[84:87], v[108:111], v[28:31]
    ds_read_b64_tr_b16 v[64:65], v6 offset:34848
    ds_read_b64_tr_b16 v[66:67], v6 offset:39456
    v_mfma_f32_16x16x32_bf16 v[32:35], v[84:87], v[112:115], v[32:35]
    ds_read_b64_tr_b16 v[68:69], v6 offset:34880
    ds_read_b64_tr_b16 v[70:71], v6 offset:39488
    s_waitcnt lgkmcnt(12)
    v_mfma_f32_16x16x32_bf16 v[36:39], v[88:91], v[108:111], v[36:39]
    ds_read_b64_tr_b16 v[72:73], v6 offset:34912
    ds_read_b64_tr_b16 v[74:75], v6 offset:39520
    s_add_u32 m0, s29, 112640
    s_nop 0
    buffer_load_dwordx4 v4, s[12:15], s26 offen lds
    v_mfma_f32_16x16x32_bf16 v[40:43], v[88:91], v[112:115], v[40:43]
    ds_read_b64_tr_b16 v[76:77], v6 offset:34944
    ds_read_b64_tr_b16 v[78:79], v6 offset:39552
    s_waitcnt lgkmcnt(14)
    v_mfma_f32_16x16x32_bf16 v[44:47], v[92:95], v[108:111], v[44:47]
    v_mfma_f32_16x16x32_bf16 v[48:51], v[92:95], v[112:115], v[48:51]
    s_add_u32 m0, s29, 131072
    s_nop 0
    buffer_load_dwordx4 v2, s[8:11], s28 offen sc1 lds
    s_add_u32 s28, s28, 2048
    s_waitcnt lgkmcnt(12)
    v_mfma_f32_16x16x32_bf16 v[52:55], v[96:99], v[108:111], v[52:55]
    v_mfma_f32_16x16x32_bf16 v[56:59], v[96:99], v[112:115], v[56:59]
    s_waitcnt lgkmcnt(8)
    v_mfma_f32_16x16x32_bf16 v[20:23], v[60:63], v[100:103], v[20:23]
    ds_read_b128 v[108:111], v10 offset:53248
    ds_read_b128 v[112:115], v10 offset:55296
    v_mfma_f32_16x16x32_bf16 v[24:27], v[60:63], v[104:107], v[24:27]
    ds_read_b64_tr_b16 v[80:81], v6 offset:44032
    ds_read_b64_tr_b16 v[82:83], v6 offset:48640
    s_cmp_ge_u32 s20, 2
    s_cbranch_scc1 k234_mid_kernel_f_h0sk4
    s_add_u32 m0, s29, 120832
    s_nop 0
    buffer_load_dwordx4 v5, s[12:15], s26 offen lds
k234_mid_kernel_f_h0sk4:
    s_add_u32 s26, s26, 73728
    s_waitcnt lgkmcnt(10)
    v_mfma_f32_16x16x32_bf16 v[28:31], v[64:67], v[100:103], v[28:31]
    ds_read_b64_tr_b16 v[84:85], v6 offset:44064
    ds_read_b64_tr_b16 v[86:87], v6 offset:48672
    v_mfma_f32_16x16x32_bf16 v[32:35], v[64:67], v[104:107], v[32:35]
    ds_read_b64_tr_b16 v[88:89], v6 offset:44096
    ds_read_b64_tr_b16 v[90:91], v6 offset:48704
    s_waitcnt lgkmcnt(12)
    v_mfma_f32_16x16x32_bf16 v[36:39], v[68:71], v[100:103], v[36:39]
    ds_read_b64_tr_b16 v[92:93], v6 offset:44128
    ds_read_b64_tr_b16 v[94:95], v6 offset:48736
    v_mfma_f32_16x16x32_bf16 v[40:43], v[68:71], v[104:107], v[40:43]
    ds_read_b64_tr_b16 v[96:97], v6 offset:44160
    ds_read_b64_tr_b16 v[98:99], v6 offset:48768
    s_waitcnt lgkmcnt(14)
    v_mfma_f32_16x16x32_bf16 v[44:47], v[72:75], v[100:103], v[44:47]
    v_mfma_f32_16x16x32_bf16 v[48:51], v[72:75], v[104:107], v[48:51]
    s_waitcnt lgkmcnt(12)
    v_mfma_f32_16x16x32_bf16 v[52:55], v[76:79], v[100:103], v[52:55]
    v_mfma_f32_16x16x32_bf16 v[56:59], v[76:79], v[104:107], v[56:59]
    s_waitcnt vmcnt(4)
    s_barrier
    s_waitcnt lgkmcnt(8)
    v_mfma_f32_16x16x32_bf16 v[20:23], v[80:83], v[108:111], v[20:23]
    ds_read_b128 v[100:103], v9 offset:18432
    ds_read_b128 v[104:107], v9 offset:20480
    v_mfma_f32_16x16x32_bf16 v[24:27], v[80:83], v[112:115], v[24:27]
    ds_read_b64_tr_b16 v[60:61], v7 offset:0
    ds_read_b64_tr_b16 v[62:63], v7 offset:4608
    s_add_u32 m0, s29, 0
    s_nop 0
    buffer_load_dwordx4 v3, s[12:15], s26 offen lds
    s_waitcnt lgkmcnt(10)
    v_mfma_f32_16x16x32_bf16 v[28:31], v[84:87], v[108:111], v[28:31]
    ds_read_b64_tr_b16 v[64:65], v7 offset:32
    ds_read_b64_tr_b16 v[66:67], v7 offset:4640
    v_mfma_f32_16x16x32_bf16 v[32:35], v[84:87], v[112:115], v[32:35]
    ds_read_b64_tr_b16 v[68:69], v7 offset:64
    ds_read_b64_tr_b16 v[70:71], v7 offset:4672
    s_waitcnt lgkmcnt(12)
    v_mfma_f32_16x16x32_bf16 v[36:39], v[88:91], v[108:111], v[36:39]
    ds_read_b64_tr_b16 v[72:73], v7 offset:96
    ds_read_b64_tr_b16 v[74:75], v7 offset:4704
    s_add_u32 m0, s29, 18432
    s_nop 0
    buffer_load_dwordx4 v2, s[8:11], s27 offen sc1 lds
    s_add_u32 s27, s27, 2048
    v_mfma_f32_16x16x32_bf16 v[40:43], v[88:91], v[112:115], v[40:43]
    ds_read_b64_tr_b16 v[76:77], v7 offset:128
    ds_read_b64_tr_b16 v[78:79], v7 offset:4736
    s_waitcnt lgkmcnt(14)
    v_mfma_f32_16x16x32_bf16 v[44:47], v[92:95], v[108:111], v[44:47]
    v_mfma_f32_16x16x32_bf16 v[48:51], v[92:95], v[112:115], v[48:51]
    s_add_u32 m0, s29, 8192
    s_nop 0
    buffer_load_dwordx4 v4, s[12:15], s26 offen lds
    s_waitcnt lgkmcnt(12)
    v_mfma_f32_16x16x32_bf16 v[52:55], v[96:99], v[108:111], v[52:55]
    v_mfma_f32_16x16x32_bf16 v[56:59], v[96:99], v[112:115], v[56:59]
    s_waitcnt lgkmcnt(8)
    v_mfma_f32_16x16x32_bf16 v[20:23], v[60:63], v[100:103], v[20:23]
    ds_read_b128 v[108:111], v11 offset:18432
    ds_read_b128 v[112:115], v11 offset:20480
    v_mfma_f32_16x16x32_bf16 v[24:27], v[60:63], v[104:107], v[24:27]
    ds_read_b64_tr_b16 v[80:81], v7 offset:9216
    ds_read_b64_tr_b16 v[82:83], v7 offset:13824
    s_add_u32 m0, s29, 26624
    s_nop 0
    buffer_load_dwordx4 v2, s[8:11], s28 offen sc1 lds
    s_add_u32 s28, s28, 2048
    s_waitcnt lgkmcnt(10)
    v_mfma_f32_16x16x32_bf16 v[28:31], v[64:67], v[100:103], v[28:31]
    ds_read_b64_tr_b16 v[84:85], v7 offset:9248
    ds_read_b64_tr_b16 v[86:87], v7 offset:13856
    v_mfma_f32_16x16x32_bf16 v[32:35], v[64:67], v[104:107], v[32:35]
    ds_read_b64_tr_b16 v[88:89], v7 offset:9280
    ds_read_b64_tr_b16 v[90:91], v7 offset:13888
    s_waitcnt lgkmcnt(12)
    v_mfma_f32_16x16x32_bf16 v[36:39], v[68:71], v[100:103], v[36:39]
    ds_read_b64_tr_b16 v[92:93], v7 offset:9312
    ds_read_b64_tr_b16 v[94:95], v7 offset:13920
    s_cmp_ge_u32 s20, 2
    s_cbranch_scc1 k234_mid_kernel_f_h0sk5
    s_add_u32 m0, s29, 16384
    s_nop 0
    buffer_load_dwordx4 v5, s[12:15], s26 offen lds
k234_mid_kernel_f_h0sk5:
    s_add_u32 s26, s26, 73728
    v_mfma_f32_16x16x32_bf16 v[40:43], v[68:71], v[104:107], v[40:43]
    ds_read_b64_tr_b16 v[96:97], v7 offset:9344
    ds_read_b64_tr_b16 v[98:99], v7 offset:13952
    s_waitcnt lgkmcnt(14)
    v_mfma_f32_16x16x32_bf16 v[44:47], v[72:75], v[100:103], v[44:47]
    v_mfma_f32_16x16x32_bf16 v[48:51], v[72:75], v[104:107], v[48:51]
    s_waitcnt lgkmcnt(12)
    v_mfma_f32_16x16x32_bf16 v[52:55], v[76:79], v[100:103], v[52:55]
    v_mfma_f32_16x16x32_bf16 v[56:59], v[76:79], v[104:107], v[56:59]
    s_waitcnt vmcnt(4)
    s_barrier
    s_waitcnt lgkmcnt(8)
    v_mfma_f32_16x16x32_bf16 v[20:23], v[80:83], v[108:111], v[20:23]
    ds_read_b128 v[100:103], v9 offset:53248
    ds_read_b128 v[104:107], v9 offset:55296
    v_mfma_f32_16x16x32_bf16 v[24:27], v[80:83], v[112:115], v[24:27]
    ds_read_b64_tr_b16 v[60:61], v7 offset:34816
    ds_read_b64_tr_b16 v[62:63], v7 offset:39424
    s_add_u32 m0, s29, 34816
    s_nop 0
    buffer_load_dwordx4 v3, s[12:15], s26 offen lds
    s_waitcnt lgkmcnt(10)
    v_mfma_f32_16x16x32_bf16 v[28:31], v[84:87], v[108:111], v[28:31]
    ds_read_b64_tr_b16 v[64:65], v7 offset:34848
    ds_read_b64_tr_b16 v[66:67], v7 offset:39456
    v_mfma_f32_16x16x32_bf16 v[32:35], v[84:87], v[112:115], v[32:35]
    ds_read_b64_tr_b16 v[68:69], v7 offset:34880
    ds_read_b64_tr_b16 v[70:71], v7 offset:39488
    s_waitcnt lgkmcnt(12)
    v_mfma_f32_16x16x32_bf16 v[36:39], v[88:91], v[108:111], v[36:39]
    ds_read_b64_tr_b16 v[72:73], v7 offset:34912
    ds_read_b64_tr_b16 v[74:75], v7 offset:39520
    s_add_u32 m0, s29, 53248
    s_nop 0
    buffer_load_dwordx4 v2, s[8:11], s27 offen sc1 lds
    s_add_u32 s27, s27, 2048
    v_mfma_f32_16x16x32_bf16 v[40:43], v[88:91], v[112:115], v[40:43]
    ds_read_b64_tr_b16 v[76:77], v7 offset:34944
    ds_read_b64_tr_b16 v[78:79], v7 offset:39552
    s_waitcnt lgkmcnt(14)
    v_mfma_f32_16x16x32_bf16 v[44:47], v[92:95], v[108:111], v[44:47]
    v_mfma_f32_16x16x32_bf16 v[48:51], v[92:95], v[112:115], v[48:51]
    s_add_u32 m0, s29, 43008
    s_nop 0
    buffer_load_dwordx4 v4, s[12:15], s26 offen lds
    s_waitcnt lgkmcnt(12)
    v_mfma_f32_16x16x32_bf16 v[52:55], v[96:99], v[108:111], v[52:55]
    v_mfma_f32_16x16x32_bf16 v[56:59], v[96:99], v[112:115], v[56:59]
    s_waitcnt lgkmcnt(8)
    v_mfma_f32_16x16x32_bf16 v[20:23], v[60:63], v[100:103], v[20:23]
    ds_read_b128 v[108:111], v11 offset:53248
    ds_read_b128 v[112:115], v11 offset:55296
    v_mfma_f32_16x16x32_bf16 v[24:27], v[60:63], v[104:107], v[24:27]
    ds_read_b64_tr_b16 v[80:81], v7 offset:44032
    ds_read_b64_tr_b16 v[82:83], v7 offset:48640
    s_add_u32 m0, s29, 61440
    s_nop 0
    buffer_load_dwordx4 v2, s[8:11], s28 offen sc1 lds
    s_add_u32 s28, s28, 2048
    s_waitcnt lgkmcnt(10)
    v_mfma_f32_16x16x32_bf16 v[28:31], v[64:67], v[100:103], v[28:31]
    ds_read_b64_tr_b16 v[84:85], v7 offset:44064
    ds_read_b64_tr_b16 v[86:87], v7 offset:48672
    v_mfma_f32_16x16x32_bf16 v[32:35], v[64:67], v[104:107], v[32:35]
    ds_read_b64_tr_b16 v[88:89], v7 offset:44096
    ds_read_b64_tr_b16 v[90:91], v7 offset:48704
    s_waitcnt lgkmcnt(12)
    v_mfma_f32_16x16x32_bf16 v[36:39], v[68:71], v[100:103], v[36:39]
    ds_read_b64_tr_b16 v[92:93], v7 offset:44128
    ds_read_b64_tr_b16 v[94:95], v7 offset:48736
    s_cmp_ge_u32 s20, 2
    s_cbranch_scc1 k234_mid_kernel_f_h0sk6
    s_add_u32 m0, s29, 51200
    s_nop 0
    buffer_load_dwordx4 v5, s[12:15], s26 offen lds
k234_mid_kernel_f_h0sk6:
    s_add_u32 s26, s26, 73728
    v_mfma_f32_16x16x32_bf16 v[40:43], v[68:71], v[104:107], v[40:43]
    ds_read_b64_tr_b16 v[96:97], v7 offset:44160
    ds_read_b64_tr_b16 v[98:99], v7 offset:48768
    s_waitcnt lgkmcnt(14)
    v_mfma_f32_16x16x32_bf16 v[44:47], v[72:75], v[100:103], v[44:47]
    v_mfma_f32_16x16x32_bf16 v[48:51], v[72:75], v[104:107], v[48:51]
    s_waitcnt lgkmcnt(12)
    v_mfma_f32_16x16x32_bf16 v[52:55], v[76:79], v[100:103], v[52:55]
    v_mfma_f32_16x16x32_bf16 v[56:59], v[76:79], v[104:107], v[56:59]
    s_waitcnt vmcnt(4)
    s_barrier
    s_waitcnt lgkmcnt(8)
    v_mfma_f32_16x16x32_bf16 v[20:23], v[80:83], v[108:111], v[20:23]
    ds_read_b128 v[100:103], v8 offset:18432
    ds_read_b128 v[104:107], v8 offset:20480
    v_mfma_f32_16x16x32_bf16 v[24:27], v[80:83], v[112:115], v[24:27]
    ds_read_b64_tr_b16 v[60:61], v6 offset:0
    ds_read_b64_tr_b16 v[62:63], v6 offset:4608
    s_add_u32 m0, s29, 69632
    s_nop 0
    buffer_load_dwordx4 v3, s[12:15], s26 offen lds
    s_waitcnt lgkmcnt(10)
    v_mfma_f32_16x16x32_bf16 v[28:31], v[84:87], v[108:111], v[28:31]
    ds_read_b64_tr_b16 v[64:65], v6 offset:32
    ds_read_b64_tr_b16 v[66:67], v6 offset:4640
    v_mfma_f32_16x16x32_bf16 v[32:35], v[84:87], v[112:115], v[32:35]
    ds_read_b64_tr_b16 v[68:69], v6 offset:64
    ds_read_b64_tr_b16 v[70:71], v6 offset:4672
    s_waitcnt lgkmcnt(12)
    v_mfma_f32_16x16x32_bf16 v[36:39], v[88:91], v[108:111], v[36:39]
    ds_read_b64_tr_b16 v[72:73], v6 offset:96
    ds_read_b64_tr_b16 v[74:75], v6 offset:4704
    s_add_u32 m0, s29, 88064
    s_nop 0
    buffer_load_dwordx4 v2, s[8:11], s27 offen sc1 lds
    s_add_u32 s27, s27, 2048
    v_mfma_f32_16x16x32_bf16 v[40:43], v[88:91], v[112:115], v[40:43]
    ds_read_b64_tr_b16 v[76:77], v6 offset:128
    ds_read_b64_tr_b16 v[78:79], v6 offset:4736
    s_waitcnt lgkmcnt(14)
    v_mfma_f32_16x16x32_bf16 v[44:47], v[92:95], v[108:111], v[44:47]
    v_mfma_f32_16x16x32_bf16 v[48:51], v[92:95], v[112:115], v[48:51]
    s_add_u32 m0, s29, 77824
    s_nop 0
    buffer_load_dwordx4 v4, s[12:15], s26 offen lds
    s_waitcnt lgkmcnt(12)
    v_mfma_f32_16x16x32_bf16 v[52:55], v[96:99], v[108:111], v[52:55]
    v_mfma_f32_16x16x32_bf16 v[56:59], v[96:99], v[112:115], v[56:59]
    s_waitcnt lgkmcnt(8)
    v_mfma_f32_16x16x32_bf16 v[20:23], v[60:63], v[100:103], v[20:23]
    ds_read_b128 v[108:111], v10 offset:18432
    ds_read_b128 v[112:115], v10 offset:20480
    v_mfma_f32_16x16x32_bf16 v[24:27], v[60:63], v[104:107], v[24:27]
    ds_read_b64_tr_b16 v[80:81], v6 offset:9216
    ds_read_b64_tr_b16 v[82:83], v6 offset:13824
    s_add_u32 m0, s29, 96256
    s_nop 0
    buffer_load_dwordx4 v2, s[8:11], s28 offen sc1 lds
    s_add_u32 s28, s28, 2048
    s_waitcnt lgkmcnt(10)
    v_mfma_f32_16x16x32_bf16 v[28:31], v[64:67], v[100:103], v[28:31]
    ds_read_b64_tr_b16 v[84:85], v6 offset:9248
    ds_read_b64_tr_b16 v[86:87], v6 offset:13856
    v_mfma_f32_16x16x32_bf16 v[32:35], v[64:67], v[104:107], v[32:35]
    ds_read_b64_tr_b16 v[88:89], v6 offset:9280
    ds_read_b64_tr_b16 v[90:91], v6 offset:13888
    s_waitcnt lgkmcnt(12)
    v_mfma_f32_16x16x32_bf16 v[36:39], v[68:71], v[100:103], v[36:39]
    ds_read_b64_tr_b16 v[92:93], v6 offset:9312
    ds_read_b64_tr_b16 v[94:95], v6 offset:13920
    s_cmp_ge_u32 s20, 2
    s_cbranch_scc1 k234_mid_kernel_f_h0sk7
    s_add_u32 m0, s29, 86016
    s_nop 0
    buffer_load_dwordx4 v5, s[12:15], s26 offen lds
k234_mid_kernel_f_h0sk7:
    s_add_u32 s26, s26, 73728
    v_mfma_f32_16x16x32_bf16 v[40:43], v[68:71], v[104:107], v[40:43]
    ds_read_b64_tr_b16 v[96:97], v6 offset:9344
    ds_read_b64_tr_b16 v[98:99], v6 offset:13952
    s_waitcnt lgkmcnt(14)
    v_mfma_f32_16x16x32_bf16 v[44:47], v[72:75], v[100:103], v[44:47]
    v_mfma_f32_16x16x32_bf16 v[48:51], v[72:75], v[104:107], v[48:51]
    s_waitcnt lgkmcnt(12)
    v_mfma_f32_16x16x32_bf16 v[52:55], v[76:79], v[100:103], v[52:55]
    v_mfma_f32_16x16x32_bf16 v[56:59], v[76:79], v[104:107], v[56:59]
    s_waitcnt vmcnt(4)
    s_barrier
    s_waitcnt lgkmcnt(8)
    v_mfma_f32_16x16x32_bf16 v[20:23], v[80:83], v[108:111], v[20:23]
    ds_read_b128 v[100:103], v8 offset:53248
    ds_read_b128 v[104:107], v8 offset:55296
    v_mfma_f32_16x16x32_bf16 v[24:27], v[80:83], v[112:115], v[24:27]
    ds_read_b64_tr_b16 v[60:61], v6 offset:34816
    ds_read_b64_tr_b16 v[62:63], v6 offset:39424
    s_add_u32 m0, s29, 104448
    s_nop 0
    buffer_load_dwordx4 v3, s[12:15], s26 offen lds
    s_waitcnt lgkmcnt(10)
    v_mfma_f32_16x16x32_bf16 v[28:31], v[84:87], v[108:111], v[28:31]
    ds_read_b64_tr_b16 v[64:65], v6 offset:34848
    ds_read_b64_tr_b16 v[66:67], v6 offset:39456
    v_mfma_f32_16x16x32_bf16 v[32:35], v[84:87], v[112:115], v[32:35]
    ds_read_b64_tr_b16 v[68:69], v6 offset:34880
    ds_read_b64_tr_b16 v[70:71], v6 offset:39488
    s_waitcnt lgkmcnt(12)
    v_mfma_f32_16x16x32_bf16 v[36:39], v[88:91], v[108:111], v[36:39]
    ds_read_b64_tr_b16 v[72:73], v6 offset:34912
    ds_read_b64_tr_b16 v[74:75], v6 offset:39520
    s_add_u32 m0, s29, 122880
    s_nop 0
    buffer_load_dwordx4 v2, s[8:11], s27 offen sc1 lds
    s_add_u32 s27, s27, 2048
    v_mfma_f32_16x16x32_bf16 v[40:43], v[88:91], v[112:115], v[40:43]
    ds_read_b64_tr_b16 v[76:77], v6 offset:34944
    ds_read_b64_tr_b16 v[78:79], v6 offset:39552
    s_waitcnt lgkmcnt(14)
    v_mfma_f32_16x16x32_bf16 v[44:47], v[92:95], v[108:111], v[44:47]
    v_mfma_f32_16x16x32_bf16 v[48:51], v[92:95], v[112:115], v[48:51]
    s_add_u32 m0, s29, 112640
    s_nop 0
    buffer_load_dwordx4 v4, s[12:15], s26 offen lds
    s_waitcnt lgkmcnt(12)
    v_mfma_f32_16x16x32_bf16 v[52:55], v[96:99], v[108:111], v[52:55]
    v_mfma_f32_16x16x32_bf16 v[56:59], v[96:99], v[112:115], v[56:59]
    s_waitcnt lgkmcnt(8)
    v_mfma_f32_16x16x32_bf16 v[20:23], v[60:63], v[100:103], v[20:23]
    ds_read_b128 v[108:111], v10 offset:53248
    ds_read_b128 v[112:115], v10 offset:55296
    v_mfma_f32_16x16x32_bf16 v[24:27], v[60:63], v[104:107], v[24:27]
    ds_read_b64_tr_b16 v[80:81], v6 offset:44032
    ds_read_b64_tr_b16 v[82:83], v6 offset:48640
    s_add_u32 m0, s29, 131072
    s_nop 0
    buffer_load_dwordx4 v2, s[8:11], s28 offen sc1 lds
    s_add_u32 s28, s28, 2048
    s_waitcnt lgkmcnt(10)
    v_mfma_f32_16x16x32_bf16 v[28:31], v[64:67], v[100:103], v[28:31]
    ds_read_b64_tr_b16 v[84:85], v6 offset:44064
    ds_read_b64_tr_b16 v[86:87], v6 offset:48672
    v_mfma_f32_16x16x32_bf16 v[32:35], v[64:67], v[104:107], v[32:35]
    ds_read_b64_tr_b16 v[88:89], v6 offset:44096
    ds_read_b64_tr_b16 v[90:91], v6 offset:48704
    s_waitcnt lgkmcnt(12)
    v_mfma_f32_16x16x32_bf16 v[36:39], v[68:71], v[100:103], v[36:39]
    ds_read_b64_tr_b16 v[92:93], v6 offset:44128
    ds_read_b64_tr_b16 v[94:95], v6 offset:48736
    s_cmp_ge_u32 s20, 2
    s_cbranch_scc1 k234_mid_kernel_f_h0sk8
    s_add_u32 m0, s29, 120832
    s_nop 0
    buffer_load_dwordx4 v5, s[12:15], s26 offen lds
k234_mid_kernel_f_h0sk8:
    s_add_u32 s26, s26, 73728
    v_mfma_f32_16x16x32_bf16 v[40:43], v[68:71], v[104:107], v[40:43]
    ds_read_b64_tr_b16 v[96:97], v6 offset:44160
    ds_read_b64_tr_b16 v[98:99], v6 offset:48768
    s_waitcnt lgkmcnt(14)
    v_mfma_f32_16x16x32_bf16 v[44:47], v[72:75], v[100:103], v[44:47]
    v_mfma_f32_16x16x32_bf16 v[48:51], v[72:75], v[104:107], v[48:51]
    s_waitcnt lgkmcnt(12)
    v_mfma_f32_16x16x32_bf16 v[52:55], v[76:79], v[100:103], v[52:55]
    v_mfma_f32_16x16x32_bf16 v[56:59], v[76:79], v[104:107], v[56:59]
    s_waitcnt vmcnt(4)
    s_barrier
    s_waitcnt lgkmcnt(8)
    v_mfma_f32_16x16x32_bf16 v[20:23], v[80:83], v[108:111], v[20:23]
    ds_read_b128 v[100:103], v9 offset:18432
    ds_read_b128 v[104:107], v9 offset:20480
    v_mfma_f32_16x16x32_bf16 v[24:27], v[80:83], v[112:115], v[24:27]
    ds_read_b64_tr_b16 v[60:61], v7 offset:0
    ds_read_b64_tr_b16 v[62:63], v7 offset:4608
    s_add_u32 m0, s29, 0
    s_nop 0
    buffer_load_dwordx4 v3, s[12:15], s26 offen lds
    s_waitcnt lgkmcnt(10)
    v_mfma_f32_16x16x32_bf16 v[28:31], v[84:87], v[108:111], v[28:31]
    ds_read_b64_tr_b16 v[64:65], v7 offset:32
    ds_read_b64_tr_b16 v[66:67], v7 offset:4640
    v_mfma_f32_16x16x32_bf16 v[32:35], v[84:87], v[112:115], v[32:35]
    ds_read_b64_tr_b16 v[68:69], v7 offset:64
    ds_read_b64_tr_b16 v[70:71], v7 offset:4672
    s_waitcnt lgkmcnt(12)
    v_mfma_f32_16x16x32_bf16 v[36:39], v[88:91], v[108:111], v[36:39]
    ds_read_b64_tr_b16 v[72:73], v7 offset:96
    ds_read_b64_tr_b16 v[74:75], v7 offset:4704
    s_add_u32 m0, s29, 18432
    s_nop 0
    buffer_load_dwordx4 v2, s[8:11], s27 offen sc1 lds
    s_add_u32 s27, s27, 2048
    v_mfma_f32_16x16x32_bf16 v[40:43], v[88:91], v[112:115], v[40:43]
    ds_read_b64_tr_b16 v[76:77], v7 offset:128
    ds_read_b64_tr_b16 v[78:79], v7 offset:4736
    s_waitcnt lgkmcnt(14)
    v_mfma_f32_16x16x32_bf16 v[44:47], v[92:95], v[108:111], v[44:47]
    v_mfma_f32_16x16x32_bf16 v[48:51], v[92:95], v[112:115], v[48:51]
    s_add_u32 m0, s29, 8192
    s_nop 0
    buffer_load_dwordx4 v4, s[12:15], s26 offen lds
    s_waitcnt lgkmcnt(12)
    v_mfma_f32_16x16x32_bf16 v[52:55], v[96:99], v[108:111], v[52:55]
    v_mfma_f32_16x16x32_bf16 v[56:59], v[96:99], v[112:115], v[56:59]
    s_waitcnt lgkmcnt(8)
    v_mfma_f32_16x16x32_bf16 v[20:23], v[60:63], v[100:103], v[20:23]
    ds_read_b128 v[108:111], v11 offset:18432
    ds_read_b128 v[112:115], v11 offset:20480
    v_mfma_f32_16x16x32_bf16 v[24:27], v[60:63], v[104:107], v[24:27]
    ds_read_b64_tr_b16 v[80:81], v7 offset:9216
    ds_read_b64_tr_b16 v[82:83], v7 offset:13824
    s_add_u32 m0, s29, 26624
    s_nop 0
    buffer_load_dwordx4 v2, s[8:11], s28 offen sc1 lds
    s_add_u32 s28, s28, 2048
    s_waitcnt lgkmcnt(10)
    v_mfma_f32_16x16x32_bf16 v[28:31], v[64:67], v[100:103], v[28:31]
    ds_read_b64_tr_b16 v[84:85], v7 offset:9248
    ds_read_b64_tr_b16 v[86:87], v7 offset:13856
    v_mfma_f32_16x16x32_bf16 v[32:35], v[64:67], v[104:107], v[32:35]
    ds_read_b64_tr_b16 v[88:89], v7 offset:9280
    ds_read_b64_tr_b16 v[90:91], v7 offset:13888
    s_waitcnt lgkmcnt(12)
    v_mfma_f32_16x16x32_bf16 v[36:39], v[68:71], v[100:103], v[36:39]
    ds_read_b64_tr_b16 v[92:93], v7 offset:9312
    ds_read_b64_tr_b16 v[94:95], v7 offset:13920
    s_cmp_ge_u32 s20, 2
    s_cbranch_scc1 k234_mid_kernel_f_h0sk9
    s_add_u32 m0, s29, 16384
    s_nop 0
    buffer_load_dwordx4 v5, s[12:15], s26 offen lds
k234_mid_kernel_f_h0sk9:
    s_add_u32 s26, s26, 73728
    v_mfma_f32_16x16x32_bf16 v[40:43], v[68:71], v[104:107], v[40:43]
    ds_read_b64_tr_b16 v[96:97], v7 offset:9344
    ds_read_b64_tr_b16 v[98:99], v7 offset:13952
    s_waitcnt lgkmcnt(14)
    v_mfma_f32_16x16x32_bf16 v[44:47], v[72:75], v[100:103], v[44:47]
    v_mfma_f32_16x16x32_bf16 v[48:51], v[72:75], v[104:107], v[48:51]
    s_waitcnt lgkmcnt(12)
    v_mfma_f32_16x16x32_bf16 v[52:55], v[76:79], v[100:103], v[52:55]
    v_mfma_f32_16x16x32_bf16 v[56:59], v[76:79], v[104:107], v[56:59]
    s_waitcnt vmcnt(4)
    s_barrier
    s_waitcnt lgkmcnt(8)
    v_mfma_f32_16x16x32_bf16 v[20:23], v[80:83], v[108:111], v[20:23]
    ds_read_b128 v[100:103], v9 offset:53248
    ds_read_b128 v[104:107], v9 offset:55296
    v_mfma_f32_16x16x32_bf16 v[24:27], v[80:83], v[112:115], v[24:27]
    ds_read_b64_tr_b16 v[60:61], v7 offset:34816
    ds_read_b64_tr_b16 v[62:63], v7 offset:39424
    s_add_u32 m0, s29, 34816
    s_nop 0
    buffer_load_dwordx4 v3, s[12:15], s26 offen lds
    s_waitcnt lgkmcnt(10)
    v_mfma_f32_16x16x32_bf16 v[28:31], v[84:87], v[108:111], v[28:31]
    ds_read_b64_tr_b16 v[64:65], v7 offset:34848
    ds_read_b64_tr_b16 v[66:67], v7 offset:39456
    v_mfma_f32_16x16x32_bf16 v[32:35], v[84:87], v[112:115], v[32:35]
    ds_read_b64_tr_b16 v[68:69], v7 offset:34880
    ds_read_b64_tr_b16 v[70:71], v7 offset:39488
    s_waitcnt lgkmcnt(12)
    v_mfma_f32_16x16x32_bf16 v[36:39], v[88:91], v[108:111], v[36:39]
    ds_read_b64_tr_b16 v[72:73], v7 offset:34912
    ds_read_b64_tr_b16 v[74:75], v7 offset:39520
    s_add_u32 m0, s29, 53248
    s_nop 0
    buffer_load_dwordx4 v2, s[8:11], s27 offen sc1 lds
    s_add_u32 s27, s27, 2048
    v_mfma_f32_16x16x32_bf16 v[40:43], v[88:91], v[112:115], v[40:43]
    ds_read_b64_tr_b16 v[76:77], v7 offset:34944
    ds_read_b64_tr_b16 v[78:79], v7 offset:39552
    s_waitcnt lgkmcnt(14)
    v_mfma_f32_16x16x32_bf16 v[44:47], v[92:95], v[108:111], v[44:47]
    v_mfma_f32_16x16x32_bf16 v[48:51], v[92:95], v[112:115], v[48:51]
    s_add_u32 m0, s29, 43008
    s_nop 0
    buffer_load_dwordx4 v4, s[12:15], s26 offen lds
    s_waitcnt lgkmcnt(12)
    v_mfma_f32_16x16x32_bf16 v[52:55], v[96:99], v[108:111], v[52:55]
    v_mfma_f32_16x16x32_bf16 v[56:59], v[96:99], v[112:115], v[56:59]
    s_waitcnt lgkmcnt(8)
    v_mfma_f32_16x16x32_bf16 v[20:23], v[60:63], v[100:103], v[20:23]
    ds_read_b128 v[108:111], v11 offset:53248
    ds_read_b128 v[112:115], v11 offset:55296
    v_mfma_f32_16x16x32_bf16 v[24:27], v[60:63], v[104:107], v[24:27]
    ds_read_b64_tr_b16 v[80:81], v7 offset:44032
    ds_read_b64_tr_b16 v[82:83], v7 offset:48640
    s_add_u32 m0, s29, 61440
    s_nop 0
    buffer_load_dwordx4 v2, s[8:11], s28 offen sc1 lds
    s_add_u32 s28, s28, 2048
    s_waitcnt lgkmcnt(10)
    v_mfma_f32_16x16x32_bf16 v[28:31], v[64:67], v[100:103], v[28:31]
    ds_read_b64_tr_b16 v[84:85], v7 offset:44064
    ds_read_b64_tr_b16 v[86:87], v7 offset:48672
    v_mfma_f32_16x16x32_bf16 v[32:35], v[64:67], v[104:107], v[32:35]
    ds_read_b64_tr_b16 v[88:89], v7 offset:44096
    ds_read_b64_tr_b16 v[90:91], v7 offset:48704
    s_waitcnt lgkmcnt(12)
    v_mfma_f32_16x16x32_bf16 v[36:39], v[68:71], v[100:103], v[36:39]
    ds_read_b64_tr_b16 v[92:93], v7 offset:44128
    ds_read_b64_tr_b16 v[94:95], v7 offset:48736
    s_cmp_ge_u32 s20, 2
    s_cbranch_scc1 k234_mid_kernel_f_h0sk10
    s_add_u32 m0, s29, 51200
    s_nop 0
    buffer_load_dwordx4 v5, s[12:15], s26 offen lds
k234_mid_kernel_f_h0sk10:
    s_add_u32 s26, s26, 73728
    v_mfma_f32_16x16x32_bf16 v[40:43], v[68:71], v[104:107], v[40:43]
    ds_read_b64_tr_b16 v[96:97], v7 offset:44160
    ds_read_b64_tr_b16 v[98:99], v7 offset:48768
    s_waitcnt lgkmcnt(14)
    v_mfma_f32_16x16x32_bf16 v[44:47], v[72:75], v[100:103], v[44:47]
    v_mfma_f32_16x16x32_bf16 v[48:51], v[72:75], v[104:107], v[48:51]
    s_waitcnt lgkmcnt(12)
    v_mfma_f32_16x16x32_bf16 v[52:55], v[76:79], v[100:103], v[52:55]
    v_mfma_f32_16x16x32_bf16 v[56:59], v[76:79], v[104:107], v[56:59]
    s_waitcnt vmcnt(4)
    s_barrier
    s_waitcnt lgkmcnt(8)
    v_mfma_f32_16x16x32_bf16 v[20:23], v[80:83], v[108:111], v[20:23]
    ds_read_b128 v[100:103], v8 offset:18432
    ds_read_b128 v[104:107], v8 offset:20480
    v_mfma_f32_16x16x32_bf16 v[24:27], v[80:83], v[112:115], v[24:27]
    ds_read_b64_tr_b16 v[60:61], v6 offset:0
    ds_read_b64_tr_b16 v[62:63], v6 offset:4608
    s_add_u32 m0, s29, 69632
    s_nop 0
    buffer_load_dwordx4 v3, s[12:15], s26 offen lds
    s_waitcnt lgkmcnt(10)
    v_mfma_f32_16x16x32_bf16 v[28:31], v[84:87], v[108:111], v[28:31]
    ds_read_b64_tr_b16 v[64:65], v6 offset:32
    ds_read_b64_tr_b16 v[66:67], v6 offset:4640
    v_mfma_f32_16x16x32_bf16 v[32:35], v[84:87], v[112:115], v[32:35]
    ds_read_b64_tr_b16 v[68:69], v6 offset:64
    ds_read_b64_tr_b16 v[70:71], v6 offset:4672
    s_waitcnt lgkmcnt(12)
    v_mfma_f32_16x16x32_bf16 v[36:39], v[88:91], v[108:111], v[36:39]
    ds_read_b64_tr_b16 v[72:73], v6 offset:96
    ds_read_b64_tr_b16 v[74:75], v6 offset:4704
    s_add_u32 m0, s29, 88064
    s_nop 0
    buffer_load_dwordx4 v2, s[8:11], s27 offen sc1 lds
    s_add_u32 s27, s27, 2048
    v_mfma_f32_16x16x32_bf16 v[40:43], v[88:91], v[112:115], v[40:43]
    ds_read_b64_tr_b16 v[76:77], v6 offset:128
    ds_read_b64_tr_b16 v[78:79], v6 offset:4736
    s_waitcnt lgkmcnt(14)
    v_mfma_f32_16x16x32_bf16 v[44:47], v[92:95], v[108:111], v[44:47]
    v_mfma_f32_16x16x32_bf16 v[48:51], v[92:95], v[112:115], v[48:51]
    s_add_u32 m0, s29, 77824
    s_nop 0
    buffer_load_dwordx4 v4, s[12:15], s26 offen lds
    s_waitcnt lgkmcnt(12)
    v_mfma_f32_16x16x32_bf16 v[52:55], v[96:99], v[108:111], v[52:55]
    v_mfma_f32_16x16x32_bf16 v[56:59], v[96:99], v[112:115], v[56:59]
    s_waitcnt lgkmcnt(8)
    v_mfma_f32_16x16x32_bf16 v[20:23], v[60:63], v[100:103], v[20:23]
    ds_read_b128 v[108:111], v10 offset:18432
    ds_read_b128 v[112:115], v10 offset:20480
    v_mfma_f32_16x16x32_bf16 v[24:27], v[60:63], v[104:107], v[24:27]
    ds_read_b64_tr_b16 v[80:81], v6 offset:9216
    ds_read_b64_tr_b16 v[82:83], v6 offset:13824
    s_add_u32 m0, s29, 96256
    s_nop 0
    buffer_load_dwordx4 v2, s[8:11], s28 offen sc1 lds
    s_add_u32 s28, s28, 2048
    s_waitcnt lgkmcnt(10)
    v_mfma_f32_16x16x32_bf16 v[28:31], v[64:67], v[100:103], v[28:31]
    ds_read_b64_tr_b16 v[84:85], v6 offset:9248
    ds_read_b64_tr_b16 v[86:87], v6 offset:13856
    v_mfma_f32_16x16x32_bf16 v[32:35], v[64:67], v[104:107], v[32:35]
    ds_read_b64_tr_b16 v[88:89], v6 offset:9280
    ds_read_b64_tr_b16 v[90:91], v6 offset:13888
    s_waitcnt lgkmcnt(12)
    v_mfma_f32_16x16x32_bf16 v[36:39], v[68:71], v[100:103], v[36:39]
    ds_read_b64_tr_b16 v[92:93], v6 offset:9312
    ds_read_b64_tr_b16 v[94:95], v6 offset:13920
    s_cmp_ge_u32 s20, 2
    s_cbranch_scc1 k234_mid_kernel_f_h0sk11
    s_add_u32 m0, s29, 86016
    s_nop 0
    buffer_load_dwordx4 v5, s[12:15], s26 offen lds
k234_mid_kernel_f_h0sk11:
    s_add_u32 s26, s26, 73728
    v_mfma_f32_16x16x32_bf16 v[40:43], v[68:71], v[104:107], v[40:43]
    ds_read_b64_tr_b16 v[96:97], v6 offset:9344
    ds_read_b64_tr_b16 v[98:99], v6 offset:13952
    s_waitcnt lgkmcnt(14)
    v_mfma_f32_16x16x32_bf16 v[44:47], v[72:75], v[100:103], v[44:47]
    v_mfma_f32_16x16x32_bf16 v[48:51], v[72:75], v[104:107], v[48:51]
    s_waitcnt lgkmcnt(12)
    v_mfma_f32_16x16x32_bf16 v[52:55], v[76:79], v[100:103], v[52:55]
    v_mfma_f32_16x16x32_bf16 v[56:59], v[76:79], v[104:107], v[56:59]
    s_waitcnt vmcnt(4)
    s_barrier
    s_waitcnt lgkmcnt(8)
    v_mfma_f32_16x16x32_bf16 v[20:23], v[80:83], v[108:111], v[20:23]
    ds_read_b128 v[100:103], v8 offset:53248
    ds_read_b128 v[104:107], v8 offset:55296
    v_mfma_f32_16x16x32_bf16 v[24:27], v[80:83], v[112:115], v[24:27]
    ds_read_b64_tr_b16 v[60:61], v6 offset:34816
    ds_read_b64_tr_b16 v[62:63], v6 offset:39424
    s_add_u32 m0, s29, 104448
    s_nop 0
    buffer_load_dwordx4 v3, s[12:15], s26 offen lds
    s_waitcnt lgkmcnt(10)
    v_mfma_f32_16x16x32_bf16 v[28:31], v[84:87], v[108:111], v[28:31]
    ds_read_b64_tr_b16 v[64:65], v6 offset:34848
    ds_read_b64_tr_b16 v[66:67], v6 offset:39456
    v_mfma_f32_16x16x32_bf16 v[32:35], v[84:87], v[112:115], v[32:35]
    ds_read_b64_tr_b16 v[68:69], v6 offset:34880
    ds_read_b64_tr_b16 v[70:71], v6 offset:39488
    s_waitcnt lgkmcnt(12)
    v_mfma_f32_16x16x32_bf16 v[36:39], v[88:91], v[108:111], v[36:39]
    ds_read_b64_tr_b16 v[72:73], v6 offset:34912
    ds_read_b64_tr_b16 v[74:75], v6 offset:39520
    s_add_u32 m0, s29, 122880
    s_nop 0
    buffer_load_dwordx4 v2, s[8:11], s27 offen sc1 lds
    s_add_u32 s27, s27, 2048
    v_mfma_f32_16x16x32_bf16 v[40:43], v[88:91], v[112:115], v[40:43]
    ds_read_b64_tr_b16 v[76:77], v6 offset:34944
    ds_read_b64_tr_b16 v[78:79], v6 offset:39552
    s_waitcnt lgkmcnt(14)
    v_mfma_f32_16x16x32_bf16 v[44:47], v[92:95], v[108:111], v[44:47]
    v_mfma_f32_16x16x32_bf16 v[48:51], v[92:95], v[112:115], v[48:51]
    s_add_u32 m0, s29, 112640
    s_nop 0
    buffer_load_dwordx4 v4, s[12:15], s26 offen lds
    s_waitcnt lgkmcnt(12)
    v_mfma_f32_16x16x32_bf16 v[52:55], v[96:99], v[108:111], v[52:55]
    v_mfma_f32_16x16x32_bf16 v[56:59], v[96:99], v[112:115], v[56:59]
    s_waitcnt lgkmcnt(8)
    v_mfma_f32_16x16x32_bf16 v[20:23], v[60:63], v[100:103], v[20:23]
    ds_read_b128 v[108:111], v10 offset:53248
    ds_read_b128 v[112:115], v10 offset:55296
    v_mfma_f32_16x16x32_bf16 v[24:27], v[60:63], v[104:107], v[24:27]
    ds_read_b64_tr_b16 v[80:81], v6 offset:44032
    ds_read_b64_tr_b16 v[82:83], v6 offset:48640
    s_add_u32 m0, s29, 131072
    s_nop 0
    buffer_load_dwordx4 v2, s[8:11], s28 offen sc1 lds
    s_add_u32 s28, s28, 2048
    s_waitcnt lgkmcnt(10)
    v_mfma_f32_16x16x32_bf16 v[28:31], v[64:67], v[100:103], v[28:31]
    ds_read_b64_tr_b16 v[84:85], v6 offset:44064
    ds_read_b64_tr_b16 v[86:87], v6 offset:48672
    v_mfma_f32_16x16x32_bf16 v[32:35], v[64:67], v[104:107], v[32:35]
    ds_read_b64_tr_b16 v[88:89], v6 offset:44096
    ds_read_b64_tr_b16 v[90:91], v6 offset:48704
    s_waitcnt lgkmcnt(12)
    v_mfma_f32_16x16x32_bf16 v[36:39], v[68:71], v[100:103], v[36:39]
    ds_read_b64_tr_b16 v[92:93], v6 offset:44128
    ds_read_b64_tr_b16 v[94:95], v6 offset:48736
    s_cmp_ge_u32 s20, 2
    s_cbranch_scc1 k234_mid_kernel_f_h0sk12
    s_add_u32 m0, s29, 120832
    s_nop 0
    buffer_load_dwordx4 v5, s[12:15], s26 offen lds
k234_mid_kernel_f_h0sk12:
    s_add_u32 s26, s26, 73728
    v_mfma_f32_16x16x32_bf16 v[40:43], v[68:71], v[104:107], v[40:43]
    ds_read_b64_tr_b16 v[96:97], v6 offset:44160
    ds_read_b64_tr_b16 v[98:99], v6 offset:48768
    s_waitcnt lgkmcnt(14)
    v_mfma_f32_16x16x32_bf16 v[44:47], v[72:75], v[100:103], v[44:47]
    v_mfma_f32_16x16x32_bf16 v[48:51], v[72:75], v[104:107], v[48:51]
    s_waitcnt lgkmcnt(12)
    v_mfma_f32_16x16x32_bf16 v[52:55], v[76:79], v[100:103], v[52:55]
    v_mfma_f32_16x16x32_bf16 v[56:59], v[76:79], v[104:107], v[56:59]
    s_waitcnt vmcnt(4)
    s_barrier
    s_waitcnt lgkmcnt(8)
    v_mfma_f32_16x16x32_bf16 v[20:23], v[80:83], v[108:111], v[20:23]
    ds_read_b128 v[100:103], v9 offset:18432
    ds_read_b128 v[104:107], v9 offset:20480
    v_mfma_f32_16x16x32_bf16 v[24:27], v[80:83], v[112:115], v[24:27]
    ds_read_b64_tr_b16 v[60:61], v7 offset:0
    ds_read_b64_tr_b16 v[62:63], v7 offset:4608
    s_add_u32 m0, s29, 0
    s_nop 0
    buffer_load_dwordx4 v3, s[12:15], s26 offen lds
    s_waitcnt lgkmcnt(10)
    v_mfma_f32_16x16x32_bf16 v[28:31], v[84:87], v[108:111], v[28:31]
    ds_read_b64_tr_b16 v[64:65], v7 offset:32
    ds_read_b64_tr_b16 v[66:67], v7 offset:4640
    v_mfma_f32_16x16x32_bf16 v[32:35], v[84:87], v[112:115], v[32:35]
    ds_read_b64_tr_b16 v[68:69], v7 offset:64
    ds_read_b64_tr_b16 v[70:71], v7 offset:4672
    s_waitcnt lgkmcnt(12)
    v_mfma_f32_16x16x32_bf16 v[36:39], v[88:91], v[108:111], v[36:39]
    ds_read_b64_tr_b16 v[72:73], v7 offset:96
    ds_read_b64_tr_b16 v[74:75], v7 offset:4704
    s_add_u32 m0, s29, 18432
    s_nop 0
    buffer_load_dwordx4 v2, s[8:11], s27 offen sc1 lds
    s_add_u32 s27, s27, 2048
    v_mfma_f32_16x16x32_bf16 v[40:43], v[88:91], v[112:115], v[40:43]
    ds_read_b64_tr_b16 v[76:77], v7 offset:128
    ds_read_b64_tr_b16 v[78:79], v7 offset:4736
    s_waitcnt lgkmcnt(14)
    v_mfma_f32_16x16x32_bf16 v[44:47], v[92:95], v[108:111], v[44:47]
    v_mfma_f32_16x16x32_bf16 v[48:51], v[92:95], v[112:115], v[48:51]
    s_add_u32 m0, s29, 8192
    s_nop 0
    buffer_load_dwordx4 v4, s[12:15], s26 offen lds
    s_waitcnt lgkmcnt(12)
    v_mfma_f32_16x16x32_bf16 v[52:55], v[96:99], v[108:111], v[52:55]
    v_mfma_f32_16x16x32_bf16 v[56:59], v[96:99], v[112:115], v[56:59]
    s_waitcnt lgkmcnt(8)
    v_mfma_f32_16x16x32_bf16 v[20:23], v[60:63], v[100:103], v[20:23]
    ds_read_b128 v[108:111], v11 offset:18432
    ds_read_b128 v[112:115], v11 offset:20480
    v_mfma_f32_16x16x32_bf16 v[24:27], v[60:63], v[104:107], v[24:27]
    ds_read_b64_tr_b16 v[80:81], v7 offset:9216
    ds_read_b64_tr_b16 v[82:83], v7 offset:13824
    s_add_u32 m0, s29, 26624
    s_nop 0
    buffer_load_dwordx4 v2, s[8:11], s28 offen sc1 lds
    s_add_u32 s28, s28, 2048
    s_waitcnt lgkmcnt(10)
    v_mfma_f32_16x16x32_bf16 v[28:31], v[64:67], v[100:103], v[28:31]
    ds_read_b64_tr_b16 v[84:85], v7 offset:9248
    ds_read_b64_tr_b16 v[86:87], v7 offset:13856
    v_mfma_f32_16x16x32_bf16 v[32:35], v[64:67], v[104:107], v[32:35]
    ds_read_b64_tr_b16 v[88:89], v7 offset:9280
    ds_read_b64_tr_b16 v[90:91], v7 offset:13888
    s_waitcnt lgkmcnt(12)
    v_mfma_f32_16x16x32_bf16 v[36:39], v[68:71], v[100:103], v[36:39]
    ds_read_b64_tr_b16 v[92:93], v7 offset:9312
    ds_read_b64_tr_b16 v[94:95], v7 offset:13920
    s_cmp_ge_u32 s20, 2
    s_cbranch_scc1 k234_mid_kernel_f_h0sk13
    s_add_u32 m0, s29, 16384
    s_nop 0
    buffer_load_dwordx4 v5, s[12:15], s26 offen lds
k234_mid_kernel_f_h0sk13:
    s_add_u32 s26, s26, 73728
    v_mfma_f32_16x16x32_bf16 v[40:43], v[68:71], v[104:107], v[40:43]
    ds_read_b64_tr_b16 v[96:97], v7 offset:9344
    ds_read_b64_tr_b16 v[98:99], v7 offset:13952
    s_waitcnt lgkmcnt(14)
    v_mfma_f32_16x16x32_bf16 v[44:47], v[72:75], v[100:103], v[44:47]
    v_mfma_f32_16x16x32_bf16 v[48:51], v[72:75], v[104:107], v[48:51]
    s_waitcnt lgkmcnt(12)
    v_mfma_f32_16x16x32_bf16 v[52:55], v[76:79], v[100:103], v[52:55]
    v_mfma_f32_16x16x32_bf16 v[56:59], v[76:79], v[104:107], v[56:59]
    s_waitcnt vmcnt(4)
    s_barrier
    s_waitcnt lgkmcnt(8)
    v_mfma_f32_16x16x32_bf16 v[20:23], v[80:83], v[108:111], v[20:23]
    ds_read_b128 v[100:103], v9 offset:53248
    ds_read_b128 v[104:107], v9 offset:55296
    v_mfma_f32_16x16x32_bf16 v[24:27], v[80:83], v[112:115], v[24:27]
    ds_read_b64_tr_b16 v[60:61], v7 offset:34816
    ds_read_b64_tr_b16 v[62:63], v7 offset:39424
    s_add_u32 m0, s29, 34816
    s_nop 0
    buffer_load_dwordx4 v3, s[12:15], s26 offen lds
    s_waitcnt lgkmcnt(10)
    v_mfma_f32_16x16x32_bf16 v[28:31], v[84:87], v[108:111], v[28:31]
    ds_read_b64_tr_b16 v[64:65], v7 offset:34848
    ds_read_b64_tr_b16 v[66:67], v7 offset:39456
    v_mfma_f32_16x16x32_bf16 v[32:35], v[84:87], v[112:115], v[32:35]
    ds_read_b64_tr_b16 v[68:69], v7 offset:34880
    ds_read_b64_tr_b16 v[70:71], v7 offset:39488
    s_waitcnt lgkmcnt(12)
    v_mfma_f32_16x16x32_bf16 v[36:39], v[88:91], v[108:111], v[36:39]
    ds_read_b64_tr_b16 v[72:73], v7 offset:34912
    ds_read_b64_tr_b16 v[74:75], v7 offset:39520
    s_add_u32 m0, s29, 53248
    s_nop 0
    buffer_load_dwordx4 v2, s[8:11], s27 offen sc1 lds
    s_add_u32 s27, s27, 2048
    v_mfma_f32_16x16x32_bf16 v[40:43], v[88:91], v[112:115], v[40:43]
    ds_read_b64_tr_b16 v[76:77], v7 offset:34944
    ds_read_b64_tr_b16 v[78:79], v7 offset:39552
    s_waitcnt lgkmcnt(14)
    v_mfma_f32_16x16x32_bf16 v[44:47], v[92:95], v[108:111], v[44:47]
    v_mfma_f32_16x16x32_bf16 v[48:51], v[92:95], v[112:115], v[48:51]
    s_add_u32 m0, s29, 43008
    s_nop 0
    buffer_load_dwordx4 v4, s[12:15], s26 offen lds
    s_waitcnt lgkmcnt(12)
    v_mfma_f32_16x16x32_bf16 v[52:55], v[96:99], v[108:111], v[52:55]
    v_mfma_f32_16x16x32_bf16 v[56:59], v[96:99], v[112:115], v[56:59]
    s_waitcnt lgkmcnt(8)
    v_mfma_f32_16x16x32_bf16 v[20:23], v[60:63], v[100:103], v[20:23]
    ds_read_b128 v[108:111], v11 offset:53248
    ds_read_b128 v[112:115], v11 offset:55296
    v_mfma_f32_16x16x32_bf16 v[24:27], v[60:63], v[104:107], v[24:27]
    ds_read_b64_tr_b16 v[80:81], v7 offset:44032
    ds_read_b64_tr_b16 v[82:83], v7 offset:48640
    s_add_u32 m0, s29, 61440
    s_nop 0
    buffer_load_dwordx4 v2, s[8:11], s28 offen sc1 lds
    s_add_u32 s28, s28, 2048
    s_waitcnt lgkmcnt(10)
    v_mfma_f32_16x16x32_bf16 v[28:31], v[64:67], v[100:103], v[28:31]
    ds_read_b64_tr_b16 v[84:85], v7 offset:44064
    ds_read_b64_tr_b16 v[86:87], v7 offset:48672
    v_mfma_f32_16x16x32_bf16 v[32:35], v[64:67], v[104:107], v[32:35]
    ds_read_b64_tr_b16 v[88:89], v7 offset:44096
    ds_read_b64_tr_b16 v[90:91], v7 offset:48704
    s_waitcnt lgkmcnt(12)
    v_mfma_f32_16x16x32_bf16 v[36:39], v[68:71], v[100:103], v[36:39]
    ds_read_b64_tr_b16 v[92:93], v7 offset:44128
    ds_read_b64_tr_b16 v[94:95], v7 offset:48736
    s_cmp_ge_u32 s20, 2
    s_cbranch_scc1 k234_mid_kernel_f_h0sk14
    s_add_u32 m0, s29, 51200
    s_nop 0
    buffer_load_dwordx4 v5, s[12:15], s26 offen lds
k234_mid_kernel_f_h0sk14:
    s_add_u32 s26, s26, 73728
    v_mfma_f32_16x16x32_bf16 v[40:43], v[68:71], v[104:107], v[40:43]
    ds_read_b64_tr_b16 v[96:97], v7 offset:44160
    ds_read_b64_tr_b16 v[98:99], v7 offset:48768
    s_waitcnt lgkmcnt(14)
    v_mfma_f32_16x16x32_bf16 v[44:47], v[72:75], v[100:103], v[44:47]
    v_mfma_f32_16x16x32_bf16 v[48:51], v[72:75], v[104:107], v[48:51]
    s_waitcnt lgkmcnt(12)
    v_mfma_f32_16x16x32_bf16 v[52:55], v[76:79], v[100:103], v[52:55]
    v_mfma_f32_16x16x32_bf16 v[56:59], v[76:79], v[104:107], v[56:59]
    s_waitcnt vmcnt(4)
    s_barrier
    s_waitcnt lgkmcnt(8)
    v_mfma_f32_16x16x32_bf16 v[20:23], v[80:83], v[108:111], v[20:23]
    ds_read_b128 v[100:103], v8 offset:18432
    ds_read_b128 v[104:107], v8 offset:20480
    v_mfma_f32_16x16x32_bf16 v[24:27], v[80:83], v[112:115], v[24:27]
    ds_read_b64_tr_b16 v[60:61], v6 offset:0
    ds_read_b64_tr_b16 v[62:63], v6 offset:4608
    s_add_u32 m0, s29, 69632
    s_nop 0
    buffer_load_dwordx4 v3, s[12:15], s26 offen lds
    s_waitcnt lgkmcnt(10)
    v_mfma_f32_16x16x32_bf16 v[28:31], v[84:87], v[108:111], v[28:31]
    ds_read_b64_tr_b16 v[64:65], v6 offset:32
    ds_read_b64_tr_b16 v[66:67], v6 offset:4640
    v_mfma_f32_16x16x32_bf16 v[32:35], v[84:87], v[112:115], v[32:35]
    ds_read_b64_tr_b16 v[68:69], v6 offset:64
    ds_read_b64_tr_b16 v[70:71], v6 offset:4672
    s_waitcnt lgkmcnt(12)
    v_mfma_f32_16x16x32_bf16 v[36:39], v[88:91], v[108:111], v[36:39]
    ds_read_b64_tr_b16 v[72:73], v6 offset:96
    ds_read_b64_tr_b16 v[74:75], v6 offset:4704
    s_add_u32 m0, s29, 88064
    s_nop 0
    buffer_load_dwordx4 v2, s[8:11], s27 offen sc1 lds
    s_add_u32 s27, s27, 2048
    v_mfma_f32_16x16x32_bf16 v[40:43], v[88:91], v[112:115], v[40:43]
    ds_read_b64_tr_b16 v[76:77], v6 offset:128
    ds_read_b64_tr_b16 v[78:79], v6 offset:4736
    s_waitcnt lgkmcnt(14)
    v_mfma_f32_16x16x32_bf16 v[44:47], v[92:95], v[108:111], v[44:47]
    v_mfma_f32_16x16x32_bf16 v[48:51], v[92:95], v[112:115], v[48:51]
    s_add_u32 m0, s29, 77824
    s_nop 0
    buffer_load_dwordx4 v4, s[12:15], s26 offen lds
    s_waitcnt lgkmcnt(12)
    v_mfma_f32_16x16x32_bf16 v[52:55], v[96:99], v[108:111], v[52:55]
    v_mfma_f32_16x16x32_bf16 v[56:59], v[96:99], v[112:115], v[56:59]
    s_waitcnt lgkmcnt(8)
    v_mfma_f32_16x16x32_bf16 v[20:23], v[60:63], v[100:103], v[20:23]
    ds_read_b128 v[108:111], v10 offset:18432
    ds_read_b128 v[112:115], v10 offset:20480
    v_mfma_f32_16x16x32_bf16 v[24:27], v[60:63], v[104:107], v[24:27]
    ds_read_b64_tr_b16 v[80:81], v6 offset:9216
    ds_read_b64_tr_b16 v[82:83], v6 offset:13824
    s_add_u32 m0, s29, 96256
    s_nop 0
    buffer_load_dwordx4 v2, s[8:11], s28 offen sc1 lds
    s_add_u32 s28, s28, 2048
    s_waitcnt lgkmcnt(10)
    v_mfma_f32_16x16x32_bf16 v[28:31], v[64:67], v[100:103], v[28:31]
    ds_read_b64_tr_b16 v[84:85], v6 offset:9248
    ds_read_b64_tr_b16 v[86:87], v6 offset:13856
    v_mfma_f32_16x16x32_bf16 v[32:35], v[64:67], v[104:107], v[32:35]
    ds_read_b64_tr_b16 v[88:89], v6 offset:9280
    ds_read_b64_tr_b16 v[90:91], v6 offset:13888
    s_waitcnt lgkmcnt(12)
    v_mfma_f32_16x16x32_bf16 v[36:39], v[68:71], v[100:103], v[36:39]
    ds_read_b64_tr_b16 v[92:93], v6 offset:9312
    ds_read_b64_tr_b16 v[94:95], v6 offset:13920
    s_cmp_ge_u32 s20, 2
    s_cbranch_scc1 k234_mid_kernel_f_h0sk15
    s_add_u32 m0, s29, 86016
    s_nop 0
    buffer_load_dwordx4 v5, s[12:15], s26 offen lds
k234_mid_kernel_f_h0sk15:
    s_add_u32 s26, s26, 73728
    v_mfma_f32_16x16x32_bf16 v[40:43], v[68:71], v[104:107], v[40:43]
    ds_read_b64_tr_b16 v[96:97], v6 offset:9344
    ds_read_b64_tr_b16 v[98:99], v6 offset:13952
    s_waitcnt lgkmcnt(14)
    v_mfma_f32_16x16x32_bf16 v[44:47], v[72:75], v[100:103], v[44:47]
    v_mfma_f32_16x16x32_bf16 v[48:51], v[72:75], v[104:107], v[48:51]
    s_waitcnt lgkmcnt(12)
    v_mfma_f32_16x16x32_bf16 v[52:55], v[76:79], v[100:103], v[52:55]
    v_mfma_f32_16x16x32_bf16 v[56:59], v[76:79], v[104:107], v[56:59]
    s_waitcnt vmcnt(4)
    s_barrier
    s_waitcnt lgkmcnt(8)
    v_mfma_f32_16x16x32_bf16 v[20:23], v[80:83], v[108:111], v[20:23]
    ds_read_b128 v[100:103], v8 offset:53248
    ds_read_b128 v[104:107], v8 offset:55296
    v_mfma_f32_16x16x32_bf16 v[24:27], v[80:83], v[112:115], v[24:27]
    ds_read_b64_tr_b16 v[60:61], v6 offset:34816
    ds_read_b64_tr_b16 v[62:63], v6 offset:39424
    s_add_u32 m0, s29, 104448
    s_nop 0
    buffer_load_dwordx4 v3, s[12:15], s26 offen lds
    s_waitcnt lgkmcnt(10)
    v_mfma_f32_16x16x32_bf16 v[28:31], v[84:87], v[108:111], v[28:31]
    ds_read_b64_tr_b16 v[64:65], v6 offset:34848
    ds_read_b64_tr_b16 v[66:67], v6 offset:39456
    v_mfma_f32_16x16x32_bf16 v[32:35], v[84:87], v[112:115], v[32:35]
    ds_read_b64_tr_b16 v[68:69], v6 offset:34880
    ds_read_b64_tr_b16 v[70:71], v6 offset:39488
    s_waitcnt lgkmcnt(12)
    v_mfma_f32_16x16x32_bf16 v[36:39], v[88:91], v[108:111], v[36:39]
    ds_read_b64_tr_b16 v[72:73], v6 offset:34912
    ds_read_b64_tr_b16 v[74:75], v6 offset:39520
    s_add_u32 m0, s29, 122880
    s_nop 0
    buffer_load_dwordx4 v2, s[8:11], s27 offen sc1 lds
    s_add_u32 s27, s27, 2048
    v_mfma_f32_16x16x32_bf16 v[40:43], v[88:91], v[112:115], v[40:43]
    ds_read_b64_tr_b16 v[76:77], v6 offset:34944
    ds_read_b64_tr_b16 v[78:79], v6 offset:39552
    s_waitcnt lgkmcnt(14)
    v_mfma_f32_16x16x32_bf16 v[44:47], v[92:95], v[108:111], v[44:47]
    v_mfma_f32_16x16x32_bf16 v[48:51], v[92:95], v[112:115], v[48:51]
    s_add_u32 m0, s29, 112640
    s_nop 0
    buffer_load_dwordx4 v4, s[12:15], s26 offen lds
    s_waitcnt lgkmcnt(12)
    v_mfma_f32_16x16x32_bf16 v[52:55], v[96:99], v[108:111], v[52:55]
    v_mfma_f32_16x16x32_bf16 v[56:59], v[96:99], v[112:115], v[56:59]
    s_waitcnt lgkmcnt(8)
    v_mfma_f32_16x16x32_bf16 v[20:23], v[60:63], v[100:103], v[20:23]
    ds_read_b128 v[108:111], v10 offset:53248
    ds_read_b128 v[112:115], v10 offset:55296
    v_mfma_f32_16x16x32_bf16 v[24:27], v[60:63], v[104:107], v[24:27]
    ds_read_b64_tr_b16 v[80:81], v6 offset:44032
    ds_read_b64_tr_b16 v[82:83], v6 offset:48640
    s_add_u32 m0, s29, 131072
    s_nop 0
    buffer_load_dwordx4 v2, s[8:11], s28 offen sc1 lds
    s_add_u32 s28, s28, 2048
    s_waitcnt lgkmcnt(10)
    v_mfma_f32_16x16x32_bf16 v[28:31], v[64:67], v[100:103], v[28:31]
    ds_read_b64_tr_b16 v[84:85], v6 offset:44064
    ds_read_b64_tr_b16 v[86:87], v6 offset:48672
    v_mfma_f32_16x16x32_bf16 v[32:35], v[64:67], v[104:107], v[32:35]
    ds_read_b64_tr_b16 v[88:89], v6 offset:44096
    ds_read_b64_tr_b16 v[90:91], v6 offset:48704
    s_waitcnt lgkmcnt(12)
    v_mfma_f32_16x16x32_bf16 v[36:39], v[68:71], v[100:103], v[36:39]
    ds_read_b64_tr_b16 v[92:93], v6 offset:44128
    ds_read_b64_tr_b16 v[94:95], v6 offset:48736
    s_cmp_ge_u32 s20, 2
    s_cbranch_scc1 k234_mid_kernel_f_h0sk16
    s_add_u32 m0, s29, 120832
    s_nop 0
    buffer_load_dwordx4 v5, s[12:15], s26 offen lds
k234_mid_kernel_f_h0sk16:
    s_add_u32 s26, s26, 73728
    v_mfma_f32_16x16x32_bf16 v[40:43], v[68:71], v[104:107], v[40:43]
    ds_read_b64_tr_b16 v[96:97], v6 offset:44160
    ds_read_b64_tr_b16 v[98:99], v6 offset:48768
    s_waitcnt lgkmcnt(14)
    v_mfma_f32_16x16x32_bf16 v[44:47], v[72:75], v[100:103], v[44:47]
    v_mfma_f32_16x16x32_bf16 v[48:51], v[72:75], v[104:107], v[48:51]
    s_waitcnt lgkmcnt(12)
    v_mfma_f32_16x16x32_bf16 v[52:55], v[76:79], v[100:103], v[52:55]
    v_mfma_f32_16x16x32_bf16 v[56:59], v[76:79], v[104:107], v[56:59]
    s_waitcnt vmcnt(4)
    s_barrier
    s_waitcnt lgkmcnt(8)
    v_mfma_f32_16x16x32_bf16 v[20:23], v[80:83], v[108:111], v[20:23]
    ds_read_b128 v[100:103], v9 offset:18432
    ds_read_b128 v[104:107], v9 offset:20480
    v_mfma_f32_16x16x32_bf16 v[24:27], v[80:83], v[112:115], v[24:27]
    ds_read_b64_tr_b16 v[60:61], v7 offset:0
    ds_read_b64_tr_b16 v[62:63], v7 offset:4608
    s_add_u32 m0, s29, 0
    s_nop 0
    buffer_load_dwordx4 v3, s[12:15], s26 offen lds
    s_waitcnt lgkmcnt(10)
    v_mfma_f32_16x16x32_bf16 v[28:31], v[84:87], v[108:111], v[28:31]
    ds_read_b64_tr_b16 v[64:65], v7 offset:32
    ds_read_b64_tr_b16 v[66:67], v7 offset:4640
    v_mfma_f32_16x16x32_bf16 v[32:35], v[84:87], v[112:115], v[32:35]
    ds_read_b64_tr_b16 v[68:69], v7 offset:64
    ds_read_b64_tr_b16 v[70:71], v7 offset:4672
    s_waitcnt lgkmcnt(12)
    v_mfma_f32_16x16x32_bf16 v[36:39], v[88:91], v[108:111], v[36:39]
    ds_read_b64_tr_b16 v[72:73], v7 offset:96
    ds_read_b64_tr_b16 v[74:75], v7 offset:4704
    s_add_u32 m0, s29, 18432
    s_nop 0
    buffer_load_dwordx4 v2, s[8:11], s27 offen sc1 lds
    s_add_u32 s27, s27, 2048
    v_mfma_f32_16x16x32_bf16 v[40:43], v[88:91], v[112:115], v[40:43]
    ds_read_b64_tr_b16 v[76:77], v7 offset:128
    ds_read_b64_tr_b16 v[78:79], v7 offset:4736
    s_waitcnt lgkmcnt(14)
    v_mfma_f32_16x16x32_bf16 v[44:47], v[92:95], v[108:111], v[44:47]
    v_mfma_f32_16x16x32_bf16 v[48:51], v[92:95], v[112:115], v[48:51]
    s_add_u32 m0, s29, 8192
    s_nop 0
    buffer_load_dwordx4 v4, s[12:15], s26 offen lds
    s_waitcnt lgkmcnt(12)
    v_mfma_f32_16x16x32_bf16 v[52:55], v[96:99], v[108:111], v[52:55]
    v_mfma_f32_16x16x32_bf16 v[56:59], v[96:99], v[112:115], v[56:59]
    s_waitcnt lgkmcnt(8)
    v_mfma_f32_16x16x32_bf16 v[20:23], v[60:63], v[100:103], v[20:23]
    ds_read_b128 v[108:111], v11 offset:18432
    ds_read_b128 v[112:115], v11 offset:20480
    v_mfma_f32_16x16x32_bf16 v[24:27], v[60:63], v[104:107], v[24:27]
    ds_read_b64_tr_b16 v[80:81], v7 offset:9216
    ds_read_b64_tr_b16 v[82:83], v7 offset:13824
    s_add_u32 m0, s29, 26624
    s_nop 0
    buffer_load_dwordx4 v2, s[8:11], s28 offen sc1 lds
    s_add_u32 s28, s28, 2048
    s_waitcnt lgkmcnt(10)
    v_mfma_f32_16x16x32_bf16 v[28:31], v[64:67], v[100:103], v[28:31]
    ds_read_b64_tr_b16 v[84:85], v7 offset:9248
    ds_read_b64_tr_b16 v[86:87], v7 offset:13856
    v_mfma_f32_16x16x32_bf16 v[32:35], v[64:67], v[104:107], v[32:35]
    ds_read_b64_tr_b16 v[88:89], v7 offset:9280
    ds_read_b64_tr_b16 v[90:91], v7 offset:13888
    s_waitcnt lgkmcnt(12)
    v_mfma_f32_16x16x32_bf16 v[36:39], v[68:71], v[100:103], v[36:39]
    ds_read_b64_tr_b16 v[92:93], v7 offset:9312
    ds_read_b64_tr_b16 v[94:95], v7 offset:13920
    s_cmp_ge_u32 s20, 2
    s_cbranch_scc1 k234_mid_kernel_f_h0sk17
    s_add_u32 m0, s29, 16384
    s_nop 0
    buffer_load_dwordx4 v5, s[12:15], s26 offen lds
k234_mid_kernel_f_h0sk17:
    s_add_u32 s26, s26, 73728
    v_mfma_f32_16x16x32_bf16 v[40:43], v[68:71], v[104:107], v[40:43]
    ds_read_b64_tr_b16 v[96:97], v7 offset:9344
    ds_read_b64_tr_b16 v[98:99], v7 offset:13952
    s_waitcnt lgkmcnt(14)
    v_mfma_f32_16x16x32_bf16 v[44:47], v[72:75], v[100:103], v[44:47]
    v_mfma_f32_16x16x32_bf16 v[48:51], v[72:75], v[104:107], v[48:51]
    s_waitcnt lgkmcnt(12)
    v_mfma_f32_16x16x32_bf16 v[52:55], v[76:79], v[100:103], v[52:55]
    v_mfma_f32_16x16x32_bf16 v[56:59], v[76:79], v[104:107], v[56:59]
    s_waitcnt vmcnt(4)
    s_barrier
    s_waitcnt lgkmcnt(8)
    v_mfma_f32_16x16x32_bf16 v[20:23], v[80:83], v[108:111], v[20:23]
    ds_read_b128 v[100:103], v9 offset:53248
    ds_read_b128 v[104:107], v9 offset:55296
    v_mfma_f32_16x16x32_bf16 v[24:27], v[80:83], v[112:115], v[24:27]
    ds_read_b64_tr_b16 v[60:61], v7 offset:34816
    ds_read_b64_tr_b16 v[62:63], v7 offset:39424
    s_add_u32 m0, s29, 34816
    s_nop 0
    buffer_load_dwordx4 v3, s[12:15], s26 offen lds
    s_waitcnt lgkmcnt(10)
    v_mfma_f32_16x16x32_bf16 v[28:31], v[84:87], v[108:111], v[28:31]
    ds_read_b64_tr_b16 v[64:65], v7 offset:34848
    ds_read_b64_tr_b16 v[66:67], v7 offset:39456
    v_mfma_f32_16x16x32_bf16 v[32:35], v[84:87], v[112:115], v[32:35]
    ds_read_b64_tr_b16 v[68:69], v7 offset:34880
    ds_read_b64_tr_b16 v[70:71], v7 offset:39488
    s_waitcnt lgkmcnt(12)
    v_mfma_f32_16x16x32_bf16 v[36:39], v[88:91], v[108:111], v[36:39]
    ds_read_b64_tr_b16 v[72:73], v7 offset:34912
    ds_read_b64_tr_b16 v[74:75], v7 offset:39520
    s_add_u32 m0, s29, 53248
    s_nop 0
    buffer_load_dwordx4 v2, s[8:11], s27 offen sc1 lds
    s_add_u32 s27, s27, 2048
    v_mfma_f32_16x16x32_bf16 v[40:43], v[88:91], v[112:115], v[40:43]
    ds_read_b64_tr_b16 v[76:77], v7 offset:34944
    ds_read_b64_tr_b16 v[78:79], v7 offset:39552
    s_waitcnt lgkmcnt(14)
    v_mfma_f32_16x16x32_bf16 v[44:47], v[92:95], v[108:111], v[44:47]
    v_mfma_f32_16x16x32_bf16 v[48:51], v[92:95], v[112:115], v[48:51]
    s_add_u32 m0, s29, 43008
    s_nop 0
    buffer_load_dwordx4 v4, s[12:15], s26 offen lds
    s_waitcnt lgkmcnt(12)
    v_mfma_f32_16x16x32_bf16 v[52:55], v[96:99], v[108:111], v[52:55]
    v_mfma_f32_16x16x32_bf16 v[56:59], v[96:99], v[112:115], v[56:59]
    s_waitcnt lgkmcnt(8)
    v_mfma_f32_16x16x32_bf16 v[20:23], v[60:63], v[100:103], v[20:23]
    ds_read_b128 v[108:111], v11 offset:53248
    ds_read_b128 v[112:115], v11 offset:55296
    v_mfma_f32_16x16x32_bf16 v[24:27], v[60:63], v[104:107], v[24:27]
    ds_read_b64_tr_b16 v[80:81], v7 offset:44032
    ds_read_b64_tr_b16 v[82:83], v7 offset:48640
    s_add_u32 m0, s29, 61440
    s_nop 0
    buffer_load_dwordx4 v2, s[8:11], s28 offen sc1 lds
    s_add_u32 s28, s28, 2048
    s_waitcnt lgkmcnt(10)
    v_mfma_f32_16x16x32_bf16 v[28:31], v[64:67], v[100:103], v[28:31]
    ds_read_b64_tr_b16 v[84:85], v7 offset:44064
    ds_read_b64_tr_b16 v[86:87], v7 offset:48672
    v_mfma_f32_16x16x32_bf16 v[32:35], v[64:67], v[104:107], v[32:35]
    ds_read_b64_tr_b16 v[88:89], v7 offset:44096
    ds_read_b64_tr_b16 v[90:91], v7 offset:48704
    s_waitcnt lgkmcnt(12)
    v_mfma_f32_16x16x32_bf16 v[36:39], v[68:71], v[100:103], v[36:39]
    ds_read_b64_tr_b16 v[92:93], v7 offset:44128
    ds_read_b64_tr_b16 v[94:95], v7 offset:48736
    s_cmp_ge_u32 s20, 2
    s_cbranch_scc1 k234_mid_kernel_f_h0sk18
    s_add_u32 m0, s29, 51200
    s_nop 0
    buffer_load_dwordx4 v5, s[12:15], s26 offen lds
k234_mid_kernel_f_h0sk18:
    s_add_u32 s26, s26, 73728
    v_mfma_f32_16x16x32_bf16 v[40:43], v[68:71], v[104:107], v[40:43]
    ds_read_b64_tr_b16 v[96:97], v7 offset:44160
    ds_read_b64_tr_b16 v[98:99], v7 offset:48768
    s_waitcnt lgkmcnt(14)
    v_mfma_f32_16x16x32_bf16 v[44:47], v[72:75], v[100:103], v[44:47]
    v_mfma_f32_16x16x32_bf16 v[48:51], v[72:75], v[104:107], v[48:51]
    s_waitcnt lgkmcnt(12)
    v_mfma_f32_16x16x32_bf16 v[52:55], v[76:79], v[100:103], v[52:55]
    v_mfma_f32_16x16x32_bf16 v[56:59], v[76:79], v[104:107], v[56:59]
    s_waitcnt vmcnt(4)
    s_barrier
    s_waitcnt lgkmcnt(8)
    v_mfma_f32_16x16x32_bf16 v[20:23], v[80:83], v[108:111], v[20:23]
    ds_read_b128 v[100:103], v8 offset:18432
    ds_read_b128 v[104:107], v8 offset:20480
    v_mfma_f32_16x16x32_bf16 v[24:27], v[80:83], v[112:115], v[24:27]
    ds_read_b64_tr_b16 v[60:61], v6 offset:0
    ds_read_b64_tr_b16 v[62:63], v6 offset:4608
    s_waitcnt lgkmcnt(10)
    v_mfma_f32_16x16x32_bf16 v[28:31], v[84:87], v[108:111], v[28:31]
    ds_read_b64_tr_b16 v[64:65], v6 offset:32
    ds_read_b64_tr_b16 v[66:67], v6 offset:4640
    v_mfma_f32_16x16x32_bf16 v[32:35], v[84:87], v[112:115], v[32:35]
    ds_read_b64_tr_b16 v[68:69], v6 offset:64
    ds_read_b64_tr_b16 v[70:71], v6 offset:4672
    s_waitcnt lgkmcnt(12)
    v_mfma_f32_16x16x32_bf16 v[36:39], v[88:91], v[108:111], v[36:39]
    ds_read_b64_tr_b16 v[72:73], v6 offset:96
    ds_read_b64_tr_b16 v[74:75], v6 offset:4704
    v_mfma_f32_16x16x32_bf16 v[40:43], v[88:91], v[112:115], v[40:43]
    ds_read_b64_tr_b16 v[76:77], v6 offset:128
    ds_read_b64_tr_b16 v[78:79], v6 offset:4736
    s_waitcnt lgkmcnt(14)
    v_mfma_f32_16x16x32_bf16 v[44:47], v[92:95], v[108:111], v[44:47]
    v_mfma_f32_16x16x32_bf16 v[48:51], v[92:95], v[112:115], v[48:51]
    s_waitcnt lgkmcnt(12)
    v_mfma_f32_16x16x32_bf16 v[52:55], v[96:99], v[108:111], v[52:55]
    v_mfma_f32_16x16x32_bf16 v[56:59], v[96:99], v[112:115], v[56:59]
    s_waitcnt lgkmcnt(8)
    v_mfma_f32_16x16x32_bf16 v[20:23], v[60:63], v[100:103], v[20:23]
    ds_read_b128 v[108:111], v10 offset:18432
    ds_read_b128 v[112:115], v10 offset:20480
    v_mfma_f32_16x16x32_bf16 v[24:27], v[60:63], v[104:107], v[24:27]
    ds_read_b64_tr_b16 v[80:81], v6 offset:9216
    ds_read_b64_tr_b16 v[82:83], v6 offset:13824
    s_waitcnt lgkmcnt(10)
    v_mfma_f32_16x16x32_bf16 v[28:31], v[64:67], v[100:103], v[28:31]
    ds_read_b64_tr_b16 v[84:85], v6 offset:9248
    ds_read_b64_tr_b16 v[86:87], v6 offset:13856
    v_mfma_f32_16x16x32_bf16 v[32:35], v[64:67], v[104:107], v[32:35]
    ds_read_b64_tr_b16 v[88:89], v6 offset:9280
    ds_read_b64_tr_b16 v[90:91], v6 offset:13888
    s_waitcnt lgkmcnt(12)
    v_mfma_f32_16x16x32_bf16 v[36:39], v[68:71], v[100:103], v[36:39]
    ds_read_b64_tr_b16 v[92:93], v6 offset:9312
    ds_read_b64_tr_b16 v[94:95], v6 offset:13920
    v_mfma_f32_16x16x32_bf16 v[40:43], v[68:71], v[104:107], v[40:43]
    ds_read_b64_tr_b16 v[96:97], v6 offset:9344
    ds_read_b64_tr_b16 v[98:99], v6 offset:13952
    s_waitcnt lgkmcnt(14)
    v_mfma_f32_16x16x32_bf16 v[44:47], v[72:75], v[100:103], v[44:47]
    v_mfma_f32_16x16x32_bf16 v[48:51], v[72:75], v[104:107], v[48:51]
    s_waitcnt lgkmcnt(12)
    v_mfma_f32_16x16x32_bf16 v[52:55], v[76:79], v[100:103], v[52:55]
    v_mfma_f32_16x16x32_bf16 v[56:59], v[76:79], v[104:107], v[56:59]
    s_waitcnt vmcnt(0)
    s_barrier
    s_waitcnt lgkmcnt(8)
    v_mfma_f32_16x16x32_bf16 v[20:23], v[80:83], v[108:111], v[20:23]
    ds_read_b128 v[100:103], v8 offset:53248
    ds_read_b128 v[104:107], v8 offset:55296
    v_mfma_f32_16x16x32_bf16 v[24:27], v[80:83], v[112:115], v[24:27]
    ds_read_b64_tr_b16 v[60:61], v6 offset:34816
    ds_read_b64_tr_b16 v[62:63], v6 offset:39424
    s_waitcnt lgkmcnt(10)
    v_mfma_f32_16x16x32_bf16 v[28:31], v[84:87], v[108:111], v[28:31]
    ds_read_b64_tr_b16 v[64:65], v6 offset:34848
    ds_read_b64_tr_b16 v[66:67], v6 offset:39456
    v_mfma_f32_16x16x32_bf16 v[32:35], v[84:87], v[112:115], v[32:35]
    ds_read_b64_tr_b16 v[68:69], v6 offset:34880
    ds_read_b64_tr_b16 v[70:71], v6 offset:39488
    s_waitcnt lgkmcnt(12)
    v_mfma_f32_16x16x32_bf16 v[36:39], v[88:91], v[108:111], v[36:39]
    ds_read_b64_tr_b16 v[72:73], v6 offset:34912
    ds_read_b64_tr_b16 v[74:75], v6 offset:39520
    v_mfma_f32_16x16x32_bf16 v[40:43], v[88:91], v[112:115], v[40:43]
    ds_read_b64_tr_b16 v[76:77], v6 offset:34944
    ds_read_b64_tr_b16 v[78:79], v6 offset:39552
    s_waitcnt lgkmcnt(14)
    v_mfma_f32_16x16x32_bf16 v[44:47], v[92:95], v[108:111], v[44:47]
    v_mfma_f32_16x16x32_bf16 v[48:51], v[92:95], v[112:115], v[48:51]
    s_waitcnt lgkmcnt(12)
    v_mfma_f32_16x16x32_bf16 v[52:55], v[96:99], v[108:111], v[52:55]
    v_mfma_f32_16x16x32_bf16 v[56:59], v[96:99], v[112:115], v[56:59]
    s_waitcnt lgkmcnt(8)
    v_mfma_f32_16x16x32_bf16 v[20:23], v[60:63], v[100:103], v[20:23]
    ds_read_b128 v[108:111], v10 offset:53248
    ds_read_b128 v[112:115], v10 offset:55296
    v_mfma_f32_16x16x32_bf16 v[24:27], v[60:63], v[104:107], v[24:27]
    ds_read_b64_tr_b16 v[80:81], v6 offset:44032
    ds_read_b64_tr_b16 v[82:83], v6 offset:48640
    s_waitcnt lgkmcnt(10)
    v_mfma_f32_16x16x32_bf16 v[28:31], v[64:67], v[100:103], v[28:31]
    ds_read_b64_tr_b16 v[84:85], v6 offset:44064
    ds_read_b64_tr_b16 v[86:87], v6 offset:48672
    v_mfma_f32_16x16x32_bf16 v[32:35], v[64:67], v[104:107], v[32:35]
    ds_read_b64_tr_b16 v[88:89], v6 offset:44096
    ds_read_b64_tr_b16 v[90:91], v6 offset:48704
    s_waitcnt lgkmcnt(12)
    v_mfma_f32_16x16x32_bf16 v[36:39], v[68:71], v[100:103], v[36:39]
    ds_read_b64_tr_b16 v[92:93], v6 offset:44128
    ds_read_b64_tr_b16 v[94:95], v6 offset:48736
    v_mfma_f32_16x16x32_bf16 v[40:43], v[68:71], v[104:107], v[40:43]
    ds_read_b64_tr_b16 v[96:97], v6 offset:44160
    ds_read_b64_tr_b16 v[98:99], v6 offset:48768
    s_waitcnt lgkmcnt(14)
    v_mfma_f32_16x16x32_bf16 v[44:47], v[72:75], v[100:103], v[44:47]
    v_mfma_f32_16x16x32_bf16 v[48:51], v[72:75], v[104:107], v[48:51]
    s_waitcnt lgkmcnt(12)
    v_mfma_f32_16x16x32_bf16 v[52:55], v[76:79], v[100:103], v[52:55]
    v_mfma_f32_16x16x32_bf16 v[56:59], v[76:79], v[104:107], v[56:59]
    s_waitcnt lgkmcnt(8)
    v_mfma_f32_16x16x32_bf16 v[20:23], v[80:83], v[108:111], v[20:23]
    v_mfma_f32_16x16x32_bf16 v[24:27], v[80:83], v[112:115], v[24:27]
    s_waitcnt lgkmcnt(6)
    v_mfma_f32_16x16x32_bf16 v[28:31], v[84:87], v[108:111], v[28:31]
    v_mfma_f32_16x16x32_bf16 v[32:35], v[84:87], v[112:115], v[32:35]
    s_waitcnt lgkmcnt(4)
    v_mfma_f32_16x16x32_bf16 v[36:39], v[88:91], v[108:111], v[36:39]
    v_mfma_f32_16x16x32_bf16 v[40:43], v[88:91], v[112:115], v[40:43]
    s_waitcnt lgkmcnt(2)
    v_mfma_f32_16x16x32_bf16 v[44:47], v[92:95], v[108:111], v[44:47]
    v_mfma_f32_16x16x32_bf16 v[48:51], v[92:95], v[112:115], v[48:51]
    s_waitcnt lgkmcnt(0)
    v_mfma_f32_16x16x32_bf16 v[52:55], v[96:99], v[108:111], v[52:55]
    v_mfma_f32_16x16x32_bf16 v[56:59], v[96:99], v[112:115], v[56:59]
    s_cmp_eq_u32 s24, s21
    s_cbranch_scc1 k234_mid_kernel_f_h0own
    s_mul_i32 s32, s30, 3
    s_sub_u32 s33, s21, s24
    s_sub_u32 s33, s33, 1
    s_and_b32 s33, s33, 3
    s_add_u32 s32, s32, s33
    s_mul_i32 s32, s32, 9216
    s_add_u32 s32, s32, 37748736
    s_add_u32 s33, s32, 4096
    v_cvt_pk_bf16_f32 v60, v20, v21
    v_cvt_pk_bf16_f32 v61, v22, v23
    v_cvt_pk_bf16_f32 v62, v24, v25
    v_cvt_pk_bf16_f32 v63, v26, v27
    buffer_store_dwordx4 v[60:63], v2, s[8:11], s32 offen offset:0 sc1
    v_cvt_pk_bf16_f32 v64, v28, v29
    v_cvt_pk_bf16_f32 v65, v30, v31
    v_cvt_pk_bf16_f32 v66, v32, v33
    v_cvt_pk_bf16_f32 v67, v34, v35
    buffer_store_dwordx4 v[64:67], v2, s[8:11], s32 offen offset:1024 sc1
    v_cvt_pk_bf16_f32 v68, v36, v37
    v_cvt_pk_bf16_f32 v69, v38, v39
    v_cvt_pk_bf16_f32 v70, v40, v41
    v_cvt_pk_bf16_f32 v71, v42, v43
    buffer_store_dwordx4 v[68:71], v2, s[8:11], s32 offen offset:2048 sc1
    v_cvt_pk_bf16_f32 v72, v44, v45
    v_cvt_pk_bf16_f32 v73, v46, v47
    v_cvt_pk_bf16_f32 v74, v48, v49
    v_cvt_pk_bf16_f32 v75, v50, v51
    buffer_store_dwordx4 v[72:75], v2, s[8:11], s32 offen offset:3072 sc1
    v_cvt_pk_bf16_f32 v76, v52, v53
    v_cvt_pk_bf16_f32 v77, v54, v55
    v_cvt_pk_bf16_f32 v78, v56, v57
    v_cvt_pk_bf16_f32 v79, v58, v59
    buffer_store_dwordx4 v[76:79], v2, s[8:11], s33 offen offset:0 sc1
    s_branch k234_mid_kernel_f_fin1
k234_mid_kernel_f_h0own:
    v_add_u32 v12, 69632, v2
    ds_write_b128 v12, v[20:23] offset:0
    ds_write_b128 v12, v[24:27] offset:1024
    ds_write_b128 v12, v[28:31] offset:2048
    ds_write_b128 v12, v[32:35] offset:3072
    ds_write_b128 v12, v[36:39] offset:4096
    ds_write_b128 v12, v[40:43] offset:5120
    ds_write_b128 v12, v[44:47] offset:6144
    ds_write_b128 v12, v[48:51] offset:7168
    ds_write_b128 v12, v[52:55] offset:8192
    ds_write_b128 v12, v[56:59] offset:9216
    s_mul_i32 s32, s2, 27648
    s_add_u32 s32, s32, 37752832
    v_min_u32 v14, 2, v1
    v_mul_u32_u24 v14, 9216, v14
    s_mov_b32 s38, 100000
    s_branch k234_mid_kernel_f_fin1
k234_mid_kernel_f_h1:
    ds_read_b128 v[100:103], v8 offset:18432
    ds_read_b128 v[104:107], v8 offset:20480
    ds_read_b64_tr_b16 v[60:61], v6 offset:160
    ds_read_b64_tr_b16 v[62:63], v6 offset:4768
    ds_read_b64_tr_b16 v[64:65], v6 offset:192
    ds_read_b64_tr_b16 v[66:67], v6 offset:4800
    ds_read_b64_tr_b16 v[68:69], v6 offset:224
    ds_read_b64_tr_b16 v[70:71], v6 offset:4832
    ds_read_b64_tr_b16 v[72:73], v6 offset:256
    ds_read_b64_tr_b16 v[74:75], v6 offset:4864
    s_waitcnt lgkmcnt(6)
    v_mfma_f32_16x16x32_bf16 v[20:23], v[60:63], v[100:103], 0
    ds_read_b128 v[108:111], v10 offset:18432
    ds_read_b128 v[112:115], v10 offset:20480
    s_add_u32 m0, s29, 69632
    s_nop 0
    buffer_load_dwordx4 v3, s[12:15], s26 offen lds
    v_mfma_f32_16x16x32_bf16 v[24:27], v[60:63], v[104:107], 0
    ds_read_b64_tr_b16 v[80:81], v6 offset:9376
    ds_read_b64_tr_b16 v[82:83], v6 offset:13984
    s_add_u32 m0, s29, 88064
    s_nop 0
    buffer_load_dwordx4 v2, s[8:11], s27 offen sc1 lds
    s_add_u32 s27, s27, 2048
    s_waitcnt lgkmcnt(8)
    v_mfma_f32_16x16x32_bf16 v[28:31], v[64:67], v[100:103], 0
    ds_read_b64_tr_b16 v[84:85], v6 offset:9408
    ds_read_b64_tr_b16 v[86:87], v6 offset:14016
    s_add_u32 m0, s29, 77824
    s_nop 0
    buffer_load_dwordx4 v4, s[12:15], s26 offen lds
    v_mfma_f32_16x16x32_bf16 v[32:35], v[64:67], v[104:107], 0
    ds_read_b64_tr_b16 v[88:89], v6 offset:9440
    ds_read_b64_tr_b16 v[90:91], v6 offset:14048
    s_waitcnt lgkmcnt(10)
    v_mfma_f32_16x16x32_bf16 v[36:39], v[68:71], v[100:103], 0
    ds_read_b64_tr_b16 v[92:93], v6 offset:9472
    ds_read_b64_tr_b16 v[94:95], v6 offset:14080
    s_add_u32 m0, s29, 96256
    s_nop 0
    buffer_load_dwordx4 v2, s[8:11], s28 offen sc1 lds
    s_add_u32 s28, s28, 2048
    v_mfma_f32_16x16x32_bf16 v[40:43], v[68:71], v[104:107], 0
    s_waitcnt lgkmcnt(10)
    v_mfma_f32_16x16x32_bf16 v[44:47], v[72:75], v[100:103], 0
    s_add_u32 s26, s26, 73728
    v_mfma_f32_16x16x32_bf16 v[48:51], v[72:75], v[104:107], 0
    s_add_u32 m0, s29, 104448
    s_nop 0
    buffer_load_dwordx4 v3, s[12:15], s26 offen lds
    s_waitcnt vmcnt(5)
    s_barrier
    s_waitcnt lgkmcnt(6)
    v_mfma_f32_16x16x32_bf16 v[20:23], v[80:83], v[108:111], v[20:23]
    ds_read_b128 v[100:103], v8 offset:53248
    ds_read_b128 v[104:107], v8 offset:55296
    v_mfma_f32_16x16x32_bf16 v[24:27], v[80:83], v[112:115], v[24:27]
    ds_read_b64_tr_b16 v[60:61], v6 offset:34976
    ds_read_b64_tr_b16 v[62:63], v6 offset:39584
    s_add_u32 m0, s29, 122880
    s_nop 0
    buffer_load_dwordx4 v2, s[8:11], s27 offen sc1 lds
    s_add_u32 s27, s27, 2048
    s_waitcnt lgkmcnt(8)
    v_mfma_f32_16x16x32_bf16 v[28:31], v[84:87], v[108:111], v[28:31]
    ds_read_b64_tr_b16 v[64:65], v6 offset:35008
    ds_read_b64_tr_b16 v[66:67], v6 offset:39616
    v_mfma_f32_16x16x32_bf16 v[32:35], v[84:87], v[112:115], v[32:35]
    ds_read_b64_tr_b16 v[68:69], v6 offset:35040
    ds_read_b64_tr_b16 v[70:71], v6 offset:39648
    s_waitcnt lgkmcnt(10)
    v_mfma_f32_16x16x32_bf16 v[36:39], v[88:91], v[108:111], v[36:39]
    ds_read_b64_tr_b16 v[72:73], v6 offset:35072
    ds_read_b64_tr_b16 v[74:75], v6 offset:39680
    s_add_u32 m0, s29, 112640
    s_nop 0
    buffer_load_dwordx4 v4, s[12:15], s26 offen lds
    v_mfma_f32_16x16x32_bf16 v[40:43], v[88:91], v[112:115], v[40:43]
    s_waitcnt lgkmcnt(10)
    v_mfma_f32_16x16x32_bf16 v[44:47], v[92:95], v[108:111], v[44:47]
    v_mfma_f32_16x16x32_bf16 v[48:51], v[92:95], v[112:115], v[48:51]
    s_add_u32 m0, s29, 131072
    s_nop 0
    buffer_load_dwordx4 v2, s[8:11], s28 offen sc1 lds
    s_add_u32 s28, s28, 2048
    s_waitcnt lgkmcnt(6)
    v_mfma_f32_16x16x32_bf16 v[20:23], v[60:63], v[100:103], v[20:23]
    ds_read_b128 v[108:111], v10 offset:53248
    ds_read_b128 v[112:115], v10 offset:55296
    v_mfma_f32_16x16x32_bf16 v[24:27], v[60:63], v[104:107], v[24:27]
    ds_read_b64_tr_b16 v[80:81], v6 offset:44192
    ds_read_b64_tr_b16 v[82:83], v6 offset:48800
    s_add_u32 s26, s26, 73728
    s_waitcnt lgkmcnt(8)
    v_mfma_f32_16x16x32_bf16 v[28:31], v[64:67], v[100:103], v[28:31]
    ds_read_b64_tr_b16 v[84:85], v6 offset:44224
    ds_read_b64_tr_b16 v[86:87], v6 offset:48832
    v_mfma_f32_16x16x32_bf16 v[32:35], v[64:67], v[104:107], v[32:35]
    ds_read_b64_tr_b16 v[88:89], v6 offset:44256
    ds_read_b64_tr_b16 v[90:91], v6 offset:48864
    s_waitcnt lgkmcnt(10)
    v_mfma_f32_16x16x32_bf16 v[36:39], v[68:71], v[100:103], v[36:39]
    ds_read_b64_tr_b16 v[92:93], v6 offset:44288
    ds_read_b64_tr_b16 v[94:95], v6 offset:48896
    v_mfma_f32_16x16x32_bf16 v[40:43], v[68:71], v[104:107], v[40:43]
    s_waitcnt lgkmcnt(10)
    v_mfma_f32_16x16x32_bf16 v[44:47], v[72:75], v[100:103], v[44:47]
    v_mfma_f32_16x16x32_bf16 v[48:51], v[72:75], v[104:107], v[48:51]
    s_waitcnt vmcnt(4)
    s_barrier
    s_waitcnt lgkmcnt(6)
    v_mfma_f32_16x16x32_bf16 v[20:23], v[80:83], v[108:111], v[20:23]
    ds_read_b128 v[100:103], v9 offset:18432
    ds_read_b128 v[104:107], v9 offset:20480
    v_mfma_f32_16x16x32_bf16 v[24:27], v[80:83], v[112:115], v[24:27]
    ds_read_b64_tr_b16 v[60:61], v7 offset:160
    ds_read_b64_tr_b16 v[62:63], v7 offset:4768
    s_add_u32 m0, s29, 0
    s_nop 0
    buffer_load_dwordx4 v3, s[12:15], s26 offen lds
    s_waitcnt lgkmcnt(8)
    v_mfma_f32_16x16x32_bf16 v[28:31], v[84:87], v[108:111], v[28:31]
    ds_read_b64_tr_b16 v[64:65], v7 offset:192
    ds_read_b64_tr_b16 v[66:67], v7 offset:4800
    v_mfma_f32_16x16x32_bf16 v[32:35], v[84:87], v[112:115], v[32:35]
    ds_read_b64_tr_b16 v[68:69], v7 offset:224
    ds_read_b64_tr_b16 v[70:71], v7 offset:4832
    s_waitcnt lgkmcnt(10)
    v_mfma_f32_16x16x32_bf16 v[36:39], v[88:91], v[108:111], v[36:39]
    ds_read_b64_tr_b16 v[72:73], v7 offset:256
    ds_read_b64_tr_b16 v[74:75], v7 offset:4864
    s_add_u32 m0, s29, 18432
    s_nop 0
    buffer_load_dwordx4 v2, s[8:11], s27 offen sc1 lds
    s_add_u32 s27, s27, 2048
    v_mfma_f32_16x16x32_bf16 v[40:43], v[88:91], v[112:115], v[40:43]
    s_waitcnt lgkmcnt(10)
    v_mfma_f32_16x16x32_bf16 v[44:47], v[92:95], v[108:111], v[44:47]
    v_mfma_f32_16x16x32_bf16 v[48:51], v[92:95], v[112:115], v[48:51]
    s_add_u32 m0, s29, 8192
    s_nop 0
    buffer_load_dwordx4 v4, s[12:15], s26 offen lds
    s_waitcnt lgkmcnt(6)
    v_mfma_f32_16x16x32_bf16 v[20:23], v[60:63], v[100:103], v[20:23]
    ds_read_b128 v[108:111], v11 offset:18432
    ds_read_b128 v[112:115], v11 offset:20480
    v_mfma_f32_16x16x32_bf16 v[24:27], v[60:63], v[104:107], v[24:27]
    ds_read_b64_tr_b16 v[80:81], v7 offset:9376
    ds_read_b64_tr_b16 v[82:83], v7 offset:13984
    s_add_u32 m0, s29, 26624
    s_nop 0
    buffer_load_dwordx4 v2, s[8:11], s28 offen sc1 lds
    s_add_u32 s28, s28, 2048
    s_waitcnt lgkmcnt(8)
    v_mfma_f32_16x16x32_bf16 v[28:31], v[64:67], v[100:103], v[28:31]
    ds_read_b64_tr_b16 v[84:85], v7 offset:9408
    ds_read_b64_tr_b16 v[86:87], v7 offset:14016
    v_mfma_f32_16x16x32_bf16 v[32:35], v[64:67], v[104:107], v[32:35]
    ds_read_b64_tr_b16 v[88:89], v7 offset:9440
    ds_read_b64_tr_b16 v[90:91], v7 offset:14048
    s_waitcnt lgkmcnt(10)
    v_mfma_f32_16x16x32_bf16 v[36:39], v[68:71], v[100:103], v[36:39]
    ds_read_b64_tr_b16 v[92:93], v7 offset:9472
    ds_read_b64_tr_b16 v[94:95], v7 offset:14080
    s_add_u32 s26, s26, 73728
    v_mfma_f32_16x16x32_bf16 v[40:43], v[68:71], v[104:107], v[40:43]
    s_waitcnt lgkmcnt(10)
    v_mfma_f32_16x16x32_bf16 v[44:47], v[72:75], v[100:103], v[44:47]
    v_mfma_f32_16x16x32_bf16 v[48:51], v[72:75], v[104:107], v[48:51]
    s_waitcnt vmcnt(4)
    s_barrier
    s_waitcnt lgkmcnt(6)
    v_mfma_f32_16x16x32_bf16 v[20:23], v[80:83], v[108:111], v[20:23]
    ds_read_b128 v[100:103], v9 offset:53248
    ds_read_b128 v[104:107], v9 offset:55296
    v_mfma_f32_16x16x32_bf16 v[24:27], v[80:83], v[112:115], v[24:27]
    ds_read_b64_tr_b16 v[60:61], v7 offset:34976
    ds_read_b64_tr_b16 v[62:63], v7 offset:39584
    s_add_u32 m0, s29, 34816
    s_nop 0
    buffer_load_dwordx4 v3, s[12:15], s26 offen lds
    s_waitcnt lgkmcnt(8)
    v_mfma_f32_16x16x32_bf16 v[28:31], v[84:87], v[108:111], v[28:31]
    ds_read_b64_tr_b16 v[64:65], v7 offset:35008
    ds_read_b64_tr_b16 v[66:67], v7 offset:39616
    v_mfma_f32_16x16x32_bf16 v[32:35], v[84:87], v[112:115], v[32:35]
    ds_read_b64_tr_b16 v[68:69], v7 offset:35040
    ds_read_b64_tr_b16 v[70:71], v7 offset:39648
    s_waitcnt lgkmcnt(10)
    v_mfma_f32_16x16x32_bf16 v[36:39], v[88:91], v[108:111], v[36:39]
    ds_read_b64_tr_b16 v[72:73], v7 offset:35072
    ds_read_b64_tr_b16 v[74:75], v7 offset:39680
    s_add_u32 m0, s29, 53248
    s_nop 0
    buffer_load_dwordx4 v2, s[8:11], s27 offen sc1 lds
    s_add_u32 s27, s27, 2048
    v_mfma_f32_16x16x32_bf16 v[40:43], v[88:91], v[112:115], v[40:43]
    s_waitcnt lgkmcnt(10)
    v_mfma_f32_16x16x32_bf16 v[44:47], v[92:95], v[108:111], v[44:47]
    v_mfma_f32_16x16x32_bf16 v[48:51], v[92:95], v[112:115], v[48:51]
    s_add_u32 m0, s29, 43008
    s_nop 0
    buffer_load_dwordx4 v4, s[12:15], s26 offen lds
    s_waitcnt lgkmcnt(6)
    v_mfma_f32_16x16x32_bf16 v[20:23], v[60:63], v[100:103], v[20:23]
    ds_read_b128 v[108:111], v11 offset:53248
    ds_read_b128 v[112:115], v11 offset:55296
    v_mfma_f32_16x16x32_bf16 v[24:27], v[60:63], v[104:107], v[24:27]
    ds_read_b64_tr_b16 v[80:81], v7 offset:44192
    ds_read_b64_tr_b16 v[82:83], v7 offset:48800
    s_add_u32 m0, s29, 61440
    s_nop 0
    buffer_load_dwordx4 v2, s[8:11], s28 offen sc1 lds
    s_add_u32 s28, s28, 2048
    s_waitcnt lgkmcnt(8)
    v_mfma_f32_16x16x32_bf16 v[28:31], v[64:67], v[100:103], v[28:31]
    ds_read_b64_tr_b16 v[84:85], v7 offset:44224
    ds_read_b64_tr_b16 v[86:87], v7 offset:48832
    v_mfma_f32_16x16x32_bf16 v[32:35], v[64:67], v[104:107], v[32:35]
    ds_read_b64_tr_b16 v[88:89], v7 offset:44256
    ds_read_b64_tr_b16 v[90:91], v7 offset:48864
    s_waitcnt lgkmcnt(10)
    v_mfma_f32_16x16x32_bf16 v[36:39], v[68:71], v[100:103], v[36:39]
    ds_read_b64_tr_b16 v[92:93], v7 offset:44288
    ds_read_b64_tr_b16 v[94:95], v7 offset:48896
    s_add_u32 s26, s26, 73728
    v_mfma_f32_16x16x32_bf16 v[40:43], v[68:71], v[104:107], v[40:43]
    s_waitcnt lgkmcnt(10)
    v_mfma_f32_16x16x32_bf16 v[44:47], v[72:75], v[100:103], v[44:47]
    v_mfma_f32_16x16x32_bf16 v[48:51], v[72:75], v[104:107], v[48:51]
    s_waitcnt vmcnt(4)
    s_barrier
    s_waitcnt lgkmcnt(6)
    v_mfma_f32_16x16x32_bf16 v[20:23], v[80:83], v[108:111], v[20:23]
    ds_read_b128 v[100:103], v8 offset:18432
    ds_read_b128 v[104:107], v8 offset:20480
    v_mfma_f32_16x16x32_bf16 v[24:27], v[80:83], v[112:115], v[24:27]
    ds_read_b64_tr_b16 v[60:61], v6 offset:160
    ds_read_b64_tr_b16 v[62:63], v6 offset:4768
    s_add_u32 m0, s29, 69632
    s_nop 0
    buffer_load_dwordx4 v3, s[12:15], s26 offen lds
    s_waitcnt lgkmcnt(8)
    v_mfma_f32_16x16x32_bf16 v[28:31], v[84:87], v[108:111], v[28:31]
    ds_read_b64_tr_b16 v[64:65], v6 offset:192
    ds_read_b64_tr_b16 v[66:67], v6 offset:4800
    v_mfma_f32_16x16x32_bf16 v[32:35], v[84:87], v[112:115], v[32:35]
    ds_read_b64_tr_b16 v[68:69], v6 offset:224
    ds_read_b64_tr_b16 v[70:71], v6 offset:4832
    s_waitcnt lgkmcnt(10)
    v_mfma_f32_16x16x32_bf16 v[36:39], v[88:91], v[108:111], v[36:39]
    ds_read_b64_tr_b16 v[72:73], v6 offset:256
    ds_read_b64_tr_b16 v[74:75], v6 offset:4864
    s_add_u32 m0, s29, 88064
    s_nop 0
    buffer_load_dwordx4 v2, s[8:11], s27 offen sc1 lds
    s_add_u32 s27, s27, 2048
    v_mfma_f32_16x16x32_bf16 v[40:43], v[88:91], v[112:115], v[40:43]
    s_waitcnt lgkmcnt(10)
    v_mfma_f32_16x16x32_bf16 v[44:47], v[92:95], v[108:111], v[44:47]
    v_mfma_f32_16x16x32_bf16 v[48:51], v[92:95], v[112:115], v[48:51]
    s_add_u32 m0, s29, 77824
    s_nop 0
    buffer_load_dwordx4 v4, s[12:15], s26 offen lds
    s_waitcnt lgkmcnt(6)
    v_mfma_f32_16x16x32_bf16 v[20:23], v[60:63], v[100:103], v[20:23]
    ds_read_b128 v[108:111], v10 offset:18432
    ds_read_b128 v[112:115], v10 offset:20480
    v_mfma_f32_16x16x32_bf16 v[24:27], v[60:63], v[104:107], v[24:27]
    ds_read_b64_tr_b16 v[80:81], v6 offset:9376
    ds_read_b64_tr_b16 v[82:83], v6 offset:13984
    s_add_u32 m0, s29, 96256
    s_nop 0
    buffer_load_dwordx4 v2, s[8:11], s28 offen sc1 lds
    s_add_u32 s28, s28, 2048
    s_waitcnt lgkmcnt(8)
    v_mfma_f32_16x16x32_bf16 v[28:31], v[64:67], v[100:103], v[28:31]
    ds_read_b64_tr_b16 v[84:85], v6 offset:9408
    ds_read_b64_tr_b16 v[86:87], v6 offset:14016
    v_mfma_f32_16x16x32_bf16 v[32:35], v[64:67], v[104:107], v[32:35]
    ds_read_b64_tr_b16 v[88:89], v6 offset:9440
    ds_read_b64_tr_b16 v[90:91], v6 offset:14048
    s_waitcnt lgkmcnt(10)
    v_mfma_f32_16x16x32_bf16 v[36:39], v[68:71], v[100:103], v[36:39]
    ds_read_b64_tr_b16 v[92:93], v6 offset:9472
    ds_read_b64_tr_b16 v[94:95], v6 offset:14080
    s_add_u32 s26, s26, 73728
    v_mfma_f32_16x16x32_bf16 v[40:43], v[68:71], v[104:107], v[40:43]
    s_waitcnt lgkmcnt(10)
    v_mfma_f32_16x16x32_bf16 v[44:47], v[72:75], v[100:103], v[44:47]
    v_mfma_f32_16x16x32_bf16 v[48:51], v[72:75], v[104:107], v[48:51]
    s_waitcnt vmcnt(4)
    s_barrier
    s_waitcnt lgkmcnt(6)
    v_mfma_f32_16x16x32_bf16 v[20:23], v[80:83], v[108:111], v[20:23]
    ds_read_b128 v[100:103], v8 offset:53248
    ds_read_b128 v[104:107], v8 offset:55296
    v_mfma_f32_16x16x32_bf16 v[24:27], v[80:83], v[112:115], v[24:27]
    ds_read_b64_tr_b16 v[60:61], v6 offset:34976
    ds_read_b64_tr_b16 v[62:63], v6 offset:39584
    s_add_u32 m0, s29, 104448
    s_nop 0
    buffer_load_dwordx4 v3, s[12:15], s26 offen lds
    s_waitcnt lgkmcnt(8)
    v_mfma_f32_16x16x32_bf16 v[28:31], v[84:87], v[108:111], v[28:31]
    ds_read_b64_tr_b16 v[64:65], v6 offset:35008
    ds_read_b64_tr_b16 v[66:67], v6 offset:39616
    v_mfma_f32_16x16x32_bf16 v[32:35], v[84:87], v[112:115], v[32:35]
    ds_read_b64_tr_b16 v[68:69], v6 offset:35040
    ds_read_b64_tr_b16 v[70:71], v6 offset:39648
    s_waitcnt lgkmcnt(10)
    v_mfma_f32_16x16x32_bf16 v[36:39], v[88:91], v[108:111], v[36:39]
    ds_read_b64_tr_b16 v[72:73], v6 offset:35072
    ds_read_b64_tr_b16 v[74:75], v6 offset:39680
    s_add_u32 m0, s29, 122880
    s_nop 0
    buffer_load_dwordx4 v2, s[8:11], s27 offen sc1 lds
    s_add_u32 s27, s27, 2048
    v_mfma_f32_16x16x32_bf16 v[40:43], v[88:91], v[112:115], v[40:43]
    s_waitcnt lgkmcnt(10)
    v_mfma_f32_16x16x32_bf16 v[44:47], v[92:95], v[108:111], v[44:47]
    v_mfma_f32_16x16x32_bf16 v[48:51], v[92:95], v[112:115], v[48:51]
    s_add_u32 m0, s29, 112640
    s_nop 0
    buffer_load_dwordx4 v4, s[12:15], s26 offen lds
    s_waitcnt lgkmcnt(6)
    v_mfma_f32_16x16x32_bf16 v[20:23], v[60:63], v[100:103], v[20:23]
    ds_read_b128 v[108:111], v10 offset:53248
    ds_read_b128 v[112:115], v10 offset:55296
    v_mfma_f32_16x16x32_bf16 v[24:27], v[60:63], v[104:107], v[24:27]
    ds_read_b64_tr_b16 v[80:81], v6 offset:44192
    ds_read_b64_tr_b16 v[82:83], v6 offset:48800
    s_add_u32 m0, s29, 131072
    s_nop 0
    buffer_load_dwordx4 v2, s[8:11], s28 offen sc1 lds
    s_add_u32 s28, s28, 2048
    s_waitcnt lgkmcnt(8)
    v_mfma_f32_16x16x32_bf16 v[28:31], v[64:67], v[100:103], v[28:31]
    ds_read_b64_tr_b16 v[84:85], v6 offset:44224
    ds_read_b64_tr_b16 v[86:87], v6 offset:48832
    v_mfma_f32_16x16x32_bf16 v[32:35], v[64:67], v[104:107], v[32:35]
    ds_read_b64_tr_b16 v[88:89], v6 offset:44256
    ds_read_b64_tr_b16 v[90:91], v6 offset:48864
    s_waitcnt lgkmcnt(10)
    v_mfma_f32_16x16x32_bf16 v[36:39], v[68:71], v[100:103], v[36:39]
    ds_read_b64_tr_b16 v[92:93], v6 offset:44288
    ds_read_b64_tr_b16 v[94:95], v6 offset:48896
    s_add_u32 s26, s26, 73728
    v_mfma_f32_16x16x32_bf16 v[40:43], v[68:71], v[104:107], v[40:43]
    s_waitcnt lgkmcnt(10)
    v_mfma_f32_16x16x32_bf16 v[44:47], v[72:75], v[100:103], v[44:47]
    v_mfma_f32_16x16x32_bf16 v[48:51], v[72:75], v[104:107], v[48:51]
    s_waitcnt vmcnt(4)
    s_barrier
    s_waitcnt lgkmcnt(6)
    v_mfma_f32_16x16x32_bf16 v[20:23], v[80:83], v[108:111], v[20:23]
    ds_read_b128 v[100:103], v9 offset:18432
    ds_read_b128 v[104:107], v9 offset:20480
    v_mfma_f32_16x16x32_bf16 v[24:27], v[80:83], v[112:115], v[24:27]
    ds_read_b64_tr_b16 v[60:61], v7 offset:160
    ds_read_b64_tr_b16 v[62:63], v7 offset:4768
    s_add_u32 m0, s29, 0
    s_nop 0
    buffer_load_dwordx4 v3, s[12:15], s26 offen lds
    s_waitcnt lgkmcnt(8)
    v_mfma_f32_16x16x32_bf16 v[28:31], v[84:87], v[108:111], v[28:31]
    ds_read_b64_tr_b16 v[64:65], v7 offset:192
    ds_read_b64_tr_b16 v[66:67], v7 offset:4800
    v_mfma_f32_16x16x32_bf16 v[32:35], v[84:87], v[112:115], v[32:35]
    ds_read_b64_tr_b16 v[68:69], v7 offset:224
    ds_read_b64_tr_b16 v[70:71], v7 offset:4832
    s_waitcnt lgkmcnt(10)
    v_mfma_f32_16x16x32_bf16 v[36:39], v[88:91], v[108:111], v[36:39]
    ds_read_b64_tr_b16 v[72:73], v7 offset:256
    ds_read_b64_tr_b16 v[74:75], v7 offset:4864
    s_add_u32 m0, s29, 18432
    s_nop 0
    buffer_load_dwordx4 v2, s[8:11], s27 offen sc1 lds
    s_add_u32 s27, s27, 2048
    v_mfma_f32_16x16x32_bf16 v[40:43], v[88:91], v[112:115], v[40:43]
    s_waitcnt lgkmcnt(10)
    v_mfma_f32_16x16x32_bf16 v[44:47], v[92:95], v[108:111], v[44:47]
    v_mfma_f32_16x16x32_bf16 v[48:51], v[92:95], v[112:115], v[48:51]
    s_add_u32 m0, s29, 8192
    s_nop 0
    buffer_load_dwordx4 v4, s[12:15], s26 offen lds
    s_waitcnt lgkmcnt(6)
    v_mfma_f32_16x16x32_bf16 v[20:23], v[60:63], v[100:103], v[20:23]
    ds_read_b128 v[108:111], v11 offset:18432
    ds_read_b128 v[112:115], v11 offset:20480
    v_mfma_f32_16x16x32_bf16 v[24:27], v[60:63], v[104:107], v[24:27]
    ds_read_b64_tr_b16 v[80:81], v7 offset:9376
    ds_read_b64_tr_b16 v[82:83], v7 offset:13984
    s_add_u32 m0, s29, 26624
    s_nop 0
    buffer_load_dwordx4 v2, s[8:11], s28 offen sc1 lds
    s_add_u32 s28, s28, 2048
    s_waitcnt lgkmcnt(8)
    v_mfma_f32_16x16x32_bf16 v[28:31], v[64:67], v[100:103], v[28:31]
    ds_read_b64_tr_b16 v[84:85], v7 offset:9408
    ds_read_b64_tr_b16 v[86:87], v7 offset:14016
    v_mfma_f32_16x16x32_bf16 v[32:35], v[64:67], v[104:107], v[32:35]
    ds_read_b64_tr_b16 v[88:89], v7 offset:9440
    ds_read_b64_tr_b16 v[90:91], v7 offset:14048
    s_waitcnt lgkmcnt(10)
    v_mfma_f32_16x16x32_bf16 v[36:39], v[68:71], v[100:103], v[36:39]
    ds_read_b64_tr_b16 v[92:93], v7 offset:9472
    ds_read_b64_tr_b16 v[94:95], v7 offset:14080
    s_add_u32 s26, s26, 73728
    v_mfma_f32_16x16x32_bf16 v[40:43], v[68:71], v[104:107], v[40:43]
    s_waitcnt lgkmcnt(10)
    v_mfma_f32_16x16x32_bf16 v[44:47], v[72:75], v[100:103], v[44:47]
    v_mfma_f32_16x16x32_bf16 v[48:51], v[72:75], v[104:107], v[48:51]
    s_waitcnt vmcnt(4)
    s_barrier
    s_waitcnt lgkmcnt(6)
    v_mfma_f32_16x16x32_bf16 v[20:23], v[80:83], v[108:111], v[20:23]
    ds_read_b128 v[100:103], v9 offset:53248
    ds_read_b128 v[104:107], v9 offset:55296
    v_mfma_f32_16x16x32_bf16 v[24:27], v[80:83], v[112:115], v[24:27]
    ds_read_b64_tr_b16 v[60:61], v7 offset:34976
    ds_read_b64_tr_b16 v[62:63], v7 offset:39584
    s_add_u32 m0, s29, 34816
    s_nop 0
    buffer_load_dwordx4 v3, s[12:15], s26 offen lds
    s_waitcnt lgkmcnt(8)
    v_mfma_f32_16x16x32_bf16 v[28:31], v[84:87], v[108:111], v[28:31]
    ds_read_b64_tr_b16 v[64:65], v7 offset:35008
    ds_read_b64_tr_b16 v[66:67], v7 offset:39616
    v_mfma_f32_16x16x32_bf16 v[32:35], v[84:87], v[112:115], v[32:35]
    ds_read_b64_tr_b16 v[68:69], v7 offset:35040
    ds_read_b64_tr_b16 v[70:71], v7 offset:39648
    s_waitcnt lgkmcnt(10)
    v_mfma_f32_16x16x32_bf16 v[36:39], v[88:91], v[108:111], v[36:39]
    ds_read_b64_tr_b16 v[72:73], v7 offset:35072
    ds_read_b64_tr_b16 v[74:75], v7 offset:39680
    s_add_u32 m0, s29, 53248
    s_nop 0
    buffer_load_dwordx4 v2, s[8:11], s27 offen sc1 lds
    s_add_u32 s27, s27, 2048
    v_mfma_f32_16x16x32_bf16 v[40:43], v[88:91], v[112:115], v[40:43]
    s_waitcnt lgkmcnt(10)
    v_mfma_f32_16x16x32_bf16 v[44:47], v[92:95], v[108:111], v[44:47]
    v_mfma_f32_16x16x32_bf16 v[48:51], v[92:95], v[112:115], v[48:51]
    s_add_u32 m0, s29, 43008
    s_nop 0
    buffer_load_dwordx4 v4, s[12:15], s26 offen lds
    s_waitcnt lgkmcnt(6)
    v_mfma_f32_16x16x32_bf16 v[20:23], v[60:63], v[100:103], v[20:23]
    ds_read_b128 v[108:111], v11 offset:53248
    ds_read_b128 v[112:115], v11 offset:55296
    v_mfma_f32_16x16x32_bf16 v[24:27], v[60:63], v[104:107], v[24:27]
    ds_read_b64_tr_b16 v[80:81], v7 offset:44192
    ds_read_b64_tr_b16 v[82:83], v7 offset:48800
    s_add_u32 m0, s29, 61440
    s_nop 0
    buffer_load_dwordx4 v2, s[8:11], s28 offen sc1 lds
    s_add_u32 s28, s28, 2048
    s_waitcnt lgkmcnt(8)
    v_mfma_f32_16x16x32_bf16 v[28:31], v[64:67], v[100:103], v[28:31]
    ds_read_b64_tr_b16 v[84:85], v7 offset:44224
    ds_read_b64_tr_b16 v[86:87], v7 offset:48832
    v_mfma_f32_16x16x32_bf16 v[32:35], v[64:67], v[104:107], v[32:35]
    ds_read_b64_tr_b16 v[88:89], v7 offset:44256
    ds_read_b64_tr_b16 v[90:91], v7 offset:48864
    s_waitcnt lgkmcnt(10)
    v_mfma_f32_16x16x32_bf16 v[36:39], v[68:71], v[100:103], v[36:39]
    ds_read_b64_tr_b16 v[92:93], v7 offset:44288
    ds_read_b64_tr_b16 v[94:95], v7 offset:48896
    s_add_u32 s26, s26, 73728
    v_mfma_f32_16x16x32_bf16 v[40:43], v[68:71], v[104:107], v[40:43]
    s_waitcnt lgkmcnt(10)
    v_mfma_f32_16x16x32_bf16 v[44:47], v[72:75], v[100:103], v[44:47]
    v_mfma_f32_16x16x32_bf16 v[48:51], v[72:75], v[104:107], v[48:51]
    s_waitcnt vmcnt(4)
    s_barrier
    s_waitcnt lgkmcnt(6)
    v_mfma_f32_16x16x32_bf16 v[20:23], v[80:83], v[108:111], v[20:23]
    ds_read_b128 v[100:103], v8 offset:18432
    ds_read_b128 v[104:107], v8 offset:20480
    v_mfma_f32_16x16x32_bf16 v[24:27], v[80:83], v[112:115], v[24:27]
    ds_read_b64_tr_b16 v[60:61], v6 offset:160
    ds_read_b64_tr_b16 v[62:63], v6 offset:4768
    s_add_u32 m0, s29, 69632
    s_nop 0
    buffer_load_dwordx4 v3, s[12:15], s26 offen lds
    s_waitcnt lgkmcnt(8)
    v_mfma_f32_16x16x32_bf16 v[28:31], v[84:87], v[108:111], v[28:31]
    ds_read_b64_tr_b16 v[64:65], v6 offset:192
    ds_read_b64_tr_b16 v[66:67], v6 offset:4800
    v_mfma_f32_16x16x32_bf16 v[32:35], v[84:87], v[112:115], v[32:35]
    ds_read_b64_tr_b16 v[68:69], v6 offset:224
    ds_read_b64_tr_b16 v[70:71], v6 offset:4832
    s_waitcnt lgkmcnt(10)
    v_mfma_f32_16x16x32_bf16 v[36:39], v[88:91], v[108:111], v[36:39]
    ds_read_b64_tr_b16 v[72:73], v6 offset:256
    ds_read_b64_tr_b16 v[74:75], v6 offset:4864
    s_add_u32 m0, s29, 88064
    s_nop 0
    buffer_load_dwordx4 v2, s[8:11], s27 offen sc1 lds
    s_add_u32 s27, s27, 2048
    v_mfma_f32_16x16x32_bf16 v[40:43], v[88:91], v[112:115], v[40:43]
    s_waitcnt lgkmcnt(10)
    v_mfma_f32_16x16x32_bf16 v[44:47], v[92:95], v[108:111], v[44:47]
    v_mfma_f32_16x16x32_bf16 v[48:51], v[92:95], v[112:115], v[48:51]
    s_add_u32 m0, s29, 77824
    s_nop 0
    buffer_load_dwordx4 v4, s[12:15], s26 offen lds
    s_waitcnt lgkmcnt(6)
    v_mfma_f32_16x16x32_bf16 v[20:23], v[60:63], v[100:103], v[20:23]
    ds_read_b128 v[108:111], v10 offset:18432
    ds_read_b128 v[112:115], v10 offset:20480
    v_mfma_f32_16x16x32_bf16 v[24:27], v[60:63], v[104:107], v[24:27]
    ds_read_b64_tr_b16 v[80:81], v6 offset:9376
    ds_read_b64_tr_b16 v[82:83], v6 offset:13984
    s_add_u32 m0, s29, 96256
    s_nop 0
    buffer_load_dwordx4 v2, s[8:11], s28 offen sc1 lds
    s_add_u32 s28, s28, 2048
    s_waitcnt lgkmcnt(8)
    v_mfma_f32_16x16x32_bf16 v[28:31], v[64:67], v[100:103], v[28:31]
    ds_read_b64_tr_b16 v[84:85], v6 offset:9408
    ds_read_b64_tr_b16 v[86:87], v6 offset:14016
    v_mfma_f32_16x16x32_bf16 v[32:35], v[64:67], v[104:107], v[32:35]
    ds_read_b64_tr_b16 v[88:89], v6 offset:9440
    ds_read_b64_tr_b16 v[90:91], v6 offset:14048
    s_waitcnt lgkmcnt(10)
    v_mfma_f32_16x16x32_bf16 v[36:39], v[68:71], v[100:103], v[36:39]
    ds_read_b64_tr_b16 v[92:93], v6 offset:9472
    ds_read_b64_tr_b16 v[94:95], v6 offset:14080
    s_add_u32 s26, s26, 73728
    v_mfma_f32_16x16x32_bf16 v[40:43], v[68:71], v[104:107], v[40:43]
    s_waitcnt lgkmcnt(10)
    v_mfma_f32_16x16x32_bf16 v[44:47], v[72:75], v[100:103], v[44:47]
    v_mfma_f32_16x16x32_bf16 v[48:51], v[72:75], v[104:107], v[48:51]
    s_waitcnt vmcnt(4)
    s_barrier
    s_waitcnt lgkmcnt(6)
    v_mfma_f32_16x16x32_bf16 v[20:23], v[80:83], v[108:111], v[20:23]
    ds_read_b128 v[100:103], v8 offset:53248
    ds_read_b128 v[104:107], v8 offset:55296
    v_mfma_f32_16x16x32_bf16 v[24:27], v[80:83], v[112:115], v[24:27]
    ds_read_b64_tr_b16 v[60:61], v6 offset:34976
    ds_read_b64_tr_b16 v[62:63], v6 offset:39584
    s_add_u32 m0, s29, 104448
    s_nop 0
    buffer_load_dwordx4 v3, s[12:15], s26 offen lds
    s_waitcnt lgkmcnt(8)
    v_mfma_f32_16x16x32_bf16 v[28:31], v[84:87], v[108:111], v[28:31]
    ds_read_b64_tr_b16 v[64:65], v6 offset:35008
    ds_read_b64_tr_b16 v[66:67], v6 offset:39616
    v_mfma_f32_16x16x32_bf16 v[32:35], v[84:87], v[112:115], v[32:35]
    ds_read_b64_tr_b16 v[68:69], v6 offset:35040
    ds_read_b64_tr_b16 v[70:71], v6 offset:39648
    s_waitcnt lgkmcnt(10)
    v_mfma_f32_16x16x32_bf16 v[36:39], v[88:91], v[108:111], v[36:39]
    ds_read_b64_tr_b16 v[72:73], v6 offset:35072
    ds_read_b64_tr_b16 v[74:75], v6 offset:39680
    s_add_u32 m0, s29, 122880
    s_nop 0
    buffer_load_dwordx4 v2, s[8:11], s27 offen sc1 lds
    s_add_u32 s27, s27, 2048
    v_mfma_f32_16x16x32_bf16 v[40:43], v[88:91], v[112:115], v[40:43]
    s_waitcnt lgkmcnt(10)
    v_mfma_f32_16x16x32_bf16 v[44:47], v[92:95], v[108:111], v[44:47]
    v_mfma_f32_16x16x32_bf16 v[48:51], v[92:95], v[112:115], v[48:51]
    s_add_u32 m0, s29, 112640
    s_nop 0
    buffer_load_dwordx4 v4, s[12:15], s26 offen lds
    s_waitcnt lgkmcnt(6)
    v_mfma_f32_16x16x32_bf16 v[20:23], v[60:63], v[100:103], v[20:23]
    ds_read_b128 v[108:111], v10 offset:53248
    ds_read_b128 v[112:115], v10 offset:55296
    v_mfma_f32_16x16x32_bf16 v[24:27], v[60:63], v[104:107], v[24:27]
    ds_read_b64_tr_b16 v[80:81], v6 offset:44192
    ds_read_b64_tr_b16 v[82:83], v6 offset:48800
    s_add_u32 m0, s29, 131072
    s_nop 0
    buffer_load_dwordx4 v2, s[8:11], s28 offen sc1 lds
    s_add_u32 s28, s28, 2048
    s_waitcnt lgkmcnt(8)
    v_mfma_f32_16x16x32_bf16 v[28:31], v[64:67], v[100:103], v[28:31]
    ds_read_b64_tr_b16 v[84:85], v6 offset:44224
    ds_read_b64_tr_b16 v[86:87], v6 offset:48832
    v_mfma_f32_16x16x32_bf16 v[32:35], v[64:67], v[104:107], v[32:35]
    ds_read_b64_tr_b16 v[88:89], v6 offset:44256
    ds_read_b64_tr_b16 v[90:91], v6 offset:48864
    s_waitcnt lgkmcnt(10)
    v_mfma_f32_16x16x32_bf16 v[36:39], v[68:71], v[100:103], v[36:39]
    ds_read_b64_tr_b16 v[92:93], v6 offset:44288
    ds_read_b64_tr_b16 v[94:95], v6 offset:48896
    s_add_u32 s26, s26, 73728
    v_mfma_f32_16x16x32_bf16 v[40:43], v[68:71], v[104:107], v[40:43]
    s_waitcnt lgkmcnt(10)
    v_mfma_f32_16x16x32_bf16 v[44:47], v[72:75], v[100:103], v[44:47]
    v_mfma_f32_16x16x32_bf16 v[48:51], v[72:75], v[104:107], v[48:51]
    s_waitcnt vmcnt(4)
    s_barrier
    s_waitcnt lgkmcnt(6)
    v_mfma_f32_16x16x32_bf16 v[20:23], v[80:83], v[108:111], v[20:23]
    ds_read_b128 v[100:103], v9 offset:18432
    ds_read_b128 v[104:107], v9 offset:20480
    v_mfma_f32_16x16x32_bf16 v[24:27], v[80:83], v[112:115], v[24:27]
    ds_read_b64_tr_b16 v[60:61], v7 offset:160
    ds_read_b64_tr_b16 v[62:63], v7 offset:4768
    s_add_u32 m0, s29, 0
    s_nop 0
    buffer_load_dwordx4 v3, s[12:15], s26 offen lds
    s_waitcnt lgkmcnt(8)
    v_mfma_f32_16x16x32_bf16 v[28:31], v[84:87], v[108:111], v[28:31]
    ds_read_b64_tr_b16 v[64:65], v7 offset:192
    ds_read_b64_tr_b16 v[66:67], v7 offset:4800
    v_mfma_f32_16x16x32_bf16 v[32:35], v[84:87], v[112:115], v[32:35]
    ds_read_b64_tr_b16 v[68:69], v7 offset:224
    ds_read_b64_tr_b16 v[70:71], v7 offset:4832
    s_waitcnt lgkmcnt(10)
    v_mfma_f32_16x16x32_bf16 v[36:39], v[88:91], v[108:111], v[36:39]
    ds_read_b64_tr_b16 v[72:73], v7 offset:256
    ds_read_b64_tr_b16 v[74:75], v7 offset:4864
    s_add_u32 m0, s29, 18432
    s_nop 0
    buffer_load_dwordx4 v2, s[8:11], s27 offen sc1 lds
    s_add_u32 s27, s27, 2048
    v_mfma_f32_16x16x32_bf16 v[40:43], v[88:91], v[112:115], v[40:43]
    s_waitcnt lgkmcnt(10)
    v_mfma_f32_16x16x32_bf16 v[44:47], v[92:95], v[108:111], v[44:47]
    v_mfma_f32_16x16x32_bf16 v[48:51], v[92:95], v[112:115], v[48:51]
    s_add_u32 m0, s29, 8192
    s_nop 0
    buffer_load_dwordx4 v4, s[12:15], s26 offen lds
    s_waitcnt lgkmcnt(6)
    v_mfma_f32_16x16x32_bf16 v[20:23], v[60:63], v[100:103], v[20:23]
    ds_read_b128 v[108:111], v11 offset:18432
    ds_read_b128 v[112:115], v11 offset:20480
    v_mfma_f32_16x16x32_bf16 v[24:27], v[60:63], v[104:107], v[24:27]
    ds_read_b64_tr_b16 v[80:81], v7 offset:9376
    ds_read_b64_tr_b16 v[82:83], v7 offset:13984
    s_add_u32 m0, s29, 26624
    s_nop 0
    buffer_load_dwordx4 v2, s[8:11], s28 offen sc1 lds
    s_add_u32 s28, s28, 2048
    s_waitcnt lgkmcnt(8)
    v_mfma_f32_16x16x32_bf16 v[28:31], v[64:67], v[100:103], v[28:31]
    ds_read_b64_tr_b16 v[84:85], v7 offset:9408
    ds_read_b64_tr_b16 v[86:87], v7 offset:14016
    v_mfma_f32_16x16x32_bf16 v[32:35], v[64:67], v[104:107], v[32:35]
    ds_read_b64_tr_b16 v[88:89], v7 offset:9440
    ds_read_b64_tr_b16 v[90:91], v7 offset:14048
    s_waitcnt lgkmcnt(10)
    v_mfma_f32_16x16x32_bf16 v[36:39], v[68:71], v[100:103], v[36:39]
    ds_read_b64_tr_b16 v[92:93], v7 offset:9472
    ds_read_b64_tr_b16 v[94:95], v7 offset:14080
    s_add_u32 s26, s26, 73728
    v_mfma_f32_16x16x32_bf16 v[40:43], v[68:71], v[104:107], v[40:43]
    s_waitcnt lgkmcnt(10)
    v_mfma_f32_16x16x32_bf16 v[44:47], v[72:75], v[100:103], v[44:47]
    v_mfma_f32_16x16x32_bf16 v[48:51], v[72:75], v[104:107], v[48:51]
    s_waitcnt vmcnt(4)
    s_barrier
    s_waitcnt lgkmcnt(6)
    v_mfma_f32_16x16x32_bf16 v[20:23], v[80:83], v[108:111], v[20:23]
    ds_read_b128 v[100:103], v9 offset:53248
    ds_read_b128 v[104:107], v9 offset:55296
    v_mfma_f32_16x16x32_bf16 v[24:27], v[80:83], v[112:115], v[24:27]
    ds_read_b64_tr_b16 v[60:61], v7 offset:34976
    ds_read_b64_tr_b16 v[62:63], v7 offset:39584
    s_add_u32 m0, s29, 34816
    s_nop 0
    buffer_load_dwordx4 v3, s[12:15], s26 offen lds
    s_waitcnt lgkmcnt(8)
    v_mfma_f32_16x16x32_bf16 v[28:31], v[84:87], v[108:111], v[28:31]
    ds_read_b64_tr_b16 v[64:65], v7 offset:35008
    ds_read_b64_tr_b16 v[66:67], v7 offset:39616
    v_mfma_f32_16x16x32_bf16 v[32:35], v[84:87], v[112:115], v[32:35]
    ds_read_b64_tr_b16 v[68:69], v7 offset:35040
    ds_read_b64_tr_b16 v[70:71], v7 offset:39648
    s_waitcnt lgkmcnt(10)
    v_mfma_f32_16x16x32_bf16 v[36:39], v[88:91], v[108:111], v[36:39]
    ds_read_b64_tr_b16 v[72:73], v7 offset:35072
    ds_read_b64_tr_b16 v[74:75], v7 offset:39680
    s_add_u32 m0, s29, 53248
    s_nop 0
    buffer_load_dwordx4 v2, s[8:11], s27 offen sc1 lds
    s_add_u32 s27, s27, 2048
    v_mfma_f32_16x16x32_bf16 v[40:43], v[88:91], v[112:115], v[40:43]
    s_waitcnt lgkmcnt(10)
    v_mfma_f32_16x16x32_bf16 v[44:47], v[92:95], v[108:111], v[44:47]
    v_mfma_f32_16x16x32_bf16 v[48:51], v[92:95], v[112:115], v[48:51]
    s_add_u32 m0, s29, 43008
    s_nop 0
    buffer_load_dwordx4 v4, s[12:15], s26 offen lds
    s_waitcnt lgkmcnt(6)
    v_mfma_f32_16x16x32_bf16 v[20:23], v[60:63], v[100:103], v[20:23]
    ds_read_b128 v[108:111], v11 offset:53248
    ds_read_b128 v[112:115], v11 offset:55296
    v_mfma_f32_16x16x32_bf16 v[24:27], v[60:63], v[104:107], v[24:27]
    ds_read_b64_tr_b16 v[80:81], v7 offset:44192
    ds_read_b64_tr_b16 v[82:83], v7 offset:48800
    s_add_u32 m0, s29, 61440
    s_nop 0
    buffer_load_dwordx4 v2, s[8:11], s28 offen sc1 lds
    s_add_u32 s28, s28, 2048
    s_waitcnt lgkmcnt(8)
    v_mfma_f32_16x16x32_bf16 v[28:31], v[64:67], v[100:103], v[28:31]
    ds_read_b64_tr_b16 v[84:85], v7 offset:44224
    ds_read_b64_tr_b16 v[86:87], v7 offset:48832
    v_mfma_f32_16x16x32_bf16 v[32:35], v[64:67], v[104:107], v[32:35]
    ds_read_b64_tr_b16 v[88:89], v7 offset:44256
    ds_read_b64_tr_b16 v[90:91], v7 offset:48864
    s_waitcnt lgkmcnt(10)
    v_mfma_f32_16x16x32_bf16 v[36:39], v[68:71], v[100:103], v[36:39]
    ds_read_b64_tr_b16 v[92:93], v7 offset:44288
    ds_read_b64_tr_b16 v[94:95], v7 offset:48896
    s_add_u32 s26, s26, 73728
    v_mfma_f32_16x16x32_bf16 v[40:43], v[68:71], v[104:107], v[40:43]
    s_waitcnt lgkmcnt(10)
    v_mfma_f32_16x16x32_bf16 v[44:47], v[72:75], v[100:103], v[44:47]
    v_mfma_f32_16x16x32_bf16 v[48:51], v[72:75], v[104:107], v[48:51]
    s_waitcnt vmcnt(4)
    s_barrier
    s_waitcnt lgkmcnt(6)
    v_mfma_f32_16x16x32_bf16 v[20:23], v[80:83], v[108:111], v[20:23]
    ds_read_b128 v[100:103], v8 offset:18432
    ds_read_b128 v[104:107], v8 offset:20480
    v_mfma_f32_16x16x32_bf16 v[24:27], v[80:83], v[112:115], v[24:27]
    ds_read_b64_tr_b16 v[60:61], v6 offset:160
    ds_read_b64_tr_b16 v[62:63], v6 offset:4768
    s_add_u32 m0, s29, 69632
    s_nop 0
    buffer_load_dwordx4 v3, s[12:15], s26 offen lds
    s_waitcnt lgkmcnt(8)
    v_mfma_f32_16x16x32_bf16 v[28:31], v[84:87], v[108:111], v[28:31]
    ds_read_b64_tr_b16 v[64:65], v6 offset:192
    ds_read_b64_tr_b16 v[66:67], v6 offset:4800
    v_mfma_f32_16x16x32_bf16 v[32:35], v[84:87], v[112:115], v[32:35]
    ds_read_b64_tr_b16 v[68:69], v6 offset:224
    ds_read_b64_tr_b16 v[70:71], v6 offset:4832
    s_waitcnt lgkmcnt(10)
    v_mfma_f32_16x16x32_bf16 v[36:39], v[88:91], v[108:111], v[36:39]
    ds_read_b64_tr_b16 v[72:73], v6 offset:256
    ds_read_b64_tr_b16 v[74:75], v6 offset:4864
    s_add_u32 m0, s29, 88064
    s_nop 0
    buffer_load_dwordx4 v2, s[8:11], s27 offen sc1 lds
    s_add_u32 s27, s27, 2048
    v_mfma_f32_16x16x32_bf16 v[40:43], v[88:91], v[112:115], v[40:43]
    s_waitcnt lgkmcnt(10)
    v_mfma_f32_16x16x32_bf16 v[44:47], v[92:95], v[108:111], v[44:47]
    v_mfma_f32_16x16x32_bf16 v[48:51], v[92:95], v[112:115], v[48:51]
    s_add_u32 m0, s29, 77824
    s_nop 0
    buffer_load_dwordx4 v4, s[12:15], s26 offen lds
    s_waitcnt lgkmcnt(6)
    v_mfma_f32_16x16x32_bf16 v[20:23], v[60:63], v[100:103], v[20:23]
    ds_read_b128 v[108:111], v10 offset:18432
    ds_read_b128 v[112:115], v10 offset:20480
    v_mfma_f32_16x16x32_bf16 v[24:27], v[60:63], v[104:107], v[24:27]
    ds_read_b64_tr_b16 v[80:81], v6 offset:9376
    ds_read_b64_tr_b16 v[82:83], v6 offset:13984
    s_add_u32 m0, s29, 96256
    s_nop 0
    buffer_load_dwordx4 v2, s[8:11], s28 offen sc1 lds
    s_add_u32 s28, s28, 2048
    s_waitcnt lgkmcnt(8)
    v_mfma_f32_16x16x32_bf16 v[28:31], v[64:67], v[100:103], v[28:31]
    ds_read_b64_tr_b16 v[84:85], v6 offset:9408
    ds_read_b64_tr_b16 v[86:87], v6 offset:14016
    v_mfma_f32_16x16x32_bf16 v[32:35], v[64:67], v[104:107], v[32:35]
    ds_read_b64_tr_b16 v[88:89], v6 offset:9440
    ds_read_b64_tr_b16 v[90:91], v6 offset:14048
    s_waitcnt lgkmcnt(10)
    v_mfma_f32_16x16x32_bf16 v[36:39], v[68:71], v[100:103], v[36:39]
    ds_read_b64_tr_b16 v[92:93], v6 offset:9472
    ds_read_b64_tr_b16 v[94:95], v6 offset:14080
    s_add_u32 s26, s26, 73728
    v_mfma_f32_16x16x32_bf16 v[40:43], v[68:71], v[104:107], v[40:43]
    s_waitcnt lgkmcnt(10)
    v_mfma_f32_16x16x32_bf16 v[44:47], v[72:75], v[100:103], v[44:47]
    v_mfma_f32_16x16x32_bf16 v[48:51], v[72:75], v[104:107], v[48:51]
    s_waitcnt vmcnt(4)
    s_barrier
    s_waitcnt lgkmcnt(6)
    v_mfma_f32_16x16x32_bf16 v[20:23], v[80:83], v[108:111], v[20:23]
    ds_read_b128 v[100:103], v8 offset:53248
    ds_read_b128 v[104:107], v8 offset:55296
    v_mfma_f32_16x16x32_bf16 v[24:27], v[80:83], v[112:115], v[24:27]
    ds_read_b64_tr_b16 v[60:61], v6 offset:34976
    ds_read_b64_tr_b16 v[62:63], v6 offset:39584
    s_add_u32 m0, s29, 104448
    s_nop 0
    buffer_load_dwordx4 v3, s[12:15], s26 offen lds
    s_waitcnt lgkmcnt(8)
    v_mfma_f32_16x16x32_bf16 v[28:31], v[84:87], v[108:111], v[28:31]
    ds_read_b64_tr_b16 v[64:65], v6 offset:35008
    ds_read_b64_tr_b16 v[66:67], v6 offset:39616
    v_mfma_f32_16x16x32_bf16 v[32:35], v[84:87], v[112:115], v[32:35]
    ds_read_b64_tr_b16 v[68:69], v6 offset:35040
    ds_read_b64_tr_b16 v[70:71], v6 offset:39648
    s_waitcnt lgkmcnt(10)
    v_mfma_f32_16x16x32_bf16 v[36:39], v[88:91], v[108:111], v[36:39]
    ds_read_b64_tr_b16 v[72:73], v6 offset:35072
    ds_read_b64_tr_b16 v[74:75], v6 offset:39680
    s_add_u32 m0, s29, 122880
    s_nop 0
    buffer_load_dwordx4 v2, s[8:11], s27 offen sc1 lds
    s_add_u32 s27, s27, 2048
    v_mfma_f32_16x16x32_bf16 v[40:43], v[88:91], v[112:115], v[40:43]
    s_waitcnt lgkmcnt(10)
    v_mfma_f32_16x16x32_bf16 v[44:47], v[92:95], v[108:111], v[44:47]
    v_mfma_f32_16x16x32_bf16 v[48:51], v[92:95], v[112:115], v[48:51]
    s_add_u32 m0, s29, 112640
    s_nop 0
    buffer_load_dwordx4 v4, s[12:15], s26 offen lds
    s_waitcnt lgkmcnt(6)
    v_mfma_f32_16x16x32_bf16 v[20:23], v[60:63], v[100:103], v[20:23]
    ds_read_b128 v[108:111], v10 offset:53248
    ds_read_b128 v[112:115], v10 offset:55296
    v_mfma_f32_16x16x32_bf16 v[24:27], v[60:63], v[104:107], v[24:27]
    ds_read_b64_tr_b16 v[80:81], v6 offset:44192
    ds_read_b64_tr_b16 v[82:83], v6 offset:48800
    s_add_u32 m0, s29, 131072
    s_nop 0
    buffer_load_dwordx4 v2, s[8:11], s28 offen sc1 lds
    s_add_u32 s28, s28, 2048
    s_waitcnt lgkmcnt(8)
    v_mfma_f32_16x16x32_bf16 v[28:31], v[64:67], v[100:103], v[28:31]
    ds_read_b64_tr_b16 v[84:85], v6 offset:44224
    ds_read_b64_tr_b16 v[86:87], v6 offset:48832
    v_mfma_f32_16x16x32_bf16 v[32:35], v[64:67], v[104:107], v[32:35]
    ds_read_b64_tr_b16 v[88:89], v6 offset:44256
    ds_read_b64_tr_b16 v[90:91], v6 offset:48864
    s_waitcnt lgkmcnt(10)
    v_mfma_f32_16x16x32_bf16 v[36:39], v[68:71], v[100:103], v[36:39]
    ds_read_b64_tr_b16 v[92:93], v6 offset:44288
    ds_read_b64_tr_b16 v[94:95], v6 offset:48896
    s_add_u32 s26, s26, 73728
    v_mfma_f32_16x16x32_bf16 v[40:43], v[68:71], v[104:107], v[40:43]
    s_waitcnt lgkmcnt(10)
    v_mfma_f32_16x16x32_bf16 v[44:47], v[72:75], v[100:103], v[44:47]
    v_mfma_f32_16x16x32_bf16 v[48:51], v[72:75], v[104:107], v[48:51]
    s_waitcnt vmcnt(4)
    s_barrier
    s_waitcnt lgkmcnt(6)
    v_mfma_f32_16x16x32_bf16 v[20:23], v[80:83], v[108:111], v[20:23]
    ds_read_b128 v[100:103], v9 offset:18432
    ds_read_b128 v[104:107], v9 offset:20480
    v_mfma_f32_16x16x32_bf16 v[24:27], v[80:83], v[112:115], v[24:27]
    ds_read_b64_tr_b16 v[60:61], v7 offset:160
    ds_read_b64_tr_b16 v[62:63], v7 offset:4768
    s_add_u32 m0, s29, 0
    s_nop 0
    buffer_load_dwordx4 v3, s[12:15], s26 offen lds
    s_waitcnt lgkmcnt(8)
    v_mfma_f32_16x16x32_bf16 v[28:31], v[84:87], v[108:111], v[28:31]
    ds_read_b64_tr_b16 v[64:65], v7 offset:192
    ds_read_b64_tr_b16 v[66:67], v7 offset:4800
    v_mfma_f32_16x16x32_bf16 v[32:35], v[84:87], v[112:115], v[32:35]
    ds_read_b64_tr_b16 v[68:69], v7 offset:224
    ds_read_b64_tr_b16 v[70:71], v7 offset:4832
    s_waitcnt lgkmcnt(10)
    v_mfma_f32_16x16x32_bf16 v[36:39], v[88:91], v[108:111], v[36:39]
    ds_read_b64_tr_b16 v[72:73], v7 offset:256
    ds_read_b64_tr_b16 v[74:75], v7 offset:4864
    s_add_u32 m0, s29, 18432
    s_nop 0
    buffer_load_dwordx4 v2, s[8:11], s27 offen sc1 lds
    s_add_u32 s27, s27, 2048
    v_mfma_f32_16x16x32_bf16 v[40:43], v[88:91], v[112:115], v[40:43]
    s_waitcnt lgkmcnt(10)
    v_mfma_f32_16x16x32_bf16 v[44:47], v[92:95], v[108:111], v[44:47]
    v_mfma_f32_16x16x32_bf16 v[48:51], v[92:95], v[112:115], v[48:51]
    s_add_u32 m0, s29, 8192
    s_nop 0
    buffer_load_dwordx4 v4, s[12:15], s26 offen lds
    s_waitcnt lgkmcnt(6)
    v_mfma_f32_16x16x32_bf16 v[20:23], v[60:63], v[100:103], v[20:23]
    ds_read_b128 v[108:111], v11 offset:18432
    ds_read_b128 v[112:115], v11 offset:20480
    v_mfma_f32_16x16x32_bf16 v[24:27], v[60:63], v[104:107], v[24:27]
    ds_read_b64_tr_b16 v[80:81], v7 offset:9376
    ds_read_b64_tr_b16 v[82:83], v7 offset:13984
    s_add_u32 m0, s29, 26624
    s_nop 0
    buffer_load_dwordx4 v2, s[8:11], s28 offen sc1 lds
    s_add_u32 s28, s28, 2048
    s_waitcnt lgkmcnt(8)
    v_mfma_f32_16x16x32_bf16 v[28:31], v[64:67], v[100:103], v[28:31]
    ds_read_b64_tr_b16 v[84:85], v7 offset:9408
    ds_read_b64_tr_b16 v[86:87], v7 offset:14016
    v_mfma_f32_16x16x32_bf16 v[32:35], v[64:67], v[104:107], v[32:35]
    ds_read_b64_tr_b16 v[88:89], v7 offset:9440
    ds_read_b64_tr_b16 v[90:91], v7 offset:14048
    s_waitcnt lgkmcnt(10)
    v_mfma_f32_16x16x32_bf16 v[36:39], v[68:71], v[100:103], v[36:39]
    ds_read_b64_tr_b16 v[92:93], v7 offset:9472
    ds_read_b64_tr_b16 v[94:95], v7 offset:14080
    s_add_u32 s26, s26, 73728
    v_mfma_f32_16x16x32_bf16 v[40:43], v[68:71], v[104:107], v[40:43]
    s_waitcnt lgkmcnt(10)
    v_mfma_f32_16x16x32_bf16 v[44:47], v[72:75], v[100:103], v[44:47]
    v_mfma_f32_16x16x32_bf16 v[48:51], v[72:75], v[104:107], v[48:51]
    s_waitcnt vmcnt(4)
    s_barrier
    s_waitcnt lgkmcnt(6)
    v_mfma_f32_16x16x32_bf16 v[20:23], v[80:83], v[108:111], v[20:23]
    ds_read_b128 v[100:103], v9 offset:53248
    ds_read_b128 v[104:107], v9 offset:55296
    v_mfma_f32_16x16x32_bf16 v[24:27], v[80:83], v[112:115], v[24:27]
    ds_read_b64_tr_b16 v[60:61], v7 offset:34976
    ds_read_b64_tr_b16 v[62:63], v7 offset:39584
    s_add_u32 m0, s29, 34816
    s_nop 0
    buffer_load_dwordx4 v3, s[12:15], s26 offen lds
    s_waitcnt lgkmcnt(8)
    v_mfma_f32_16x16x32_bf16 v[28:31], v[84:87], v[108:111], v[28:31]
    ds_read_b64_tr_b16 v[64:65], v7 offset:35008
    ds_read_b64_tr_b16 v[66:67], v7 offset:39616
    v_mfma_f32_16x16x32_bf16 v[32:35], v[84:87], v[112:115], v[32:35]
    ds_read_b64_tr_b16 v[68:69], v7 offset:35040
    ds_read_b64_tr_b16 v[70:71], v7 offset:39648
    s_waitcnt lgkmcnt(10)
    v_mfma_f32_16x16x32_bf16 v[36:39], v[88:91], v[108:111], v[36:39]
    ds_read_b64_tr_b16 v[72:73], v7 offset:35072
    ds_read_b64_tr_b16 v[74:75], v7 offset:39680
    s_add_u32 m0, s29, 53248
    s_nop 0
    buffer_load_dwordx4 v2, s[8:11], s27 offen sc1 lds
    s_add_u32 s27, s27, 2048
    v_mfma_f32_16x16x32_bf16 v[40:43], v[88:91], v[112:115], v[40:43]
    s_waitcnt lgkmcnt(10)
    v_mfma_f32_16x16x32_bf16 v[44:47], v[92:95], v[108:111], v[44:47]
    v_mfma_f32_16x16x32_bf16 v[48:51], v[92:95], v[112:115], v[48:51]
    s_add_u32 m0, s29, 43008
    s_nop 0
    buffer_load_dwordx4 v4, s[12:15], s26 offen lds
    s_waitcnt lgkmcnt(6)
    v_mfma_f32_16x16x32_bf16 v[20:23], v[60:63], v[100:103], v[20:23]
    ds_read_b128 v[108:111], v11 offset:53248
    ds_read_b128 v[112:115], v11 offset:55296
    v_mfma_f32_16x16x32_bf16 v[24:27], v[60:63], v[104:107], v[24:27]
    ds_read_b64_tr_b16 v[80:81], v7 offset:44192
    ds_read_b64_tr_b16 v[82:83], v7 offset:48800
    s_add_u32 m0, s29, 61440
    s_nop 0
    buffer_load_dwordx4 v2, s[8:11], s28 offen sc1 lds
    s_add_u32 s28, s28, 2048
    s_waitcnt lgkmcnt(8)
    v_mfma_f32_16x16x32_bf16 v[28:31], v[64:67], v[100:103], v[28:31]
    ds_read_b64_tr_b16 v[84:85], v7 offset:44224
    ds_read_b64_tr_b16 v[86:87], v7 offset:48832
    v_mfma_f32_16x16x32_bf16 v[32:35], v[64:67], v[104:107], v[32:35]
    ds_read_b64_tr_b16 v[88:89], v7 offset:44256
    ds_read_b64_tr_b16 v[90:91], v7 offset:48864
    s_waitcnt lgkmcnt(10)
    v_mfma_f32_16x16x32_bf16 v[36:39], v[68:71], v[100:103], v[36:39]
    ds_read_b64_tr_b16 v[92:93], v7 offset:44288
    ds_read_b64_tr_b16 v[94:95], v7 offset:48896
    s_add_u32 s26, s26, 73728
    v_mfma_f32_16x16x32_bf16 v[40:43], v[68:71], v[104:107], v[40:43]
    s_waitcnt lgkmcnt(10)
    v_mfma_f32_16x16x32_bf16 v[44:47], v[72:75], v[100:103], v[44:47]
    v_mfma_f32_16x16x32_bf16 v[48:51], v[72:75], v[104:107], v[48:51]
    s_waitcnt vmcnt(4)
    s_barrier
    s_waitcnt lgkmcnt(6)
    v_mfma_f32_16x16x32_bf16 v[20:23], v[80:83], v[108:111], v[20:23]
    ds_read_b128 v[100:103], v8 offset:18432
    ds_read_b128 v[104:107], v8 offset:20480
    v_mfma_f32_16x16x32_bf16 v[24:27], v[80:83], v[112:115], v[24:27]
    ds_read_b64_tr_b16 v[60:61], v6 offset:160
    ds_read_b64_tr_b16 v[62:63], v6 offset:4768
    s_waitcnt lgkmcnt(8)
    v_mfma_f32_16x16x32_bf16 v[28:31], v[84:87], v[108:111], v[28:31]
    ds_read_b64_tr_b16 v[64:65], v6 offset:192
    ds_read_b64_tr_b16 v[66:67], v6 offset:4800
    v_mfma_f32_16x16x32_bf16 v[32:35], v[84:87], v[112:115], v[32:35]
    ds_read_b64_tr_b16 v[68:69], v6 offset:224
    ds_read_b64_tr_b16 v[70:71], v6 offset:4832
    s_waitcnt lgkmcnt(10)
    v_mfma_f32_16x16x32_bf16 v[36:39], v[88:91], v[108:111], v[36:39]
    ds_read_b64_tr_b16 v[72:73], v6 offset:256
    ds_read_b64_tr_b16 v[74:75], v6 offset:4864
    v_mfma_f32_16x16x32_bf16 v[40:43], v[88:91], v[112:115], v[40:43]
    s_waitcnt lgkmcnt(10)
    v_mfma_f32_16x16x32_bf16 v[44:47], v[92:95], v[108:111], v[44:47]
    v_mfma_f32_16x16x32_bf16 v[48:51], v[92:95], v[112:115], v[48:51]
    s_waitcnt lgkmcnt(6)
    v_mfma_f32_16x16x32_bf16 v[20:23], v[60:63], v[100:103], v[20:23]
    ds_read_b128 v[108:111], v10 offset:18432
    ds_read_b128 v[112:115], v10 offset:20480
    v_mfma_f32_16x16x32_bf16 v[24:27], v[60:63], v[104:107], v[24:27]
    ds_read_b64_tr_b16 v[80:81], v6 offset:9376
    ds_read_b64_tr_b16 v[82:83], v6 offset:13984
    s_waitcnt lgkmcnt(8)
    v_mfma_f32_16x16x32_bf16 v[28:31], v[64:67], v[100:103], v[28:31]
    ds_read_b64_tr_b16 v[84:85], v6 offset:9408
    ds_read_b64_tr_b16 v[86:87], v6 offset:14016
    v_mfma_f32_16x16x32_bf16 v[32:35], v[64:67], v[104:107], v[32:35]
    ds_read_b64_tr_b16 v[88:89], v6 offset:9440
    ds_read_b64_tr_b16 v[90:91], v6 offset:14048
    s_waitcnt lgkmcnt(10)
    v_mfma_f32_16x16x32_bf16 v[36:39], v[68:71], v[100:103], v[36:39]
    ds_read_b64_tr_b16 v[92:93], v6 offset:9472
    ds_read_b64_tr_b16 v[94:95], v6 offset:14080
    v_mfma_f32_16x16x32_bf16 v[40:43], v[68:71], v[104:107], v[40:43]
    s_waitcnt lgkmcnt(10)
    v_mfma_f32_16x16x32_bf16 v[44:47], v[72:75], v[100:103], v[44:47]
    v_mfma_f32_16x16x32_bf16 v[48:51], v[72:75], v[104:107], v[48:51]
    s_waitcnt vmcnt(0)
    s_barrier
    s_waitcnt lgkmcnt(6)
    v_mfma_f32_16x16x32_bf16 v[20:23], v[80:83], v[108:111], v[20:23]
    ds_read_b128 v[100:103], v8 offset:53248
    ds_read_b128 v[104:107], v8 offset:55296
    v_mfma_f32_16x16x32_bf16 v[24:27], v[80:83], v[112:115], v[24:27]
    ds_read_b64_tr_b16 v[60:61], v6 offset:34976
    ds_read_b64_tr_b16 v[62:63], v6 offset:39584
    s_waitcnt lgkmcnt(8)
    v_mfma_f32_16x16x32_bf16 v[28:31], v[84:87], v[108:111], v[28:31]
    ds_read_b64_tr_b16 v[64:65], v6 offset:35008
    ds_read_b64_tr_b16 v[66:67], v6 offset:39616
    v_mfma_f32_16x16x32_bf16 v[32:35], v[84:87], v[112:115], v[32:35]
    ds_read_b64_tr_b16 v[68:69], v6 offset:35040
    ds_read_b64_tr_b16 v[70:71], v6 offset:39648
    s_waitcnt lgkmcnt(10)
    v_mfma_f32_16x16x32_bf16 v[36:39], v[88:91], v[108:111], v[36:39]
    ds_read_b64_tr_b16 v[72:73], v6 offset:35072
    ds_read_b64_tr_b16 v[74:75], v6 offset:39680
    v_mfma_f32_16x16x32_bf16 v[40:43], v[88:91], v[112:115], v[40:43]
    s_waitcnt lgkmcnt(10)
    v_mfma_f32_16x16x32_bf16 v[44:47], v[92:95], v[108:111], v[44:47]
    v_mfma_f32_16x16x32_bf16 v[48:51], v[92:95], v[112:115], v[48:51]
    s_waitcnt lgkmcnt(6)
    v_mfma_f32_16x16x32_bf16 v[20:23], v[60:63], v[100:103], v[20:23]
    ds_read_b128 v[108:111], v10 offset:53248
    ds_read_b128 v[112:115], v10 offset:55296
    v_mfma_f32_16x16x32_bf16 v[24:27], v[60:63], v[104:107], v[24:27]
    ds_read_b64_tr_b16 v[80:81], v6 offset:44192
    ds_read_b64_tr_b16 v[82:83], v6 offset:48800
    s_waitcnt lgkmcnt(8)
    v_mfma_f32_16x16x32_bf16 v[28:31], v[64:67], v[100:103], v[28:31]
    ds_read_b64_tr_b16 v[84:85], v6 offset:44224
    ds_read_b64_tr_b16 v[86:87], v6 offset:48832
    v_mfma_f32_16x16x32_bf16 v[32:35], v[64:67], v[104:107], v[32:35]
    ds_read_b64_tr_b16 v[88:89], v6 offset:44256
    ds_read_b64_tr_b16 v[90:91], v6 offset:48864
    s_waitcnt lgkmcnt(10)
    v_mfma_f32_16x16x32_bf16 v[36:39], v[68:71], v[100:103], v[36:39]
    ds_read_b64_tr_b16 v[92:93], v6 offset:44288
    ds_read_b64_tr_b16 v[94:95], v6 offset:48896
    v_mfma_f32_16x16x32_bf16 v[40:43], v[68:71], v[104:107], v[40:43]
    s_waitcnt lgkmcnt(10)
    v_mfma_f32_16x16x32_bf16 v[44:47], v[72:75], v[100:103], v[44:47]
    v_mfma_f32_16x16x32_bf16 v[48:51], v[72:75], v[104:107], v[48:51]
    s_waitcnt lgkmcnt(6)
    v_mfma_f32_16x16x32_bf16 v[20:23], v[80:83], v[108:111], v[20:23]
    v_mfma_f32_16x16x32_bf16 v[24:27], v[80:83], v[112:115], v[24:27]
    s_waitcnt lgkmcnt(4)
    v_mfma_f32_16x16x32_bf16 v[28:31], v[84:87], v[108:111], v[28:31]
    v_mfma_f32_16x16x32_bf16 v[32:35], v[84:87], v[112:115], v[32:35]
    s_waitcnt lgkmcnt(2)
    v_mfma_f32_16x16x32_bf16 v[36:39], v[88:91], v[108:111], v[36:39]
    v_mfma_f32_16x16x32_bf16 v[40:43], v[88:91], v[112:115], v[40:43]
    s_waitcnt lgkmcnt(0)
    v_mfma_f32_16x16x32_bf16 v[44:47], v[92:95], v[108:111], v[44:47]
    v_mfma_f32_16x16x32_bf16 v[48:51], v[92:95], v[112:115], v[48:51]
    s_cmp_eq_u32 s24, s21
    s_cbranch_scc1 k234_mid_kernel_f_h1own
    s_mul_i32 s32, s30, 3
    s_sub_u32 s33, s21, s24
    s_sub_u32 s33, s33, 1
    s_and_b32 s33, s33, 3
    s_add_u32 s32, s32, s33
    s_mul_i32 s32, s32, 9216
    s_add_u32 s32, s32, 37753856
    s_add_u32 s33, s32, 4096
    v_cvt_pk_bf16_f32 v60, v20, v21
    v_cvt_pk_bf16_f32 v61, v22, v23
    v_cvt_pk_bf16_f32 v62, v24, v25
    v_cvt_pk_bf16_f32 v63, v26, v27
    buffer_store_dwordx4 v[60:63], v2, s[8:11], s32 offen offset:0 sc1
    v_cvt_pk_bf16_f32 v64, v28, v29
    v_cvt_pk_bf16_f32 v65, v30, v31
    v_cvt_pk_bf16_f32 v66, v32, v33
    v_cvt_pk_bf16_f32 v67, v34, v35
    buffer_store_dwordx4 v[64:67], v2, s[8:11], s32 offen offset:1024 sc1
    v_cvt_pk_bf16_f32 v68, v36, v37
    v_cvt_pk_bf16_f32 v69, v38, v39
    v_cvt_pk_bf16_f32 v70, v40, v41
    v_cvt_pk_bf16_f32 v71, v42, v43
    buffer_store_dwordx4 v[68:71], v2, s[8:11], s32 offen offset:2048 sc1
    v_cvt_pk_bf16_f32 v72, v44, v45
    v_cvt_pk_bf16_f32 v73, v46, v47
    v_cvt_pk_bf16_f32 v74, v48, v49
    v_cvt_pk_bf16_f32 v75, v50, v51
    buffer_store_dwordx4 v[72:75], v2, s[8:11], s32 offen offset:3072 sc1
    s_branch k234_mid_kernel_f_fin1
k234_mid_kernel_f_h1own:
    v_add_u32 v12, 69632, v2
    ds_write_b128 v12, v[20:23] offset:10240
    ds_write_b128 v12, v[24:27] offset:11264
    ds_write_b128 v12, v[28:31] offset:12288
    ds_write_b128 v12, v[32:35] offset:13312
    ds_write_b128 v12, v[36:39] offset:14336
    ds_write_b128 v12, v[40:43] offset:15360
    ds_write_b128 v12, v[44:47] offset:16384
    ds_write_b128 v12, v[48:51] offset:17408
    s_mul_i32 s32, s2, 27648
    s_add_u32 s32, s32, 37756928
    v_min_u32 v14, 2, v1
    v_mul_u32_u24 v14, 9216, v14
    s_mov_b32 s38, 100000
    s_branch k234_mid_kernel_f_fin2
k234_mid_kernel_f_fin1:
    s_nop 1
    s_lshl_b32 s32, s22, 3
    s_lshl_b32 s33, s21, 1
    s_add_u32 s34, s32, s33
    s_lshl_b32 s32, s34, 4
    v_and_b32 v12, 15, v1
    v_add_u32 v12, s32, v12
    v_lshlrev_b32 v13, 2, v12
    s_mov_b32 s32, 7249920
    buffer_load_dword v140, v13, s[8:11], s32 offen sc1
    buffer_load_dword v141, v13, s[8:11], s32 offen offset:64 sc1
    v_bfe_u32 v13, v1, 4, 1
    v_lshl_add_u32 v12, v13, 4, v12
    v_mul_u32_u24 v16, 1152, v12
    v_lshrrev_b32 v13, 5, v1
    v_lshl_add_u32 v16, v13, 4, v16
    s_mul_i32 s34, s34, 18432
    s_add_u32 s34, s34, 10747904
    s_mul_i32 s35, s23, 9
    s_mul_i32 s32, s2, 27648
    s_add_u32 s39, s32, 37748736
    s_mul_i32 s48, s23, 288
    s_mov_b32 s38, 100000
    s_add_u32 s32, s35, s20
    s_lshr_b32 s33, s32, 1
    s_lshl_b32 s33, s33, 10
    s_and_b32 s32, s32, 1
    s_lshl_b32 s32, s32, 3
    s_add_u32 s32, s32, s33
    s_add_u32 s32, s32, s34
    s_add_u32 s33, s32, 18432
    buffer_load_dwordx2 v[124:125], v2, s[8:11], s32 offen sc1
    buffer_load_dwordx2 v[126:127], v2, s[8:11], s33 offen sc1
    s_lshl_b32 s32, s20, 10
    s_add_u32 s42, s39, s32
    s_add_u32 s43, s42, 9216
    s_add_u32 s44, s42, 18432
    s_lshl_b32 s32, s20, 5
    s_add_u32 s49, s48, s32
    s_lshl_b32 s32, s20, 11
    s_add_u32 s32, s32, 69632
    v_add_u32 v12, s32, v2
    v_add_u32 v13, 86016, v2
    s_waitcnt lgkmcnt(0)
    s_barrier
    ds_read_b128 v[20:23], v12 offset:0
    ds_read_b128 v[24:27], v12 offset:1024
    s_sleep 16
k234_mid_kernel_f_fin1_p:
    buffer_load_dwordx4 v[100:103], v2, s[8:11], s42 offen sc1
    buffer_load_dwordx4 v[108:111], v2, s[8:11], s43 offen sc1
    buffer_load_dwordx4 v[116:119], v2, s[8:11], s44 offen sc1
    s_waitcnt vmcnt(0)
    v_max3_u32 v17, v100, v101, v102
    v_max3_u32 v17, v103, v108, v17
    v_max3_u32 v17, v109, v110, v17
    v_max3_u32 v17, v111, v116, v17
    v_max3_u32 v17, v117, v118, v17
    v_max_u32 v17, v119, v17
    v_cmp_eq_u32 vcc, -1, v17
    s_sub_u32 s38, s38, 1
    s_cmp_eq_u32 s38, 0
    s_cbranch_scc1 k234_mid_kernel_f_fin1_x
    s_cbranch_vccz k234_mid_kernel_f_fin1_x
    s_sleep 4
    s_branch k234_mid_kernel_f_fin1_p
k234_mid_kernel_f_fin1_x:
    s_waitcnt lgkmcnt(0)
    v_add_f32 v20, v20, v140
    v_add_f32 v21, v21, v140
    v_add_f32 v22, v22, v140
    v_add_f32 v23, v23, v140
    v_add_f32 v24, v24, v141
    v_add_f32 v25, v25, v141
    v_add_f32 v26, v26, v141
    v_add_f32 v27, v27, v141
    v_dot2_f32_bf16 v20, v124, s36, v20
    v_dot2_f32_bf16 v21, v124, s37, v21
    v_dot2_f32_bf16 v22, v125, s36, v22
    v_dot2_f32_bf16 v23, v125, s37, v23
    v_dot2_f32_bf16 v24, v126, s36, v24
    v_dot2_f32_bf16 v25, v126, s37, v25
    v_dot2_f32_bf16 v26, v127, s36, v26
    v_dot2_f32_bf16 v27, v127, s37, v27
    v_dot2_f32_bf16 v20, v100, s36, v20
    v_dot2_f32_bf16 v21, v100, s37, v21
    v_dot2_f32_bf16 v22, v101, s36, v22
    v_dot2_f32_bf16 v23, v101, s37, v23
    v_dot2_f32_bf16 v24, v102, s36, v24
    v_dot2_f32_bf16 v25, v102, s37, v25
    v_dot2_f32_bf16 v26, v103, s36, v26
    v_dot2_f32_bf16 v27, v103, s37, v27
    v_dot2_f32_bf16 v20, v108, s36, v20
    v_dot2_f32_bf16 v21, v108, s37, v21
    v_dot2_f32_bf16 v22, v109, s36, v22
    v_dot2_f32_bf16 v23, v109, s37, v23
    v_dot2_f32_bf16 v24, v110, s36, v24
    v_dot2_f32_bf16 v25, v110, s37, v25
    v_dot2_f32_bf16 v26, v111, s36, v26
    v_dot2_f32_bf16 v27, v111, s37, v27
    v_dot2_f32_bf16 v20, v116, s36, v20
    v_dot2_f32_bf16 v21, v116, s37, v21
    v_dot2_f32_bf16 v22, v117, s36, v22
    v_dot2_f32_bf16 v23, v117, s37, v23
    v_dot2_f32_bf16 v24, v118, s36, v24
    v_dot2_f32_bf16 v25, v118, s37, v25
    v_dot2_f32_bf16 v26, v119, s36, v26
    v_dot2_f32_bf16 v27, v119, s37, v27
    v_cvt_pk_bf16_f32 v100, v20, v21
    v_cvt_pk_bf16_f32 v101, v22, v23
    v_cvt_pk_bf16_f32 v102, v24, v25
    v_cvt_pk_bf16_f32 v103, v26, v27
    s_nop 0
    v_permlane16_swap_b32 v100, v102
    v_permlane16_swap_b32 v101, v103
    buffer_store_dwordx4 v[100:103], v16, s[16:19], s49 offen
    s_branch k234_mid_kernel_f_done
k234_mid_kernel_f_fin2:
    s_nop 1
    s_lshl_b32 s32, s22, 3
    s_lshl_b32 s33, s21, 1
    s_add_u32 s34, s32, s33
    s_lshl_b32 s32, s34, 4
    v_and_b32 v12, 15, v1
    v_add_u32 v12, s32, v12
    v_lshlrev_b32 v13, 2, v12
    s_mov_b32 s32, 7249920
    buffer_load_dword v140, v13, s[8:11], s32 offen sc1
    buffer_load_dword v141, v13, s[8:11], s32 offen offset:64 sc1
    v_bfe_u32 v13, v1, 4, 1
    v_lshl_add_u32 v12, v13, 4, v12
    v_mul_u32_u24 v16, 1152, v12
    v_lshrrev_b32 v13, 5, v1
    v_lshl_add_u32 v16, v13, 4, v16
    s_mul_i32 s34, s34, 18432
    s_add_u32 s34, s34, 10747904
    s_mul_i32 s35, s23, 9
    s_mul_i32 s32, s2, 27648
    s_add_u32 s39, s32, 37748736
    s_mul_i32 s48, s23, 288
    s_mov_b32 s38, 100000
    s_add_u32 s32, s35, s20
    s_lshr_b32 s33, s32, 1
    s_lshl_b32 s33, s33, 10
    s_and_b32 s32, s32, 1
    s_lshl_b32 s32, s32, 3
    s_add_u32 s32, s32, s33
    s_add_u32 s32, s32, s34
    s_add_u32 s33, s32, 18432
    buffer_load_dwordx2 v[124:125], v2, s[8:11], s32 offen sc1
    buffer_load_dwordx2 v[126:127], v2, s[8:11], s33 offen sc1
    s_lshl_b32 s32, s20, 10
    s_add_u32 s42, s39, s32
    s_add_u32 s43, s42, 9216
    s_add_u32 s44, s42, 18432
    s_lshl_b32 s32, s20, 5
    s_add_u32 s49, s48, s32
    s_add_u32 s32, s35, 8
    s_lshr_b32 s33, s32, 1
    s_lshl_b32 s33, s33, 10
    s_and_b32 s32, s32, 1
    s_lshl_b32 s32, s32, 3
    s_add_u32 s32, s32, s33
    s_add_u32 s32, s32, s34
    s_add_u32 s33, s32, 18432
    buffer_load_dwordx2 v[128:129], v2, s[8:11], s32 offen sc1
    buffer_load_dwordx2 v[130:131], v2, s[8:11], s33 offen sc1
    s_lshl_b32 s32, 8, 10
    s_add_u32 s45, s39, s32
    s_add_u32 s46, s45, 9216
    s_add_u32 s47, s45, 18432
    s_lshl_b32 s32, 8, 5
    s_add_u32 s50, s48, s32
    s_lshl_b32 s32, s20, 11
    s_add_u32 s32, s32, 69632
    v_add_u32 v12, s32, v2
    v_add_u32 v13, 86016, v2
    s_waitcnt lgkmcnt(0)
    s_barrier
    ds_read_b128 v[20:23], v12 offset:0
    ds_read_b128 v[24:27], v12 offset:1024
    ds_read_b128 v[28:31], v13 offset:0
    ds_read_b128 v[32:35], v13 offset:1024
    s_sleep 16
k234_mid_kernel_f_fin2_p:
    buffer_load_dwordx4 v[100:103], v2, s[8:11], s42 offen sc1
    buffer_load_dwordx4 v[108:111], v2, s[8:11], s43 offen sc1
    buffer_load_dwordx4 v[116:119], v2, s[8:11], s44 offen sc1
    buffer_load_dwordx4 v[104:107], v2, s[8:11], s45 offen sc1
    buffer_load_dwordx4 v[112:115], v2, s[8:11], s46 offen sc1
    buffer_load_dwordx4 v[120:123], v2, s[8:11], s47 offen sc1
    s_waitcnt vmcnt(0)
    v_max3_u32 v17, v100, v101, v102
    v_max3_u32 v17, v103, v104, v17
    v_max3_u32 v17, v105, v106, v17
    v_max3_u32 v17, v107, v108, v17
    v_max3_u32 v17, v109, v110, v17
    v_max3_u32 v17, v111, v112, v17
    v_max3_u32 v17, v113, v114, v17
    v_max3_u32 v17, v115, v116, v17
    v_max3_u32 v17, v117, v118, v17
    v_max3_u32 v17, v119, v120, v17
    v_max3_u32 v17, v121, v122, v17
    v_max_u32 v17, v123, v17
    v_cmp_eq_u32 vcc, -1, v17
    s_sub_u32 s38, s38, 1
    s_cmp_eq_u32 s38, 0
    s_cbranch_scc1 k234_mid_kernel_f_fin2_x
    s_cbranch_vccz k234_mid_kernel_f_fin2_x
    s_sleep 4
    s_branch k234_mid_kernel_f_fin2_p
k234_mid_kernel_f_fin2_x:
    s_waitcnt lgkmcnt(0)
    v_add_f32 v20, v20, v140
    v_add_f32 v21, v21, v140
    v_add_f32 v22, v22, v140
    v_add_f32 v23, v23, v140
    v_add_f32 v24, v24, v141
    v_add_f32 v25, v25, v141
    v_add_f32 v26, v26, v141
    v_add_f32 v27, v27, v141
    v_dot2_f32_bf16 v20, v124, s36, v20
    v_dot2_f32_bf16 v21, v124, s37, v21
    v_dot2_f32_bf16 v22, v125, s36, v22
    v_dot2_f32_bf16 v23, v125, s37, v23
    v_dot2_f32_bf16 v24, v126, s36, v24
    v_dot2_f32_bf16 v25, v126, s37, v25
    v_dot2_f32_bf16 v26, v127, s36, v26
    v_dot2_f32_bf16 v27, v127, s37, v27
    v_dot2_f32_bf16 v20, v100, s36, v20
    v_dot2_f32_bf16 v21, v100, s37, v21
    v_dot2_f32_bf16 v22, v101, s36, v22
    v_dot2_f32_bf16 v23, v101, s37, v23
    v_dot2_f32_bf16 v24, v102, s36, v24
    v_dot2_f32_bf16 v25, v102, s37, v25
    v_dot2_f32_bf16 v26, v103, s36, v26
    v_dot2_f32_bf16 v27, v103, s37, v27
    v_dot2_f32_bf16 v20, v108, s36, v20
    v_dot2_f32_bf16 v21, v108, s37, v21
    v_dot2_f32_bf16 v22, v109, s36, v22
    v_dot2_f32_bf16 v23, v109, s37, v23
    v_dot2_f32_bf16 v24, v110, s36, v24
    v_dot2_f32_bf16 v25, v110, s37, v25
    v_dot2_f32_bf16 v26, v111, s36, v26
    v_dot2_f32_bf16 v27, v111, s37, v27
    v_dot2_f32_bf16 v20, v116, s36, v20
    v_dot2_f32_bf16 v21, v116, s37, v21
    v_dot2_f32_bf16 v22, v117, s36, v22
    v_dot2_f32_bf16 v23, v117, s37, v23
    v_dot2_f32_bf16 v24, v118, s36, v24
    v_dot2_f32_bf16 v25, v118, s37, v25
    v_dot2_f32_bf16 v26, v119, s36, v26
    v_dot2_f32_bf16 v27, v119, s37, v27
    v_cvt_pk_bf16_f32 v100, v20, v21
    v_cvt_pk_bf16_f32 v101, v22, v23
    v_cvt_pk_bf16_f32 v102, v24, v25
    v_cvt_pk_bf16_f32 v103, v26, v27
    s_nop 0
    v_permlane16_swap_b32 v100, v102
    v_permlane16_swap_b32 v101, v103
    buffer_store_dwordx4 v[100:103], v16, s[16:19], s49 offen
    v_add_f32 v28, v28, v140
    v_add_f32 v29, v29, v140
    v_add_f32 v30, v30, v140
    v_add_f32 v31, v31, v140
    v_add_f32 v32, v32, v141
    v_add_f32 v33, v33, v141
    v_add_f32 v34, v34, v141
    v_add_f32 v35, v35, v141
    v_dot2_f32_bf16 v28, v128, s36, v28
    v_dot2_f32_bf16 v29, v128, s37, v29
    v_dot2_f32_bf16 v30, v129, s36, v30
    v_dot2_f32_bf16 v31, v129, s37, v31
    v_dot2_f32_bf16 v32, v130, s36, v32
    v_dot2_f32_bf16 v33, v130, s37, v33
    v_dot2_f32_bf16 v34, v131, s36, v34
    v_dot2_f32_bf16 v35, v131, s37, v35
    v_dot2_f32_bf16 v28, v104, s36, v28
    v_dot2_f32_bf16 v29, v104, s37, v29
    v_dot2_f32_bf16 v30, v105, s36, v30
    v_dot2_f32_bf16 v31, v105, s37, v31
    v_dot2_f32_bf16 v32, v106, s36, v32
    v_dot2_f32_bf16 v33, v106, s37, v33
    v_dot2_f32_bf16 v34, v107, s36, v34
    v_dot2_f32_bf16 v35, v107, s37, v35
    v_dot2_f32_bf16 v28, v112, s36, v28
    v_dot2_f32_bf16 v29, v112, s37, v29
    v_dot2_f32_bf16 v30, v113, s36, v30
    v_dot2_f32_bf16 v31, v113, s37, v31
    v_dot2_f32_bf16 v32, v114, s36, v32
    v_dot2_f32_bf16 v33, v114, s37, v33
    v_dot2_f32_bf16 v34, v115, s36, v34
    v_dot2_f32_bf16 v35, v115, s37, v35
    v_dot2_f32_bf16 v28, v120, s36, v28
    v_dot2_f32_bf16 v29, v120, s37, v29
    v_dot2_f32_bf16 v30, v121, s36, v30
    v_dot2_f32_bf16 v31, v121, s37, v31
    v_dot2_f32_bf16 v32, v122, s36, v32
    v_dot2_f32_bf16 v33, v122, s37, v33
    v_dot2_f32_bf16 v34, v123, s36, v34
    v_dot2_f32_bf16 v35, v123, s37, v35
    v_cvt_pk_bf16_f32 v104, v28, v29
    v_cvt_pk_bf16_f32 v105, v30, v31
    v_cvt_pk_bf16_f32 v106, v32, v33
    v_cvt_pk_bf16_f32 v107, v34, v35
    s_nop 0
    v_permlane16_swap_b32 v104, v106
    v_permlane16_swap_b32 v105, v107
    buffer_store_dwordx4 v[104:107], v16, s[16:19], s50 offen
k234_mid_kernel_f_done:
k234_mid_kernel_end:
    s_endpgm
    s_nop 7
k234_mid_kernel_oslow:
    v_max3_u32 v198, v80, v81, v82
    v_max_u32 v198, v83, v198
    v_cmp_eq_u32 s[44:45], -1, v198
    v_max3_u32 v198, v84, v85, v86
    v_max_u32 v198, v87, v198
    v_cmp_eq_u32 s[46:47], -1, v198
    s_nop 4
    s_mov_b32 s62, 0
    s_and_b32 s30, s44, 65535
    s_cselect_b32 s30, 0, 1
    s_or_b32 s62, s62, s30
    s_and_b32 s30, s44, 4294901760
    s_cselect_b32 s30, 0, 2
    s_or_b32 s62, s62, s30
    s_and_b32 s30, s45, 65535
    s_cselect_b32 s30, 0, 4
    s_or_b32 s62, s62, s30
    s_and_b32 s30, s45, 4294901760
    s_cselect_b32 s30, 0, 8
    s_or_b32 s62, s62, s30
    s_and_b32 s30, s46, 65535
    s_cselect_b32 s30, 0, 16
    s_or_b32 s62, s62, s30
    s_and_b32 s30, s46, 4294901760
    s_cselect_b32 s30, 0, 32
    s_or_b32 s62, s62, s30
    s_and_b32 s30, s47, 65535
    s_cselect_b32 s30, 0, 64
    s_or_b32 s62, s62, s30
    s_and_b32 s30, s47, 4294901760
    s_cselect_b32 s30, 0, 128
    s_or_b32 s62, s62, s30
    s_and_b32 s31, s62, s63
    s_bitcmp0_b32 s31, 0
    s_cbranch_scc1 k234_mid_kernel_ot0
    v_max3_u32 v198, v16, v17, v18
    v_max3_u32 v198, v19, v20, v198
    v_max3_u32 v198, v21, v22, v198
    v_max_u32 v198, v23, v198
    v_cmp_eq_u32 vcc, -1, v198
    s_nop 4
    s_cbranch_vccnz k234_mid_kernel_ot0
    s_bitset1_b32 s53, 0
k234_mid_kernel_ot0:
    s_bitcmp0_b32 s31, 1
    s_cbranch_scc1 k234_mid_kernel_ot1
    v_max3_u32 v198, v24, v25, v26
    v_max3_u32 v198, v27, v28, v198
    v_max3_u32 v198, v29, v30, v198
    v_max_u32 v198, v31, v198
    v_cmp_eq_u32 vcc, -1, v198
    s_nop 4
    s_cbranch_vccnz k234_mid_kernel_ot1
    s_bitset1_b32 s53, 1
k234_mid_kernel_ot1:
    s_bitcmp0_b32 s31, 2
    s_cbranch_scc1 k234_mid_kernel_ot2
    v_max3_u32 v198, v32, v33, v34
    v_max3_u32 v198, v35, v36, v198
    v_max3_u32 v198, v37, v38, v198
    v_max_u32 v198, v39, v198
    v_cmp_eq_u32 vcc, -1, v198
    s_nop 4
    s_cbranch_vccnz k234_mid_kernel_ot2
    s_bitset1_b32 s53, 2
k234_mid_kernel_ot2:
    s_bitcmp0_b32 s31, 3
    s_cbranch_scc1 k234_mid_kernel_ot3
    v_max3_u32 v198, v40, v41, v42
    v_max3_u32 v198, v43, v44, v198
    v_max3_u32 v198, v45, v46, v198
    v_max_u32 v198, v47, v198
    v_cmp_eq_u32 vcc, -1, v198
    s_nop 4
    s_cbranch_vccnz k234_mid_kernel_ot3
    s_bitset1_b32 s53, 3
k234_mid_kernel_ot3:
    s_bitcmp0_b32 s31, 4
    s_cbranch_scc1 k234_mid_kernel_ot4
    v_max3_u32 v198, v48, v49, v50
    v_max3_u32 v198, v51, v52, v198
    v_max3_u32 v198, v53, v54, v198
    v_max_u32 v198, v55, v198
    v_cmp_eq_u32 vcc, -1, v198
    s_nop 4
    s_cbranch_vccnz k234_mid_kernel_ot4
    s_bitset1_b32 s53, 4
k234_mid_kernel_ot4:
    s_bitcmp0_b32 s31, 5
    s_cbranch_scc1 k234_mid_kernel_ot5
    v_max3_u32 v198, v56, v57, v58
    v_max3_u32 v198, v59, v60, v198
    v_max3_u32 v198, v61, v62, v198
    v_max_u32 v198, v63, v198
    v_cmp_eq_u32 vcc, -1, v198
    s_nop 4
    s_cbranch_vccnz k234_mid_kernel_ot5
    s_bitset1_b32 s53, 5
k234_mid_kernel_ot5:
    s_bitcmp0_b32 s31, 6
    s_cbranch_scc1 k234_mid_kernel_ot6
    v_max3_u32 v198, v64, v65, v66
    v_max3_u32 v198, v67, v68, v198
    v_max3_u32 v198, v69, v70, v198
    v_max_u32 v198, v71, v198
    v_cmp_eq_u32 vcc, -1, v198
    s_nop 4
    s_cbranch_vccnz k234_mid_kernel_ot6
    s_bitset1_b32 s53, 6
k234_mid_kernel_ot6:
    s_bitcmp0_b32 s31, 7
    s_cbranch_scc1 k234_mid_kernel_ot7
    v_max3_u32 v198, v72, v73, v74
    v_max3_u32 v198, v75, v76, v198
    v_max3_u32 v198, v77, v78, v198
    v_max_u32 v198, v79, v198
    v_cmp_eq_u32 vcc, -1, v198
    s_nop 4
    s_cbranch_vccnz k234_mid_kernel_ot7
    s_bitset1_b32 s53, 7
k234_mid_kernel_ot7:
    s_andn2_b32 s30, 0xff, s53
    s_and_b32 s63, s30, s62
    s_bcnt1_i32_b32 s31, s30
    s_cmp_le_u32 s31, 2
    s_cselect_b32 s63, s30, s63
    s_cmp_le_i32 s59, 0
    s_cbranch_scc1 k234_mid_kernel_ogo
    s_sleep 1
    s_branch k234_mid_kernel_ol
k234_mid_kernel_xend:
text_end:
    s_endpgm
.section .rodata,"a"
.p2align 6
.amdhsa_kernel k234_mid_kernel
  .amdhsa_next_free_vgpr 256
  .amdhsa_next_free_sgpr 64
  .amdhsa_accum_offset 256
  .amdhsa_group_segment_fixed_size 0
  .amdhsa_kernarg_size 80
  .amdhsa_user_sgpr_count 2
  .amdhsa_user_sgpr_kernarg_segment_ptr 1
  .amdhsa_system_sgpr_workgroup_id_x 1
.end_amdhsa_kernel
```
